```python
import torch

def _softmax(x, axis=-1):
    return torch.softmax(x, dim=axis)

def _gelu(x):
    return torch.nn.functional.gelu(x, approximate='tanh')

def _silu(x):
    return torch.nn.functional.silu(x)

def _sigmoid(x):
    return torch.sigmoid(x)

def _layernorm(x, axis=-1, eps=1e-05):
    m = x.mean(dim=axis, keepdim=True)
    v = x.var(dim=axis, keepdim=True, unbiased=False)
    return (x - m) / torch.sqrt(v + eps)

def _scatter_add(tgt, idx, src, axis=0):
    return tgt.clone().index_add_(axis, idx, src)

def _segment_sum(src, seg, n):
    out = torch.zeros((n,) + src.shape[1:], dtype=src.dtype)
    return out.index_add_(0, seg, src)

def _pad(x, pw):
    flat = tuple((v for pair in reversed(pw) for v in pair))
    return torch.nn.functional.pad(x, flat)
kernel_name = 'standalone__varlen_attn_packed__ragged'

def setup_inputs():

    _w = lambda a: (lambda t: t.to(torch.bfloat16) if t.is_floating_point() else t)(torch.as_tensor(a))
    cu = torch.tensor([0, 580, 1085, 2082, 2797, 3498, 4341, 5079, 6042], dtype=torch.int64)
    T, H, D = (int(cu[-1]), 16, 128)
    return {'q': _w((lambda *s: torch.randn(*s, dtype=torch.bfloat16) * 0.8)(T, H, D)), 'k': _w((lambda *s: torch.randn(*s, dtype=torch.bfloat16) * 0.8)(T, H, D)), 'v': _w((lambda *s: torch.randn(*s, dtype=torch.bfloat16) * 0.05)(T, H, D)), 'cu': _w(cu)}

def reference(q, k, v, cu):
    T, H, D = q.shape
    out = torch.zeros_like(q)
    scale = D ** (-0.5)
    outs = []
    for i in range(len(cu) - 1):
        s, e = (int(cu[i]), int(cu[i + 1]))
        qi, ki, vi = (q[s:e].clone(), k[s:e].clone(), v[s:e].clone())
        p = _softmax(torch.einsum('qhd,khd->hqk', qi, ki) * scale, axis=-1)
        outs.append(torch.einsum('hqk,khd->qhd', p, vi))
    return torch.concatenate(outs, axis=0)
```

```asm
; @launch grid=(256,1,1) block=(256,1,1) lds=152832
.amdgcn_target "amdgcn-amd-amdhsa--gfx950"
.text
.globl standalone__varlen_attn_packed__ragged_kernel
.p2align 8
.type standalone__varlen_attn_packed__ragged_kernel,@function
standalone__varlen_attn_packed__ragged_kernel:
    s_cmpk_ge_u32 s2, 256
    s_cbranch_scc1 L_end
    s_load_dwordx8 s[8:15], s[0:1], 0
    s_load_dwordx2 s[20:21], s[0:1], 32
    s_getpc_b64 s[74:75]
L_pc:
    s_lshr_b32 s4, s2, 4
    s_lshl3_add_u32 s5, s4, L_tab1-L_pc
    s_load_dwordx2 s[72:73], s[74:75], s5
    s_bfe_u32 s6, s2, 262147
    v_lshrrev_b32 v138, 2, v0
    v_lshl_add_u32 v138, v138, 4, s6
    v_lshlrev_b32 v138, 7, v138
    v_min_u32 v138, L_codeend-L_pc-4, v138
    global_load_dword v241, v138, s[74:75]
    v_lshrrev_b32 v129, 6, v0
    s_branch L_go
L_tab1:
    .long 0x187ca43d, 0x203f2244
    .long 0x19fca43d, 0x223f2244
    .long 0x2b7ca43d, 0x0
    .long 0x2dfca43d, 0x0
    .long 0x107873d7, 0x20596822
    .long 0x117873d7, 0x22596822
    .long 0x127873d7, 0x24596822
    .long 0x2b7873d7, 0x0
    .long 0x2df873d7, 0x0
    .long 0x20696daa, 0x105c50f5
    .long 0x22696daa, 0x115c50f5
    .long 0x1c696daa, 0x20488000
    .long 0x1de96daa, 0x22488000
    .long 0x1857aaed, 0x225c50f5
    .long 0x19d7aaed, 0x245c50f5
    .long 0x2b57aaed, 0x14488000
L_go:
    v_readfirstlane_b32 s64, v129
    v_bfe_u32 v130, v0, 4, 2
    v_and_b32 v131, 15, v0
    v_lshl_add_u32 v134, v129, 2, v130
    v_xor_b32 v135, v131, v130
    v_lshlrev_b32 v135, 4, v135
    v_lshl_add_u32 v234, v134, 12, v135
    v_add_u32 v235, 64512, v234
    s_and_b32 s65, s2, 7
    s_bfe_u32 s6, s2, 65539
    s_lshl1_add_u32 s65, s65, s6
    s_mul_i32 s28, s64, 4160
    s_mul_i32 s32, s64, 17408
    s_add_u32 s32, s32, 83200
    s_mov_b32 s19, 0x20000
    s_waitcnt lgkmcnt(0)
    s_and_b32 s4, s72, 0x1fff
    s_bfe_u32 s38, s72, 655373
    s_bfe_u32 s36, s72, 196635
    s_bfe_u32 s5, s72, 262167
    s_add_u32 s31, s4, s38
    s_lshl_b32 s31, s31, 12
    s_lshl4_add_u32 s4, s4, s65
    s_lshl_b32 s30, s4, 8
    s_mul_i32 s6, s36, s64
    s_lshl2_add_u32 s5, s5, s6
    s_lshl_b32 s5, s5, 2
    s_sub_u32 s5, s5, s64
    s_lshl_b32 s5, s5, 14
    s_add_u32 s34, s30, s5
    s_mov_b64 s[16:17], s[8:9]
    s_mov_b64 s[8:9], s[10:11]
    s_mov_b32 s10, s31
    s_mov_b32 s11, s19
    s_mov_b32 s18, s31
    s_add_u32 m0, s32, 0
    s_add_u32 s35, s34, 0
    buffer_load_dwordx4 v234, s[16:19], s35 offen offset:0 lds
    s_add_u32 s35, s34, 15296
    buffer_load_dwordx4 v234, s[16:19], s35 offen offset:1088 lds
    s_add_u32 s35, s34, 30592
    buffer_load_dwordx4 v234, s[16:19], s35 offen offset:2176 lds
    s_add_u32 s35, s34, 45888
    buffer_load_dwordx4 v234, s[16:19], s35 offen offset:3264 lds
    s_mov_b32 m0, s28
    s_mov_b32 s24, s30
    buffer_load_dwordx4 v234, s[8:11], s24 offen lds
    buffer_load_dwordx4 v235, s[8:11], s24 offen offset:1024 lds
    s_cmp_ge_u32 s36, 5
    s_cbranch_scc1 L_noq1
    s_add_u32 m0, s32, 4352
    s_add_u32 s35, s34, 65536
    buffer_load_dwordx4 v234, s[16:19], s35 offen offset:0 lds
    s_add_u32 s35, s34, 80832
    buffer_load_dwordx4 v234, s[16:19], s35 offen offset:1088 lds
    s_add_u32 s35, s34, 96128
    buffer_load_dwordx4 v234, s[16:19], s35 offen offset:2176 lds
    s_add_u32 s35, s34, 111424
    buffer_load_dwordx4 v234, s[16:19], s35 offen offset:3264 lds
L_noq1:
    s_add_u32 s37, s38, 31
    s_lshr_b32 s37, s37, 5
    s_sub_u32 s38, s38, 1
    s_and_b32 s38, s38, 31
    s_add_u32 s38, s38, 1
    s_add_u32 s29, s28, 83200
    s_sub_u32 s12, s12, 4096
    s_subb_u32 s13, s13, 0
    s_mov_b32 s15, 0x20000
    s_mov_b32 s23, 0x20000
    s_sub_u32 s3, s37, 1
    s_add_u32 s14, s10, 4096
    s_mov_b32 s25, s24
    s_add_u32 s24, s24, 131072
    s_sub_u32 s3, s3, 1
    s_mov_b32 s27, s28
    v_and_b32 v132, 3, v0
    v_lshrrev_b32 v133, 2, v131
    v_lshlrev_b32 v134, 3, v130
    v_lshl_add_u32 v134, v129, 1, v134
    v_lshlrev_b32 v135, 4, v131
    v_lshl_add_u32 v135, v134, 12, v135
    v_add_u32 v236, 2048, v135
    v_add_u32 v237, 5088, v135
    v_lshlrev_b32 v240, 2, v130
    v_and_b32 v135, 1, v130
    v_lshrrev_b32 v136, 1, v130
    v_lshlrev_b32 v134, 4, v131
    v_lshl_add_u32 v239, v130, 12, v134
    s_mov_b32 s4, s32
    v_lshl_add_u32 v137, v130, 8, v134
    v_lshl_add_u32 v137, v136, 4, v137
    v_lshl_add_u32 v137, v135, 3, v137
    v_add_u32 v243, s4, v137
    v_xor_b32 v245, 8, v243
    v_lshrrev_b32 v137, 1, v131
    v_add_u32 v137, v137, v136
    v_lshlrev_b32 v137, 4, v137
    v_lshl_add_u32 v137, v131, 8, v137
    v_xor_b32 v134, v130, v131
    v_and_b32 v134, 1, v134
    v_lshl_add_u32 v137, v134, 3, v137
    v_add_u32 v242, s4, v137
    v_mul_u32_u24 v134, 4160, v133
    v_lshl_add_u32 v134, v132, 8, v134
    v_xor_b32 v137, v130, v132
    v_lshl_add_u32 v230, v137, 4, v134
    v_subrev_u32 v232, s28, v230
    v_lshlrev_b32 v134, 8, v132
    v_lshl_add_u32 v134, v137, 4, v134
    v_lshl_add_u32 v247, v133, 10, v134
    v_lshl_add_u32 v134, v133, 6, v247
    v_add_u32 v238, s32, v134
    v_add_u32 v247, s28, v247
    v_lshl_add_u32 v137, v135, 2, v133
    v_lshrrev_b32 v134, 1, v137
    v_mul_u32_u24 v134, 4160, v134
    v_and_b32 v137, 1, v137
    v_mul_u32_u24 v137, 1056, v137
    v_add_u32 v134, v134, v137
    v_lshl_add_u32 v134, v136, 8, v134
    v_lshl_add_u32 v134, v132, 3, v134
    v_add_u32 v134, 2048, v134
    v_subrev_u32 v233, s28, v134
    v_cmp_eq_u32 vcc, 0, v132
    v_mov_b32 v134, 0x3f803f80
    s_nop 0
    v_cndmask_b32 v134, 0, v134, vcc
    v_accvgpr_write_b32 a224, v134
    v_accvgpr_write_b32 a225, v134
    v_accvgpr_write_b32 a226, v134
    v_accvgpr_write_b32 a227, v134
    v_and_b32 v134, 1, v0
    v_lshlrev_b32 v134, 4, v134
    v_lshrrev_b32 v137, 1, v132
    v_lshl_add_u32 v137, v133, 1, v137
    v_lshlrev_b32 v138, 1, v130
    v_cmp_eq_u32 s[68:69], v137, v138
    v_add_u32 v138, 1, v138
    v_cmp_eq_u32 vcc, v137, v138
    v_mov_b32 v139, 0
    v_mov_b32 v140, 0x3e03
    v_lshlrev_b32 v140, v134, v140
    v_cndmask_b32 v141, 0, v140, s[68:69]
    v_cndmask_b32 v140, 0, v140, vcc
    v_accvgpr_write_b32 a82, v141
    v_accvgpr_write_b32 a83, v140
    v_mov_b32 v140, 0xb9d8
    v_lshlrev_b32 v140, v134, v140
    v_cndmask_b32 v141, 0, v140, s[68:69]
    v_cndmask_b32 v140, 0, v140, vcc
    v_accvgpr_write_b32 a86, v141
    v_accvgpr_write_b32 a87, v140
    v_accvgpr_write_b32 a80, v139
    v_accvgpr_write_b32 a81, v139
    v_accvgpr_write_b32 a84, v139
    v_accvgpr_write_b32 a85, v139
    v_accvgpr_write_b32 a88, v139
    v_accvgpr_write_b32 a89, v139
    s_mov_b32 s60, 0x3e0293ee
    s_mov_b32 s61, 0x3e0293ee
    s_mov_b32 s62, 0xffff0000
    s_mov_b32 s63, 0x49800000
    s_mov_b64 s[56:57], 0
    s_mov_b32 s58, 0
    s_mov_b32 s59, 0
    s_cmp_eq_u32 s36, 2
    s_cbranch_scc1 L_first2
    s_cmp_eq_u32 s36, 3
    s_cbranch_scc1 L_first3
    s_cmp_eq_u32 s36, 4
    s_cbranch_scc1 L_first4
    s_branch L_first5
L_first2:
    s_mov_b32 s39, s34
    s_sub_u32 s26, s37, 4
    s_mov_b32 s91, 0
    s_mov_b32 s4, s31
    s_lshl_b32 s5, s64, 14
    s_add_u32 s5, s5, s34
    s_cmp_le_u32 s38, 16
    s_cselect_b32 s71, 8, 0
    s_mov_b32 s22, s4
    s_mov_b32 s33, s5
    v_sub_u32 v244, s38, v240
    s_and_b32 s4, s73, 0x1fff
    s_bfe_u32 s38, s73, 655373
    s_bfe_u32 s36, s73, 196635
    s_bfe_u32 s5, s73, 262167
    s_add_u32 s31, s4, s38
    s_lshl_b32 s31, s31, 12
    s_lshl4_add_u32 s4, s4, s65
    s_lshl_b32 s30, s4, 8
    s_mul_i32 s6, s36, s64
    s_lshl2_add_u32 s5, s5, s6
    s_lshl_b32 s5, s5, 2
    s_sub_u32 s5, s5, s64
    s_lshl_b32 s5, s5, 14
    s_add_u32 s34, s30, s5
    s_add_u32 s37, s38, 31
    s_lshr_b32 s37, s37, 5
    s_sub_u32 s38, s38, 1
    s_and_b32 s38, s38, 31
    s_add_u32 s38, s38, 1
    s_cmp_eq_u32 s36, 0
    s_cselect_b32 s30, 0x40000000, s30
    s_cmp_lg_u32 s36, 0
    s_cselect_b32 s6, 0, 0
    s_sub_u32 s26, s26, s6
    s_add_u32 s71, s71, s36
    s_lshl_b32 s94, s36, 1
    s_sub_u32 s91, s26, s94
    s_sub_u32 s91, s91, 4
    s_sub_u32 s94, s94, 1
    s_cmp_lg_u32 s36, 0
    s_cselect_b32 s26, 4, s26
    s_cselect_b32 s91, s91, 0
    s_mov_b32 s92, s32
    s_mov_b32 s93, s34
    s_waitcnt vmcnt(6)
    ds_read_b128 v[0:3], v238 offset:0
    ds_read_b128 v[4:7], v238 offset:64
    s_add_u32 m0, s28, 16640
    ds_read_b128 v[8:11], v238 offset:128
    buffer_load_dwordx4 v236, s[12:15], s25 offen offset:2048 lds
    ds_read_b128 v[12:15], v238 offset:192
    v_cmp_gt_i32 s[40:41], v244, 0
    v_cmp_gt_i32 s[42:43], v244, 1
    v_cmp_gt_i32 s[44:45], v244, 2
    v_cmp_gt_i32 s[46:47], v244, 3
    v_cmp_gt_i32 s[48:49], v244, 16
    v_cmp_gt_i32 s[50:51], v244, 17
    v_cmp_gt_i32 s[52:53], v244, 18
    v_cmp_gt_i32 s[54:55], v244, 19
    s_waitcnt lgkmcnt(3)
    v_lshlrev_b32 v32, 16, v0
    v_and_b32 v33, s62, v0
    v_pk_mul_f32 v[32:33], v[32:33], s[60:61]
    v_cvt_pk_bf16_f32 v35, v32, v33
    v_lshlrev_b32 v36, 16, v1
    v_and_b32 v37, s62, v1
    v_accvgpr_write_b32 a0, v35
    v_pk_mul_f32 v[36:37], v[36:37], s[60:61]
    buffer_load_dwordx4 v237, s[12:15], s25 offen offset:3104 lds
    v_lshlrev_b32 v40, 16, v2
    v_and_b32 v41, s62, v2
    v_pk_mul_f32 v[40:41], v[40:41], s[60:61]
    s_add_u32 s14, s10, 4096
    v_cvt_pk_bf16_f32 v39, v36, v37
    v_cvt_pk_bf16_f32 v43, v40, v41
    v_accvgpr_write_b32 a1, v39
    v_accvgpr_write_b32 a2, v43
    v_lshlrev_b32 v44, 16, v3
    s_mov_b32 s25, s24
    v_and_b32 v45, s62, v3
    v_pk_mul_f32 v[44:45], v[44:45], s[60:61]
    s_waitcnt lgkmcnt(0)
    v_lshlrev_b32 v48, 16, v4
    v_and_b32 v49, s62, v4
    v_cvt_pk_bf16_f32 v47, v44, v45
    v_pk_mul_f32 v[48:49], v[48:49], s[60:61]
    buffer_load_dwordx4 v234, s[8:11], s24 offen lds
    v_accvgpr_write_b32 a3, v47
    v_cvt_pk_bf16_f32 v51, v48, v49
    buffer_load_dwordx4 v235, s[8:11], s24 offen offset:1024 lds
    v_lshlrev_b32 v52, 16, v5
    v_and_b32 v53, s62, v5
    v_lshlrev_b32 v56, 16, v6
    v_and_b32 v57, s62, v6
    v_lshlrev_b32 v60, 16, v7
    v_and_b32 v61, s62, v7
    s_add_u32 s24, s24, 131072
    v_pk_mul_f32 v[52:53], v[52:53], s[60:61]
    v_pk_mul_f32 v[56:57], v[56:57], s[60:61]
    v_pk_mul_f32 v[60:61], v[60:61], s[60:61]
    v_cvt_pk_bf16_f32 v55, v52, v53
    v_cvt_pk_bf16_f32 v59, v56, v57
    v_cvt_pk_bf16_f32 v63, v60, v61
    s_sub_u32 s3, s3, 1
    v_accvgpr_write_b32 a4, v51
    v_accvgpr_write_b32 a5, v55
    v_accvgpr_write_b32 a6, v59
    v_accvgpr_write_b32 a7, v63
    s_waitcnt vmcnt(8)
    s_barrier
    ds_read_b128 a[96:99], v230 offset:0
    ds_read_b128 a[100:103], v230 offset:64
    ds_read_b128 a[104:107], v230 offset:128
    ds_read_b128 a[108:111], v230 offset:192
    ds_read_b128 a[112:115], v230 offset:1024
    v_lshlrev_b32 v32, 16, v8
    v_and_b32 v33, s62, v8
    v_lshlrev_b32 v36, 16, v9
    v_and_b32 v37, s62, v9
    v_lshlrev_b32 v40, 16, v10
    v_and_b32 v41, s62, v10
    v_lshlrev_b32 v44, 16, v11
    v_and_b32 v45, s62, v11
    v_lshlrev_b32 v48, 16, v12
    v_and_b32 v49, s62, v12
    v_lshlrev_b32 v52, 16, v13
    v_and_b32 v53, s62, v13
    v_lshlrev_b32 v56, 16, v14
    v_and_b32 v57, s62, v14
    v_lshlrev_b32 v60, 16, v15
    v_and_b32 v61, s62, v15
    ds_read_b128 a[116:119], v230 offset:1088
    v_pk_mul_f32 v[32:33], v[32:33], s[60:61]
    v_pk_mul_f32 v[36:37], v[36:37], s[60:61]
    v_pk_mul_f32 v[40:41], v[40:41], s[60:61]
    v_pk_mul_f32 v[44:45], v[44:45], s[60:61]
    v_pk_mul_f32 v[48:49], v[48:49], s[60:61]
    v_pk_mul_f32 v[52:53], v[52:53], s[60:61]
    v_pk_mul_f32 v[56:57], v[56:57], s[60:61]
    v_pk_mul_f32 v[60:61], v[60:61], s[60:61]
    ds_read_b128 a[120:123], v230 offset:1152
    v_cvt_pk_bf16_f32 v35, v32, v33
    v_cvt_pk_bf16_f32 v39, v36, v37
    v_cvt_pk_bf16_f32 v43, v40, v41
    v_cvt_pk_bf16_f32 v47, v44, v45
    v_cvt_pk_bf16_f32 v51, v48, v49
    v_cvt_pk_bf16_f32 v55, v52, v53
    v_cvt_pk_bf16_f32 v59, v56, v57
    v_cvt_pk_bf16_f32 v63, v60, v61
    ds_read_b128 a[124:127], v230 offset:1216
    v_accvgpr_write_b32 a8, v35
    v_accvgpr_write_b32 a9, v39
    v_accvgpr_write_b32 a10, v43
    v_accvgpr_write_b32 a11, v47
    v_accvgpr_write_b32 a12, v51
    v_accvgpr_write_b32 a13, v55
    v_accvgpr_write_b32 a14, v59
    v_accvgpr_write_b32 a15, v63
    s_add_u32 m0, s28, 33280
    s_nop 0
    buffer_load_dwordx4 v236, s[12:15], s25 offen offset:2048 lds
    buffer_load_dwordx4 v237, s[12:15], s25 offen offset:3104 lds
    s_add_u32 s14, s10, 4096
    s_mov_b32 s25, s24
    buffer_load_dwordx4 v234, s[8:11], s24 offen lds
    buffer_load_dwordx4 v235, s[8:11], s24 offen offset:1024 lds
    s_add_u32 s24, s24, 131072
    s_sub_u32 s3, s3, 1
    s_waitcnt lgkmcnt(2)
    v_mfma_f32_16x16x32_bf16 v[128:131], a[96:99], a[0:3], 0
    v_mfma_f32_16x16x32_bf16 v[128:131], a[100:103], a[4:7], v[128:131]
    v_mfma_f32_16x16x32_bf16 v[128:131], a[104:107], a[8:11], v[128:131]
    v_mfma_f32_16x16x32_bf16 v[128:131], a[108:111], a[12:15], v[128:131]
    v_mfma_f32_16x16x32_bf16 v[132:135], a[112:115], a[0:3], 0
    v_mfma_f32_16x16x32_bf16 v[132:135], a[116:119], a[4:7], v[132:135]
    s_waitcnt lgkmcnt(0)
    v_mfma_f32_16x16x32_bf16 v[132:135], a[120:123], a[8:11], v[132:135]
    v_mfma_f32_16x16x32_bf16 v[132:135], a[124:127], a[12:15], v[132:135]
    s_nop 2
    v_max3_f32 v176, v128, v129, v130
    s_nop 3
    v_max3_f32 v177, v132, v133, v134
    v_max3_f32 v176, v176, v131, v135
    v_max_f32 v176, v176, v177
    v_mov_b32 v177, v176
    s_nop 1
    v_permlane32_swap_b32 v177, v176
    v_max_f32 v176, v176, v177
    v_mov_b32 v177, v176
    s_nop 1
    v_permlane16_swap_b32 v177, v176
    v_max_f32 v176, v176, v177
    v_sub_f32 v200, 0, v176
    v_sub_f32 v201, 0, v176
    v_sub_f32 v202, 0, v176
    v_sub_f32 v203, 0, v176
    v_sub_f32 v128, v128, v176
    v_sub_f32 v129, v129, v176
    v_sub_f32 v130, v130, v176
    v_sub_f32 v131, v131, v176
    v_sub_f32 v132, v132, v176
    v_sub_f32 v133, v133, v176
    v_sub_f32 v134, v134, v176
    v_sub_f32 v135, v135, v176
    v_exp_f32 v128, v128
    v_exp_f32 v129, v129
    v_exp_f32 v130, v130
    v_cvt_pk_bf16_f32 v176, v128, v129
    v_exp_f32 v131, v131
    v_exp_f32 v132, v132
    v_cvt_pk_bf16_f32 v177, v130, v131
    v_exp_f32 v133, v133
    v_exp_f32 v134, v134
    v_cvt_pk_bf16_f32 v178, v132, v133
    v_exp_f32 v135, v135
    s_nop 0
    v_cvt_pk_bf16_f32 v179, v134, v135
    s_waitcnt vmcnt(8)
    ds_read_b128 v[16:19], v238 offset:4352
    ds_read_b128 v[20:23], v238 offset:4416
    s_add_u32 m0, s28, 49920
    ds_read_b128 v[24:27], v238 offset:4480
    buffer_load_dwordx4 v236, s[12:15], s25 offen offset:2048 lds
    ds_read_b128 v[28:31], v238 offset:4544
    s_waitcnt lgkmcnt(3)
    v_lshlrev_b32 v32, 16, v16
    v_and_b32 v33, s62, v16
    v_pk_mul_f32 v[32:33], v[32:33], s[60:61]
    v_cvt_pk_bf16_f32 v35, v32, v33
    v_lshlrev_b32 v36, 16, v17
    v_and_b32 v37, s62, v17
    v_accvgpr_write_b32 a16, v35
    v_pk_mul_f32 v[36:37], v[36:37], s[60:61]
    buffer_load_dwordx4 v237, s[12:15], s25 offen offset:3104 lds
    v_lshlrev_b32 v40, 16, v18
    v_and_b32 v41, s62, v18
    v_pk_mul_f32 v[40:41], v[40:41], s[60:61]
    s_add_u32 s14, s10, 4096
    v_cvt_pk_bf16_f32 v39, v36, v37
    v_cvt_pk_bf16_f32 v43, v40, v41
    v_accvgpr_write_b32 a17, v39
    v_accvgpr_write_b32 a18, v43
    v_lshlrev_b32 v44, 16, v19
    s_mov_b32 s25, s24
    v_and_b32 v45, s62, v19
    v_pk_mul_f32 v[44:45], v[44:45], s[60:61]
    s_waitcnt lgkmcnt(2)
    v_lshlrev_b32 v48, 16, v20
    v_and_b32 v49, s62, v20
    v_cvt_pk_bf16_f32 v47, v44, v45
    v_pk_mul_f32 v[48:49], v[48:49], s[60:61]
    buffer_load_dwordx4 v234, s[8:11], s24 offen lds
    v_accvgpr_write_b32 a19, v47
    v_cvt_pk_bf16_f32 v51, v48, v49
    buffer_load_dwordx4 v235, s[8:11], s24 offen offset:1024 lds
    s_add_u32 s24, s24, 131072
    s_sub_u32 s3, s3, 1
    v_lshlrev_b32 v52, 16, v21
    v_and_b32 v53, s62, v21
    v_lshlrev_b32 v56, 16, v22
    v_and_b32 v57, s62, v22
    v_lshlrev_b32 v60, 16, v23
    v_and_b32 v61, s62, v23
    v_pk_mul_f32 v[52:53], v[52:53], s[60:61]
    v_pk_mul_f32 v[56:57], v[56:57], s[60:61]
    v_pk_mul_f32 v[60:61], v[60:61], s[60:61]
    v_cvt_pk_bf16_f32 v55, v52, v53
    v_cvt_pk_bf16_f32 v59, v56, v57
    v_cvt_pk_bf16_f32 v63, v60, v61
    s_waitcnt lgkmcnt(0)
    v_lshlrev_b32 v32, 16, v24
    v_and_b32 v33, s62, v24
    v_lshlrev_b32 v36, 16, v25
    v_and_b32 v37, s62, v25
    v_lshlrev_b32 v40, 16, v26
    v_and_b32 v41, s62, v26
    v_lshlrev_b32 v44, 16, v27
    v_and_b32 v45, s62, v27
    v_lshlrev_b32 v48, 16, v28
    v_and_b32 v49, s62, v28
    v_lshlrev_b32 v52, 16, v29
    v_and_b32 v53, s62, v29
    v_lshlrev_b32 v56, 16, v30
    v_and_b32 v57, s62, v30
    v_lshlrev_b32 v60, 16, v31
    v_and_b32 v61, s62, v31
    v_pk_mul_f32 v[32:33], v[32:33], s[60:61]
    v_pk_mul_f32 v[36:37], v[36:37], s[60:61]
    v_pk_mul_f32 v[40:41], v[40:41], s[60:61]
    v_pk_mul_f32 v[44:45], v[44:45], s[60:61]
    v_accvgpr_write_b32 a20, v51
    v_pk_mul_f32 v[48:49], v[48:49], s[60:61]
    v_accvgpr_write_b32 a21, v55
    v_pk_mul_f32 v[52:53], v[52:53], s[60:61]
    v_accvgpr_write_b32 a22, v59
    v_pk_mul_f32 v[56:57], v[56:57], s[60:61]
    v_accvgpr_write_b32 a23, v63
    v_pk_mul_f32 v[60:61], v[60:61], s[60:61]
    v_cvt_pk_bf16_f32 v35, v32, v33
    v_cvt_pk_bf16_f32 v39, v36, v37
    v_cvt_pk_bf16_f32 v43, v40, v41
    v_cvt_pk_bf16_f32 v47, v44, v45
    v_cvt_pk_bf16_f32 v51, v48, v49
    v_cvt_pk_bf16_f32 v55, v52, v53
    v_cvt_pk_bf16_f32 v59, v56, v57
    v_cvt_pk_bf16_f32 v63, v60, v61
    v_accvgpr_write_b32 a24, v35
    v_accvgpr_write_b32 a25, v39
    v_accvgpr_write_b32 a26, v43
    v_accvgpr_write_b32 a27, v47
    v_accvgpr_write_b32 a28, v51
    v_accvgpr_write_b32 a29, v55
    v_accvgpr_write_b32 a30, v59
    v_accvgpr_write_b32 a31, v63
    v_mfma_f32_16x16x32_bf16 v[136:139], a[96:99], a[16:19], 0
    v_add_u32 v241, 16384, v239
    v_add_u32 v246, 32768, v239
    v_mfma_f32_16x16x32_bf16 v[136:139], a[100:103], a[20:23], v[136:139]
    v_add_u32 v247, 49152, v239
    v_mfma_f32_16x16x32_bf16 v[136:139], a[104:107], a[24:27], v[136:139]
    s_mov_b32 s70, s27
    v_mfma_f32_16x16x32_bf16 v[136:139], a[108:111], a[28:31], v[136:139]
    s_add_u32 s27, s27, 16640
    v_mfma_f32_16x16x32_bf16 v[140:143], a[112:115], a[16:19], 0
    s_cmp_eq_u32 s27, s29
    v_mfma_f32_16x16x32_bf16 v[140:143], a[116:119], a[20:23], v[140:143]
    s_cselect_b32 s27, s28, s27
    v_mfma_f32_16x16x32_bf16 v[140:143], a[120:123], a[24:27], v[140:143]
    s_waitcnt vmcnt(8)
    v_mfma_f32_16x16x32_bf16 v[140:143], a[124:127], a[28:31], v[140:143]
    s_barrier
    v_add_u32 v231, s27, v233
    ds_read_b64_tr_b16 a[128:129], v231 offset:0
    ds_read_b64_tr_b16 a[130:131], v231 offset:512
    ds_read_b64_tr_b16 a[132:133], v231 offset:32
    ds_read_b64_tr_b16 a[134:135], v231 offset:544
    ds_read_b64_tr_b16 a[136:137], v231 offset:64
    ds_read_b64_tr_b16 a[138:139], v231 offset:576
    ds_read_b64_tr_b16 a[140:141], v231 offset:96
    ds_read_b64_tr_b16 a[142:143], v231 offset:608
    ds_read_b64_tr_b16 a[144:145], v231 offset:128
    ds_read_b64_tr_b16 a[146:147], v231 offset:640
    ds_read_b64_tr_b16 a[148:149], v231 offset:160
    ds_read_b64_tr_b16 a[150:151], v231 offset:672
    ds_read_b64_tr_b16 a[152:153], v231 offset:192
    ds_read_b64_tr_b16 a[154:155], v231 offset:704
    ds_read_b64_tr_b16 a[156:157], v231 offset:224
    v_add_u32 v230, s27, v232
    ds_read_b64_tr_b16 a[158:159], v231 offset:736
    ds_read_b128 a[96:99], v230 offset:0
    ds_read_b128 a[100:103], v230 offset:64
    ds_read_b128 a[104:107], v230 offset:128
    ds_read_b128 a[108:111], v230 offset:192
    ds_read_b128 a[112:115], v230 offset:1024
    ds_read_b128 a[116:119], v230 offset:1088
    ds_read_b128 a[120:123], v230 offset:1152
    ds_read_b128 a[124:127], v230 offset:1216
    s_waitcnt lgkmcnt(15)
    v_mfma_f32_16x16x32_bf16 v[0:3], a[128:131], v[176:179], 0
    s_add_u32 m0, s28, 66560
    v_max3_f32 v180, v136, v137, v138
    v_max3_f32 v181, v140, v141, v142
    v_max3_f32 v180, v180, v139, v143
    v_mfma_f32_16x16x32_bf16 a[228:231], a[224:227], v[176:179], 0
    buffer_load_dwordx4 v236, s[12:15], s25 offen offset:2048 lds
    v_mfma_f32_16x16x32_bf16 v[4:7], a[132:135], v[176:179], 0
    buffer_load_dwordx4 v237, s[12:15], s25 offen offset:3104 lds
    v_mfma_f32_16x16x32_bf16 v[8:11], a[136:139], v[176:179], 0
    s_add_u32 s14, s10, 4096
    v_max_f32 v180, v180, v181
    v_mov_b32 v181, v180
    s_mov_b32 s25, s24
    v_mfma_f32_16x16x32_bf16 v[12:15], a[140:143], v[176:179], 0
    s_waitcnt lgkmcnt(13)
    buffer_load_dwordx4 v234, s[8:11], s24 offen lds
    v_mfma_f32_16x16x32_bf16 v[16:19], a[144:147], v[176:179], 0
    s_waitcnt lgkmcnt(0)
    buffer_load_dwordx4 v235, s[8:11], s24 offen offset:1024 lds
    v_mfma_f32_16x16x32_bf16 v[20:23], a[148:151], v[176:179], 0
    s_add_u32 s24, s24, 131072
    v_permlane32_swap_b32 v181, v180
    v_max_f32 v180, v180, v181
    v_mov_b32 v181, v180
    v_mfma_f32_16x16x32_bf16 v[24:27], a[152:155], v[176:179], 0
    s_sub_u32 s3, s3, 1
    v_permlane16_swap_b32 v181, v180
    v_max_f32 v180, v180, v181
    v_sub_f32 v204, 0, v180
    v_mfma_f32_16x16x32_bf16 v[28:31], a[156:159], v[176:179], 0
    s_mov_b32 s18, s31
    v_sub_f32 v205, 0, v180
    v_sub_f32 v206, 0, v180
    v_sub_f32 v207, 0, v180
    v_mfma_f32_16x16x32_bf16 v[128:131], a[96:99], a[0:3], v[200:203]
    s_mov_b32 m0, s70
    v_sub_f32 v136, v136, v180
    v_sub_f32 v137, v137, v180
    v_sub_f32 v138, v138, v180
    v_mfma_f32_16x16x32_bf16 v[128:131], a[100:103], a[4:7], v[128:131]
    buffer_load_dwordx4 v236, s[12:15], s25 offen offset:2048 lds
    v_mfma_f32_16x16x32_bf16 v[128:131], a[104:107], a[8:11], v[128:131]
    s_mov_b32 m0, s70
    v_sub_f32 v139, v139, v180
    v_sub_f32 v140, v140, v180
    v_sub_f32 v141, v141, v180
    v_mfma_f32_16x16x32_bf16 v[128:131], a[108:111], a[12:15], v[128:131]
    buffer_load_dwordx4 v237, s[12:15], s25 offen offset:3104 lds
    v_mfma_f32_16x16x32_bf16 v[132:135], a[112:115], a[0:3], v[200:203]
    s_add_u32 s14, s10, 4096
    v_sub_f32 v142, v142, v180
    v_sub_f32 v143, v143, v180
    s_mov_b32 s25, s24
    v_mfma_f32_16x16x32_bf16 v[132:135], a[116:119], a[4:7], v[132:135]
    s_mov_b32 m0, s70
    v_exp_f32 v136, v136
    v_mfma_f32_16x16x32_bf16 v[132:135], a[120:123], a[8:11], v[132:135]
    buffer_load_dwordx4 v234, s[8:11], s24 offen lds
    v_mfma_f32_16x16x32_bf16 v[132:135], a[124:127], a[12:15], v[132:135]
    s_mov_b32 m0, s70
    v_exp_f32 v137, v137
    v_exp_f32 v138, v138
    v_cvt_pk_bf16_f32 v180, v136, v137
    v_exp_f32 v139, v139
    v_exp_f32 v140, v140
    v_cvt_pk_bf16_f32 v181, v138, v139
    v_exp_f32 v141, v141
    v_exp_f32 v142, v142
    v_cvt_pk_bf16_f32 v182, v140, v141
    v_exp_f32 v143, v143
    v_exp_f32 v128, v128
    v_cvt_pk_bf16_f32 v183, v142, v143
    s_nop 1
    v_mfma_f32_16x16x32_bf16 v[32:35], a[128:131], v[180:183], 0
    buffer_load_dwordx4 v235, s[8:11], s24 offen offset:1024 lds
    v_mfma_f32_16x16x32_bf16 a[232:235], a[224:227], v[180:183], 0
    s_add_u32 s24, s24, 131072
    s_sub_u32 s3, s3, 1
    s_mov_b32 s70, s27
    s_add_u32 s27, s27, 16640
    v_mfma_f32_16x16x32_bf16 v[36:39], a[132:135], v[180:183], 0
    s_cmp_eq_u32 s27, s29
    s_cselect_b32 s27, s28, s27
    s_waitcnt vmcnt(12)
    v_mfma_f32_16x16x32_bf16 v[40:43], a[136:139], v[180:183], 0
    s_barrier
    v_mfma_f32_16x16x32_bf16 v[44:47], a[140:143], v[180:183], 0
    s_mov_b32 m0, s70
    v_add_u32 v231, s27, v233
    v_add_u32 v230, s27, v232
    v_mfma_f32_16x16x32_bf16 v[48:51], a[144:147], v[180:183], 0
    buffer_load_dwordx4 v236, s[12:15], s25 offen offset:2048 lds
    v_mfma_f32_16x16x32_bf16 v[52:55], a[148:151], v[180:183], 0
    s_mov_b32 m0, s70
    ds_read_b64_tr_b16 a[128:129], v231 offset:0
    ds_read_b64_tr_b16 a[130:131], v231 offset:512
    ds_read_b64_tr_b16 a[132:133], v231 offset:32
    v_mfma_f32_16x16x32_bf16 v[56:59], a[152:155], v[180:183], 0
    buffer_load_dwordx4 v237, s[12:15], s25 offen offset:3104 lds
    v_mfma_f32_16x16x32_bf16 v[60:63], a[156:159], v[180:183], 0
    s_add_u32 s14, s10, 4096
    ds_read_b64_tr_b16 a[134:135], v231 offset:544
    ds_read_b64_tr_b16 a[136:137], v231 offset:64
    ds_read_b64_tr_b16 a[138:139], v231 offset:576
    ds_read_b64_tr_b16 a[140:141], v231 offset:96
    ds_read_b64_tr_b16 a[142:143], v231 offset:608
    ds_read_b64_tr_b16 a[144:145], v231 offset:128
    ds_read_b64_tr_b16 a[146:147], v231 offset:640
    ds_read_b64_tr_b16 a[148:149], v231 offset:160
    s_mov_b32 s25, s24
    s_mov_b32 m0, s70
    v_exp_f32 v129, v129
    v_exp_f32 v130, v130
    v_cvt_pk_bf16_f32 v176, v128, v129
    s_branch L_loop2
L_first3:
    s_mov_b32 s39, s34
    s_sub_u32 s26, s37, 4
    s_mov_b32 s91, 0
    s_mov_b32 s4, s31
    s_lshl_b32 s5, s64, 14
    s_add_u32 s5, s5, s34
    s_cmp_le_u32 s38, 16
    s_cselect_b32 s71, 8, 0
    s_mov_b32 s22, s4
    s_mov_b32 s33, s5
    v_sub_u32 v244, s38, v240
    s_and_b32 s4, s73, 0x1fff
    s_bfe_u32 s38, s73, 655373
    s_bfe_u32 s36, s73, 196635
    s_bfe_u32 s5, s73, 262167
    s_add_u32 s31, s4, s38
    s_lshl_b32 s31, s31, 12
    s_lshl4_add_u32 s4, s4, s65
    s_lshl_b32 s30, s4, 8
    s_mul_i32 s6, s36, s64
    s_lshl2_add_u32 s5, s5, s6
    s_lshl_b32 s5, s5, 2
    s_sub_u32 s5, s5, s64
    s_lshl_b32 s5, s5, 14
    s_add_u32 s34, s30, s5
    s_add_u32 s37, s38, 31
    s_lshr_b32 s37, s37, 5
    s_sub_u32 s38, s38, 1
    s_and_b32 s38, s38, 31
    s_add_u32 s38, s38, 1
    s_cmp_eq_u32 s36, 0
    s_cselect_b32 s30, 0x40000000, s30
    s_cmp_lg_u32 s36, 0
    s_cselect_b32 s6, 0, 0
    s_sub_u32 s26, s26, s6
    s_add_u32 s71, s71, s36
    s_lshl_b32 s94, s36, 1
    s_sub_u32 s91, s26, s94
    s_sub_u32 s91, s91, 4
    s_sub_u32 s94, s94, 1
    s_cmp_lg_u32 s36, 0
    s_cselect_b32 s26, 4, s26
    s_cselect_b32 s91, s91, 0
    s_mov_b32 s92, s32
    s_mov_b32 s93, s34
    s_waitcnt vmcnt(6)
    ds_read_b128 v[0:3], v238 offset:0
    s_add_u32 m0, s32, 8704
    ds_read_b128 v[4:7], v238 offset:64
    s_add_u32 s35, s39, 131072
    buffer_load_dwordx4 v234, s[16:19], s35 offen offset:0 lds
    s_add_u32 s35, s39, 146368
    ds_read_b128 v[8:11], v238 offset:128
    ds_read_b128 v[12:15], v238 offset:192
    v_cmp_gt_i32 s[40:41], v244, 0
    v_cmp_gt_i32 s[42:43], v244, 1
    v_cmp_gt_i32 s[44:45], v244, 2
    v_cmp_gt_i32 s[46:47], v244, 3
    v_cmp_gt_i32 s[48:49], v244, 16
    v_cmp_gt_i32 s[50:51], v244, 17
    v_cmp_gt_i32 s[52:53], v244, 18
    v_cmp_gt_i32 s[54:55], v244, 19
    s_waitcnt lgkmcnt(3)
    v_lshlrev_b32 v32, 16, v0
    v_and_b32 v33, s62, v0
    v_pk_mul_f32 v[32:33], v[32:33], s[60:61]
    v_cvt_pk_bf16_f32 v35, v32, v33
    v_lshlrev_b32 v36, 16, v1
    v_and_b32 v37, s62, v1
    v_accvgpr_write_b32 a0, v35
    v_pk_mul_f32 v[36:37], v[36:37], s[60:61]
    v_lshlrev_b32 v40, 16, v2
    v_and_b32 v41, s62, v2
    buffer_load_dwordx4 v234, s[16:19], s35 offen offset:1088 lds
    v_pk_mul_f32 v[40:41], v[40:41], s[60:61]
    v_cvt_pk_bf16_f32 v39, v36, v37
    v_cvt_pk_bf16_f32 v43, v40, v41
    v_accvgpr_write_b32 a1, v39
    v_accvgpr_write_b32 a2, v43
    v_lshlrev_b32 v44, 16, v3
    s_add_u32 s35, s39, 161664
    v_and_b32 v45, s62, v3
    buffer_load_dwordx4 v234, s[16:19], s35 offen offset:2176 lds
    v_pk_mul_f32 v[44:45], v[44:45], s[60:61]
    s_waitcnt lgkmcnt(0)
    v_lshlrev_b32 v48, 16, v4
    v_and_b32 v49, s62, v4
    v_cvt_pk_bf16_f32 v47, v44, v45
    v_pk_mul_f32 v[48:49], v[48:49], s[60:61]
    v_accvgpr_write_b32 a3, v47
    v_cvt_pk_bf16_f32 v51, v48, v49
    s_add_u32 s35, s39, 176960
    v_lshlrev_b32 v52, 16, v5
    v_and_b32 v53, s62, v5
    v_lshlrev_b32 v56, 16, v6
    v_and_b32 v57, s62, v6
    v_lshlrev_b32 v60, 16, v7
    v_and_b32 v61, s62, v7
    v_pk_mul_f32 v[52:53], v[52:53], s[60:61]
    v_pk_mul_f32 v[56:57], v[56:57], s[60:61]
    v_pk_mul_f32 v[60:61], v[60:61], s[60:61]
    v_cvt_pk_bf16_f32 v55, v52, v53
    v_cvt_pk_bf16_f32 v59, v56, v57
    v_cvt_pk_bf16_f32 v63, v60, v61
    buffer_load_dwordx4 v234, s[16:19], s35 offen offset:3264 lds
    v_accvgpr_write_b32 a4, v51
    v_accvgpr_write_b32 a5, v55
    v_accvgpr_write_b32 a6, v59
    v_accvgpr_write_b32 a7, v63
    s_waitcnt vmcnt(8)
    s_barrier
    ds_read_b128 a[96:99], v230 offset:0
    ds_read_b128 a[100:103], v230 offset:64
    ds_read_b128 a[104:107], v230 offset:128
    ds_read_b128 a[108:111], v230 offset:192
    ds_read_b128 a[112:115], v230 offset:1024
    v_lshlrev_b32 v32, 16, v8
    v_and_b32 v33, s62, v8
    v_lshlrev_b32 v36, 16, v9
    v_and_b32 v37, s62, v9
    v_lshlrev_b32 v40, 16, v10
    v_and_b32 v41, s62, v10
    v_lshlrev_b32 v44, 16, v11
    v_and_b32 v45, s62, v11
    v_lshlrev_b32 v48, 16, v12
    v_and_b32 v49, s62, v12
    v_lshlrev_b32 v52, 16, v13
    v_and_b32 v53, s62, v13
    v_lshlrev_b32 v56, 16, v14
    v_and_b32 v57, s62, v14
    v_lshlrev_b32 v60, 16, v15
    v_and_b32 v61, s62, v15
    ds_read_b128 a[116:119], v230 offset:1088
    v_pk_mul_f32 v[32:33], v[32:33], s[60:61]
    v_pk_mul_f32 v[36:37], v[36:37], s[60:61]
    v_pk_mul_f32 v[40:41], v[40:41], s[60:61]
    v_pk_mul_f32 v[44:45], v[44:45], s[60:61]
    v_pk_mul_f32 v[48:49], v[48:49], s[60:61]
    v_pk_mul_f32 v[52:53], v[52:53], s[60:61]
    v_pk_mul_f32 v[56:57], v[56:57], s[60:61]
    v_pk_mul_f32 v[60:61], v[60:61], s[60:61]
    ds_read_b128 a[120:123], v230 offset:1152
    v_cvt_pk_bf16_f32 v35, v32, v33
    v_cvt_pk_bf16_f32 v39, v36, v37
    v_cvt_pk_bf16_f32 v43, v40, v41
    v_cvt_pk_bf16_f32 v47, v44, v45
    v_cvt_pk_bf16_f32 v51, v48, v49
    v_cvt_pk_bf16_f32 v55, v52, v53
    v_cvt_pk_bf16_f32 v59, v56, v57
    v_cvt_pk_bf16_f32 v63, v60, v61
    ds_read_b128 a[124:127], v230 offset:1216
    v_accvgpr_write_b32 a8, v35
    v_accvgpr_write_b32 a9, v39
    v_accvgpr_write_b32 a10, v43
    v_accvgpr_write_b32 a11, v47
    v_accvgpr_write_b32 a12, v51
    v_accvgpr_write_b32 a13, v55
    v_accvgpr_write_b32 a14, v59
    v_accvgpr_write_b32 a15, v63
    s_add_u32 m0, s28, 16640
    s_nop 0
    buffer_load_dwordx4 v236, s[12:15], s25 offen offset:2048 lds
    buffer_load_dwordx4 v237, s[12:15], s25 offen offset:3104 lds
    s_add_u32 s14, s10, 4096
    s_mov_b32 s25, s24
    buffer_load_dwordx4 v234, s[8:11], s24 offen lds
    buffer_load_dwordx4 v235, s[8:11], s24 offen offset:1024 lds
    s_add_u32 s24, s24, 131072
    s_sub_u32 s3, s3, 1
    s_waitcnt lgkmcnt(2)
    v_mfma_f32_16x16x32_bf16 v[128:131], a[96:99], a[0:3], 0
    v_mfma_f32_16x16x32_bf16 v[128:131], a[100:103], a[4:7], v[128:131]
    v_mfma_f32_16x16x32_bf16 v[128:131], a[104:107], a[8:11], v[128:131]
    v_mfma_f32_16x16x32_bf16 v[128:131], a[108:111], a[12:15], v[128:131]
    v_mfma_f32_16x16x32_bf16 v[132:135], a[112:115], a[0:3], 0
    v_mfma_f32_16x16x32_bf16 v[132:135], a[116:119], a[4:7], v[132:135]
    s_waitcnt lgkmcnt(0)
    v_mfma_f32_16x16x32_bf16 v[132:135], a[120:123], a[8:11], v[132:135]
    v_mfma_f32_16x16x32_bf16 v[132:135], a[124:127], a[12:15], v[132:135]
    s_nop 2
    v_max3_f32 v176, v128, v129, v130
    s_nop 3
    v_max3_f32 v177, v132, v133, v134
    v_max3_f32 v176, v176, v131, v135
    v_max_f32 v176, v176, v177
    v_mov_b32 v177, v176
    s_nop 1
    v_permlane32_swap_b32 v177, v176
    v_max_f32 v176, v176, v177
    v_mov_b32 v177, v176
    s_nop 1
    v_permlane16_swap_b32 v177, v176
    v_max_f32 v176, v176, v177
    v_sub_f32 v200, 0, v176
    v_sub_f32 v201, 0, v176
    v_sub_f32 v202, 0, v176
    v_sub_f32 v203, 0, v176
    v_sub_f32 v128, v128, v176
    v_sub_f32 v129, v129, v176
    v_sub_f32 v130, v130, v176
    v_sub_f32 v131, v131, v176
    v_sub_f32 v132, v132, v176
    v_sub_f32 v133, v133, v176
    v_sub_f32 v134, v134, v176
    v_sub_f32 v135, v135, v176
    v_exp_f32 v128, v128
    v_exp_f32 v129, v129
    v_exp_f32 v130, v130
    v_cvt_pk_bf16_f32 v176, v128, v129
    v_exp_f32 v131, v131
    v_exp_f32 v132, v132
    v_cvt_pk_bf16_f32 v177, v130, v131
    v_exp_f32 v133, v133
    v_exp_f32 v134, v134
    v_cvt_pk_bf16_f32 v178, v132, v133
    v_exp_f32 v135, v135
    s_nop 0
    v_cvt_pk_bf16_f32 v179, v134, v135
    s_waitcnt vmcnt(8)
    ds_read_b128 v[16:19], v238 offset:4352
    ds_read_b128 v[20:23], v238 offset:4416
    s_add_u32 m0, s28, 33280
    ds_read_b128 v[24:27], v238 offset:4480
    ds_read_b128 v[28:31], v238 offset:4544
    buffer_load_dwordx4 v236, s[12:15], s25 offen offset:2048 lds
    s_waitcnt lgkmcnt(3)
    v_lshlrev_b32 v32, 16, v16
    v_and_b32 v33, s62, v16
    v_pk_mul_f32 v[32:33], v[32:33], s[60:61]
    v_cvt_pk_bf16_f32 v35, v32, v33
    v_lshlrev_b32 v36, 16, v17
    v_and_b32 v37, s62, v17
    v_accvgpr_write_b32 a16, v35
    v_pk_mul_f32 v[36:37], v[36:37], s[60:61]
    buffer_load_dwordx4 v237, s[12:15], s25 offen offset:3104 lds
    v_lshlrev_b32 v40, 16, v18
    v_and_b32 v41, s62, v18
    v_pk_mul_f32 v[40:41], v[40:41], s[60:61]
    s_add_u32 s14, s10, 4096
    v_cvt_pk_bf16_f32 v39, v36, v37
    v_cvt_pk_bf16_f32 v43, v40, v41
    v_accvgpr_write_b32 a17, v39
    v_accvgpr_write_b32 a18, v43
    v_lshlrev_b32 v44, 16, v19
    s_mov_b32 s25, s24
    v_and_b32 v45, s62, v19
    v_pk_mul_f32 v[44:45], v[44:45], s[60:61]
    s_waitcnt lgkmcnt(2)
    v_lshlrev_b32 v48, 16, v20
    v_and_b32 v49, s62, v20
    v_cvt_pk_bf16_f32 v47, v44, v45
    v_pk_mul_f32 v[48:49], v[48:49], s[60:61]
    buffer_load_dwordx4 v234, s[8:11], s24 offen lds
    v_accvgpr_write_b32 a19, v47
    v_cvt_pk_bf16_f32 v51, v48, v49
    v_lshlrev_b32 v52, 16, v21
    v_and_b32 v53, s62, v21
    v_lshlrev_b32 v56, 16, v22
    v_and_b32 v57, s62, v22
    v_lshlrev_b32 v60, 16, v23
    v_and_b32 v61, s62, v23
    v_pk_mul_f32 v[52:53], v[52:53], s[60:61]
    v_pk_mul_f32 v[56:57], v[56:57], s[60:61]
    v_pk_mul_f32 v[60:61], v[60:61], s[60:61]
    buffer_load_dwordx4 v235, s[8:11], s24 offen offset:1024 lds
    v_cvt_pk_bf16_f32 v55, v52, v53
    v_cvt_pk_bf16_f32 v59, v56, v57
    v_cvt_pk_bf16_f32 v63, v60, v61
    s_waitcnt lgkmcnt(0)
    v_lshlrev_b32 v48, 16, v28
    v_and_b32 v49, s62, v28
    v_lshlrev_b32 v52, 16, v29
    v_and_b32 v53, s62, v29
    v_lshlrev_b32 v56, 16, v30
    v_and_b32 v57, s62, v30
    v_lshlrev_b32 v60, 16, v31
    v_and_b32 v61, s62, v31
    s_add_u32 s24, s24, 131072
    v_accvgpr_write_b32 a20, v51
    v_accvgpr_write_b32 a21, v55
    v_accvgpr_write_b32 a22, v59
    v_accvgpr_write_b32 a23, v63
    v_pk_mul_f32 v[48:49], v[48:49], s[60:61]
    v_pk_mul_f32 v[52:53], v[52:53], s[60:61]
    v_pk_mul_f32 v[56:57], v[56:57], s[60:61]
    v_pk_mul_f32 v[60:61], v[60:61], s[60:61]
    v_cvt_pk_bf16_f32 v51, v48, v49
    v_cvt_pk_bf16_f32 v55, v52, v53
    v_cvt_pk_bf16_f32 v59, v56, v57
    v_cvt_pk_bf16_f32 v63, v60, v61
    s_sub_u32 s3, s3, 1
    v_accvgpr_write_b32 a28, v51
    v_accvgpr_write_b32 a29, v55
    v_accvgpr_write_b32 a30, v59
    v_accvgpr_write_b32 a31, v63
    v_lshlrev_b32 v32, 16, v24
    v_and_b32 v33, s62, v24
    v_pk_mul_f32 v[32:33], v[32:33], s[60:61]
    v_cvt_pk_bf16_f32 v35, v32, v33
    v_lshlrev_b32 v36, 16, v25
    v_and_b32 v37, s62, v25
    v_pk_mul_f32 v[36:37], v[36:37], s[60:61]
    v_accvgpr_write_b32 a24, v35
    v_cvt_pk_bf16_f32 v39, v36, v37
    v_lshlrev_b32 v40, 16, v26
    v_and_b32 v41, s62, v26
    v_pk_mul_f32 v[40:41], v[40:41], s[60:61]
    v_cvt_pk_bf16_f32 v43, v40, v41
    v_lshlrev_b32 v44, 16, v27
    v_and_b32 v45, s62, v27
    v_accvgpr_write_b32 a25, v39
    v_accvgpr_write_b32 a26, v43
    v_pk_mul_f32 v[44:45], v[44:45], s[60:61]
    v_cvt_pk_bf16_f32 v47, v44, v45
    v_accvgpr_write_b32 a27, v47
    v_mfma_f32_16x16x32_bf16 v[136:139], a[96:99], a[16:19], 0
    v_mfma_f32_16x16x32_bf16 v[136:139], a[100:103], a[20:23], v[136:139]
    v_mfma_f32_16x16x32_bf16 v[136:139], a[104:107], a[24:27], v[136:139]
    v_mfma_f32_16x16x32_bf16 v[136:139], a[108:111], a[28:31], v[136:139]
    v_mfma_f32_16x16x32_bf16 v[140:143], a[112:115], a[16:19], 0
    v_mfma_f32_16x16x32_bf16 v[140:143], a[116:119], a[20:23], v[140:143]
    v_mfma_f32_16x16x32_bf16 v[140:143], a[120:123], a[24:27], v[140:143]
    v_mfma_f32_16x16x32_bf16 v[140:143], a[124:127], a[28:31], v[140:143]
    s_nop 3
    v_max3_f32 v180, v136, v137, v138
    s_nop 2
    v_max3_f32 v181, v140, v141, v142
    v_max3_f32 v180, v180, v139, v143
    v_max_f32 v180, v180, v181
    v_mov_b32 v181, v180
    s_nop 1
    v_permlane32_swap_b32 v181, v180
    v_max_f32 v180, v180, v181
    v_mov_b32 v181, v180
    s_nop 1
    v_permlane16_swap_b32 v181, v180
    v_max_f32 v180, v180, v181
    v_sub_f32 v204, 0, v180
    v_sub_f32 v205, 0, v180
    v_sub_f32 v206, 0, v180
    v_sub_f32 v207, 0, v180
    v_sub_f32 v136, v136, v180
    v_sub_f32 v137, v137, v180
    v_sub_f32 v138, v138, v180
    v_sub_f32 v139, v139, v180
    v_sub_f32 v140, v140, v180
    v_sub_f32 v141, v141, v180
    v_sub_f32 v142, v142, v180
    v_sub_f32 v143, v143, v180
    v_exp_f32 v136, v136
    v_exp_f32 v137, v137
    v_exp_f32 v138, v138
    v_cvt_pk_bf16_f32 v180, v136, v137
    v_exp_f32 v139, v139
    v_exp_f32 v140, v140
    v_cvt_pk_bf16_f32 v181, v138, v139
    v_exp_f32 v141, v141
    v_exp_f32 v142, v142
    v_cvt_pk_bf16_f32 v182, v140, v141
    v_exp_f32 v143, v143
    s_nop 0
    v_cvt_pk_bf16_f32 v183, v142, v143
    s_waitcnt vmcnt(8)
    ds_read_b128 v[0:3], v238 offset:8704
    ds_read_b128 v[4:7], v238 offset:8768
    s_add_u32 m0, s28, 49920
    ds_read_b128 v[8:11], v238 offset:8832
    buffer_load_dwordx4 v236, s[12:15], s25 offen offset:2048 lds
    ds_read_b128 v[12:15], v238 offset:8896
    s_waitcnt lgkmcnt(3)
    v_lshlrev_b32 v32, 16, v0
    v_and_b32 v33, s62, v0
    v_pk_mul_f32 v[32:33], v[32:33], s[60:61]
    v_cvt_pk_bf16_f32 v35, v32, v33
    v_lshlrev_b32 v36, 16, v1
    v_and_b32 v37, s62, v1
    v_accvgpr_write_b32 a32, v35
    v_pk_mul_f32 v[36:37], v[36:37], s[60:61]
    buffer_load_dwordx4 v237, s[12:15], s25 offen offset:3104 lds
    v_lshlrev_b32 v40, 16, v2
    v_and_b32 v41, s62, v2
    v_pk_mul_f32 v[40:41], v[40:41], s[60:61]
    s_add_u32 s14, s10, 4096
    v_cvt_pk_bf16_f32 v39, v36, v37
    v_cvt_pk_bf16_f32 v43, v40, v41
    v_accvgpr_write_b32 a33, v39
    v_accvgpr_write_b32 a34, v43
    v_lshlrev_b32 v44, 16, v3
    s_mov_b32 s25, s24
    v_and_b32 v45, s62, v3
    v_pk_mul_f32 v[44:45], v[44:45], s[60:61]
    s_waitcnt lgkmcnt(2)
    v_lshlrev_b32 v48, 16, v4
    v_and_b32 v49, s62, v4
    v_cvt_pk_bf16_f32 v47, v44, v45
    v_pk_mul_f32 v[48:49], v[48:49], s[60:61]
    buffer_load_dwordx4 v234, s[8:11], s24 offen lds
    v_accvgpr_write_b32 a35, v47
    v_cvt_pk_bf16_f32 v51, v48, v49
    buffer_load_dwordx4 v235, s[8:11], s24 offen offset:1024 lds
    s_add_u32 s24, s24, 131072
    s_sub_u32 s3, s3, 1
    v_lshlrev_b32 v52, 16, v5
    v_and_b32 v53, s62, v5
    v_lshlrev_b32 v56, 16, v6
    v_and_b32 v57, s62, v6
    v_lshlrev_b32 v60, 16, v7
    v_and_b32 v61, s62, v7
    v_pk_mul_f32 v[52:53], v[52:53], s[60:61]
    v_pk_mul_f32 v[56:57], v[56:57], s[60:61]
    v_pk_mul_f32 v[60:61], v[60:61], s[60:61]
    v_cvt_pk_bf16_f32 v55, v52, v53
    v_cvt_pk_bf16_f32 v59, v56, v57
    v_cvt_pk_bf16_f32 v63, v60, v61
    s_waitcnt lgkmcnt(0)
    v_lshlrev_b32 v32, 16, v8
    v_and_b32 v33, s62, v8
    v_lshlrev_b32 v36, 16, v9
    v_and_b32 v37, s62, v9
    v_lshlrev_b32 v40, 16, v10
    v_and_b32 v41, s62, v10
    v_lshlrev_b32 v44, 16, v11
    v_and_b32 v45, s62, v11
    v_lshlrev_b32 v48, 16, v12
    v_and_b32 v49, s62, v12
    v_lshlrev_b32 v52, 16, v13
    v_and_b32 v53, s62, v13
    v_lshlrev_b32 v56, 16, v14
    v_and_b32 v57, s62, v14
    v_lshlrev_b32 v60, 16, v15
    v_and_b32 v61, s62, v15
    v_pk_mul_f32 v[32:33], v[32:33], s[60:61]
    v_pk_mul_f32 v[36:37], v[36:37], s[60:61]
    v_pk_mul_f32 v[40:41], v[40:41], s[60:61]
    v_pk_mul_f32 v[44:45], v[44:45], s[60:61]
    v_accvgpr_write_b32 a36, v51
    v_pk_mul_f32 v[48:49], v[48:49], s[60:61]
    v_accvgpr_write_b32 a37, v55
    v_pk_mul_f32 v[52:53], v[52:53], s[60:61]
    v_accvgpr_write_b32 a38, v59
    v_pk_mul_f32 v[56:57], v[56:57], s[60:61]
    v_accvgpr_write_b32 a39, v63
    v_pk_mul_f32 v[60:61], v[60:61], s[60:61]
    v_cvt_pk_bf16_f32 v35, v32, v33
    v_cvt_pk_bf16_f32 v39, v36, v37
    v_cvt_pk_bf16_f32 v43, v40, v41
    v_cvt_pk_bf16_f32 v47, v44, v45
    v_cvt_pk_bf16_f32 v51, v48, v49
    v_cvt_pk_bf16_f32 v55, v52, v53
    v_cvt_pk_bf16_f32 v59, v56, v57
    v_cvt_pk_bf16_f32 v63, v60, v61
    v_accvgpr_write_b32 a40, v35
    v_accvgpr_write_b32 a41, v39
    v_accvgpr_write_b32 a42, v43
    v_accvgpr_write_b32 a43, v47
    v_accvgpr_write_b32 a44, v51
    v_accvgpr_write_b32 a45, v55
    v_accvgpr_write_b32 a46, v59
    v_accvgpr_write_b32 a47, v63
    v_mfma_f32_16x16x32_bf16 v[144:147], a[96:99], a[32:35], 0
    v_add_u32 v241, 16384, v239
    v_add_u32 v246, 32768, v239
    v_mfma_f32_16x16x32_bf16 v[144:147], a[100:103], a[36:39], v[144:147]
    v_add_u32 v247, 49152, v239
    v_mfma_f32_16x16x32_bf16 v[144:147], a[104:107], a[40:43], v[144:147]
    s_mov_b32 s70, s27
    v_mfma_f32_16x16x32_bf16 v[144:147], a[108:111], a[44:47], v[144:147]
    s_add_u32 s27, s27, 16640
    v_mfma_f32_16x16x32_bf16 v[148:151], a[112:115], a[32:35], 0
    s_cmp_eq_u32 s27, s29
    v_mfma_f32_16x16x32_bf16 v[148:151], a[116:119], a[36:39], v[148:151]
    s_cselect_b32 s27, s28, s27
    v_mfma_f32_16x16x32_bf16 v[148:151], a[120:123], a[40:43], v[148:151]
    s_waitcnt vmcnt(8)
    v_mfma_f32_16x16x32_bf16 v[148:151], a[124:127], a[44:47], v[148:151]
    s_barrier
    v_add_u32 v231, s27, v233
    ds_read_b64_tr_b16 a[128:129], v231 offset:0
    ds_read_b64_tr_b16 a[130:131], v231 offset:512
    ds_read_b64_tr_b16 a[132:133], v231 offset:32
    ds_read_b64_tr_b16 a[134:135], v231 offset:544
    ds_read_b64_tr_b16 a[136:137], v231 offset:64
    ds_read_b64_tr_b16 a[138:139], v231 offset:576
    ds_read_b64_tr_b16 a[140:141], v231 offset:96
    ds_read_b64_tr_b16 a[142:143], v231 offset:608
    ds_read_b64_tr_b16 a[144:145], v231 offset:128
    ds_read_b64_tr_b16 a[146:147], v231 offset:640
    ds_read_b64_tr_b16 a[148:149], v231 offset:160
    ds_read_b64_tr_b16 a[150:151], v231 offset:672
    ds_read_b64_tr_b16 a[152:153], v231 offset:192
    ds_read_b64_tr_b16 a[154:155], v231 offset:704
    ds_read_b64_tr_b16 a[156:157], v231 offset:224
    v_add_u32 v230, s27, v232
    ds_read_b64_tr_b16 a[158:159], v231 offset:736
    ds_read_b128 a[96:99], v230 offset:0
    ds_read_b128 a[100:103], v230 offset:64
    ds_read_b128 a[104:107], v230 offset:128
    ds_read_b128 a[108:111], v230 offset:192
    ds_read_b128 a[112:115], v230 offset:1024
    ds_read_b128 a[116:119], v230 offset:1088
    ds_read_b128 a[120:123], v230 offset:1152
    ds_read_b128 a[124:127], v230 offset:1216
    v_mfma_f32_16x16x32_bf16 a[228:231], a[224:227], v[176:179], 0
    s_waitcnt lgkmcnt(15)
    v_max3_f32 v184, v144, v145, v146
    v_max3_f32 v185, v148, v149, v150
    v_max3_f32 v184, v184, v147, v151
    v_mfma_f32_16x16x32_bf16 v[0:3], a[128:131], v[176:179], 0
    s_add_u32 m0, s28, 66560
    v_max_f32 v184, v184, v185
    v_mov_b32 v185, v184
    v_mfma_f32_16x16x32_bf16 v[4:7], a[132:135], v[176:179], 0
    buffer_load_dwordx4 v236, s[12:15], s25 offen offset:2048 lds
    v_mfma_f32_16x16x32_bf16 v[8:11], a[136:139], v[176:179], 0
    buffer_load_dwordx4 v237, s[12:15], s25 offen offset:3104 lds
    v_mfma_f32_16x16x32_bf16 v[12:15], a[140:143], v[176:179], 0
    s_waitcnt lgkmcnt(14)
    v_permlane32_swap_b32 v185, v184
    v_max_f32 v184, v184, v185
    v_mov_b32 v185, v184
    v_mfma_f32_16x16x32_bf16 v[16:19], a[144:147], v[176:179], 0
    s_waitcnt lgkmcnt(0)
    v_permlane16_swap_b32 v185, v184
    v_max_f32 v184, v184, v185
    v_sub_f32 v208, 0, v184
    v_mfma_f32_16x16x32_bf16 v[20:23], a[148:151], v[176:179], 0
    s_add_u32 s14, s10, 4096
    v_sub_f32 v209, 0, v184
    v_sub_f32 v210, 0, v184
    v_sub_f32 v211, 0, v184
    v_mfma_f32_16x16x32_bf16 v[24:27], a[152:155], v[176:179], 0
    s_mov_b32 s25, s24
    buffer_load_dwordx4 v234, s[8:11], s24 offen lds
    v_mfma_f32_16x16x32_bf16 v[28:31], a[156:159], v[176:179], 0
    buffer_load_dwordx4 v235, s[8:11], s24 offen offset:1024 lds
    v_mfma_f32_16x16x32_bf16 v[128:131], a[96:99], a[0:3], v[200:203]
    s_add_u32 s24, s24, 131072
    v_sub_f32 v144, v144, v184
    v_sub_f32 v145, v145, v184
    v_sub_f32 v146, v146, v184
    v_mfma_f32_16x16x32_bf16 v[128:131], a[100:103], a[4:7], v[128:131]
    s_sub_u32 s3, s3, 1
    v_sub_f32 v147, v147, v184
    v_sub_f32 v148, v148, v184
    v_sub_f32 v149, v149, v184
    v_mfma_f32_16x16x32_bf16 v[128:131], a[104:107], a[8:11], v[128:131]
    s_mov_b32 s18, s31
    v_sub_f32 v150, v150, v184
    v_sub_f32 v151, v151, v184
    s_mov_b32 m0, s70
    v_mfma_f32_16x16x32_bf16 v[128:131], a[108:111], a[12:15], v[128:131]
    buffer_load_dwordx4 v236, s[12:15], s25 offen offset:2048 lds
    v_mfma_f32_16x16x32_bf16 v[132:135], a[112:115], a[0:3], v[200:203]
    s_mov_b32 m0, s70
    v_exp_f32 v144, v144
    v_mfma_f32_16x16x32_bf16 v[132:135], a[116:119], a[4:7], v[132:135]
    buffer_load_dwordx4 v237, s[12:15], s25 offen offset:3104 lds
    v_mfma_f32_16x16x32_bf16 v[132:135], a[120:123], a[8:11], v[132:135]
    s_add_u32 s14, s10, 4096
    v_exp_f32 v145, v145
    s_mov_b32 s25, s24
    v_mfma_f32_16x16x32_bf16 v[132:135], a[124:127], a[12:15], v[132:135]
    s_mov_b32 m0, s70
    v_cvt_pk_bf16_f32 v184, v144, v145
    v_exp_f32 v146, v146
    v_mfma_f32_16x16x32_bf16 a[232:235], a[224:227], v[180:183], 0
    buffer_load_dwordx4 v234, s[8:11], s24 offen lds
    v_mfma_f32_16x16x32_bf16 v[32:35], a[128:131], v[180:183], 0
    s_mov_b32 m0, s70
    v_exp_f32 v147, v147
    v_mfma_f32_16x16x32_bf16 v[36:39], a[132:135], v[180:183], 0
    buffer_load_dwordx4 v235, s[8:11], s24 offen offset:1024 lds
    v_mfma_f32_16x16x32_bf16 v[40:43], a[136:139], v[180:183], 0
    s_add_u32 s24, s24, 131072
    v_cvt_pk_bf16_f32 v185, v146, v147
    v_exp_f32 v148, v148
    v_mfma_f32_16x16x32_bf16 v[44:47], a[140:143], v[180:183], 0
    s_sub_u32 s3, s3, 1
    v_exp_f32 v149, v149
    s_mov_b32 s70, s27
    v_mfma_f32_16x16x32_bf16 v[48:51], a[144:147], v[180:183], 0
    s_add_u32 s27, s27, 16640
    v_cvt_pk_bf16_f32 v186, v148, v149
    v_exp_f32 v150, v150
    v_mfma_f32_16x16x32_bf16 v[52:55], a[148:151], v[180:183], 0
    s_cmp_eq_u32 s27, s29
    v_exp_f32 v151, v151
    s_cselect_b32 s27, s28, s27
    v_mfma_f32_16x16x32_bf16 v[56:59], a[152:155], v[180:183], 0
    s_waitcnt vmcnt(12)
    v_cvt_pk_bf16_f32 v187, v150, v151
    v_exp_f32 v128, v128
    v_mfma_f32_16x16x32_bf16 v[60:63], a[156:159], v[180:183], 0
    s_barrier
    v_mfma_f32_16x16x32_bf16 a[236:239], a[224:227], v[184:187], 0
    s_mov_b32 m0, s70
    v_add_u32 v231, s27, v233
    v_add_u32 v230, s27, v232
    v_mfma_f32_16x16x32_bf16 v[64:67], a[128:131], v[184:187], 0
    buffer_load_dwordx4 v236, s[12:15], s25 offen offset:2048 lds
    v_mfma_f32_16x16x32_bf16 v[68:71], a[132:135], v[184:187], 0
    s_mov_b32 m0, s70
    ds_read_b64_tr_b16 a[128:129], v231 offset:0
    v_exp_f32 v129, v129
    v_mfma_f32_16x16x32_bf16 v[72:75], a[136:139], v[184:187], 0
    buffer_load_dwordx4 v237, s[12:15], s25 offen offset:3104 lds
    v_mfma_f32_16x16x32_bf16 v[76:79], a[140:143], v[184:187], 0
    s_add_u32 s14, s10, 4096
    ds_read_b64_tr_b16 a[130:131], v231 offset:512
    v_cvt_pk_bf16_f32 v176, v128, v129
    s_mov_b32 s25, s24
    v_mfma_f32_16x16x32_bf16 v[80:83], a[144:147], v[184:187], 0
    ds_read_b64_tr_b16 a[132:133], v231 offset:32
    v_exp_f32 v130, v130
    v_mfma_f32_16x16x32_bf16 v[84:87], a[148:151], v[184:187], 0
    ds_read_b64_tr_b16 a[134:135], v231 offset:544
    v_exp_f32 v131, v131
    v_mfma_f32_16x16x32_bf16 v[88:91], a[152:155], v[184:187], 0
    s_mov_b32 m0, s70
    v_cvt_pk_bf16_f32 v177, v130, v131
    v_exp_f32 v132, v132
    v_mfma_f32_16x16x32_bf16 v[92:95], a[156:159], v[184:187], 0
    v_exp_f32 v133, v133
    ds_read_b64_tr_b16 a[136:137], v231 offset:64
    ds_read_b64_tr_b16 a[138:139], v231 offset:576
    ds_read_b64_tr_b16 a[140:141], v231 offset:96
    v_cvt_pk_bf16_f32 v178, v132, v133
    v_exp_f32 v134, v134
    v_exp_f32 v135, v135
    s_branch L_loop3
L_first4:
    s_mov_b32 s39, s34
    s_sub_u32 s26, s37, 4
    s_mov_b32 s91, 0
    s_mov_b32 s4, s31
    s_lshl_b32 s5, s64, 14
    s_add_u32 s5, s5, s34
    s_cmp_le_u32 s38, 16
    s_cselect_b32 s71, 8, 0
    s_mov_b32 s22, s4
    s_mov_b32 s33, s5
    v_sub_u32 v244, s38, v240
    s_and_b32 s4, s73, 0x1fff
    s_bfe_u32 s38, s73, 655373
    s_bfe_u32 s36, s73, 196635
    s_bfe_u32 s5, s73, 262167
    s_add_u32 s31, s4, s38
    s_lshl_b32 s31, s31, 12
    s_lshl4_add_u32 s4, s4, s65
    s_lshl_b32 s30, s4, 8
    s_mul_i32 s6, s36, s64
    s_lshl2_add_u32 s5, s5, s6
    s_lshl_b32 s5, s5, 2
    s_sub_u32 s5, s5, s64
    s_lshl_b32 s5, s5, 14
    s_add_u32 s34, s30, s5
    s_add_u32 s37, s38, 31
    s_lshr_b32 s37, s37, 5
    s_sub_u32 s38, s38, 1
    s_and_b32 s38, s38, 31
    s_add_u32 s38, s38, 1
    s_cmp_eq_u32 s36, 0
    s_cselect_b32 s30, 0x40000000, s30
    s_cmp_lg_u32 s36, 0
    s_cselect_b32 s6, 0, 0
    s_sub_u32 s26, s26, s6
    s_add_u32 s71, s71, s36
    s_lshl_b32 s94, s36, 1
    s_sub_u32 s91, s26, s94
    s_sub_u32 s91, s91, 4
    s_sub_u32 s94, s94, 1
    s_cmp_lg_u32 s36, 0
    s_cselect_b32 s26, 4, s26
    s_cselect_b32 s91, s91, 0
    s_mov_b32 s92, s32
    s_mov_b32 s93, s34
    s_waitcnt vmcnt(6)
    ds_read_b128 v[0:3], v238 offset:0
    ds_read_b128 v[4:7], v238 offset:64
    ds_read_b128 v[8:11], v238 offset:128
    ds_read_b128 v[12:15], v238 offset:192
    v_cmp_gt_i32 s[40:41], v244, 0
    v_cmp_gt_i32 s[42:43], v244, 1
    v_cmp_gt_i32 s[44:45], v244, 2
    v_cmp_gt_i32 s[46:47], v244, 3
    v_cmp_gt_i32 s[48:49], v244, 16
    v_cmp_gt_i32 s[50:51], v244, 17
    v_cmp_gt_i32 s[52:53], v244, 18
    v_cmp_gt_i32 s[54:55], v244, 19
    s_waitcnt lgkmcnt(3)
    v_lshlrev_b32 v32, 16, v0
    v_and_b32 v33, s62, v0
    v_lshlrev_b32 v36, 16, v1
    v_and_b32 v37, s62, v1
    v_lshlrev_b32 v40, 16, v2
    v_and_b32 v41, s62, v2
    v_lshlrev_b32 v44, 16, v3
    v_and_b32 v45, s62, v3
    v_pk_mul_f32 v[32:33], v[32:33], s[60:61]
    v_pk_mul_f32 v[36:37], v[36:37], s[60:61]
    v_pk_mul_f32 v[40:41], v[40:41], s[60:61]
    v_pk_mul_f32 v[44:45], v[44:45], s[60:61]
    v_cvt_pk_bf16_f32 v35, v32, v33
    s_waitcnt lgkmcnt(2)
    v_lshlrev_b32 v48, 16, v4
    v_and_b32 v49, s62, v4
    v_lshlrev_b32 v52, 16, v5
    v_and_b32 v53, s62, v5
    v_lshlrev_b32 v56, 16, v6
    v_and_b32 v57, s62, v6
    v_lshlrev_b32 v60, 16, v7
    v_and_b32 v61, s62, v7
    v_pk_mul_f32 v[48:49], v[48:49], s[60:61]
    v_pk_mul_f32 v[52:53], v[52:53], s[60:61]
    v_pk_mul_f32 v[56:57], v[56:57], s[60:61]
    v_pk_mul_f32 v[60:61], v[60:61], s[60:61]
    v_cvt_pk_bf16_f32 v39, v36, v37
    v_cvt_pk_bf16_f32 v43, v40, v41
    v_cvt_pk_bf16_f32 v47, v44, v45
    v_cvt_pk_bf16_f32 v51, v48, v49
    v_cvt_pk_bf16_f32 v55, v52, v53
    v_cvt_pk_bf16_f32 v59, v56, v57
    v_cvt_pk_bf16_f32 v63, v60, v61
    v_accvgpr_write_b32 a0, v35
    v_accvgpr_write_b32 a1, v39
    v_accvgpr_write_b32 a2, v43
    v_accvgpr_write_b32 a3, v47
    v_accvgpr_write_b32 a4, v51
    v_accvgpr_write_b32 a5, v55
    v_accvgpr_write_b32 a6, v59
    v_accvgpr_write_b32 a7, v63
    s_waitcnt vmcnt(4)
    s_barrier
    ds_read_b128 a[96:99], v230 offset:0
    ds_read_b128 a[100:103], v230 offset:64
    ds_read_b128 a[104:107], v230 offset:128
    ds_read_b128 a[108:111], v230 offset:192
    ds_read_b128 a[112:115], v230 offset:1024
    s_waitcnt lgkmcnt(5)
    v_lshlrev_b32 v32, 16, v8
    v_and_b32 v33, s62, v8
    v_lshlrev_b32 v36, 16, v9
    v_and_b32 v37, s62, v9
    v_lshlrev_b32 v40, 16, v10
    v_and_b32 v41, s62, v10
    v_lshlrev_b32 v44, 16, v11
    v_and_b32 v45, s62, v11
    v_lshlrev_b32 v48, 16, v12
    v_and_b32 v49, s62, v12
    v_lshlrev_b32 v52, 16, v13
    v_and_b32 v53, s62, v13
    v_lshlrev_b32 v56, 16, v14
    v_and_b32 v57, s62, v14
    v_lshlrev_b32 v60, 16, v15
    v_and_b32 v61, s62, v15
    ds_read_b128 a[116:119], v230 offset:1088
    v_pk_mul_f32 v[32:33], v[32:33], s[60:61]
    v_pk_mul_f32 v[36:37], v[36:37], s[60:61]
    v_pk_mul_f32 v[40:41], v[40:41], s[60:61]
    v_pk_mul_f32 v[44:45], v[44:45], s[60:61]
    v_pk_mul_f32 v[48:49], v[48:49], s[60:61]
    v_pk_mul_f32 v[52:53], v[52:53], s[60:61]
    v_pk_mul_f32 v[56:57], v[56:57], s[60:61]
    v_pk_mul_f32 v[60:61], v[60:61], s[60:61]
    s_add_u32 m0, s32, 8704
    ds_read_b128 a[120:123], v230 offset:1152
    v_cvt_pk_bf16_f32 v35, v32, v33
    v_cvt_pk_bf16_f32 v39, v36, v37
    v_cvt_pk_bf16_f32 v43, v40, v41
    v_cvt_pk_bf16_f32 v47, v44, v45
    v_cvt_pk_bf16_f32 v51, v48, v49
    v_cvt_pk_bf16_f32 v55, v52, v53
    v_cvt_pk_bf16_f32 v59, v56, v57
    v_cvt_pk_bf16_f32 v63, v60, v61
    ds_read_b128 a[124:127], v230 offset:1216
    v_accvgpr_write_b32 a8, v35
    v_accvgpr_write_b32 a9, v39
    v_accvgpr_write_b32 a10, v43
    v_accvgpr_write_b32 a11, v47
    v_accvgpr_write_b32 a12, v51
    v_accvgpr_write_b32 a13, v55
    v_accvgpr_write_b32 a14, v59
    v_accvgpr_write_b32 a15, v63
    s_add_u32 s35, s39, 131072
    buffer_load_dwordx4 v234, s[16:19], s35 offen offset:0 lds
    s_add_u32 s35, s39, 146368
    buffer_load_dwordx4 v234, s[16:19], s35 offen offset:1088 lds
    s_add_u32 s35, s39, 161664
    buffer_load_dwordx4 v234, s[16:19], s35 offen offset:2176 lds
    s_add_u32 s35, s39, 176960
    buffer_load_dwordx4 v234, s[16:19], s35 offen offset:3264 lds
    s_waitcnt lgkmcnt(2)
    v_mfma_f32_16x16x32_bf16 v[128:131], a[96:99], a[0:3], 0
    v_mfma_f32_16x16x32_bf16 v[128:131], a[100:103], a[4:7], v[128:131]
    v_mfma_f32_16x16x32_bf16 v[128:131], a[104:107], a[8:11], v[128:131]
    v_mfma_f32_16x16x32_bf16 v[128:131], a[108:111], a[12:15], v[128:131]
    v_mfma_f32_16x16x32_bf16 v[132:135], a[112:115], a[0:3], 0
    v_mfma_f32_16x16x32_bf16 v[132:135], a[116:119], a[4:7], v[132:135]
    s_waitcnt lgkmcnt(0)
    v_mfma_f32_16x16x32_bf16 v[132:135], a[120:123], a[8:11], v[132:135]
    v_mfma_f32_16x16x32_bf16 v[132:135], a[124:127], a[12:15], v[132:135]
    s_nop 2
    v_max3_f32 v176, v128, v129, v130
    s_nop 3
    v_max3_f32 v177, v132, v133, v134
    v_max3_f32 v176, v176, v131, v135
    v_max_f32 v176, v176, v177
    v_mov_b32 v177, v176
    s_nop 1
    v_permlane32_swap_b32 v177, v176
    v_max_f32 v176, v176, v177
    v_mov_b32 v177, v176
    s_nop 1
    v_permlane16_swap_b32 v177, v176
    v_max_f32 v176, v176, v177
    v_sub_f32 v200, 0, v176
    v_sub_f32 v201, 0, v176
    v_sub_f32 v202, 0, v176
    v_sub_f32 v203, 0, v176
    v_sub_f32 v128, v128, v176
    v_sub_f32 v129, v129, v176
    v_sub_f32 v130, v130, v176
    v_sub_f32 v131, v131, v176
    v_sub_f32 v132, v132, v176
    v_sub_f32 v133, v133, v176
    v_sub_f32 v134, v134, v176
    v_sub_f32 v135, v135, v176
    v_exp_f32 v128, v128
    v_exp_f32 v129, v129
    v_exp_f32 v130, v130
    v_cvt_pk_bf16_f32 v176, v128, v129
    v_exp_f32 v131, v131
    v_exp_f32 v132, v132
    v_cvt_pk_bf16_f32 v177, v130, v131
    v_exp_f32 v133, v133
    v_exp_f32 v134, v134
    v_cvt_pk_bf16_f32 v178, v132, v133
    v_exp_f32 v135, v135
    s_nop 0
    v_cvt_pk_bf16_f32 v179, v134, v135
    s_waitcnt vmcnt(4)
    ds_read_b128 v[16:19], v238 offset:4352
    ds_read_b128 v[20:23], v238 offset:4416
    ds_read_b128 v[24:27], v238 offset:4480
    ds_read_b128 v[28:31], v238 offset:4544
    s_add_u32 m0, s32, 13056
    s_add_u32 s35, s39, 196608
    s_waitcnt lgkmcnt(3)
    v_lshlrev_b32 v32, 16, v16
    v_and_b32 v33, s62, v16
    v_lshlrev_b32 v36, 16, v17
    v_and_b32 v37, s62, v17
    v_lshlrev_b32 v40, 16, v18
    v_and_b32 v41, s62, v18
    v_lshlrev_b32 v44, 16, v19
    v_and_b32 v45, s62, v19
    v_pk_mul_f32 v[32:33], v[32:33], s[60:61]
    v_pk_mul_f32 v[36:37], v[36:37], s[60:61]
    v_pk_mul_f32 v[40:41], v[40:41], s[60:61]
    v_pk_mul_f32 v[44:45], v[44:45], s[60:61]
    v_cvt_pk_bf16_f32 v35, v32, v33
    v_cvt_pk_bf16_f32 v39, v36, v37
    v_cvt_pk_bf16_f32 v43, v40, v41
    v_cvt_pk_bf16_f32 v47, v44, v45
    v_accvgpr_write_b32 a16, v35
    v_accvgpr_write_b32 a17, v39
    v_accvgpr_write_b32 a18, v43
    s_waitcnt lgkmcnt(2)
    v_lshlrev_b32 v48, 16, v20
    v_and_b32 v49, s62, v20
    v_lshlrev_b32 v52, 16, v21
    v_and_b32 v53, s62, v21
    v_lshlrev_b32 v56, 16, v22
    v_and_b32 v57, s62, v22
    v_lshlrev_b32 v60, 16, v23
    v_and_b32 v61, s62, v23
    v_pk_mul_f32 v[48:49], v[48:49], s[60:61]
    v_pk_mul_f32 v[52:53], v[52:53], s[60:61]
    v_pk_mul_f32 v[56:57], v[56:57], s[60:61]
    v_pk_mul_f32 v[60:61], v[60:61], s[60:61]
    v_cvt_pk_bf16_f32 v51, v48, v49
    v_cvt_pk_bf16_f32 v55, v52, v53
    v_cvt_pk_bf16_f32 v59, v56, v57
    v_cvt_pk_bf16_f32 v63, v60, v61
    s_waitcnt lgkmcnt(0)
    v_lshlrev_b32 v32, 16, v24
    v_and_b32 v33, s62, v24
    v_lshlrev_b32 v36, 16, v25
    v_and_b32 v37, s62, v25
    v_lshlrev_b32 v40, 16, v26
    v_and_b32 v41, s62, v26
    v_lshlrev_b32 v44, 16, v27
    v_and_b32 v45, s62, v27
    v_lshlrev_b32 v48, 16, v28
    v_and_b32 v49, s62, v28
    v_lshlrev_b32 v52, 16, v29
    v_and_b32 v53, s62, v29
    v_lshlrev_b32 v56, 16, v30
    v_and_b32 v57, s62, v30
    v_lshlrev_b32 v60, 16, v31
    v_and_b32 v61, s62, v31
    v_accvgpr_write_b32 a19, v47
    v_accvgpr_write_b32 a20, v51
    v_accvgpr_write_b32 a21, v55
    v_accvgpr_write_b32 a22, v59
    v_accvgpr_write_b32 a23, v63
    v_pk_mul_f32 v[32:33], v[32:33], s[60:61]
    v_pk_mul_f32 v[36:37], v[36:37], s[60:61]
    v_pk_mul_f32 v[40:41], v[40:41], s[60:61]
    v_pk_mul_f32 v[44:45], v[44:45], s[60:61]
    v_pk_mul_f32 v[48:49], v[48:49], s[60:61]
    v_pk_mul_f32 v[52:53], v[52:53], s[60:61]
    v_pk_mul_f32 v[56:57], v[56:57], s[60:61]
    v_pk_mul_f32 v[60:61], v[60:61], s[60:61]
    v_cvt_pk_bf16_f32 v35, v32, v33
    v_cvt_pk_bf16_f32 v39, v36, v37
    v_cvt_pk_bf16_f32 v43, v40, v41
    v_cvt_pk_bf16_f32 v47, v44, v45
    v_cvt_pk_bf16_f32 v51, v48, v49
    v_cvt_pk_bf16_f32 v55, v52, v53
    v_cvt_pk_bf16_f32 v59, v56, v57
    v_cvt_pk_bf16_f32 v63, v60, v61
    v_accvgpr_write_b32 a24, v35
    v_accvgpr_write_b32 a25, v39
    v_accvgpr_write_b32 a26, v43
    v_accvgpr_write_b32 a27, v47
    v_accvgpr_write_b32 a28, v51
    v_accvgpr_write_b32 a29, v55
    v_accvgpr_write_b32 a30, v59
    v_accvgpr_write_b32 a31, v63
    buffer_load_dwordx4 v234, s[16:19], s35 offen offset:0 lds
    s_add_u32 s35, s39, 211904
    buffer_load_dwordx4 v234, s[16:19], s35 offen offset:1088 lds
    s_add_u32 s35, s39, 227200
    buffer_load_dwordx4 v234, s[16:19], s35 offen offset:2176 lds
    s_add_u32 s35, s39, 242496
    buffer_load_dwordx4 v234, s[16:19], s35 offen offset:3264 lds
    v_mfma_f32_16x16x32_bf16 v[136:139], a[96:99], a[16:19], 0
    v_mfma_f32_16x16x32_bf16 v[136:139], a[100:103], a[20:23], v[136:139]
    v_mfma_f32_16x16x32_bf16 v[136:139], a[104:107], a[24:27], v[136:139]
    v_mfma_f32_16x16x32_bf16 v[136:139], a[108:111], a[28:31], v[136:139]
    v_mfma_f32_16x16x32_bf16 v[140:143], a[112:115], a[16:19], 0
    v_mfma_f32_16x16x32_bf16 v[140:143], a[116:119], a[20:23], v[140:143]
    v_mfma_f32_16x16x32_bf16 v[140:143], a[120:123], a[24:27], v[140:143]
    v_mfma_f32_16x16x32_bf16 v[140:143], a[124:127], a[28:31], v[140:143]
    s_nop 3
    v_max3_f32 v180, v136, v137, v138
    s_nop 2
    v_max3_f32 v181, v140, v141, v142
    v_max3_f32 v180, v180, v139, v143
    v_max_f32 v180, v180, v181
    v_mov_b32 v181, v180
    s_nop 1
    v_permlane32_swap_b32 v181, v180
    v_max_f32 v180, v180, v181
    v_mov_b32 v181, v180
    s_nop 1
    v_permlane16_swap_b32 v181, v180
    v_max_f32 v180, v180, v181
    v_sub_f32 v204, 0, v180
    v_sub_f32 v205, 0, v180
    v_sub_f32 v206, 0, v180
    v_sub_f32 v207, 0, v180
    v_sub_f32 v136, v136, v180
    v_sub_f32 v137, v137, v180
    v_sub_f32 v138, v138, v180
    v_sub_f32 v139, v139, v180
    v_sub_f32 v140, v140, v180
    v_sub_f32 v141, v141, v180
    v_sub_f32 v142, v142, v180
    v_sub_f32 v143, v143, v180
    v_exp_f32 v136, v136
    v_exp_f32 v137, v137
    v_mov_b32 v225, v136
    v_add_f32 v225, v225, v137
    v_cvt_pk_bf16_f32 v180, v136, v137
    v_exp_f32 v138, v138
    v_exp_f32 v139, v139
    v_add_f32 v225, v225, v138
    v_add_f32 v225, v225, v139
    v_cvt_pk_bf16_f32 v181, v138, v139
    v_exp_f32 v140, v140
    v_exp_f32 v141, v141
    v_add_f32 v225, v225, v140
    v_add_f32 v225, v225, v141
    v_cvt_pk_bf16_f32 v182, v140, v141
    v_exp_f32 v142, v142
    v_exp_f32 v143, v143
    v_add_f32 v225, v225, v142
    v_add_f32 v225, v225, v143
    v_cvt_pk_bf16_f32 v183, v142, v143
    s_waitcnt vmcnt(4)
    ds_read_b128 v[0:3], v238 offset:8704
    ds_read_b128 v[4:7], v238 offset:8768
    ds_read_b128 v[8:11], v238 offset:8832
    ds_read_b128 v[12:15], v238 offset:8896
    s_add_u32 m0, s28, 16640
    s_waitcnt lgkmcnt(3)
    v_lshlrev_b32 v32, 16, v0
    v_and_b32 v33, s62, v0
    v_lshlrev_b32 v36, 16, v1
    v_and_b32 v37, s62, v1
    v_lshlrev_b32 v40, 16, v2
    v_and_b32 v41, s62, v2
    v_lshlrev_b32 v44, 16, v3
    v_and_b32 v45, s62, v3
    v_pk_mul_f32 v[32:33], v[32:33], s[60:61]
    v_pk_mul_f32 v[36:37], v[36:37], s[60:61]
    v_pk_mul_f32 v[40:41], v[40:41], s[60:61]
    v_pk_mul_f32 v[44:45], v[44:45], s[60:61]
    v_cvt_pk_bf16_f32 v35, v32, v33
    v_cvt_pk_bf16_f32 v39, v36, v37
    v_cvt_pk_bf16_f32 v43, v40, v41
    v_cvt_pk_bf16_f32 v47, v44, v45
    v_accvgpr_write_b32 a32, v35
    v_accvgpr_write_b32 a33, v39
    v_accvgpr_write_b32 a34, v43
    v_accvgpr_write_b32 a35, v47
    s_waitcnt lgkmcnt(2)
    v_lshlrev_b32 v48, 16, v4
    v_and_b32 v49, s62, v4
    v_lshlrev_b32 v52, 16, v5
    v_and_b32 v53, s62, v5
    v_lshlrev_b32 v56, 16, v6
    v_and_b32 v57, s62, v6
    v_lshlrev_b32 v60, 16, v7
    v_and_b32 v61, s62, v7
    v_pk_mul_f32 v[48:49], v[48:49], s[60:61]
    v_pk_mul_f32 v[52:53], v[52:53], s[60:61]
    v_pk_mul_f32 v[56:57], v[56:57], s[60:61]
    v_pk_mul_f32 v[60:61], v[60:61], s[60:61]
    v_cvt_pk_bf16_f32 v51, v48, v49
    v_cvt_pk_bf16_f32 v55, v52, v53
    v_cvt_pk_bf16_f32 v59, v56, v57
    v_cvt_pk_bf16_f32 v63, v60, v61
    s_waitcnt lgkmcnt(0)
    v_lshlrev_b32 v32, 16, v8
    v_and_b32 v33, s62, v8
    v_lshlrev_b32 v36, 16, v9
    v_and_b32 v37, s62, v9
    v_lshlrev_b32 v40, 16, v10
    v_and_b32 v41, s62, v10
    v_lshlrev_b32 v44, 16, v11
    v_and_b32 v45, s62, v11
    v_lshlrev_b32 v48, 16, v12
    v_and_b32 v49, s62, v12
    v_lshlrev_b32 v52, 16, v13
    v_and_b32 v53, s62, v13
    v_lshlrev_b32 v56, 16, v14
    v_and_b32 v57, s62, v14
    v_lshlrev_b32 v60, 16, v15
    v_and_b32 v61, s62, v15
    v_accvgpr_write_b32 a36, v51
    v_accvgpr_write_b32 a37, v55
    v_accvgpr_write_b32 a38, v59
    v_accvgpr_write_b32 a39, v63
    v_pk_mul_f32 v[32:33], v[32:33], s[60:61]
    v_pk_mul_f32 v[36:37], v[36:37], s[60:61]
    v_pk_mul_f32 v[40:41], v[40:41], s[60:61]
    v_pk_mul_f32 v[44:45], v[44:45], s[60:61]
    v_pk_mul_f32 v[48:49], v[48:49], s[60:61]
    v_pk_mul_f32 v[52:53], v[52:53], s[60:61]
    v_pk_mul_f32 v[56:57], v[56:57], s[60:61]
    v_pk_mul_f32 v[60:61], v[60:61], s[60:61]
    v_cvt_pk_bf16_f32 v35, v32, v33
    v_cvt_pk_bf16_f32 v39, v36, v37
    v_cvt_pk_bf16_f32 v43, v40, v41
    v_cvt_pk_bf16_f32 v47, v44, v45
    v_cvt_pk_bf16_f32 v51, v48, v49
    v_cvt_pk_bf16_f32 v55, v52, v53
    v_cvt_pk_bf16_f32 v59, v56, v57
    v_cvt_pk_bf16_f32 v63, v60, v61
    v_accvgpr_write_b32 a40, v35
    v_accvgpr_write_b32 a41, v39
    v_accvgpr_write_b32 a42, v43
    v_accvgpr_write_b32 a43, v47
    v_accvgpr_write_b32 a44, v51
    v_accvgpr_write_b32 a45, v55
    v_accvgpr_write_b32 a46, v59
    v_accvgpr_write_b32 a47, v63
    buffer_load_dwordx4 v236, s[12:15], s25 offen offset:2048 lds
    buffer_load_dwordx4 v237, s[12:15], s25 offen offset:3104 lds
    s_add_u32 s14, s10, 4096
    s_mov_b32 s25, s24
    buffer_load_dwordx4 v234, s[8:11], s24 offen lds
    buffer_load_dwordx4 v235, s[8:11], s24 offen offset:1024 lds
    s_add_u32 s24, s24, 131072
    s_sub_u32 s3, s3, 1
    v_mfma_f32_16x16x32_bf16 v[144:147], a[96:99], a[32:35], 0
    v_mfma_f32_16x16x32_bf16 v[144:147], a[100:103], a[36:39], v[144:147]
    v_mfma_f32_16x16x32_bf16 v[144:147], a[104:107], a[40:43], v[144:147]
    v_mfma_f32_16x16x32_bf16 v[144:147], a[108:111], a[44:47], v[144:147]
    v_mfma_f32_16x16x32_bf16 v[148:151], a[112:115], a[32:35], 0
    v_mfma_f32_16x16x32_bf16 v[148:151], a[116:119], a[36:39], v[148:151]
    v_mfma_f32_16x16x32_bf16 v[148:151], a[120:123], a[40:43], v[148:151]
    v_mfma_f32_16x16x32_bf16 v[148:151], a[124:127], a[44:47], v[148:151]
    s_nop 3
    v_max3_f32 v184, v144, v145, v146
    s_nop 2
    v_max3_f32 v185, v148, v149, v150
    v_max3_f32 v184, v184, v147, v151
    v_max_f32 v184, v184, v185
    v_mov_b32 v185, v184
    s_nop 1
    v_permlane32_swap_b32 v185, v184
    v_max_f32 v184, v184, v185
    v_mov_b32 v185, v184
    s_nop 1
    v_permlane16_swap_b32 v185, v184
    v_max_f32 v184, v184, v185
    v_sub_f32 v208, 0, v184
    v_sub_f32 v209, 0, v184
    v_sub_f32 v210, 0, v184
    v_sub_f32 v211, 0, v184
    v_sub_f32 v144, v144, v184
    v_sub_f32 v145, v145, v184
    v_sub_f32 v146, v146, v184
    v_sub_f32 v147, v147, v184
    v_sub_f32 v148, v148, v184
    v_sub_f32 v149, v149, v184
    v_sub_f32 v150, v150, v184
    v_sub_f32 v151, v151, v184
    v_exp_f32 v144, v144
    v_exp_f32 v145, v145
    v_exp_f32 v146, v146
    v_cvt_pk_bf16_f32 v184, v144, v145
    v_exp_f32 v147, v147
    v_exp_f32 v148, v148
    v_cvt_pk_bf16_f32 v185, v146, v147
    v_exp_f32 v149, v149
    v_exp_f32 v150, v150
    v_cvt_pk_bf16_f32 v186, v148, v149
    v_exp_f32 v151, v151
    s_nop 0
    v_cvt_pk_bf16_f32 v187, v150, v151
    s_waitcnt vmcnt(4)
    ds_read_b128 v[16:19], v238 offset:13056
    ds_read_b128 v[20:23], v238 offset:13120
    ds_read_b128 v[24:27], v238 offset:13184
    ds_read_b128 v[28:31], v238 offset:13248
    s_add_u32 m0, s28, 33280
    s_waitcnt lgkmcnt(3)
    v_lshlrev_b32 v32, 16, v16
    v_and_b32 v33, s62, v16
    v_lshlrev_b32 v36, 16, v17
    v_and_b32 v37, s62, v17
    v_lshlrev_b32 v40, 16, v18
    v_and_b32 v41, s62, v18
    v_lshlrev_b32 v44, 16, v19
    v_and_b32 v45, s62, v19
    v_pk_mul_f32 v[32:33], v[32:33], s[60:61]
    v_pk_mul_f32 v[36:37], v[36:37], s[60:61]
    v_pk_mul_f32 v[40:41], v[40:41], s[60:61]
    v_pk_mul_f32 v[44:45], v[44:45], s[60:61]
    v_cvt_pk_bf16_f32 v35, v32, v33
    v_cvt_pk_bf16_f32 v39, v36, v37
    v_cvt_pk_bf16_f32 v43, v40, v41
    v_cvt_pk_bf16_f32 v47, v44, v45
    v_accvgpr_write_b32 a48, v35
    v_accvgpr_write_b32 a49, v39
    v_accvgpr_write_b32 a50, v43
    v_accvgpr_write_b32 a51, v47
    s_waitcnt lgkmcnt(2)
    v_lshlrev_b32 v48, 16, v20
    v_and_b32 v49, s62, v20
    v_lshlrev_b32 v52, 16, v21
    v_and_b32 v53, s62, v21
    v_lshlrev_b32 v56, 16, v22
    v_and_b32 v57, s62, v22
    v_lshlrev_b32 v60, 16, v23
    v_and_b32 v61, s62, v23
    v_pk_mul_f32 v[48:49], v[48:49], s[60:61]
    v_pk_mul_f32 v[52:53], v[52:53], s[60:61]
    v_pk_mul_f32 v[56:57], v[56:57], s[60:61]
    v_pk_mul_f32 v[60:61], v[60:61], s[60:61]
    v_cvt_pk_bf16_f32 v51, v48, v49
    v_cvt_pk_bf16_f32 v55, v52, v53
    v_cvt_pk_bf16_f32 v59, v56, v57
    v_cvt_pk_bf16_f32 v63, v60, v61
    s_waitcnt lgkmcnt(0)
    v_lshlrev_b32 v32, 16, v24
    v_and_b32 v33, s62, v24
    v_lshlrev_b32 v36, 16, v25
    v_and_b32 v37, s62, v25
    v_lshlrev_b32 v40, 16, v26
    v_and_b32 v41, s62, v26
    v_lshlrev_b32 v44, 16, v27
    v_and_b32 v45, s62, v27
    v_lshlrev_b32 v48, 16, v28
    v_and_b32 v49, s62, v28
    v_lshlrev_b32 v52, 16, v29
    v_and_b32 v53, s62, v29
    v_lshlrev_b32 v56, 16, v30
    v_and_b32 v57, s62, v30
    v_lshlrev_b32 v60, 16, v31
    v_and_b32 v61, s62, v31
    v_accvgpr_write_b32 a52, v51
    v_accvgpr_write_b32 a53, v55
    v_accvgpr_write_b32 a54, v59
    v_accvgpr_write_b32 a55, v63
    v_pk_mul_f32 v[32:33], v[32:33], s[60:61]
    v_pk_mul_f32 v[36:37], v[36:37], s[60:61]
    v_pk_mul_f32 v[40:41], v[40:41], s[60:61]
    v_pk_mul_f32 v[44:45], v[44:45], s[60:61]
    v_pk_mul_f32 v[48:49], v[48:49], s[60:61]
    v_pk_mul_f32 v[52:53], v[52:53], s[60:61]
    v_pk_mul_f32 v[56:57], v[56:57], s[60:61]
    v_pk_mul_f32 v[60:61], v[60:61], s[60:61]
    v_cvt_pk_bf16_f32 v35, v32, v33
    v_cvt_pk_bf16_f32 v39, v36, v37
    v_cvt_pk_bf16_f32 v43, v40, v41
    v_cvt_pk_bf16_f32 v47, v44, v45
    v_cvt_pk_bf16_f32 v51, v48, v49
    v_cvt_pk_bf16_f32 v55, v52, v53
    v_cvt_pk_bf16_f32 v59, v56, v57
    v_cvt_pk_bf16_f32 v63, v60, v61
    v_accvgpr_write_b32 a56, v35
    v_accvgpr_write_b32 a57, v39
    v_accvgpr_write_b32 a58, v43
    v_accvgpr_write_b32 a59, v47
    v_accvgpr_write_b32 a60, v51
    v_accvgpr_write_b32 a61, v55
    v_accvgpr_write_b32 a62, v59
    v_accvgpr_write_b32 a63, v63
    buffer_load_dwordx4 v236, s[12:15], s25 offen offset:2048 lds
    buffer_load_dwordx4 v237, s[12:15], s25 offen offset:3104 lds
    s_add_u32 s14, s10, 4096
    s_mov_b32 s25, s24
    buffer_load_dwordx4 v234, s[8:11], s24 offen lds
    buffer_load_dwordx4 v235, s[8:11], s24 offen offset:1024 lds
    s_add_u32 s24, s24, 131072
    s_sub_u32 s3, s3, 1
    v_mfma_f32_16x16x32_bf16 v[152:155], a[96:99], a[48:51], 0
    v_add_u32 v241, 16384, v239
    v_add_u32 v246, 32768, v239
    v_mfma_f32_16x16x32_bf16 v[152:155], a[100:103], a[52:55], v[152:155]
    v_add_u32 v247, 49152, v239
    v_mfma_f32_16x16x32_bf16 v[152:155], a[104:107], a[56:59], v[152:155]
    s_mov_b32 s70, s27
    v_mfma_f32_16x16x32_bf16 v[152:155], a[108:111], a[60:63], v[152:155]
    s_add_u32 s27, s27, 16640
    v_mfma_f32_16x16x32_bf16 v[156:159], a[112:115], a[48:51], 0
    s_cmp_eq_u32 s27, s29
    v_mfma_f32_16x16x32_bf16 v[156:159], a[116:119], a[52:55], v[156:159]
    s_cselect_b32 s27, s28, s27
    v_mfma_f32_16x16x32_bf16 v[156:159], a[120:123], a[56:59], v[156:159]
    s_waitcnt vmcnt(4)
    v_mfma_f32_16x16x32_bf16 v[156:159], a[124:127], a[60:63], v[156:159]
    s_barrier
    v_add_u32 v231, s27, v233
    ds_read_b64_tr_b16 a[128:129], v231 offset:0
    ds_read_b64_tr_b16 a[130:131], v231 offset:512
    ds_read_b64_tr_b16 a[132:133], v231 offset:32
    ds_read_b64_tr_b16 a[134:135], v231 offset:544
    ds_read_b64_tr_b16 a[136:137], v231 offset:64
    ds_read_b64_tr_b16 a[138:139], v231 offset:576
    ds_read_b64_tr_b16 a[140:141], v231 offset:96
    ds_read_b64_tr_b16 a[142:143], v231 offset:608
    ds_read_b64_tr_b16 a[144:145], v231 offset:128
    ds_read_b64_tr_b16 a[146:147], v231 offset:640
    ds_read_b64_tr_b16 a[148:149], v231 offset:160
    ds_read_b64_tr_b16 a[150:151], v231 offset:672
    ds_read_b64_tr_b16 a[152:153], v231 offset:192
    ds_read_b64_tr_b16 a[154:155], v231 offset:704
    ds_read_b64_tr_b16 a[156:157], v231 offset:224
    v_add_u32 v230, s27, v232
    ds_read_b64_tr_b16 a[158:159], v231 offset:736
    ds_read_b128 a[96:99], v230 offset:0
    ds_read_b128 a[100:103], v230 offset:64
    ds_read_b128 a[104:107], v230 offset:128
    ds_read_b128 a[108:111], v230 offset:192
    ds_read_b128 a[112:115], v230 offset:1024
    ds_read_b128 a[116:119], v230 offset:1088
    ds_read_b128 a[120:123], v230 offset:1152
    ds_read_b128 a[124:127], v230 offset:1216
    s_waitcnt lgkmcnt(15)
    v_mfma_f32_16x16x32_bf16 v[0:3], a[128:131], v[176:179], 0
    s_add_u32 m0, s28, 49920
    v_max3_f32 v188, v152, v153, v154
    v_max3_f32 v189, v156, v157, v158
    v_max3_f32 v188, v188, v155, v159
    v_mfma_f32_16x16x32_bf16 v[32:35], a[128:131], v[180:183], 0
    buffer_load_dwordx4 v236, s[12:15], s25 offen offset:2048 lds
    v_mfma_f32_16x16x32_bf16 a[228:231], a[224:227], v[176:179], 0
    buffer_load_dwordx4 v237, s[12:15], s25 offen offset:3104 lds
    v_mfma_f32_16x16x32_bf16 v[4:7], a[132:135], v[176:179], 0
    s_add_u32 s14, s10, 4096
    v_max_f32 v188, v188, v189
    v_mov_b32 v189, v188
    s_mov_b32 s25, s24
    v_mfma_f32_16x16x32_bf16 v[36:39], a[132:135], v[180:183], 0
    buffer_load_dwordx4 v234, s[8:11], s24 offen lds
    v_mfma_f32_16x16x32_bf16 v[8:11], a[136:139], v[176:179], 0
    buffer_load_dwordx4 v235, s[8:11], s24 offen offset:1024 lds
    v_mfma_f32_16x16x32_bf16 v[40:43], a[136:139], v[180:183], 0
    s_add_u32 s24, s24, 131072
    v_permlane32_swap_b32 v189, v188
    v_max_f32 v188, v188, v189
    v_mov_b32 v189, v188
    v_mfma_f32_16x16x32_bf16 v[12:15], a[140:143], v[176:179], 0
    s_sub_u32 s3, s3, 1
    v_permlane16_swap_b32 v189, v188
    v_max_f32 v188, v188, v189
    v_sub_f32 v212, 0, v188
    v_mfma_f32_16x16x32_bf16 v[44:47], a[140:143], v[180:183], 0
    s_waitcnt lgkmcnt(0)
    v_sub_f32 v213, 0, v188
    v_sub_f32 v214, 0, v188
    v_sub_f32 v215, 0, v188
    v_mfma_f32_16x16x32_bf16 v[16:19], a[144:147], v[176:179], 0
    s_add_u32 m0, s28, 66560
    v_sub_f32 v152, v152, v188
    v_sub_f32 v153, v153, v188
    v_sub_f32 v154, v154, v188
    v_mfma_f32_16x16x32_bf16 v[48:51], a[144:147], v[180:183], 0
    buffer_load_dwordx4 v236, s[12:15], s25 offen offset:2048 lds
    v_mfma_f32_16x16x32_bf16 v[20:23], a[148:151], v[176:179], 0
    buffer_load_dwordx4 v237, s[12:15], s25 offen offset:3104 lds
    v_mfma_f32_16x16x32_bf16 v[52:55], a[148:151], v[180:183], 0
    s_add_u32 s14, s10, 4096
    v_sub_f32 v155, v155, v188
    v_sub_f32 v156, v156, v188
    v_sub_f32 v157, v157, v188
    v_mfma_f32_16x16x32_bf16 v[24:27], a[152:155], v[176:179], 0
    s_mov_b32 s25, s24
    buffer_load_dwordx4 v234, s[8:11], s24 offen lds
    v_mfma_f32_16x16x32_bf16 v[56:59], a[152:155], v[180:183], 0
    buffer_load_dwordx4 v235, s[8:11], s24 offen offset:1024 lds
    v_mfma_f32_16x16x32_bf16 v[28:31], a[156:159], v[176:179], 0
    s_add_u32 s24, s24, 131072
    v_sub_f32 v158, v158, v188
    v_sub_f32 v159, v159, v188
    s_sub_u32 s3, s3, 1
    v_mfma_f32_16x16x32_bf16 v[60:63], a[156:159], v[180:183], 0
    s_mov_b32 s18, s31
    v_exp_f32 v152, v152
    s_mov_b32 m0, s70
    v_mfma_f32_16x16x32_bf16 v[128:131], a[96:99], a[0:3], v[200:203]
    buffer_load_dwordx4 v236, s[12:15], s25 offen offset:2048 lds
    v_mfma_f32_16x16x32_bf16 v[128:131], a[100:103], a[4:7], v[128:131]
    s_mov_b32 m0, s70
    v_mov_b32 v227, v152
    v_exp_f32 v153, v153
    v_mfma_f32_16x16x32_bf16 v[128:131], a[104:107], a[8:11], v[128:131]
    buffer_load_dwordx4 v237, s[12:15], s25 offen offset:3104 lds
    v_mfma_f32_16x16x32_bf16 v[128:131], a[108:111], a[12:15], v[128:131]
    s_add_u32 s14, s10, 4096
    v_add_f32 v227, v227, v153
    v_cvt_pk_bf16_f32 v188, v152, v153
    s_mov_b32 s25, s24
    v_mfma_f32_16x16x32_bf16 v[132:135], a[112:115], a[0:3], v[200:203]
    s_mov_b32 m0, s70
    v_exp_f32 v154, v154
    v_mfma_f32_16x16x32_bf16 v[132:135], a[116:119], a[4:7], v[132:135]
    buffer_load_dwordx4 v234, s[8:11], s24 offen lds
    v_mfma_f32_16x16x32_bf16 v[132:135], a[120:123], a[8:11], v[132:135]
    s_mov_b32 m0, s70
    v_add_f32 v227, v227, v154
    v_exp_f32 v155, v155
    v_mfma_f32_16x16x32_bf16 v[132:135], a[124:127], a[12:15], v[132:135]
    buffer_load_dwordx4 v235, s[8:11], s24 offen offset:1024 lds
    v_mfma_f32_16x16x32_bf16 v[136:139], a[96:99], a[16:19], v[204:207]
    s_add_u32 s24, s24, 131072
    v_add_f32 v227, v227, v155
    v_cvt_pk_bf16_f32 v189, v154, v155
    s_sub_u32 s3, s3, 1
    v_mfma_f32_16x16x32_bf16 v[136:139], a[100:103], a[20:23], v[136:139]
    s_mov_b32 s70, s27
    v_exp_f32 v156, v156
    s_add_u32 s27, s27, 16640
    v_mfma_f32_16x16x32_bf16 v[136:139], a[104:107], a[24:27], v[136:139]
    s_cmp_eq_u32 s27, s29
    v_add_f32 v227, v227, v156
    v_exp_f32 v157, v157
    v_mfma_f32_16x16x32_bf16 v[136:139], a[108:111], a[28:31], v[136:139]
    s_cselect_b32 s27, s28, s27
    v_add_f32 v227, v227, v157
    v_cvt_pk_bf16_f32 v190, v156, v157
    s_waitcnt vmcnt(12)
    v_mfma_f32_16x16x32_bf16 v[140:143], a[112:115], a[16:19], v[204:207]
    s_barrier
    v_mfma_f32_16x16x32_bf16 v[140:143], a[116:119], a[20:23], v[140:143]
    s_mov_b32 m0, s70
    v_exp_f32 v158, v158
    v_add_u32 v231, s27, v233
    v_mfma_f32_16x16x32_bf16 v[140:143], a[120:123], a[24:27], v[140:143]
    buffer_load_dwordx4 v236, s[12:15], s25 offen offset:2048 lds
    v_mfma_f32_16x16x32_bf16 v[140:143], a[124:127], a[28:31], v[140:143]
    v_add_f32 v227, v227, v158
    v_exp_f32 v159, v159
    v_mfma_f32_16x16x32_bf16 v[64:67], a[128:131], v[184:187], 0
    v_add_f32 v227, v227, v159
    v_cvt_pk_bf16_f32 v191, v158, v159
    v_add_u32 v230, s27, v232
    s_nop 0
    v_mfma_f32_16x16x32_bf16 v[96:99], a[128:131], v[188:191], 0
    ds_read_b64_tr_b16 a[128:129], v231 offset:0
    v_exp_f32 v128, v128
    v_mfma_f32_16x16x32_bf16 a[236:239], a[224:227], v[184:187], 0
    ds_read_b64_tr_b16 a[130:131], v231 offset:512
    v_exp_f32 v129, v129
    v_mfma_f32_16x16x32_bf16 v[68:71], a[132:135], v[184:187], 0
    v_cvt_pk_bf16_f32 v176, v128, v129
    v_exp_f32 v131, v131
    v_mfma_f32_16x16x32_bf16 v[100:103], a[132:135], v[188:191], 0
    ds_read_b64_tr_b16 a[132:133], v231 offset:32
    v_exp_f32 v130, v130
    v_mfma_f32_16x16x32_bf16 v[72:75], a[136:139], v[184:187], 0
    v_exp_f32 v132, v132
    v_mfma_f32_16x16x32_bf16 v[104:107], a[136:139], v[188:191], 0
    s_mov_b32 m0, s70
    v_cvt_pk_bf16_f32 v177, v130, v131
    v_exp_f32 v133, v133
    v_mfma_f32_16x16x32_bf16 v[76:79], a[140:143], v[184:187], 0
    buffer_load_dwordx4 v237, s[12:15], s25 offen offset:3104 lds
    v_mfma_f32_16x16x32_bf16 v[108:111], a[140:143], v[188:191], 0
    s_add_u32 s14, s10, 4096
    v_cvt_pk_bf16_f32 v178, v132, v133
    v_exp_f32 v134, v134
    v_mfma_f32_16x16x32_bf16 v[80:83], a[144:147], v[184:187], 0
    s_mov_b32 s25, s24
    v_exp_f32 v135, v135
    v_mfma_f32_16x16x32_bf16 v[112:115], a[144:147], v[188:191], 0
    ds_read_b64_tr_b16 a[134:135], v231 offset:544
    v_cvt_pk_bf16_f32 v179, v134, v135
    v_mfma_f32_16x16x32_bf16 v[84:87], a[148:151], v[184:187], 0
    v_exp_f32 v136, v136
    v_mfma_f32_16x16x32_bf16 v[116:119], a[148:151], v[188:191], 0
    ds_read_b64_tr_b16 a[136:137], v231 offset:64
    v_add_f32 v225, v225, v136
    v_mfma_f32_16x16x32_bf16 v[88:91], a[152:155], v[184:187], 0
    v_exp_f32 v137, v137
    v_mfma_f32_16x16x32_bf16 v[120:123], a[152:155], v[188:191], 0
    v_cvt_pk_bf16_f32 v180, v136, v137
    v_add_f32 v225, v225, v137
    v_mfma_f32_16x16x32_bf16 v[92:95], a[156:159], v[184:187], 0
    s_mov_b32 m0, s70
    v_exp_f32 v138, v138
    v_mfma_f32_16x16x32_bf16 v[124:127], a[156:159], v[188:191], 0
    ds_read_b64_tr_b16 a[138:139], v231 offset:576
    v_add_f32 v225, v225, v138
    ds_read_b64_tr_b16 a[140:141], v231 offset:96
    ds_read_b64_tr_b16 a[142:143], v231 offset:608
    ds_read_b64_tr_b16 a[144:145], v231 offset:128
    ds_read_b64_tr_b16 a[146:147], v231 offset:640
    v_exp_f32 v139, v139
    v_exp_f32 v140, v140
    v_add_f32 v225, v225, v139
    v_cvt_pk_bf16_f32 v181, v138, v139
    v_exp_f32 v141, v141
    s_branch L_loop4
L_first5:
    s_mov_b32 s39, s34
    s_sub_u32 s26, s37, 4
    s_mov_b32 s91, 0
    s_mov_b32 s4, s31
    s_lshl_b32 s5, s64, 14
    s_add_u32 s5, s5, s34
    s_cmp_le_u32 s38, 16
    s_cselect_b32 s71, 8, 0
    s_mov_b32 s22, s4
    s_mov_b32 s33, s5
    v_sub_u32 v244, s38, v240
    s_and_b32 s4, s73, 0x1fff
    s_bfe_u32 s38, s73, 655373
    s_bfe_u32 s36, s73, 196635
    s_bfe_u32 s5, s73, 262167
    s_add_u32 s31, s4, s38
    s_lshl_b32 s31, s31, 12
    s_lshl4_add_u32 s4, s4, s65
    s_lshl_b32 s30, s4, 8
    s_mul_i32 s6, s36, s64
    s_lshl2_add_u32 s5, s5, s6
    s_lshl_b32 s5, s5, 2
    s_sub_u32 s5, s5, s64
    s_lshl_b32 s5, s5, 14
    s_add_u32 s34, s30, s5
    s_add_u32 s37, s38, 31
    s_lshr_b32 s37, s37, 5
    s_sub_u32 s38, s38, 1
    s_and_b32 s38, s38, 31
    s_add_u32 s38, s38, 1
    s_cmp_eq_u32 s36, 0
    s_cselect_b32 s30, 0x40000000, s30
    s_cmp_lg_u32 s36, 0
    s_cselect_b32 s6, 0, 0
    s_sub_u32 s26, s26, s6
    s_add_u32 s71, s71, s36
    s_lshl_b32 s94, s36, 1
    s_sub_u32 s91, s26, s94
    s_sub_u32 s91, s91, 4
    s_sub_u32 s94, s94, 1
    s_cmp_lg_u32 s36, 0
    s_cselect_b32 s26, 4, s26
    s_cselect_b32 s91, s91, 0
    s_mov_b32 s92, s32
    s_mov_b32 s93, s34
    s_waitcnt vmcnt(2)
    ds_read_b128 v[0:3], v238 offset:0
    s_add_u32 m0, s32, 4352
    ds_read_b128 v[4:7], v238 offset:64
    s_add_u32 s35, s39, 65536
    buffer_load_dwordx4 v234, s[16:19], s35 offen offset:0 lds
    s_add_u32 s35, s39, 80832
    ds_read_b128 v[8:11], v238 offset:128
    ds_read_b128 v[12:15], v238 offset:192
    v_cmp_gt_i32 s[40:41], v244, 0
    v_cmp_gt_i32 s[42:43], v244, 1
    v_cmp_gt_i32 s[44:45], v244, 2
    v_cmp_gt_i32 s[46:47], v244, 3
    v_cmp_gt_i32 s[48:49], v244, 16
    v_cmp_gt_i32 s[50:51], v244, 17
    v_cmp_gt_i32 s[52:53], v244, 18
    v_cmp_gt_i32 s[54:55], v244, 19
    v_add_u32 v246, 33280, v247
    s_waitcnt lgkmcnt(3)
    v_lshlrev_b32 v32, 16, v0
    v_and_b32 v33, s62, v0
    v_pk_mul_f32 v[32:33], v[32:33], s[60:61]
    v_cvt_pk_bf16_f32 v35, v32, v33
    v_lshlrev_b32 v36, 16, v1
    v_and_b32 v37, s62, v1
    v_accvgpr_write_b32 a0, v35
    v_pk_mul_f32 v[36:37], v[36:37], s[60:61]
    v_lshlrev_b32 v40, 16, v2
    v_and_b32 v41, s62, v2
    buffer_load_dwordx4 v234, s[16:19], s35 offen offset:1088 lds
    v_pk_mul_f32 v[40:41], v[40:41], s[60:61]
    v_cvt_pk_bf16_f32 v39, v36, v37
    v_cvt_pk_bf16_f32 v43, v40, v41
    v_accvgpr_write_b32 a1, v39
    v_accvgpr_write_b32 a2, v43
    v_lshlrev_b32 v44, 16, v3
    s_add_u32 s35, s39, 96128
    v_and_b32 v45, s62, v3
    buffer_load_dwordx4 v234, s[16:19], s35 offen offset:2176 lds
    v_pk_mul_f32 v[44:45], v[44:45], s[60:61]
    s_waitcnt lgkmcnt(0)
    v_lshlrev_b32 v48, 16, v4
    v_and_b32 v49, s62, v4
    v_cvt_pk_bf16_f32 v47, v44, v45
    v_pk_mul_f32 v[48:49], v[48:49], s[60:61]
    v_accvgpr_write_b32 a3, v47
    v_cvt_pk_bf16_f32 v51, v48, v49
    s_add_u32 s35, s39, 111424
    v_lshlrev_b32 v52, 16, v5
    v_and_b32 v53, s62, v5
    v_lshlrev_b32 v56, 16, v6
    v_and_b32 v57, s62, v6
    v_lshlrev_b32 v60, 16, v7
    v_and_b32 v61, s62, v7
    v_pk_mul_f32 v[52:53], v[52:53], s[60:61]
    v_pk_mul_f32 v[56:57], v[56:57], s[60:61]
    v_pk_mul_f32 v[60:61], v[60:61], s[60:61]
    v_cvt_pk_bf16_f32 v55, v52, v53
    v_cvt_pk_bf16_f32 v59, v56, v57
    v_cvt_pk_bf16_f32 v63, v60, v61
    buffer_load_dwordx4 v234, s[16:19], s35 offen offset:3264 lds
    v_accvgpr_write_b32 a4, v51
    v_accvgpr_write_b32 a5, v55
    v_accvgpr_write_b32 a6, v59
    v_accvgpr_write_b32 a7, v63
    s_waitcnt vmcnt(4)
    s_barrier
    ds_read_b128 a[96:99], v230 offset:0
    ds_read_b128 a[100:103], v230 offset:64
    ds_read_b128 a[104:107], v230 offset:128
    v_lshlrev_b32 v56, 16, v14
    v_and_b32 v57, s62, v14
    v_lshlrev_b32 v60, 16, v15
    v_and_b32 v61, s62, v15
    ds_read_b128 a[108:111], v230 offset:192
    v_pk_mul_f32 v[56:57], v[56:57], s[60:61]
    v_pk_mul_f32 v[60:61], v[60:61], s[60:61]
    ds_read_b128 a[112:115], v230 offset:1024
    v_cvt_pk_bf16_f32 v59, v56, v57
    v_cvt_pk_bf16_f32 v63, v60, v61
    ds_read_b128 a[116:119], v230 offset:1088
    v_accvgpr_write_b32 a14, v59
    v_accvgpr_write_b32 a15, v63
    ds_read_b128 a[120:123], v230 offset:1152
    ds_read_b128 a[124:127], v230 offset:1216
    v_lshlrev_b32 v32, 16, v8
    v_and_b32 v33, s62, v8
    v_pk_mul_f32 v[32:33], v[32:33], s[60:61]
    v_cvt_pk_bf16_f32 v35, v32, v33
    v_lshlrev_b32 v36, 16, v9
    v_and_b32 v37, s62, v9
    v_pk_mul_f32 v[36:37], v[36:37], s[60:61]
    v_accvgpr_write_b32 a8, v35
    v_cvt_pk_bf16_f32 v39, v36, v37
    v_lshlrev_b32 v40, 16, v10
    v_and_b32 v41, s62, v10
    v_pk_mul_f32 v[40:41], v[40:41], s[60:61]
    v_cvt_pk_bf16_f32 v43, v40, v41
    v_lshlrev_b32 v44, 16, v11
    v_and_b32 v45, s62, v11
    v_accvgpr_write_b32 a9, v39
    v_accvgpr_write_b32 a10, v43
    v_pk_mul_f32 v[44:45], v[44:45], s[60:61]
    v_cvt_pk_bf16_f32 v47, v44, v45
    v_lshlrev_b32 v48, 16, v12
    v_and_b32 v49, s62, v12
    v_pk_mul_f32 v[48:49], v[48:49], s[60:61]
    v_cvt_pk_bf16_f32 v51, v48, v49
    v_accvgpr_write_b32 a11, v47
    v_accvgpr_write_b32 a12, v51
    v_lshlrev_b32 v52, 16, v13
    v_and_b32 v53, s62, v13
    v_pk_mul_f32 v[52:53], v[52:53], s[60:61]
    v_cvt_pk_bf16_f32 v55, v52, v53
    v_accvgpr_write_b32 a13, v55
    s_waitcnt lgkmcnt(0)
    v_mfma_f32_16x16x32_bf16 v[128:131], a[96:99], a[0:3], 0
    v_mfma_f32_16x16x32_bf16 v[128:131], a[100:103], a[4:7], v[128:131]
    v_mfma_f32_16x16x32_bf16 v[128:131], a[104:107], a[8:11], v[128:131]
    v_mfma_f32_16x16x32_bf16 v[128:131], a[108:111], a[12:15], v[128:131]
    v_mfma_f32_16x16x32_bf16 v[132:135], a[112:115], a[0:3], 0
    v_mfma_f32_16x16x32_bf16 v[132:135], a[116:119], a[4:7], v[132:135]
    v_mfma_f32_16x16x32_bf16 v[132:135], a[120:123], a[8:11], v[132:135]
    v_mfma_f32_16x16x32_bf16 v[132:135], a[124:127], a[12:15], v[132:135]
    s_nop 3
    v_max3_f32 v176, v128, v129, v130
    s_nop 2
    v_max3_f32 v177, v132, v133, v134
    v_max3_f32 v176, v176, v131, v135
    v_max_f32 v176, v176, v177
    v_mov_b32 v177, v176
    s_nop 1
    v_permlane32_swap_b32 v177, v176
    v_max_f32 v176, v176, v177
    v_mov_b32 v177, v176
    s_nop 1
    v_permlane16_swap_b32 v177, v176
    v_max_f32 v176, v176, v177
    v_sub_f32 v200, 0, v176
    v_sub_f32 v201, 0, v176
    v_sub_f32 v202, 0, v176
    v_sub_f32 v203, 0, v176
    v_sub_f32 v128, v128, v176
    v_sub_f32 v129, v129, v176
    v_sub_f32 v130, v130, v176
    v_sub_f32 v131, v131, v176
    v_sub_f32 v132, v132, v176
    v_sub_f32 v133, v133, v176
    v_sub_f32 v134, v134, v176
    v_sub_f32 v135, v135, v176
    v_exp_f32 v128, v128
    v_exp_f32 v129, v129
    v_mov_b32 v224, v128
    v_add_f32 v224, v224, v129
    v_cvt_pk_bf16_f32 v176, v128, v129
    v_exp_f32 v130, v130
    v_exp_f32 v131, v131
    v_add_f32 v224, v224, v130
    v_add_f32 v224, v224, v131
    v_cvt_pk_bf16_f32 v177, v130, v131
    v_exp_f32 v132, v132
    v_exp_f32 v133, v133
    v_add_f32 v224, v224, v132
    v_add_f32 v224, v224, v133
    v_cvt_pk_bf16_f32 v178, v132, v133
    v_exp_f32 v134, v134
    v_exp_f32 v135, v135
    v_add_f32 v224, v224, v134
    v_add_f32 v224, v224, v135
    v_cvt_pk_bf16_f32 v179, v134, v135
    s_waitcnt vmcnt(0)
    ds_read_b128 v[16:19], v238 offset:4352
    ds_read_b128 v[20:23], v238 offset:4416
    s_add_u32 m0, s32, 8704
    ds_read_b128 v[24:27], v238 offset:4480
    s_add_u32 s35, s39, 131072
    ds_read_b128 v[28:31], v238 offset:4544
    buffer_load_dwordx4 v234, s[16:19], s35 offen offset:0 lds
    s_add_u32 s35, s39, 146368
    s_waitcnt lgkmcnt(3)
    v_lshlrev_b32 v32, 16, v16
    v_and_b32 v33, s62, v16
    v_pk_mul_f32 v[32:33], v[32:33], s[60:61]
    v_cvt_pk_bf16_f32 v35, v32, v33
    v_lshlrev_b32 v36, 16, v17
    v_and_b32 v37, s62, v17
    v_accvgpr_write_b32 a16, v35
    v_pk_mul_f32 v[36:37], v[36:37], s[60:61]
    v_lshlrev_b32 v40, 16, v18
    v_and_b32 v41, s62, v18
    buffer_load_dwordx4 v234, s[16:19], s35 offen offset:1088 lds
    v_pk_mul_f32 v[40:41], v[40:41], s[60:61]
    v_cvt_pk_bf16_f32 v39, v36, v37
    v_cvt_pk_bf16_f32 v43, v40, v41
    v_accvgpr_write_b32 a17, v39
    v_accvgpr_write_b32 a18, v43
    v_lshlrev_b32 v44, 16, v19
    s_add_u32 s35, s39, 161664
    v_and_b32 v45, s62, v19
    s_waitcnt lgkmcnt(2)
    v_lshlrev_b32 v56, 16, v22
    v_and_b32 v57, s62, v22
    v_lshlrev_b32 v60, 16, v23
    v_and_b32 v61, s62, v23
    buffer_load_dwordx4 v234, s[16:19], s35 offen offset:2176 lds
    v_pk_mul_f32 v[44:45], v[44:45], s[60:61]
    v_lshlrev_b32 v48, 16, v20
    v_and_b32 v49, s62, v20
    v_pk_mul_f32 v[56:57], v[56:57], s[60:61]
    v_pk_mul_f32 v[60:61], v[60:61], s[60:61]
    v_cvt_pk_bf16_f32 v47, v44, v45
    v_pk_mul_f32 v[48:49], v[48:49], s[60:61]
    v_cvt_pk_bf16_f32 v59, v56, v57
    v_cvt_pk_bf16_f32 v63, v60, v61
    v_accvgpr_write_b32 a19, v47
    v_cvt_pk_bf16_f32 v51, v48, v49
    s_add_u32 s35, s39, 176960
    s_waitcnt lgkmcnt(0)
    v_lshlrev_b32 v56, 16, v30
    v_and_b32 v57, s62, v30
    v_lshlrev_b32 v60, 16, v31
    v_and_b32 v61, s62, v31
    v_accvgpr_write_b32 a22, v59
    v_accvgpr_write_b32 a23, v63
    v_pk_mul_f32 v[56:57], v[56:57], s[60:61]
    v_pk_mul_f32 v[60:61], v[60:61], s[60:61]
    v_cvt_pk_bf16_f32 v59, v56, v57
    v_cvt_pk_bf16_f32 v63, v60, v61
    buffer_load_dwordx4 v234, s[16:19], s35 offen offset:3264 lds
    v_accvgpr_write_b32 a30, v59
    v_accvgpr_write_b32 a31, v63
    v_lshlrev_b32 v32, 16, v24
    v_and_b32 v33, s62, v24
    v_pk_mul_f32 v[32:33], v[32:33], s[60:61]
    v_cvt_pk_bf16_f32 v35, v32, v33
    v_lshlrev_b32 v36, 16, v25
    v_and_b32 v37, s62, v25
    v_pk_mul_f32 v[36:37], v[36:37], s[60:61]
    v_accvgpr_write_b32 a24, v35
    v_cvt_pk_bf16_f32 v39, v36, v37
    v_lshlrev_b32 v40, 16, v26
    v_and_b32 v41, s62, v26
    v_pk_mul_f32 v[40:41], v[40:41], s[60:61]
    v_lshlrev_b32 v52, 16, v21
    v_and_b32 v53, s62, v21
    v_cvt_pk_bf16_f32 v43, v40, v41
    v_pk_mul_f32 v[52:53], v[52:53], s[60:61]
    v_lshlrev_b32 v44, 16, v27
    v_and_b32 v45, s62, v27
    v_cvt_pk_bf16_f32 v55, v52, v53
    v_accvgpr_write_b32 a25, v39
    v_accvgpr_write_b32 a26, v43
    v_pk_mul_f32 v[44:45], v[44:45], s[60:61]
    v_cvt_pk_bf16_f32 v47, v44, v45
    v_lshlrev_b32 v48, 16, v28
    v_and_b32 v49, s62, v28
    v_lshlrev_b32 v52, 16, v29
    v_and_b32 v53, s62, v29
    v_accvgpr_write_b32 a20, v51
    v_accvgpr_write_b32 a21, v55
    v_pk_mul_f32 v[48:49], v[48:49], s[60:61]
    v_pk_mul_f32 v[52:53], v[52:53], s[60:61]
    v_cvt_pk_bf16_f32 v51, v48, v49
    v_cvt_pk_bf16_f32 v55, v52, v53
    v_accvgpr_write_b32 a27, v47
    v_accvgpr_write_b32 a28, v51
    v_accvgpr_write_b32 a29, v55
    v_mfma_f32_16x16x32_bf16 v[136:139], a[96:99], a[16:19], 0
    v_mfma_f32_16x16x32_bf16 v[136:139], a[100:103], a[20:23], v[136:139]
    v_mfma_f32_16x16x32_bf16 v[136:139], a[104:107], a[24:27], v[136:139]
    v_mfma_f32_16x16x32_bf16 v[136:139], a[108:111], a[28:31], v[136:139]
    v_mfma_f32_16x16x32_bf16 v[140:143], a[112:115], a[16:19], 0
    v_mfma_f32_16x16x32_bf16 v[140:143], a[116:119], a[20:23], v[140:143]
    v_mfma_f32_16x16x32_bf16 v[140:143], a[120:123], a[24:27], v[140:143]
    v_mfma_f32_16x16x32_bf16 v[140:143], a[124:127], a[28:31], v[140:143]
    s_nop 3
    v_max3_f32 v180, v136, v137, v138
    s_nop 2
    v_max3_f32 v181, v140, v141, v142
    v_max3_f32 v180, v180, v139, v143
    v_max_f32 v180, v180, v181
    v_mov_b32 v181, v180
    s_nop 1
    v_permlane32_swap_b32 v181, v180
    v_max_f32 v180, v180, v181
    v_mov_b32 v181, v180
    s_nop 1
    v_permlane16_swap_b32 v181, v180
    v_max_f32 v180, v180, v181
    v_sub_f32 v204, 0, v180
    v_sub_f32 v205, 0, v180
    v_sub_f32 v206, 0, v180
    v_sub_f32 v207, 0, v180
    v_sub_f32 v136, v136, v180
    v_sub_f32 v137, v137, v180
    v_sub_f32 v138, v138, v180
    v_sub_f32 v139, v139, v180
    v_sub_f32 v140, v140, v180
    v_sub_f32 v141, v141, v180
    v_sub_f32 v142, v142, v180
    v_sub_f32 v143, v143, v180
    v_exp_f32 v136, v136
    v_exp_f32 v137, v137
    v_mov_b32 v225, v136
    v_add_f32 v225, v225, v137
    v_cvt_pk_bf16_f32 v180, v136, v137
    v_exp_f32 v138, v138
    v_exp_f32 v139, v139
    v_add_f32 v225, v225, v138
    v_add_f32 v225, v225, v139
    v_cvt_pk_bf16_f32 v181, v138, v139
    v_exp_f32 v140, v140
    v_exp_f32 v141, v141
    v_add_f32 v225, v225, v140
    v_add_f32 v225, v225, v141
    v_cvt_pk_bf16_f32 v182, v140, v141
    v_exp_f32 v142, v142
    v_exp_f32 v143, v143
    v_add_f32 v225, v225, v142
    v_add_f32 v225, v225, v143
    v_cvt_pk_bf16_f32 v183, v142, v143
    s_waitcnt vmcnt(0)
    ds_read_b128 v[0:3], v238 offset:8704
    ds_read_b128 v[4:7], v238 offset:8768
    s_add_u32 m0, s32, 13056
    ds_read_b128 v[8:11], v238 offset:8832
    s_add_u32 s35, s39, 196608
    ds_read_b128 v[12:15], v238 offset:8896
    buffer_load_dwordx4 v234, s[16:19], s35 offen offset:0 lds
    s_add_u32 s35, s39, 211904
    s_waitcnt lgkmcnt(3)
    v_lshlrev_b32 v32, 16, v0
    v_and_b32 v33, s62, v0
    v_pk_mul_f32 v[32:33], v[32:33], s[60:61]
    v_cvt_pk_bf16_f32 v35, v32, v33
    v_lshlrev_b32 v36, 16, v1
    v_and_b32 v37, s62, v1
    v_accvgpr_write_b32 a32, v35
    v_pk_mul_f32 v[36:37], v[36:37], s[60:61]
    v_lshlrev_b32 v40, 16, v2
    v_and_b32 v41, s62, v2
    buffer_load_dwordx4 v234, s[16:19], s35 offen offset:1088 lds
    v_pk_mul_f32 v[40:41], v[40:41], s[60:61]
    v_cvt_pk_bf16_f32 v39, v36, v37
    v_cvt_pk_bf16_f32 v43, v40, v41
    v_accvgpr_write_b32 a33, v39
    v_accvgpr_write_b32 a34, v43
    v_lshlrev_b32 v44, 16, v3
    s_add_u32 s35, s39, 227200
    v_and_b32 v45, s62, v3
    s_waitcnt lgkmcnt(2)
    v_lshlrev_b32 v48, 16, v4
    v_and_b32 v49, s62, v4
    v_lshlrev_b32 v52, 16, v5
    v_and_b32 v53, s62, v5
    v_lshlrev_b32 v56, 16, v6
    v_and_b32 v57, s62, v6
    v_lshlrev_b32 v60, 16, v7
    v_and_b32 v61, s62, v7
    buffer_load_dwordx4 v234, s[16:19], s35 offen offset:2176 lds
    v_pk_mul_f32 v[44:45], v[44:45], s[60:61]
    v_pk_mul_f32 v[48:49], v[48:49], s[60:61]
    v_pk_mul_f32 v[52:53], v[52:53], s[60:61]
    v_pk_mul_f32 v[56:57], v[56:57], s[60:61]
    v_pk_mul_f32 v[60:61], v[60:61], s[60:61]
    v_cvt_pk_bf16_f32 v47, v44, v45
    v_cvt_pk_bf16_f32 v51, v48, v49
    v_cvt_pk_bf16_f32 v55, v52, v53
    v_cvt_pk_bf16_f32 v59, v56, v57
    v_cvt_pk_bf16_f32 v63, v60, v61
    v_accvgpr_write_b32 a35, v47
    s_add_u32 s35, s39, 242496
    s_waitcnt lgkmcnt(0)
    v_lshlrev_b32 v48, 16, v12
    v_and_b32 v49, s62, v12
    v_lshlrev_b32 v52, 16, v13
    v_and_b32 v53, s62, v13
    v_lshlrev_b32 v56, 16, v14
    v_and_b32 v57, s62, v14
    v_lshlrev_b32 v60, 16, v15
    v_and_b32 v61, s62, v15
    v_accvgpr_write_b32 a36, v51
    v_accvgpr_write_b32 a37, v55
    v_accvgpr_write_b32 a38, v59
    v_accvgpr_write_b32 a39, v63
    v_pk_mul_f32 v[48:49], v[48:49], s[60:61]
    v_pk_mul_f32 v[52:53], v[52:53], s[60:61]
    v_pk_mul_f32 v[56:57], v[56:57], s[60:61]
    v_pk_mul_f32 v[60:61], v[60:61], s[60:61]
    v_cvt_pk_bf16_f32 v51, v48, v49
    v_cvt_pk_bf16_f32 v55, v52, v53
    v_cvt_pk_bf16_f32 v59, v56, v57
    v_cvt_pk_bf16_f32 v63, v60, v61
    buffer_load_dwordx4 v234, s[16:19], s35 offen offset:3264 lds
    v_accvgpr_write_b32 a44, v51
    v_accvgpr_write_b32 a45, v55
    v_accvgpr_write_b32 a46, v59
    v_accvgpr_write_b32 a47, v63
    v_lshlrev_b32 v32, 16, v8
    v_and_b32 v33, s62, v8
    v_pk_mul_f32 v[32:33], v[32:33], s[60:61]
    v_cvt_pk_bf16_f32 v35, v32, v33
    v_lshlrev_b32 v36, 16, v9
    v_and_b32 v37, s62, v9
    v_pk_mul_f32 v[36:37], v[36:37], s[60:61]
    v_accvgpr_write_b32 a40, v35
    v_cvt_pk_bf16_f32 v39, v36, v37
    v_lshlrev_b32 v40, 16, v10
    v_and_b32 v41, s62, v10
    v_pk_mul_f32 v[40:41], v[40:41], s[60:61]
    v_cvt_pk_bf16_f32 v43, v40, v41
    v_lshlrev_b32 v44, 16, v11
    v_and_b32 v45, s62, v11
    v_accvgpr_write_b32 a41, v39
    v_accvgpr_write_b32 a42, v43
    v_pk_mul_f32 v[44:45], v[44:45], s[60:61]
    v_cvt_pk_bf16_f32 v47, v44, v45
    v_accvgpr_write_b32 a43, v47
    v_mfma_f32_16x16x32_bf16 v[144:147], a[96:99], a[32:35], 0
    v_mfma_f32_16x16x32_bf16 v[144:147], a[100:103], a[36:39], v[144:147]
    v_mfma_f32_16x16x32_bf16 v[144:147], a[104:107], a[40:43], v[144:147]
    v_mfma_f32_16x16x32_bf16 v[144:147], a[108:111], a[44:47], v[144:147]
    v_mfma_f32_16x16x32_bf16 v[148:151], a[112:115], a[32:35], 0
    v_mfma_f32_16x16x32_bf16 v[148:151], a[116:119], a[36:39], v[148:151]
    v_mfma_f32_16x16x32_bf16 v[148:151], a[120:123], a[40:43], v[148:151]
    v_mfma_f32_16x16x32_bf16 v[148:151], a[124:127], a[44:47], v[148:151]
    s_nop 3
    v_max3_f32 v184, v144, v145, v146
    s_nop 2
    v_max3_f32 v185, v148, v149, v150
    v_max3_f32 v184, v184, v147, v151
    v_max_f32 v184, v184, v185
    v_mov_b32 v185, v184
    s_nop 1
    v_permlane32_swap_b32 v185, v184
    v_max_f32 v184, v184, v185
    v_mov_b32 v185, v184
    s_nop 1
    v_permlane16_swap_b32 v185, v184
    v_max_f32 v184, v184, v185
    v_sub_f32 v208, 0, v184
    v_sub_f32 v209, 0, v184
    v_sub_f32 v210, 0, v184
    v_sub_f32 v211, 0, v184
    v_sub_f32 v144, v144, v184
    v_sub_f32 v145, v145, v184
    v_sub_f32 v146, v146, v184
    v_sub_f32 v147, v147, v184
    v_sub_f32 v148, v148, v184
    v_sub_f32 v149, v149, v184
    v_sub_f32 v150, v150, v184
    v_sub_f32 v151, v151, v184
    v_exp_f32 v144, v144
    v_exp_f32 v145, v145
    v_exp_f32 v146, v146
    v_cvt_pk_bf16_f32 v184, v144, v145
    v_exp_f32 v147, v147
    v_exp_f32 v148, v148
    v_cvt_pk_bf16_f32 v185, v146, v147
    v_exp_f32 v149, v149
    v_exp_f32 v150, v150
    v_cvt_pk_bf16_f32 v186, v148, v149
    v_exp_f32 v151, v151
    s_nop 0
    v_cvt_pk_bf16_f32 v187, v150, v151
    s_waitcnt vmcnt(0)
    ds_read_b128 v[16:19], v238 offset:13056
    ds_read_b128 v[20:23], v238 offset:13120
    s_add_u32 m0, s28, 33280
    ds_read_b128 v[24:27], v238 offset:13184
    s_add_u32 s35, s39, 262144
    ds_read_b128 v[28:31], v238 offset:13248
    buffer_load_dwordx4 v234, s[16:19], s35 offen offset:0 lds
    s_add_u32 s35, s39, 277504
    s_waitcnt lgkmcnt(3)
    v_lshlrev_b32 v32, 16, v16
    v_and_b32 v33, s62, v16
    v_pk_mul_f32 v[32:33], v[32:33], s[60:61]
    v_cvt_pk_bf16_f32 v35, v32, v33
    v_lshlrev_b32 v36, 16, v17
    v_and_b32 v37, s62, v17
    v_accvgpr_write_b32 a48, v35
    v_pk_mul_f32 v[36:37], v[36:37], s[60:61]
    v_lshlrev_b32 v40, 16, v18
    v_and_b32 v41, s62, v18
    buffer_load_dwordx4 v234, s[16:19], s35 offen offset:1024 lds
    v_pk_mul_f32 v[40:41], v[40:41], s[60:61]
    v_cvt_pk_bf16_f32 v39, v36, v37
    v_cvt_pk_bf16_f32 v43, v40, v41
    v_accvgpr_write_b32 a49, v39
    v_accvgpr_write_b32 a50, v43
    v_lshlrev_b32 v44, 16, v19
    s_add_u32 s35, s39, 292864
    v_and_b32 v45, s62, v19
    s_waitcnt lgkmcnt(2)
    v_lshlrev_b32 v56, 16, v22
    v_and_b32 v57, s62, v22
    v_lshlrev_b32 v60, 16, v23
    v_and_b32 v61, s62, v23
    buffer_load_dwordx4 v234, s[16:19], s35 offen offset:2048 lds
    v_pk_mul_f32 v[44:45], v[44:45], s[60:61]
    v_lshlrev_b32 v48, 16, v20
    v_and_b32 v49, s62, v20
    v_pk_mul_f32 v[56:57], v[56:57], s[60:61]
    v_pk_mul_f32 v[60:61], v[60:61], s[60:61]
    v_cvt_pk_bf16_f32 v47, v44, v45
    v_pk_mul_f32 v[48:49], v[48:49], s[60:61]
    v_cvt_pk_bf16_f32 v59, v56, v57
    v_cvt_pk_bf16_f32 v63, v60, v61
    v_accvgpr_write_b32 a51, v47
    v_cvt_pk_bf16_f32 v51, v48, v49
    s_add_u32 s35, s39, 308224
    s_waitcnt lgkmcnt(0)
    v_lshlrev_b32 v56, 16, v30
    v_and_b32 v57, s62, v30
    v_lshlrev_b32 v60, 16, v31
    v_and_b32 v61, s62, v31
    v_accvgpr_write_b32 a54, v59
    v_accvgpr_write_b32 a55, v63
    v_pk_mul_f32 v[56:57], v[56:57], s[60:61]
    v_pk_mul_f32 v[60:61], v[60:61], s[60:61]
    v_cvt_pk_bf16_f32 v59, v56, v57
    v_cvt_pk_bf16_f32 v63, v60, v61
    buffer_load_dwordx4 v234, s[16:19], s35 offen offset:3072 lds
    v_accvgpr_write_b32 a62, v59
    v_accvgpr_write_b32 a63, v63
    v_lshlrev_b32 v32, 16, v24
    v_and_b32 v33, s62, v24
    v_pk_mul_f32 v[32:33], v[32:33], s[60:61]
    v_cvt_pk_bf16_f32 v35, v32, v33
    v_lshlrev_b32 v36, 16, v25
    v_and_b32 v37, s62, v25
    v_pk_mul_f32 v[36:37], v[36:37], s[60:61]
    v_accvgpr_write_b32 a56, v35
    v_cvt_pk_bf16_f32 v39, v36, v37
    v_lshlrev_b32 v40, 16, v26
    v_and_b32 v41, s62, v26
    v_pk_mul_f32 v[40:41], v[40:41], s[60:61]
    v_cvt_pk_bf16_f32 v43, v40, v41
    v_lshlrev_b32 v44, 16, v27
    v_and_b32 v45, s62, v27
    v_accvgpr_write_b32 a57, v39
    v_accvgpr_write_b32 a58, v43
    v_pk_mul_f32 v[44:45], v[44:45], s[60:61]
    v_lshlrev_b32 v48, 16, v28
    v_and_b32 v49, s62, v28
    v_accvgpr_write_b32 a52, v51
    v_cvt_pk_bf16_f32 v47, v44, v45
    v_pk_mul_f32 v[48:49], v[48:49], s[60:61]
    v_cvt_pk_bf16_f32 v51, v48, v49
    v_accvgpr_write_b32 a59, v47
    v_accvgpr_write_b32 a60, v51
    v_lshlrev_b32 v52, 16, v21
    v_and_b32 v53, s62, v21
    v_pk_mul_f32 v[52:53], v[52:53], s[60:61]
    v_cvt_pk_bf16_f32 v55, v52, v53
    v_lshlrev_b32 v52, 16, v29
    v_and_b32 v53, s62, v29
    v_accvgpr_write_b32 a53, v55
    v_pk_mul_f32 v[52:53], v[52:53], s[60:61]
    v_cvt_pk_bf16_f32 v55, v52, v53
    v_accvgpr_write_b32 a61, v55
    v_mfma_f32_16x16x32_bf16 v[152:155], a[96:99], a[48:51], 0
    v_mfma_f32_16x16x32_bf16 v[152:155], a[100:103], a[52:55], v[152:155]
    v_mfma_f32_16x16x32_bf16 v[152:155], a[104:107], a[56:59], v[152:155]
    v_mfma_f32_16x16x32_bf16 v[152:155], a[108:111], a[60:63], v[152:155]
    v_mfma_f32_16x16x32_bf16 v[156:159], a[112:115], a[48:51], 0
    v_mfma_f32_16x16x32_bf16 v[156:159], a[116:119], a[52:55], v[156:159]
    v_mfma_f32_16x16x32_bf16 v[156:159], a[120:123], a[56:59], v[156:159]
    v_mfma_f32_16x16x32_bf16 v[156:159], a[124:127], a[60:63], v[156:159]
    s_nop 3
    v_max3_f32 v188, v152, v153, v154
    s_nop 2
    v_max3_f32 v189, v156, v157, v158
    v_max3_f32 v188, v188, v155, v159
    v_max_f32 v188, v188, v189
    v_mov_b32 v189, v188
    s_nop 1
    v_permlane32_swap_b32 v189, v188
    v_max_f32 v188, v188, v189
    v_mov_b32 v189, v188
    s_nop 1
    v_permlane16_swap_b32 v189, v188
    v_max_f32 v188, v188, v189
    v_sub_f32 v212, 0, v188
    v_sub_f32 v213, 0, v188
    v_sub_f32 v214, 0, v188
    v_sub_f32 v215, 0, v188
    v_sub_f32 v152, v152, v188
    v_sub_f32 v153, v153, v188
    v_sub_f32 v154, v154, v188
    v_sub_f32 v155, v155, v188
    v_sub_f32 v156, v156, v188
    v_sub_f32 v157, v157, v188
    v_sub_f32 v158, v158, v188
    v_sub_f32 v159, v159, v188
    v_exp_f32 v152, v152
    v_exp_f32 v153, v153
    v_mov_b32 v227, v152
    v_add_f32 v227, v227, v153
    v_cvt_pk_bf16_f32 v188, v152, v153
    v_exp_f32 v154, v154
    v_exp_f32 v155, v155
    v_add_f32 v227, v227, v154
    v_add_f32 v227, v227, v155
    v_cvt_pk_bf16_f32 v189, v154, v155
    v_exp_f32 v156, v156
    v_exp_f32 v157, v157
    v_add_f32 v227, v227, v156
    v_add_f32 v227, v227, v157
    v_cvt_pk_bf16_f32 v190, v156, v157
    v_exp_f32 v158, v158
    v_exp_f32 v159, v159
    v_add_f32 v227, v227, v158
    v_add_f32 v227, v227, v159
    v_cvt_pk_bf16_f32 v191, v158, v159
    s_waitcnt vmcnt(0)
    ds_read_b128 v[0:3], v246 offset:0
    ds_read_b128 v[4:7], v246 offset:64
    s_add_u32 m0, s28, 16640
    ds_read_b128 v[8:11], v246 offset:128
    buffer_load_dwordx4 v236, s[12:15], s25 offen offset:2048 lds
    ds_read_b128 v[12:15], v246 offset:192
    s_waitcnt lgkmcnt(3)
    v_lshlrev_b32 v32, 16, v0
    v_and_b32 v33, s62, v0
    v_pk_mul_f32 v[32:33], v[32:33], s[60:61]
    v_cvt_pk_bf16_f32 v35, v32, v33
    v_lshlrev_b32 v36, 16, v1
    v_and_b32 v37, s62, v1
    v_accvgpr_write_b32 a64, v35
    v_pk_mul_f32 v[36:37], v[36:37], s[60:61]
    buffer_load_dwordx4 v237, s[12:15], s25 offen offset:3104 lds
    v_lshlrev_b32 v40, 16, v2
    v_and_b32 v41, s62, v2
    v_pk_mul_f32 v[40:41], v[40:41], s[60:61]
    s_add_u32 s14, s10, 4096
    v_cvt_pk_bf16_f32 v39, v36, v37
    v_cvt_pk_bf16_f32 v43, v40, v41
    v_accvgpr_write_b32 a65, v39
    v_accvgpr_write_b32 a66, v43
    v_lshlrev_b32 v44, 16, v3
    s_mov_b32 s25, s24
    v_and_b32 v45, s62, v3
    v_pk_mul_f32 v[44:45], v[44:45], s[60:61]
    s_waitcnt lgkmcnt(2)
    v_lshlrev_b32 v48, 16, v4
    v_and_b32 v49, s62, v4
    v_cvt_pk_bf16_f32 v47, v44, v45
    v_pk_mul_f32 v[48:49], v[48:49], s[60:61]
    buffer_load_dwordx4 v234, s[8:11], s24 offen lds
    v_accvgpr_write_b32 a67, v47
    v_cvt_pk_bf16_f32 v51, v48, v49
    buffer_load_dwordx4 v235, s[8:11], s24 offen offset:1024 lds
    s_add_u32 s24, s24, 131072
    s_sub_u32 s3, s3, 1
    v_lshlrev_b32 v60, 16, v7
    v_and_b32 v61, s62, v7
    v_pk_mul_f32 v[60:61], v[60:61], s[60:61]
    v_cvt_pk_bf16_f32 v63, v60, v61
    s_waitcnt lgkmcnt(0)
    v_lshlrev_b32 v60, 16, v15
    v_and_b32 v61, s62, v15
    v_accvgpr_write_b32 a71, v63
    v_pk_mul_f32 v[60:61], v[60:61], s[60:61]
    v_cvt_pk_bf16_f32 v63, v60, v61
    v_accvgpr_write_b32 a79, v63
    v_lshlrev_b32 v52, 16, v5
    v_and_b32 v53, s62, v5
    v_lshlrev_b32 v56, 16, v6
    v_and_b32 v57, s62, v6
    v_pk_mul_f32 v[52:53], v[52:53], s[60:61]
    v_pk_mul_f32 v[56:57], v[56:57], s[60:61]
    v_cvt_pk_bf16_f32 v55, v52, v53
    v_cvt_pk_bf16_f32 v59, v56, v57
    v_lshlrev_b32 v32, 16, v8
    v_and_b32 v33, s62, v8
    v_lshlrev_b32 v36, 16, v9
    v_and_b32 v37, s62, v9
    v_lshlrev_b32 v40, 16, v10
    v_and_b32 v41, s62, v10
    v_lshlrev_b32 v44, 16, v11
    v_and_b32 v45, s62, v11
    v_lshlrev_b32 v48, 16, v12
    v_and_b32 v49, s62, v12
    v_lshlrev_b32 v52, 16, v13
    v_and_b32 v53, s62, v13
    v_lshlrev_b32 v56, 16, v14
    v_and_b32 v57, s62, v14
    v_pk_mul_f32 v[32:33], v[32:33], s[60:61]
    v_pk_mul_f32 v[36:37], v[36:37], s[60:61]
    v_pk_mul_f32 v[40:41], v[40:41], s[60:61]
    v_pk_mul_f32 v[44:45], v[44:45], s[60:61]
    v_accvgpr_write_b32 a68, v51
    v_pk_mul_f32 v[48:49], v[48:49], s[60:61]
    v_accvgpr_write_b32 a69, v55
    v_pk_mul_f32 v[52:53], v[52:53], s[60:61]
    v_accvgpr_write_b32 a70, v59
    v_pk_mul_f32 v[56:57], v[56:57], s[60:61]
    v_cvt_pk_bf16_f32 v35, v32, v33
    v_cvt_pk_bf16_f32 v39, v36, v37
    v_cvt_pk_bf16_f32 v43, v40, v41
    v_cvt_pk_bf16_f32 v47, v44, v45
    v_cvt_pk_bf16_f32 v51, v48, v49
    v_cvt_pk_bf16_f32 v55, v52, v53
    v_cvt_pk_bf16_f32 v59, v56, v57
    v_accvgpr_write_b32 a72, v35
    v_accvgpr_write_b32 a73, v39
    v_accvgpr_write_b32 a74, v43
    v_accvgpr_write_b32 a75, v47
    v_accvgpr_write_b32 a76, v51
    v_accvgpr_write_b32 a77, v55
    v_accvgpr_write_b32 a78, v59
    v_mfma_f32_16x16x32_bf16 v[160:163], a[96:99], a[64:67], 0
    v_add_u32 v241, 16384, v239
    v_add_u32 v246, 32768, v239
    v_mfma_f32_16x16x32_bf16 v[160:163], a[100:103], a[68:71], v[160:163]
    v_add_u32 v247, 49152, v239
    v_mfma_f32_16x16x32_bf16 v[160:163], a[104:107], a[72:75], v[160:163]
    s_mov_b32 s70, s27
    v_mfma_f32_16x16x32_bf16 v[160:163], a[108:111], a[76:79], v[160:163]
    s_add_u32 s27, s27, 16640
    v_mfma_f32_16x16x32_bf16 v[164:167], a[112:115], a[64:67], 0
    s_cmp_eq_u32 s27, s29
    v_mfma_f32_16x16x32_bf16 v[164:167], a[116:119], a[68:71], v[164:167]
    s_cselect_b32 s27, s28, s27
    v_mfma_f32_16x16x32_bf16 v[164:167], a[120:123], a[72:75], v[164:167]
    s_waitcnt vmcnt(0)
    v_mfma_f32_16x16x32_bf16 v[164:167], a[124:127], a[76:79], v[164:167]
    s_barrier
    v_add_u32 v231, s27, v233
    ds_read_b64_tr_b16 a[128:129], v231 offset:0
    ds_read_b64_tr_b16 a[130:131], v231 offset:512
    ds_read_b64_tr_b16 a[132:133], v231 offset:32
    ds_read_b64_tr_b16 a[134:135], v231 offset:544
    ds_read_b64_tr_b16 a[136:137], v231 offset:64
    ds_read_b64_tr_b16 a[138:139], v231 offset:576
    ds_read_b64_tr_b16 a[140:141], v231 offset:96
    ds_read_b64_tr_b16 a[142:143], v231 offset:608
    ds_read_b64_tr_b16 a[144:145], v231 offset:128
    ds_read_b64_tr_b16 a[146:147], v231 offset:640
    ds_read_b64_tr_b16 a[148:149], v231 offset:160
    ds_read_b64_tr_b16 a[150:151], v231 offset:672
    ds_read_b64_tr_b16 a[152:153], v231 offset:192
    ds_read_b64_tr_b16 a[154:155], v231 offset:704
    ds_read_b64_tr_b16 a[156:157], v231 offset:224
    v_add_u32 v230, s27, v232
    ds_read_b64_tr_b16 a[158:159], v231 offset:736
    ds_read_b128 a[96:99], v230 offset:0
    ds_read_b128 a[100:103], v230 offset:64
    ds_read_b128 a[104:107], v230 offset:128
    ds_read_b128 a[108:111], v230 offset:192
    ds_read_b128 a[112:115], v230 offset:1024
    ds_read_b128 a[116:119], v230 offset:1088
    ds_read_b128 a[120:123], v230 offset:1152
    ds_read_b128 a[124:127], v230 offset:1216
    s_waitcnt lgkmcnt(15)
    v_mfma_f32_16x16x32_bf16 v[0:3], a[128:131], v[176:179], 0
    s_add_u32 m0, s28, 33280
    v_max3_f32 v192, v160, v161, v162
    v_max3_f32 v193, v164, v165, v166
    v_max3_f32 v192, v192, v163, v167
    v_mfma_f32_16x16x32_bf16 v[32:35], a[128:131], v[180:183], 0
    buffer_load_dwordx4 v236, s[12:15], s25 offen offset:2048 lds
    v_mfma_f32_16x16x32_bf16 v[4:7], a[132:135], v[176:179], 0
    buffer_load_dwordx4 v237, s[12:15], s25 offen offset:3104 lds
    v_mfma_f32_16x16x32_bf16 v[36:39], a[132:135], v[180:183], 0
    s_add_u32 s14, s10, 4096
    v_max_f32 v192, v192, v193
    v_mov_b32 v193, v192
    s_mov_b32 s25, s24
    v_mfma_f32_16x16x32_bf16 v[8:11], a[136:139], v[176:179], 0
    buffer_load_dwordx4 v234, s[8:11], s24 offen lds
    v_mfma_f32_16x16x32_bf16 v[40:43], a[136:139], v[180:183], 0
    buffer_load_dwordx4 v235, s[8:11], s24 offen offset:1024 lds
    v_mfma_f32_16x16x32_bf16 v[12:15], a[140:143], v[176:179], 0
    s_add_u32 s24, s24, 131072
    v_permlane32_swap_b32 v193, v192
    v_max_f32 v192, v192, v193
    v_mov_b32 v193, v192
    v_mfma_f32_16x16x32_bf16 v[44:47], a[140:143], v[180:183], 0
    s_waitcnt lgkmcnt(0)
    v_permlane16_swap_b32 v193, v192
    v_max_f32 v192, v192, v193
    v_sub_f32 v216, 0, v192
    v_mfma_f32_16x16x32_bf16 v[16:19], a[144:147], v[176:179], 0
    s_sub_u32 s3, s3, 1
    v_sub_f32 v217, 0, v192
    v_sub_f32 v218, 0, v192
    v_sub_f32 v219, 0, v192
    v_mfma_f32_16x16x32_bf16 v[48:51], a[144:147], v[180:183], 0
    s_add_u32 m0, s28, 49920
    v_sub_f32 v160, v160, v192
    v_sub_f32 v161, v161, v192
    v_sub_f32 v162, v162, v192
    v_mfma_f32_16x16x32_bf16 v[20:23], a[148:151], v[176:179], 0
    buffer_load_dwordx4 v236, s[12:15], s25 offen offset:2048 lds
    v_mfma_f32_16x16x32_bf16 v[52:55], a[148:151], v[180:183], 0
    buffer_load_dwordx4 v237, s[12:15], s25 offen offset:3104 lds
    v_mfma_f32_16x16x32_bf16 v[24:27], a[152:155], v[176:179], 0
    s_add_u32 s14, s10, 4096
    v_sub_f32 v163, v163, v192
    v_sub_f32 v164, v164, v192
    v_sub_f32 v165, v165, v192
    v_mfma_f32_16x16x32_bf16 v[56:59], a[152:155], v[180:183], 0
    s_mov_b32 s25, s24
    buffer_load_dwordx4 v234, s[8:11], s24 offen lds
    v_mfma_f32_16x16x32_bf16 v[28:31], a[156:159], v[176:179], 0
    buffer_load_dwordx4 v235, s[8:11], s24 offen offset:1024 lds
    v_mfma_f32_16x16x32_bf16 v[60:63], a[156:159], v[180:183], 0
    s_add_u32 s24, s24, 131072
    v_sub_f32 v166, v166, v192
    v_sub_f32 v167, v167, v192
    s_sub_u32 s3, s3, 1
    v_mfma_f32_16x16x32_bf16 v[128:131], a[96:99], a[0:3], v[200:203]
    s_add_u32 m0, s28, 66560
    v_exp_f32 v160, v160
    v_mfma_f32_16x16x32_bf16 v[128:131], a[100:103], a[4:7], v[128:131]
    buffer_load_dwordx4 v236, s[12:15], s25 offen offset:2048 lds
    v_mfma_f32_16x16x32_bf16 v[128:131], a[104:107], a[8:11], v[128:131]
    buffer_load_dwordx4 v237, s[12:15], s25 offen offset:3104 lds
    v_mfma_f32_16x16x32_bf16 v[128:131], a[108:111], a[12:15], v[128:131]
    s_add_u32 s14, s10, 4096
    v_exp_f32 v161, v161
    s_mov_b32 s25, s24
    v_mfma_f32_16x16x32_bf16 v[132:135], a[112:115], a[0:3], v[200:203]
    buffer_load_dwordx4 v234, s[8:11], s24 offen lds
    v_mfma_f32_16x16x32_bf16 v[132:135], a[116:119], a[4:7], v[132:135]
    buffer_load_dwordx4 v235, s[8:11], s24 offen offset:1024 lds
    v_mfma_f32_16x16x32_bf16 v[132:135], a[120:123], a[8:11], v[132:135]
    s_add_u32 s24, s24, 131072
    v_cvt_pk_bf16_f32 v192, v160, v161
    v_exp_f32 v162, v162
    v_mfma_f32_16x16x32_bf16 v[132:135], a[124:127], a[12:15], v[132:135]
    s_sub_u32 s3, s3, 1
    v_exp_f32 v163, v163
    s_mov_b32 s18, s31
    v_mfma_f32_16x16x32_bf16 v[136:139], a[96:99], a[16:19], v[204:207]
    s_mov_b32 m0, s70
    v_cvt_pk_bf16_f32 v193, v162, v163
    v_exp_f32 v164, v164
    v_mfma_f32_16x16x32_bf16 v[136:139], a[100:103], a[20:23], v[136:139]
    buffer_load_dwordx4 v236, s[12:15], s25 offen offset:2048 lds
    v_mfma_f32_16x16x32_bf16 v[136:139], a[104:107], a[24:27], v[136:139]
    s_mov_b32 m0, s70
    v_exp_f32 v165, v165
    v_mfma_f32_16x16x32_bf16 v[136:139], a[108:111], a[28:31], v[136:139]
    buffer_load_dwordx4 v237, s[12:15], s25 offen offset:3104 lds
    v_mfma_f32_16x16x32_bf16 v[140:143], a[112:115], a[16:19], v[204:207]
    s_add_u32 s14, s10, 4096
    v_cvt_pk_bf16_f32 v194, v164, v165
    v_exp_f32 v166, v166
    v_mfma_f32_16x16x32_bf16 v[140:143], a[116:119], a[20:23], v[140:143]
    s_mov_b32 s25, s24
    v_exp_f32 v167, v167
    s_mov_b32 m0, s70
    v_mfma_f32_16x16x32_bf16 v[140:143], a[120:123], a[24:27], v[140:143]
    buffer_load_dwordx4 v234, s[8:11], s24 offen lds
    v_mfma_f32_16x16x32_bf16 v[140:143], a[124:127], a[28:31], v[140:143]
    s_mov_b32 m0, s70
    v_cvt_pk_bf16_f32 v195, v166, v167
    v_exp_f32 v128, v128
    v_mfma_f32_16x16x32_bf16 v[64:67], a[128:131], v[184:187], 0
    buffer_load_dwordx4 v235, s[8:11], s24 offen offset:1024 lds
    v_mfma_f32_16x16x32_bf16 v[96:99], a[128:131], v[188:191], 0
    s_add_u32 s24, s24, 131072
    s_sub_u32 s3, s3, 1
    s_mov_b32 s70, s27
    s_add_u32 s27, s27, 16640
    v_mfma_f32_16x16x32_bf16 a[160:163], a[128:131], v[192:195], 0
    s_cmp_eq_u32 s27, s29
    s_cselect_b32 s27, s28, s27
    s_waitcnt vmcnt(12)
    v_add_f32 v224, v224, v128
    v_mfma_f32_16x16x32_bf16 a[236:239], a[224:227], v[184:187], 0
    s_barrier
    v_mfma_f32_16x16x32_bf16 a[244:247], a[224:227], v[192:195], 0
    s_mov_b32 m0, s70
    v_add_u32 v231, s27, v233
    v_add_u32 v230, s27, v232
    v_mfma_f32_16x16x32_bf16 v[68:71], a[132:135], v[184:187], 0
    buffer_load_dwordx4 v236, s[12:15], s25 offen offset:2048 lds
    v_mfma_f32_16x16x32_bf16 v[100:103], a[132:135], v[188:191], 0
    ds_read_b64_tr_b16 a[128:129], v231 offset:0
    v_exp_f32 v129, v129
    v_mfma_f32_16x16x32_bf16 a[164:167], a[132:135], v[192:195], 0
    ds_read_b64_tr_b16 a[130:131], v231 offset:512
    v_add_f32 v224, v224, v129
    v_cvt_pk_bf16_f32 v176, v128, v129
    v_mfma_f32_16x16x32_bf16 v[72:75], a[136:139], v[184:187], 0
    ds_read_b64_tr_b16 a[132:133], v231 offset:32
    v_exp_f32 v130, v130
    v_mfma_f32_16x16x32_bf16 v[104:107], a[136:139], v[188:191], 0
    v_add_f32 v224, v224, v130
    v_exp_f32 v131, v131
    v_mfma_f32_16x16x32_bf16 a[168:171], a[136:139], v[192:195], 0
    ds_read_b64_tr_b16 a[134:135], v231 offset:544
    v_add_f32 v224, v224, v131
    v_cvt_pk_bf16_f32 v177, v130, v131
    v_mfma_f32_16x16x32_bf16 v[76:79], a[140:143], v[184:187], 0
    s_mov_b32 m0, s70
    ds_read_b64_tr_b16 a[136:137], v231 offset:64
    v_exp_f32 v132, v132
    v_mfma_f32_16x16x32_bf16 v[108:111], a[140:143], v[188:191], 0
    buffer_load_dwordx4 v237, s[12:15], s25 offen offset:3104 lds
    v_mfma_f32_16x16x32_bf16 a[172:175], a[140:143], v[192:195], 0
    s_add_u32 s14, s10, 4096
    v_add_f32 v224, v224, v132
    v_exp_f32 v133, v133
    v_mfma_f32_16x16x32_bf16 v[80:83], a[144:147], v[184:187], 0
    s_mov_b32 s25, s24
    v_add_f32 v224, v224, v133
    v_cvt_pk_bf16_f32 v178, v132, v133
    v_mfma_f32_16x16x32_bf16 v[112:115], a[144:147], v[188:191], 0
    v_exp_f32 v134, v134
    v_mfma_f32_16x16x32_bf16 a[176:179], a[144:147], v[192:195], 0
    ds_read_b64_tr_b16 a[138:139], v231 offset:576
    v_add_f32 v224, v224, v134
    v_mfma_f32_16x16x32_bf16 v[84:87], a[148:151], v[184:187], 0
    v_exp_f32 v135, v135
    v_mfma_f32_16x16x32_bf16 v[116:119], a[148:151], v[188:191], 0
    v_add_f32 v224, v224, v135
    v_cvt_pk_bf16_f32 v179, v134, v135
    v_mfma_f32_16x16x32_bf16 a[180:183], a[148:151], v[192:195], 0
    v_exp_f32 v136, v136
    v_mfma_f32_16x16x32_bf16 v[88:91], a[152:155], v[184:187], 0
    ds_read_b64_tr_b16 a[140:141], v231 offset:96
    v_add_f32 v225, v225, v136
    v_mfma_f32_16x16x32_bf16 v[120:123], a[152:155], v[188:191], 0
    v_exp_f32 v137, v137
    v_mfma_f32_16x16x32_bf16 a[184:187], a[152:155], v[192:195], 0
    v_add_f32 v225, v225, v137
    v_cvt_pk_bf16_f32 v180, v136, v137
    v_mfma_f32_16x16x32_bf16 v[92:95], a[156:159], v[184:187], 0
    v_exp_f32 v138, v138
    v_mfma_f32_16x16x32_bf16 v[124:127], a[156:159], v[188:191], 0
    s_mov_b32 m0, s70
    ds_read_b64_tr_b16 a[142:143], v231 offset:608
    v_add_f32 v225, v225, v138
    v_mfma_f32_16x16x32_bf16 a[188:191], a[156:159], v[192:195], 0
    v_exp_f32 v139, v139
    ds_read_b64_tr_b16 a[144:145], v231 offset:128
    v_add_f32 v225, v225, v139
    v_cvt_pk_bf16_f32 v181, v138, v139
    v_exp_f32 v140, v140
    v_exp_f32 v141, v141
    v_add_f32 v225, v225, v140
    v_add_f32 v225, v225, v141
    v_cvt_pk_bf16_f32 v182, v140, v141
    v_exp_f32 v142, v142
    s_branch L_loop5
.p2align 3
L_loop2:
    v_mfma_f32_16x16x32_bf16 v[136:139], a[96:99], a[16:19], v[204:207]
    ds_read_b64_tr_b16 a[150:151], v231 offset:672
    ds_read_b64_tr_b16 a[152:153], v231 offset:192
    ds_read_b64_tr_b16 a[154:155], v231 offset:704
    v_mfma_f32_16x16x32_bf16 v[136:139], a[100:103], a[20:23], v[136:139]
    ds_read_b64_tr_b16 a[156:157], v231 offset:224
    ds_read_b64_tr_b16 a[158:159], v231 offset:736
    ds_read_b128 a[96:99], v230 offset:0
    v_mfma_f32_16x16x32_bf16 v[136:139], a[104:107], a[24:27], v[136:139]
    v_exp_f32 v131, v131
    v_mfma_f32_16x16x32_bf16 v[136:139], a[108:111], a[28:31], v[136:139]
    ds_read_b128 a[100:103], v230 offset:64
    ds_read_b128 a[104:107], v230 offset:128
    ds_read_b128 a[108:111], v230 offset:192
    v_mfma_f32_16x16x32_bf16 v[140:143], a[112:115], a[16:19], v[204:207]
    v_exp_f32 v132, v132
    v_mfma_f32_16x16x32_bf16 v[140:143], a[116:119], a[20:23], v[140:143]
    v_exp_f32 v133, v133
    v_mfma_f32_16x16x32_bf16 v[140:143], a[120:123], a[24:27], v[140:143]
    v_exp_f32 v134, v134
    v_mfma_f32_16x16x32_bf16 v[140:143], a[124:127], a[28:31], v[140:143]
    s_waitcnt lgkmcnt(3)
    ds_read_b128 a[112:115], v230 offset:1024
    ds_read_b128 a[116:119], v230 offset:1088
    v_exp_f32 v135, v135
    v_cvt_pk_bf16_f32 v177, v130, v131
    v_cvt_pk_bf16_f32 v178, v132, v133
    v_cvt_pk_bf16_f32 v179, v134, v135
    s_nop 1
    v_mfma_f32_16x16x32_bf16 v[0:3], a[128:131], v[176:179], v[0:3]
    buffer_load_dwordx4 v234, s[8:11], s24 offen lds
    v_mfma_f32_16x16x32_bf16 a[228:231], a[224:227], v[176:179], a[228:231]
    v_exp_f32 v136, v136
    v_mfma_f32_16x16x32_bf16 v[4:7], a[132:135], v[176:179], v[4:7]
    v_exp_f32 v137, v137
    v_mfma_f32_16x16x32_bf16 v[8:11], a[136:139], v[176:179], v[8:11]
    ds_read_b128 a[120:123], v230 offset:1152
    ds_read_b128 a[124:127], v230 offset:1216
    v_mfma_f32_16x16x32_bf16 v[12:15], a[140:143], v[176:179], v[12:15]
    v_cvt_pk_bf16_f32 v180, v136, v137
    v_mfma_f32_16x16x32_bf16 v[16:19], a[144:147], v[176:179], v[16:19]
    buffer_load_dwordx4 v235, s[8:11], s24 offen offset:1024 lds
    v_mfma_f32_16x16x32_bf16 v[20:23], a[148:151], v[176:179], v[20:23]
    s_add_u32 s24, s24, 131072
    v_exp_f32 v138, v138
    v_mfma_f32_16x16x32_bf16 v[24:27], a[152:155], v[176:179], v[24:27]
    s_sub_u32 s3, s3, 1
    v_exp_f32 v139, v139
    v_mfma_f32_16x16x32_bf16 v[28:31], a[156:159], v[176:179], v[28:31]
    s_cselect_b32 s24, s30, s24
    v_exp_f32 v140, v140
    v_mfma_f32_16x16x32_bf16 v[128:131], a[96:99], a[0:3], v[200:203]
    s_waitcnt lgkmcnt(0)
    s_cselect_b32 s10, s31, s10
    v_cvt_pk_bf16_f32 v181, v138, v139
    v_mfma_f32_16x16x32_bf16 v[128:131], a[100:103], a[4:7], v[128:131]
    v_exp_f32 v141, v141
    v_mfma_f32_16x16x32_bf16 v[128:131], a[104:107], a[8:11], v[128:131]
    s_mov_b32 m0, s27
    v_exp_f32 v142, v142
    v_mfma_f32_16x16x32_bf16 v[128:131], a[108:111], a[12:15], v[128:131]
    s_add_u32 s27, s27, 16640
    v_exp_f32 v143, v143
    v_mfma_f32_16x16x32_bf16 v[132:135], a[112:115], a[0:3], v[200:203]
    s_cmp_eq_u32 s27, s29
    v_cvt_pk_bf16_f32 v182, v140, v141
    v_cvt_pk_bf16_f32 v183, v142, v143
    v_mfma_f32_16x16x32_bf16 v[132:135], a[116:119], a[4:7], v[132:135]
    s_cselect_b32 s27, s28, s27
    v_exp_f32 v128, v128
    v_mfma_f32_16x16x32_bf16 v[132:135], a[120:123], a[8:11], v[132:135]
    s_waitcnt vmcnt(12)
    v_exp_f32 v129, v129
    v_mfma_f32_16x16x32_bf16 v[132:135], a[124:127], a[12:15], v[132:135]
    s_barrier
    v_mfma_f32_16x16x32_bf16 v[32:35], a[128:131], v[180:183], v[32:35]
    v_add_u32 v231, s27, v233
    v_mfma_f32_16x16x32_bf16 a[232:235], a[224:227], v[180:183], a[232:235]
    buffer_load_dwordx4 v236, s[12:15], s25 offen offset:2048 lds
    v_mfma_f32_16x16x32_bf16 v[36:39], a[132:135], v[180:183], v[36:39]
    ds_read_b64_tr_b16 a[128:129], v231 offset:0
    v_add_u32 v230, s27, v232
    v_cvt_pk_bf16_f32 v176, v128, v129
    v_mfma_f32_16x16x32_bf16 v[40:43], a[136:139], v[180:183], v[40:43]
    v_exp_f32 v130, v130
    v_mfma_f32_16x16x32_bf16 v[44:47], a[140:143], v[180:183], v[44:47]
    ds_read_b64_tr_b16 a[130:131], v231 offset:512
    ds_read_b64_tr_b16 a[132:133], v231 offset:32
    v_mfma_f32_16x16x32_bf16 v[48:51], a[144:147], v[180:183], v[48:51]
    buffer_load_dwordx4 v237, s[12:15], s25 offen offset:3104 lds
    v_mfma_f32_16x16x32_bf16 v[52:55], a[148:151], v[180:183], v[52:55]
    s_add_u32 s14, s10, 4096
    ds_read_b64_tr_b16 a[134:135], v231 offset:544
    ds_read_b64_tr_b16 a[136:137], v231 offset:64
    v_mfma_f32_16x16x32_bf16 v[56:59], a[152:155], v[180:183], v[56:59]
    s_mov_b32 s25, s24
    ds_read_b64_tr_b16 a[138:139], v231 offset:576
    ds_read_b64_tr_b16 a[140:141], v231 offset:96
    v_mfma_f32_16x16x32_bf16 v[60:63], a[156:159], v[180:183], v[60:63]
    s_sub_u32 s26, s26, 1
    ds_read_b64_tr_b16 a[142:143], v231 offset:608
    ds_read_b64_tr_b16 a[144:145], v231 offset:128
    ds_read_b64_tr_b16 a[146:147], v231 offset:640
    ds_read_b64_tr_b16 a[148:149], v231 offset:160
    s_cbranch_scc0 L_loop2
    s_cmp_eq_u32 s91, 0
    s_cbranch_scc1 L_out2
    s_mov_b32 s26, s94
L_lq2:
    v_mfma_f32_16x16x32_bf16 v[136:139], a[96:99], a[16:19], v[204:207]
    s_mov_b32 s70, m0
    ds_read_b64_tr_b16 a[150:151], v231 offset:672
    ds_read_b64_tr_b16 a[152:153], v231 offset:192
    ds_read_b64_tr_b16 a[154:155], v231 offset:704
    v_mfma_f32_16x16x32_bf16 v[136:139], a[100:103], a[20:23], v[136:139]
    ds_read_b64_tr_b16 a[156:157], v231 offset:224
    ds_read_b64_tr_b16 a[158:159], v231 offset:736
    ds_read_b128 a[96:99], v230 offset:0
    v_mfma_f32_16x16x32_bf16 v[136:139], a[104:107], a[24:27], v[136:139]
    s_mov_b32 m0, s92
    ds_read_b128 a[100:103], v230 offset:64
    ds_read_b128 a[104:107], v230 offset:128
    v_mfma_f32_16x16x32_bf16 v[136:139], a[108:111], a[28:31], v[136:139]
    buffer_load_dwordx4 v234, s[16:19], s93 offen lds
    v_mfma_f32_16x16x32_bf16 v[140:143], a[112:115], a[16:19], v[204:207]
    s_add_u32 s92, s92, 1088
    ds_read_b128 a[108:111], v230 offset:192
    s_add_u32 s93, s93, 16384
    s_mov_b32 m0, s92
    v_mfma_f32_16x16x32_bf16 v[140:143], a[116:119], a[20:23], v[140:143]
    buffer_load_dwordx4 v234, s[16:19], s93 offen lds
    v_mfma_f32_16x16x32_bf16 v[140:143], a[120:123], a[24:27], v[140:143]
    s_add_u32 s92, s92, 1088
    ds_read_b128 a[112:115], v230 offset:1024
    s_add_u32 s93, s93, 16384
    v_mfma_f32_16x16x32_bf16 v[140:143], a[124:127], a[28:31], v[140:143]
    s_waitcnt lgkmcnt(4)
    ds_read_b128 a[116:119], v230 offset:1088
    v_exp_f32 v131, v131
    v_exp_f32 v132, v132
    v_exp_f32 v133, v133
    v_exp_f32 v134, v134
    v_exp_f32 v135, v135
    v_cvt_pk_bf16_f32 v177, v130, v131
    v_cvt_pk_bf16_f32 v178, v132, v133
    v_cvt_pk_bf16_f32 v179, v134, v135
    s_mov_b32 m0, s70
    s_nop 0
    v_mfma_f32_16x16x32_bf16 v[0:3], a[128:131], v[176:179], v[0:3]
    buffer_load_dwordx4 v234, s[8:11], s24 offen lds
    v_mfma_f32_16x16x32_bf16 a[228:231], a[224:227], v[176:179], a[228:231]
    v_exp_f32 v136, v136
    v_mfma_f32_16x16x32_bf16 v[4:7], a[132:135], v[176:179], v[4:7]
    v_exp_f32 v137, v137
    v_mfma_f32_16x16x32_bf16 v[8:11], a[136:139], v[176:179], v[8:11]
    ds_read_b128 a[120:123], v230 offset:1152
    ds_read_b128 a[124:127], v230 offset:1216
    v_mfma_f32_16x16x32_bf16 v[12:15], a[140:143], v[176:179], v[12:15]
    s_mov_b32 m0, s70
    v_cvt_pk_bf16_f32 v180, v136, v137
    v_mfma_f32_16x16x32_bf16 v[16:19], a[144:147], v[176:179], v[16:19]
    buffer_load_dwordx4 v235, s[8:11], s24 offen offset:1024 lds
    v_mfma_f32_16x16x32_bf16 v[20:23], a[148:151], v[176:179], v[20:23]
    s_add_u32 s24, s24, 131072
    v_exp_f32 v138, v138
    v_mfma_f32_16x16x32_bf16 v[24:27], a[152:155], v[176:179], v[24:27]
    s_sub_u32 s3, s3, 1
    v_exp_f32 v139, v139
    v_mfma_f32_16x16x32_bf16 v[28:31], a[156:159], v[176:179], v[28:31]
    s_cselect_b32 s24, s30, s24
    v_exp_f32 v140, v140
    v_mfma_f32_16x16x32_bf16 v[128:131], a[96:99], a[0:3], v[200:203]
    s_waitcnt lgkmcnt(0)
    s_cselect_b32 s10, s31, s10
    v_cvt_pk_bf16_f32 v181, v138, v139
    v_mfma_f32_16x16x32_bf16 v[128:131], a[100:103], a[4:7], v[128:131]
    v_exp_f32 v141, v141
    v_mfma_f32_16x16x32_bf16 v[128:131], a[104:107], a[8:11], v[128:131]
    s_mov_b32 s70, s27
    v_exp_f32 v142, v142
    v_mfma_f32_16x16x32_bf16 v[128:131], a[108:111], a[12:15], v[128:131]
    s_add_u32 s27, s27, 16640
    v_exp_f32 v143, v143
    v_mfma_f32_16x16x32_bf16 v[132:135], a[112:115], a[0:3], v[200:203]
    s_cmp_eq_u32 s27, s29
    v_cvt_pk_bf16_f32 v182, v140, v141
    v_cvt_pk_bf16_f32 v183, v142, v143
    v_mfma_f32_16x16x32_bf16 v[132:135], a[116:119], a[4:7], v[132:135]
    s_cselect_b32 s27, s28, s27
    v_exp_f32 v128, v128
    v_mfma_f32_16x16x32_bf16 v[132:135], a[120:123], a[8:11], v[132:135]
    s_waitcnt vmcnt(14)
    v_exp_f32 v129, v129
    v_mfma_f32_16x16x32_bf16 v[132:135], a[124:127], a[12:15], v[132:135]
    s_barrier
    v_mfma_f32_16x16x32_bf16 v[32:35], a[128:131], v[180:183], v[32:35]
    s_mov_b32 m0, s70
    v_add_u32 v231, s27, v233
    v_mfma_f32_16x16x32_bf16 a[232:235], a[224:227], v[180:183], a[232:235]
    buffer_load_dwordx4 v236, s[12:15], s25 offen offset:2048 lds
    v_mfma_f32_16x16x32_bf16 v[36:39], a[132:135], v[180:183], v[36:39]
    ds_read_b64_tr_b16 a[128:129], v231 offset:0
    v_add_u32 v230, s27, v232
    v_cvt_pk_bf16_f32 v176, v128, v129
    v_mfma_f32_16x16x32_bf16 v[40:43], a[136:139], v[180:183], v[40:43]
    v_exp_f32 v130, v130
    v_mfma_f32_16x16x32_bf16 v[44:47], a[140:143], v[180:183], v[44:47]
    s_mov_b32 m0, s70
    ds_read_b64_tr_b16 a[130:131], v231 offset:512
    ds_read_b64_tr_b16 a[132:133], v231 offset:32
    v_mfma_f32_16x16x32_bf16 v[48:51], a[144:147], v[180:183], v[48:51]
    buffer_load_dwordx4 v237, s[12:15], s25 offen offset:3104 lds
    v_mfma_f32_16x16x32_bf16 v[52:55], a[148:151], v[180:183], v[52:55]
    s_add_u32 s14, s10, 4096
    ds_read_b64_tr_b16 a[134:135], v231 offset:544
    ds_read_b64_tr_b16 a[136:137], v231 offset:64
    ds_read_b64_tr_b16 a[138:139], v231 offset:576
    v_mfma_f32_16x16x32_bf16 v[56:59], a[152:155], v[180:183], v[56:59]
    s_mov_b32 s25, s24
    ds_read_b64_tr_b16 a[140:141], v231 offset:96
    ds_read_b64_tr_b16 a[142:143], v231 offset:608
    ds_read_b64_tr_b16 a[144:145], v231 offset:128
    v_mfma_f32_16x16x32_bf16 v[60:63], a[156:159], v[180:183], v[60:63]
    s_mov_b32 m0, s70
    ds_read_b64_tr_b16 a[146:147], v231 offset:640
    ds_read_b64_tr_b16 a[148:149], v231 offset:160
    s_sub_u32 s26, s26, 1
    s_cbranch_scc0 L_lq2
    s_sub_u32 s26, s91, 1
    s_mov_b32 s91, 0
    s_branch L_loop2
L_out2:
    s_cmp_eq_u32 s71, 12
    s_cbranch_scc1 L_tail2_12
L_tail2_8:
    v_mfma_f32_16x16x32_bf16 v[136:139], a[96:99], a[16:19], v[204:207]
    ds_read_b64_tr_b16 a[150:151], v231 offset:672
    ds_read_b64_tr_b16 a[152:153], v231 offset:192
    ds_read_b64_tr_b16 a[154:155], v231 offset:704
    v_mfma_f32_16x16x32_bf16 v[136:139], a[100:103], a[20:23], v[136:139]
    v_exp_f32 v131, v131
    v_mfma_f32_16x16x32_bf16 v[136:139], a[104:107], a[24:27], v[136:139]
    ds_read_b64_tr_b16 a[156:157], v231 offset:224
    ds_read_b64_tr_b16 a[158:159], v231 offset:736
    ds_read_b128 a[96:99], v230 offset:0
    v_mfma_f32_16x16x32_bf16 v[136:139], a[108:111], a[28:31], v[136:139]
    ds_read_b128 a[100:103], v230 offset:64
    ds_read_b128 a[104:107], v230 offset:128
    ds_read_b128 a[108:111], v230 offset:192
    v_mfma_f32_16x16x32_bf16 v[140:143], a[112:115], a[16:19], v[204:207]
    v_exp_f32 v132, v132
    v_mfma_f32_16x16x32_bf16 v[140:143], a[116:119], a[20:23], v[140:143]
    v_exp_f32 v133, v133
    v_mfma_f32_16x16x32_bf16 v[140:143], a[120:123], a[24:27], v[140:143]
    v_exp_f32 v134, v134
    v_mfma_f32_16x16x32_bf16 v[140:143], a[124:127], a[28:31], v[140:143]
    s_waitcnt lgkmcnt(6)
    v_exp_f32 v135, v135
    v_cvt_pk_bf16_f32 v177, v130, v131
    v_cvt_pk_bf16_f32 v178, v132, v133
    v_cvt_pk_bf16_f32 v179, v134, v135
    s_nop 1
    v_mfma_f32_16x16x32_bf16 v[0:3], a[128:131], v[176:179], v[0:3]
    v_exp_f32 v136, v136
    v_mfma_f32_16x16x32_bf16 a[228:231], a[224:227], v[176:179], a[228:231]
    v_exp_f32 v137, v137
    v_mfma_f32_16x16x32_bf16 v[4:7], a[132:135], v[176:179], v[4:7]
    v_exp_f32 v138, v138
    v_mfma_f32_16x16x32_bf16 v[8:11], a[136:139], v[176:179], v[8:11]
    v_exp_f32 v139, v139
    v_mfma_f32_16x16x32_bf16 v[12:15], a[140:143], v[176:179], v[12:15]
    v_cvt_pk_bf16_f32 v180, v136, v137
    v_cvt_pk_bf16_f32 v181, v138, v139
    v_mfma_f32_16x16x32_bf16 v[16:19], a[144:147], v[176:179], v[16:19]
    v_exp_f32 v140, v140
    v_mfma_f32_16x16x32_bf16 v[20:23], a[148:151], v[176:179], v[20:23]
    v_exp_f32 v141, v141
    v_mfma_f32_16x16x32_bf16 v[24:27], a[152:155], v[176:179], v[24:27]
    s_waitcnt lgkmcnt(0)
    s_mov_b32 m0, s27
    v_exp_f32 v142, v142
    v_mfma_f32_16x16x32_bf16 v[28:31], a[156:159], v[176:179], v[28:31]
    s_add_u32 s27, s27, 16640
    v_exp_f32 v143, v143
    v_mfma_f32_16x16x32_bf16 v[128:131], a[96:99], a[0:3], v[200:203]
    s_cmp_eq_u32 s27, s29
    v_cvt_pk_bf16_f32 v182, v140, v141
    v_cvt_pk_bf16_f32 v183, v142, v143
    v_mfma_f32_16x16x32_bf16 v[128:131], a[100:103], a[4:7], v[128:131]
    s_cselect_b32 s27, s28, s27
    v_mov_b32 v178, 0
    v_mov_b32 v179, 0
    v_mfma_f32_16x16x32_bf16 v[128:131], a[104:107], a[8:11], v[128:131]
    s_waitcnt vmcnt(10)
    v_mfma_f32_16x16x32_bf16 v[128:131], a[108:111], a[12:15], v[128:131]
    s_barrier
    v_mfma_f32_16x16x32_bf16 v[32:35], a[128:131], v[180:183], v[32:35]
    s_add_u32 s66, s33, 0
    v_add_u32 v231, s27, v233
    v_add_u32 v230, s27, v232
    v_mfma_f32_16x16x32_bf16 a[232:235], a[224:227], v[180:183], a[232:235]
    s_add_u32 s67, s33, 65536
    ds_read_b64_tr_b16 a[128:129], v231 offset:0
    ds_read_b64_tr_b16 a[130:131], v231 offset:512
    v_mfma_f32_16x16x32_bf16 v[36:39], a[132:135], v[180:183], v[36:39]
    ds_read_b64_tr_b16 a[132:133], v231 offset:32
    ds_read_b64_tr_b16 a[134:135], v231 offset:544
    v_mfma_f32_16x16x32_bf16 v[40:43], a[136:139], v[180:183], v[40:43]
    ds_read_b64_tr_b16 a[136:137], v231 offset:64
    ds_read_b64_tr_b16 a[138:139], v231 offset:576
    v_mfma_f32_16x16x32_bf16 v[44:47], a[140:143], v[180:183], v[44:47]
    ds_read_b64_tr_b16 a[140:141], v231 offset:96
    ds_read_b64_tr_b16 a[142:143], v231 offset:608
    v_mfma_f32_16x16x32_bf16 v[48:51], a[144:147], v[180:183], v[48:51]
    ds_read_b64_tr_b16 a[144:145], v231 offset:128
    ds_read_b64_tr_b16 a[146:147], v231 offset:640
    v_mfma_f32_16x16x32_bf16 v[52:55], a[148:151], v[180:183], v[52:55]
    ds_read_b64_tr_b16 a[148:149], v231 offset:160
    ds_read_b64_tr_b16 a[150:151], v231 offset:672
    v_mfma_f32_16x16x32_bf16 v[56:59], a[152:155], v[180:183], v[56:59]
    ds_read_b64_tr_b16 a[152:153], v231 offset:192
    ds_read_b64_tr_b16 a[154:155], v231 offset:704
    v_mfma_f32_16x16x32_bf16 v[60:63], a[156:159], v[180:183], v[60:63]
    ds_read_b64_tr_b16 a[156:157], v231 offset:224
    ds_read_b64_tr_b16 a[158:159], v231 offset:736
    v_mov_b32 v182, 0
    v_mfma_f32_16x16x32_bf16 v[136:139], a[96:99], a[16:19], v[204:207]
    v_exp_f32 v128, v128
    v_mfma_f32_16x16x32_bf16 v[136:139], a[100:103], a[20:23], v[136:139]
    v_cndmask_b32 v128, 0, v128, s[40:41]
    v_mov_b32 v183, 0
    v_mfma_f32_16x16x32_bf16 v[136:139], a[104:107], a[24:27], v[136:139]
    v_exp_f32 v129, v129
    v_mfma_f32_16x16x32_bf16 v[136:139], a[108:111], a[28:31], v[136:139]
    s_waitcnt lgkmcnt(4)
    v_exp_f32 v130, v130
    v_cndmask_b32 v129, 0, v129, s[42:43]
    v_exp_f32 v131, v131
    v_cndmask_b32 v130, 0, v130, s[44:45]
    v_cndmask_b32 v131, 0, v131, s[46:47]
    v_cvt_pk_bf16_f32 v176, v128, v129
    v_cvt_pk_bf16_f32 v177, v130, v131
    s_nop 1
    v_mfma_f32_16x16x32_bf16 v[0:3], a[128:131], v[176:179], v[0:3]
    v_exp_f32 v136, v136
    v_mfma_f32_16x16x32_bf16 a[228:231], a[224:227], v[176:179], a[228:231]
    v_exp_f32 v137, v137
    v_cndmask_b32 v136, 0, v136, s[40:41]
    v_mfma_f32_16x16x32_bf16 v[4:7], a[132:135], v[176:179], v[4:7]
    v_exp_f32 v138, v138
    v_cndmask_b32 v137, 0, v137, s[42:43]
    v_mfma_f32_16x16x32_bf16 v[8:11], a[136:139], v[176:179], v[8:11]
    v_exp_f32 v139, v139
    v_cndmask_b32 v138, 0, v138, s[44:45]
    v_mfma_f32_16x16x32_bf16 v[12:15], a[140:143], v[176:179], v[12:15]
    v_accvgpr_read_b32 v224, a228
    v_rcp_f32 v200, v224
    v_mfma_f32_16x16x32_bf16 v[16:19], a[144:147], v[176:179], v[16:19]
    v_cmp_nle_f32 s[68:69], v224, s63
    v_cndmask_b32 v139, 0, v139, s[46:47]
    v_mfma_f32_16x16x32_bf16 v[20:23], a[148:151], v[176:179], v[20:23]
    s_waitcnt lgkmcnt(0)
    v_cvt_pk_bf16_f32 v180, v136, v137
    v_cvt_pk_bf16_f32 v181, v138, v139
    v_mfma_f32_16x16x32_bf16 v[24:27], a[152:155], v[176:179], v[24:27]
    s_or_b64 s[56:57], s[56:57], s[68:69]
    v_mfma_f32_16x16x32_bf16 v[28:31], a[156:159], v[176:179], v[28:31]
    v_pk_mul_f32 v[0:1], v[0:1], v[200:201] op_sel_hi:[1,0]
    v_pk_mul_f32 v[2:3], v[2:3], v[200:201] op_sel_hi:[1,0]
    v_cvt_pk_bf16_f32 v0, v0, v1
    v_pk_mul_f32 v[4:5], v[4:5], v[200:201] op_sel_hi:[1,0]
    v_pk_mul_f32 v[6:7], v[6:7], v[200:201] op_sel_hi:[1,0]
    v_pk_mul_f32 v[8:9], v[8:9], v[200:201] op_sel_hi:[1,0]
    v_pk_mul_f32 v[10:11], v[10:11], v[200:201] op_sel_hi:[1,0]
    v_pk_mul_f32 v[12:13], v[12:13], v[200:201] op_sel_hi:[1,0]
    v_pk_mul_f32 v[14:15], v[14:15], v[200:201] op_sel_hi:[1,0]
    v_pk_mul_f32 v[16:17], v[16:17], v[200:201] op_sel_hi:[1,0]
    v_pk_mul_f32 v[18:19], v[18:19], v[200:201] op_sel_hi:[1,0]
    v_pk_mul_f32 v[20:21], v[20:21], v[200:201] op_sel_hi:[1,0]
    v_pk_mul_f32 v[22:23], v[22:23], v[200:201] op_sel_hi:[1,0]
    v_pk_mul_f32 v[24:25], v[24:25], v[200:201] op_sel_hi:[1,0]
    v_pk_mul_f32 v[26:27], v[26:27], v[200:201] op_sel_hi:[1,0]
    v_pk_mul_f32 v[28:29], v[28:29], v[200:201] op_sel_hi:[1,0]
    v_pk_mul_f32 v[30:31], v[30:31], v[200:201] op_sel_hi:[1,0]
    v_mfma_f32_16x16x32_bf16 v[32:35], a[128:131], v[180:183], v[32:35]
    v_cvt_pk_bf16_f32 v1, v2, v3
    v_cvt_pk_bf16_f32 v2, v4, v5
    v_cvt_pk_bf16_f32 v3, v6, v7
    v_mfma_f32_16x16x32_bf16 a[232:235], a[224:227], v[180:183], a[232:235]
    ds_write_b64 v242, v[0:1] offset:0
    ds_write_b64 v242, v[2:3] offset:32
    v_cvt_pk_bf16_f32 v4, v8, v9
    v_mfma_f32_16x16x32_bf16 v[36:39], a[132:135], v[180:183], v[36:39]
    v_cvt_pk_bf16_f32 v5, v10, v11
    v_cvt_pk_bf16_f32 v6, v12, v13
    v_cvt_pk_bf16_f32 v7, v14, v15
    v_mfma_f32_16x16x32_bf16 v[40:43], a[136:139], v[180:183], v[40:43]
    ds_write_b64 v242, v[4:5] offset:64
    ds_write_b64 v242, v[6:7] offset:96
    v_cvt_pk_bf16_f32 v8, v16, v17
    v_mfma_f32_16x16x32_bf16 v[44:47], a[140:143], v[180:183], v[44:47]
    v_cvt_pk_bf16_f32 v9, v18, v19
    v_cvt_pk_bf16_f32 v10, v20, v21
    v_cvt_pk_bf16_f32 v11, v22, v23
    v_mfma_f32_16x16x32_bf16 v[48:51], a[144:147], v[180:183], v[48:51]
    ds_write_b64 v242, v[8:9] offset:128
    ds_write_b64 v242, v[10:11] offset:160
    v_cvt_pk_bf16_f32 v12, v24, v25
    v_mfma_f32_16x16x32_bf16 v[52:55], a[148:151], v[180:183], v[52:55]
    v_cvt_pk_bf16_f32 v13, v26, v27
    v_cvt_pk_bf16_f32 v14, v28, v29
    v_cvt_pk_bf16_f32 v15, v30, v31
    v_mfma_f32_16x16x32_bf16 v[56:59], a[152:155], v[180:183], v[56:59]
    ds_write_b64 v242, v[12:13] offset:192
    ds_write_b64 v242, v[14:15] offset:224
    ds_read_b64 v[16:17], v243 offset:0
    v_mfma_f32_16x16x32_bf16 v[60:63], a[156:159], v[180:183], v[60:63]
    ds_read_b64 v[18:19], v245 offset:0
    ds_read_b64 v[20:21], v243 offset:1056
    v_accvgpr_read_b32 v225, a232
    ds_read_b64 v[22:23], v245 offset:1056
    ds_read_b64 v[24:25], v243 offset:2112
    v_rcp_f32 v204, v225
    ds_read_b64 v[26:27], v245 offset:2112
    v_pk_mul_f32 v[32:33], v[32:33], v[204:205] op_sel_hi:[1,0]
    ds_read_b64 v[28:29], v243 offset:3168
    v_pk_mul_f32 v[34:35], v[34:35], v[204:205] op_sel_hi:[1,0]
    v_cvt_pk_bf16_f32 v32, v32, v33
    ds_read_b64 v[30:31], v245 offset:3168
    v_pk_mul_f32 v[36:37], v[36:37], v[204:205] op_sel_hi:[1,0]
    v_pk_mul_f32 v[38:39], v[38:39], v[204:205] op_sel_hi:[1,0]
    v_cvt_pk_bf16_f32 v33, v34, v35
    v_pk_mul_f32 v[40:41], v[40:41], v[204:205] op_sel_hi:[1,0]
    v_pk_mul_f32 v[42:43], v[42:43], v[204:205] op_sel_hi:[1,0]
    ds_write_b64 v242, v[32:33] offset:0
    v_cvt_pk_bf16_f32 v34, v36, v37
    v_cvt_pk_bf16_f32 v35, v38, v39
    v_pk_mul_f32 v[44:45], v[44:45], v[204:205] op_sel_hi:[1,0]
    v_pk_mul_f32 v[46:47], v[46:47], v[204:205] op_sel_hi:[1,0]
    ds_write_b64 v242, v[34:35] offset:32
    v_cvt_pk_bf16_f32 v36, v40, v41
    v_cvt_pk_bf16_f32 v37, v42, v43
    v_pk_mul_f32 v[48:49], v[48:49], v[204:205] op_sel_hi:[1,0]
    v_pk_mul_f32 v[50:51], v[50:51], v[204:205] op_sel_hi:[1,0]
    ds_write_b64 v242, v[36:37] offset:64
    v_cvt_pk_bf16_f32 v38, v44, v45
    v_cvt_pk_bf16_f32 v39, v46, v47
    v_pk_mul_f32 v[52:53], v[52:53], v[204:205] op_sel_hi:[1,0]
    v_pk_mul_f32 v[54:55], v[54:55], v[204:205] op_sel_hi:[1,0]
    ds_write_b64 v242, v[38:39] offset:96
    v_cvt_pk_bf16_f32 v40, v48, v49
    v_cvt_pk_bf16_f32 v41, v50, v51
    v_pk_mul_f32 v[56:57], v[56:57], v[204:205] op_sel_hi:[1,0]
    v_pk_mul_f32 v[58:59], v[58:59], v[204:205] op_sel_hi:[1,0]
    ds_write_b64 v242, v[40:41] offset:128
    v_cvt_pk_bf16_f32 v42, v52, v53
    v_cvt_pk_bf16_f32 v43, v54, v55
    v_pk_mul_f32 v[60:61], v[60:61], v[204:205] op_sel_hi:[1,0]
    v_pk_mul_f32 v[62:63], v[62:63], v[204:205] op_sel_hi:[1,0]
    ds_write_b64 v242, v[42:43] offset:160
    v_cvt_pk_bf16_f32 v44, v56, v57
    v_cvt_pk_bf16_f32 v45, v58, v59
    ds_write_b64 v242, v[44:45] offset:192
    v_cvt_pk_bf16_f32 v46, v60, v61
    v_cvt_pk_bf16_f32 v47, v62, v63
    ds_write_b64 v242, v[46:47] offset:224
    ds_read_b64 v[48:49], v243 offset:0
    ds_read_b64 v[50:51], v245 offset:0
    s_waitcnt lgkmcnt(9)
    buffer_store_dwordx4 v[16:19], v239, s[20:23], s66 offen nt
    ds_read_b64 v[52:53], v243 offset:1056
    ds_read_b64 v[54:55], v245 offset:1056
    buffer_store_dwordx4 v[20:23], v241, s[20:23], s66 offen nt
    ds_read_b64 v[56:57], v243 offset:2112
    ds_read_b64 v[58:59], v245 offset:2112
    buffer_store_dwordx4 v[24:27], v246, s[20:23], s66 offen nt
    ds_read_b64 v[60:61], v243 offset:3168
    ds_read_b64 v[62:63], v245 offset:3168
    v_cmp_nle_f32 s[68:69], v225, s63
    buffer_store_dwordx4 v[28:31], v247, s[20:23], s66 offen nt
    s_or_b64 s[56:57], s[56:57], s[68:69]
    s_cmp_lg_u64 s[56:57], 0
    s_cselect_b32 s6, 1, 0
    s_lshl_b32 s6, s6, s59
    s_or_b32 s58, s58, s6
    s_mov_b64 s[56:57], 0
    s_add_u32 s59, s59, 1
    s_waitcnt lgkmcnt(6)
    buffer_store_dwordx4 v[48:51], v239, s[20:23], s67 offen nt
    s_waitcnt lgkmcnt(4)
    buffer_store_dwordx4 v[52:55], v241, s[20:23], s67 offen nt
    s_waitcnt lgkmcnt(2)
    buffer_store_dwordx4 v[56:59], v246, s[20:23], s67 offen nt
    s_waitcnt lgkmcnt(0)
    buffer_store_dwordx4 v[60:63], v247, s[20:23], s67 offen nt
    s_branch L_fin
L_tail2_8e:
L_tail2_12:
    v_mfma_f32_16x16x32_bf16 v[136:139], a[96:99], a[16:19], v[204:207]
    s_mov_b32 s70, m0
    ds_read_b64_tr_b16 a[150:151], v231 offset:672
    ds_read_b64_tr_b16 a[152:153], v231 offset:192
    ds_read_b64_tr_b16 a[154:155], v231 offset:704
    v_mfma_f32_16x16x32_bf16 v[136:139], a[100:103], a[20:23], v[136:139]
    ds_read_b64_tr_b16 a[156:157], v231 offset:224
    ds_read_b64_tr_b16 a[158:159], v231 offset:736
    v_mfma_f32_16x16x32_bf16 v[136:139], a[104:107], a[24:27], v[136:139]
    ds_read_b128 a[96:99], v230 offset:0
    ds_read_b128 a[100:103], v230 offset:64
    v_mfma_f32_16x16x32_bf16 v[136:139], a[108:111], a[28:31], v[136:139]
    ds_read_b128 a[104:107], v230 offset:128
    ds_read_b128 a[108:111], v230 offset:192
    v_mfma_f32_16x16x32_bf16 v[140:143], a[112:115], a[16:19], v[204:207]
    v_exp_f32 v131, v131
    v_mfma_f32_16x16x32_bf16 v[140:143], a[116:119], a[20:23], v[140:143]
    v_exp_f32 v132, v132
    v_mfma_f32_16x16x32_bf16 v[140:143], a[120:123], a[24:27], v[140:143]
    s_mov_b32 m0, s70
    v_exp_f32 v133, v133
    v_mfma_f32_16x16x32_bf16 v[140:143], a[124:127], a[28:31], v[140:143]
    s_waitcnt lgkmcnt(4)
    buffer_load_dwordx4 v234, s[8:11], s24 offen lds
    v_exp_f32 v134, v134
    v_exp_f32 v135, v135
    v_cvt_pk_bf16_f32 v177, v130, v131
    v_cvt_pk_bf16_f32 v178, v132, v133
    v_cvt_pk_bf16_f32 v179, v134, v135
    v_sub_u32 v244, s38, v240
    v_cmp_gt_i32 s[48:49], v244, 16
    v_mfma_f32_16x16x32_bf16 v[0:3], a[128:131], v[176:179], v[0:3]
    s_mov_b32 m0, s70
    v_exp_f32 v136, v136
    v_mfma_f32_16x16x32_bf16 a[228:231], a[224:227], v[176:179], a[228:231]
    buffer_load_dwordx4 v235, s[8:11], s24 offen offset:1024 lds
    v_mfma_f32_16x16x32_bf16 v[4:7], a[132:135], v[176:179], v[4:7]
    s_add_u32 s24, s24, 131072
    s_sub_u32 s3, s3, 1
    v_exp_f32 v137, v137
    v_mfma_f32_16x16x32_bf16 v[8:11], a[136:139], v[176:179], v[8:11]
    v_cvt_pk_bf16_f32 v180, v136, v137
    v_cmp_gt_i32 s[50:51], v244, 17
    v_mfma_f32_16x16x32_bf16 v[12:15], a[140:143], v[176:179], v[12:15]
    v_exp_f32 v138, v138
    v_mfma_f32_16x16x32_bf16 v[16:19], a[144:147], v[176:179], v[16:19]
    v_exp_f32 v139, v139
    v_mfma_f32_16x16x32_bf16 v[20:23], a[148:151], v[176:179], v[20:23]
    v_exp_f32 v140, v140
    v_mfma_f32_16x16x32_bf16 v[24:27], a[152:155], v[176:179], v[24:27]
    s_mov_b32 s70, s27
    v_exp_f32 v141, v141
    v_mfma_f32_16x16x32_bf16 v[28:31], a[156:159], v[176:179], v[28:31]
    s_waitcnt lgkmcnt(0)
    s_add_u32 s27, s27, 16640
    v_exp_f32 v142, v142
    v_mfma_f32_16x16x32_bf16 v[128:131], a[96:99], a[0:3], v[200:203]
    s_cmp_eq_u32 s27, s29
    v_exp_f32 v143, v143
    v_mfma_f32_16x16x32_bf16 v[128:131], a[100:103], a[4:7], v[128:131]
    s_cselect_b32 s27, s28, s27
    v_cvt_pk_bf16_f32 v181, v138, v139
    v_cvt_pk_bf16_f32 v182, v140, v141
    v_mfma_f32_16x16x32_bf16 v[128:131], a[104:107], a[8:11], v[128:131]
    s_waitcnt vmcnt(12)
    v_cvt_pk_bf16_f32 v183, v142, v143
    v_mov_b32 v178, 0
    v_mfma_f32_16x16x32_bf16 v[128:131], a[108:111], a[12:15], v[128:131]
    s_barrier
    v_mfma_f32_16x16x32_bf16 v[32:35], a[128:131], v[180:183], v[32:35]
    s_mov_b32 m0, s70
    v_add_u32 v231, s27, v233
    v_add_u32 v230, s27, v232
    v_mov_b32 v179, 0
    v_mfma_f32_16x16x32_bf16 a[232:235], a[224:227], v[180:183], a[232:235]
    buffer_load_dwordx4 v236, s[12:15], s25 offen offset:2048 lds
    v_mfma_f32_16x16x32_bf16 v[36:39], a[132:135], v[180:183], v[36:39]
    ds_read_b64_tr_b16 a[128:129], v231 offset:0
    ds_read_b64_tr_b16 a[130:131], v231 offset:512
    ds_read_b64_tr_b16 a[132:133], v231 offset:32
    v_mfma_f32_16x16x32_bf16 v[40:43], a[136:139], v[180:183], v[40:43]
    ds_read_b64_tr_b16 a[134:135], v231 offset:544
    ds_read_b64_tr_b16 a[136:137], v231 offset:64
    ds_read_b64_tr_b16 a[138:139], v231 offset:576
    v_mfma_f32_16x16x32_bf16 v[44:47], a[140:143], v[180:183], v[44:47]
    s_mov_b32 m0, s70
    ds_read_b64_tr_b16 a[140:141], v231 offset:96
    ds_read_b64_tr_b16 a[142:143], v231 offset:608
    v_cmp_gt_i32 s[52:53], v244, 18
    v_mfma_f32_16x16x32_bf16 v[48:51], a[144:147], v[180:183], v[48:51]
    buffer_load_dwordx4 v237, s[12:15], s25 offen offset:3104 lds
    v_mfma_f32_16x16x32_bf16 v[52:55], a[148:151], v[180:183], v[52:55]
    s_add_u32 s14, s10, 4096
    ds_read_b64_tr_b16 a[144:145], v231 offset:128
    ds_read_b64_tr_b16 a[146:147], v231 offset:640
    ds_read_b64_tr_b16 a[148:149], v231 offset:160
    v_mfma_f32_16x16x32_bf16 v[56:59], a[152:155], v[180:183], v[56:59]
    s_mov_b32 s25, s24
    ds_read_b64_tr_b16 a[150:151], v231 offset:672
    ds_read_b64_tr_b16 a[152:153], v231 offset:192
    ds_read_b64_tr_b16 a[154:155], v231 offset:704
    v_mfma_f32_16x16x32_bf16 v[60:63], a[156:159], v[180:183], v[60:63]
    ds_read_b64_tr_b16 a[156:157], v231 offset:224
    ds_read_b64_tr_b16 a[158:159], v231 offset:736
    v_mov_b32 v182, 0
    v_mfma_f32_16x16x32_bf16 v[136:139], a[96:99], a[16:19], v[204:207]
    ds_read_b128 a[96:99], v230 offset:0
    v_exp_f32 v128, v128
    v_mfma_f32_16x16x32_bf16 v[136:139], a[100:103], a[20:23], v[136:139]
    s_mov_b32 m0, s70
    ds_read_b128 a[100:103], v230 offset:64
    v_cndmask_b32 v128, 0, v128, s[40:41]
    v_mov_b32 v183, 0
    v_mfma_f32_16x16x32_bf16 v[136:139], a[104:107], a[24:27], v[136:139]
    buffer_load_dwordx4 v234, s[8:11], s24 offen lds
    v_mfma_f32_16x16x32_bf16 v[136:139], a[108:111], a[28:31], v[136:139]
    s_waitcnt lgkmcnt(7)
    ds_read_b128 a[104:107], v230 offset:128
    ds_read_b128 a[108:111], v230 offset:192
    ds_read_b128 a[112:115], v230 offset:1024
    v_exp_f32 v129, v129
    v_exp_f32 v130, v130
    v_exp_f32 v131, v131
    v_cndmask_b32 v129, 0, v129, s[42:43]
    v_cndmask_b32 v130, 0, v130, s[44:45]
    v_cndmask_b32 v131, 0, v131, s[46:47]
    v_cvt_pk_bf16_f32 v176, v128, v129
    v_cvt_pk_bf16_f32 v177, v130, v131
    v_cmp_gt_i32 s[54:55], v244, 19
    s_nop 0
    v_mfma_f32_16x16x32_bf16 v[0:3], a[128:131], v[176:179], v[0:3]
    ds_read_b128 a[116:119], v230 offset:1088
    ds_read_b128 a[120:123], v230 offset:1152
    ds_read_b128 a[124:127], v230 offset:1216
    v_mfma_f32_16x16x32_bf16 a[228:231], a[224:227], v[176:179], a[228:231]
    s_mov_b32 m0, s70
    v_exp_f32 v136, v136
    v_mfma_f32_16x16x32_bf16 v[4:7], a[132:135], v[176:179], v[4:7]
    buffer_load_dwordx4 v235, s[8:11], s24 offen offset:1024 lds
    v_mfma_f32_16x16x32_bf16 v[8:11], a[136:139], v[176:179], v[8:11]
    s_add_u32 s24, s24, 131072
    s_sub_u32 s3, s3, 1
    s_add_u32 s66, s33, 0
    s_add_u32 s67, s33, 65536
    v_mfma_f32_16x16x32_bf16 v[12:15], a[140:143], v[176:179], v[12:15]
    s_sub_u32 s26, s37, 4
    s_mov_b32 s91, 0
    s_mov_b32 s4, s31
    s_lshl_b32 s5, s64, 14
    v_mfma_f32_16x16x32_bf16 v[16:19], a[144:147], v[176:179], v[16:19]
    s_waitcnt lgkmcnt(3)
    s_add_u32 s5, s5, s34
    s_cmp_le_u32 s38, 16
    s_cselect_b32 s71, 8, 0
    v_mfma_f32_16x16x32_bf16 v[20:23], a[148:151], v[176:179], v[20:23]
    s_mov_b32 s36, 0
    s_mov_b32 s30, 0x40000000
    v_accvgpr_read_b32 v224, a228
    s_mov_b32 s31, 0
    v_mfma_f32_16x16x32_bf16 v[24:27], a[152:155], v[176:179], v[24:27]
    v_cmp_nle_f32 s[68:69], v224, s63
    v_rcp_f32 v200, v224
    v_mfma_f32_16x16x32_bf16 v[28:31], a[156:159], v[176:179], v[28:31]
    s_or_b64 s[56:57], s[56:57], s[68:69]
    s_waitcnt vmcnt(29)
    v_pk_mul_f32 v[0:1], v[0:1], v[200:201] op_sel_hi:[1,0]
    v_pk_mul_f32 v[2:3], v[2:3], v[200:201] op_sel_hi:[1,0]
    v_pk_mul_f32 v[4:5], v[4:5], v[200:201] op_sel_hi:[1,0]
    v_pk_mul_f32 v[6:7], v[6:7], v[200:201] op_sel_hi:[1,0]
    v_pk_mul_f32 v[8:9], v[8:9], v[200:201] op_sel_hi:[1,0]
    v_pk_mul_f32 v[10:11], v[10:11], v[200:201] op_sel_hi:[1,0]
    v_pk_mul_f32 v[12:13], v[12:13], v[200:201] op_sel_hi:[1,0]
    v_pk_mul_f32 v[14:15], v[14:15], v[200:201] op_sel_hi:[1,0]
    v_pk_mul_f32 v[16:17], v[16:17], v[200:201] op_sel_hi:[1,0]
    v_pk_mul_f32 v[18:19], v[18:19], v[200:201] op_sel_hi:[1,0]
    v_pk_mul_f32 v[20:21], v[20:21], v[200:201] op_sel_hi:[1,0]
    v_pk_mul_f32 v[22:23], v[22:23], v[200:201] op_sel_hi:[1,0]
    v_pk_mul_f32 v[24:25], v[24:25], v[200:201] op_sel_hi:[1,0]
    v_pk_mul_f32 v[26:27], v[26:27], v[200:201] op_sel_hi:[1,0]
    v_pk_mul_f32 v[28:29], v[28:29], v[200:201] op_sel_hi:[1,0]
    v_pk_mul_f32 v[30:31], v[30:31], v[200:201] op_sel_hi:[1,0]
    v_cndmask_b32 v136, 0, v136, s[40:41]
    v_exp_f32 v137, v137
    v_exp_f32 v138, v138
    v_cndmask_b32 v137, 0, v137, s[42:43]
    v_cndmask_b32 v138, 0, v138, s[44:45]
    v_exp_f32 v139, v139
    v_cvt_pk_bf16_f32 v180, v136, v137
    v_cndmask_b32 v139, 0, v139, s[46:47]
    v_cvt_pk_bf16_f32 v181, v138, v139
    v_cvt_pk_bf16_f32 v0, v0, v1
    v_cvt_pk_bf16_f32 v1, v2, v3
    v_mfma_f32_16x16x32_bf16 v[32:35], a[128:131], v[180:183], v[32:35]
    ds_read_b128 a[0:3], v238 offset:0
    ds_read_b128 a[4:7], v238 offset:64
    ds_read_b128 a[8:11], v238 offset:128
    v_mfma_f32_16x16x32_bf16 a[232:235], a[224:227], v[180:183], a[232:235]
    ds_read_b128 a[12:15], v238 offset:192
    ds_write_b64 v242, v[0:1] offset:0
    v_cvt_pk_bf16_f32 v2, v4, v5
    v_mfma_f32_16x16x32_bf16 v[36:39], a[132:135], v[180:183], v[36:39]
    v_cvt_pk_bf16_f32 v3, v6, v7
    v_cvt_pk_bf16_f32 v4, v8, v9
    v_cvt_pk_bf16_f32 v5, v10, v11
    v_mfma_f32_16x16x32_bf16 v[40:43], a[136:139], v[180:183], v[40:43]
    ds_write_b64 v242, v[2:3] offset:32
    ds_write_b64 v242, v[4:5] offset:64
    v_cvt_pk_bf16_f32 v6, v12, v13
    v_mfma_f32_16x16x32_bf16 v[44:47], a[140:143], v[180:183], v[44:47]
    v_cvt_pk_bf16_f32 v7, v14, v15
    v_cvt_pk_bf16_f32 v8, v16, v17
    v_cvt_pk_bf16_f32 v9, v18, v19
    v_mfma_f32_16x16x32_bf16 v[48:51], a[144:147], v[180:183], v[48:51]
    ds_write_b64 v242, v[6:7] offset:96
    ds_write_b64 v242, v[8:9] offset:128
    v_cvt_pk_bf16_f32 v10, v20, v21
    v_mfma_f32_16x16x32_bf16 v[52:55], a[148:151], v[180:183], v[52:55]
    v_cvt_pk_bf16_f32 v11, v22, v23
    v_cvt_pk_bf16_f32 v12, v24, v25
    v_cvt_pk_bf16_f32 v13, v26, v27
    v_mfma_f32_16x16x32_bf16 v[56:59], a[152:155], v[180:183], v[56:59]
    ds_write_b64 v242, v[10:11] offset:160
    ds_write_b64 v242, v[12:13] offset:192
    v_cvt_pk_bf16_f32 v14, v28, v29
    v_mfma_f32_16x16x32_bf16 v[60:63], a[156:159], v[180:183], v[60:63]
    s_waitcnt lgkmcnt(6)
    v_cvt_pk_bf16_f32 v15, v30, v31
    v_accvgpr_read_b32 v225, a232
    v_cmp_gt_i32 s[40:41], v244, 0
    v_rcp_f32 v204, v225
    v_cmp_gt_i32 s[42:43], v244, 1
    v_pk_mul_f32 v[32:33], v[32:33], v[204:205] op_sel_hi:[1,0]
    v_pk_mul_f32 v[34:35], v[34:35], v[204:205] op_sel_hi:[1,0]
    v_pk_mul_f32 v[36:37], v[36:37], v[204:205] op_sel_hi:[1,0]
    v_pk_mul_f32 v[38:39], v[38:39], v[204:205] op_sel_hi:[1,0]
    v_pk_mul_f32 v[40:41], v[40:41], v[204:205] op_sel_hi:[1,0]
    v_pk_mul_f32 v[42:43], v[42:43], v[204:205] op_sel_hi:[1,0]
    v_pk_mul_f32 v[44:45], v[44:45], v[204:205] op_sel_hi:[1,0]
    v_pk_mul_f32 v[46:47], v[46:47], v[204:205] op_sel_hi:[1,0]
    v_pk_mul_f32 v[48:49], v[48:49], v[204:205] op_sel_hi:[1,0]
    v_pk_mul_f32 v[50:51], v[50:51], v[204:205] op_sel_hi:[1,0]
    v_pk_mul_f32 v[52:53], v[52:53], v[204:205] op_sel_hi:[1,0]
    v_pk_mul_f32 v[54:55], v[54:55], v[204:205] op_sel_hi:[1,0]
    v_pk_mul_f32 v[56:57], v[56:57], v[204:205] op_sel_hi:[1,0]
    v_pk_mul_f32 v[58:59], v[58:59], v[204:205] op_sel_hi:[1,0]
    v_pk_mul_f32 v[60:61], v[60:61], v[204:205] op_sel_hi:[1,0]
    v_pk_mul_f32 v[62:63], v[62:63], v[204:205] op_sel_hi:[1,0]
    v_mfma_f32_16x16x32_bf16 v[64:67], a[82:85], a[0:3], 0
    ds_write_b64 v242, v[14:15] offset:224
    ds_read_b64 v[16:17], v243 offset:0
    ds_read_b64 v[18:19], v245 offset:0
    v_mfma_f32_16x16x32_bf16 v[64:67], a[86:89], a[0:3], v[64:67]
    ds_read_b64 v[20:21], v243 offset:1056
    ds_read_b64 v[22:23], v245 offset:1056
    ds_read_b64 v[24:25], v243 offset:2112
    v_mfma_f32_16x16x32_bf16 v[68:71], a[80:83], a[0:3], 0
    ds_read_b64 v[26:27], v245 offset:2112
    ds_read_b64 v[28:29], v243 offset:3168
    v_cvt_pk_bf16_f32 v32, v32, v33
    v_mfma_f32_16x16x32_bf16 v[68:71], a[84:87], a[0:3], v[68:71]
    ds_read_b64 v[30:31], v245 offset:3168
    v_cvt_pk_bf16_f32 v33, v34, v35
    v_cvt_pk_bf16_f32 v34, v36, v37
    v_mfma_f32_16x16x32_bf16 v[72:75], a[82:85], a[4:7], 0
    ds_write_b64 v242, v[32:33] offset:0
    v_cvt_pk_bf16_f32 v35, v38, v39
    v_cvt_pk_bf16_f32 v36, v40, v41
    v_mfma_f32_16x16x32_bf16 v[72:75], a[86:89], a[4:7], v[72:75]
    ds_write_b64 v242, v[34:35] offset:32
    v_cvt_pk_bf16_f32 v37, v42, v43
    v_cvt_pk_bf16_f32 v38, v44, v45
    v_mfma_f32_16x16x32_bf16 v[76:79], a[80:83], a[4:7], 0
    ds_write_b64 v242, v[36:37] offset:64
    v_cvt_pk_bf16_f32 v39, v46, v47
    v_cvt_pk_bf16_f32 v40, v48, v49
    v_mfma_f32_16x16x32_bf16 v[76:79], a[84:87], a[4:7], v[76:79]
    s_waitcnt lgkmcnt(6)
    buffer_store_dwordx4 v[16:19], v239, s[20:23], s66 offen nt
    v_mfma_f32_16x16x32_bf16 v[80:83], a[82:85], a[8:11], 0
    ds_write_b64 v242, v[38:39] offset:96
    v_cvt_pk_bf16_f32 v41, v50, v51
    v_cvt_pk_bf16_f32 v42, v52, v53
    v_mfma_f32_16x16x32_bf16 v[80:83], a[86:89], a[8:11], v[80:83]
    ds_write_b64 v242, v[40:41] offset:128
    v_cvt_pk_bf16_f32 v43, v54, v55
    v_cvt_pk_bf16_f32 v44, v56, v57
    v_mfma_f32_16x16x32_bf16 v[84:87], a[80:83], a[8:11], 0
    ds_write_b64 v242, v[42:43] offset:160
    v_cvt_pk_bf16_f32 v45, v58, v59
    v_cvt_pk_bf16_f32 v46, v60, v61
    v_mfma_f32_16x16x32_bf16 v[84:87], a[84:87], a[8:11], v[84:87]
    ds_write_b64 v242, v[44:45] offset:192
    v_cvt_pk_bf16_f32 v47, v62, v63
    v_cmp_gt_i32 s[44:45], v244, 2
    v_mfma_f32_16x16x32_bf16 v[88:91], a[82:85], a[12:15], 0
    ds_write_b64 v242, v[46:47] offset:224
    ds_read_b64 v[48:49], v243 offset:0
    ds_read_b64 v[50:51], v245 offset:0
    v_mfma_f32_16x16x32_bf16 v[88:91], a[86:89], a[12:15], v[88:91]
    buffer_store_dwordx4 v[20:23], v241, s[20:23], s66 offen nt
    v_mfma_f32_16x16x32_bf16 v[92:95], a[80:83], a[12:15], 0
    ds_read_b64 v[52:53], v243 offset:1056
    ds_read_b64 v[54:55], v245 offset:1056
    v_cmp_gt_i32 s[46:47], v244, 3
    v_mfma_f32_16x16x32_bf16 v[92:95], a[84:87], a[12:15], v[92:95]
    ds_read_b64 v[56:57], v243 offset:2112
    ds_read_b64 v[58:59], v245 offset:2112
    ds_read_b64 v[60:61], v243 offset:3168
    ds_read_b64 v[62:63], v245 offset:3168
    v_cmp_nle_f32 s[68:69], v225, s63
    v_cvt_pk_bf16_f32 v64, v64, v65
    s_or_b64 s[56:57], s[56:57], s[68:69]
    s_waitcnt vmcnt(30)
    ds_read_b128 a[16:19], v238 offset:4352
    v_cvt_pk_bf16_f32 v65, v66, v67
    v_accvgpr_write_b32 a0, v64
    v_accvgpr_write_b32 a1, v65
    v_cvt_pk_bf16_f32 v68, v68, v69
    v_cvt_pk_bf16_f32 v69, v70, v71
    v_accvgpr_write_b32 a2, v68
    v_accvgpr_write_b32 a3, v69
    v_cvt_pk_bf16_f32 v72, v72, v73
    v_cvt_pk_bf16_f32 v73, v74, v75
    v_cvt_pk_bf16_f32 v76, v76, v77
    v_cvt_pk_bf16_f32 v77, v78, v79
    v_accvgpr_write_b32 a4, v72
    v_accvgpr_write_b32 a5, v73
    v_accvgpr_write_b32 a6, v76
    v_accvgpr_write_b32 a7, v77
    v_cvt_pk_bf16_f32 v80, v80, v81
    s_waitcnt lgkmcnt(0)
    v_mfma_f32_16x16x32_bf16 v[64:67], a[82:85], a[16:19], 0
    buffer_store_dwordx4 v[24:27], v246, s[20:23], s66 offen nt
    v_mfma_f32_16x16x32_bf16 v[64:67], a[86:89], a[16:19], v[64:67]
    ds_read_b128 a[20:23], v238 offset:4416
    ds_read_b128 a[24:27], v238 offset:4480
    ds_read_b128 a[28:31], v238 offset:4544
    v_mfma_f32_16x16x32_bf16 v[68:71], a[80:83], a[16:19], 0
    v_cvt_pk_bf16_f32 v81, v82, v83
    v_cvt_pk_bf16_f32 v84, v84, v85
    v_cvt_pk_bf16_f32 v85, v86, v87
    v_mfma_f32_16x16x32_bf16 v[68:71], a[84:87], a[16:19], v[68:71]
    s_waitcnt lgkmcnt(2)
    v_accvgpr_write_b32 a8, v80
    v_accvgpr_write_b32 a9, v81
    v_accvgpr_write_b32 a10, v84
    v_mfma_f32_16x16x32_bf16 v[72:75], a[82:85], a[20:23], 0
    v_accvgpr_write_b32 a11, v85
    v_cvt_pk_bf16_f32 v88, v88, v89
    v_cvt_pk_bf16_f32 v89, v90, v91
    v_mfma_f32_16x16x32_bf16 v[72:75], a[86:89], a[20:23], v[72:75]
    v_cvt_pk_bf16_f32 v92, v92, v93
    v_cvt_pk_bf16_f32 v93, v94, v95
    v_accvgpr_write_b32 a12, v88
    v_mfma_f32_16x16x32_bf16 v[76:79], a[80:83], a[20:23], 0
    buffer_store_dwordx4 v[28:31], v247, s[20:23], s66 offen nt
    v_mfma_f32_16x16x32_bf16 v[76:79], a[84:87], a[20:23], v[76:79]
    s_waitcnt lgkmcnt(0)
    v_accvgpr_write_b32 a13, v89
    v_accvgpr_write_b32 a14, v92
    v_accvgpr_write_b32 a15, v93
    v_mfma_f32_16x16x32_bf16 v[80:83], a[82:85], a[24:27], 0
    v_cvt_pk_bf16_f32 v64, v64, v65
    v_cvt_pk_bf16_f32 v65, v66, v67
    v_cvt_pk_bf16_f32 v68, v68, v69
    v_mfma_f32_16x16x32_bf16 v[80:83], a[86:89], a[24:27], v[80:83]
    v_cvt_pk_bf16_f32 v69, v70, v71
    v_accvgpr_write_b32 a16, v64
    v_accvgpr_write_b32 a17, v65
    v_mfma_f32_16x16x32_bf16 v[84:87], a[80:83], a[24:27], 0
    v_accvgpr_write_b32 a18, v68
    v_accvgpr_write_b32 a19, v69
    v_cvt_pk_bf16_f32 v72, v72, v73
    v_mfma_f32_16x16x32_bf16 v[84:87], a[84:87], a[24:27], v[84:87]
    v_cvt_pk_bf16_f32 v73, v74, v75
    v_cvt_pk_bf16_f32 v76, v76, v77
    v_cvt_pk_bf16_f32 v77, v78, v79
    v_mfma_f32_16x16x32_bf16 v[88:91], a[82:85], a[28:31], 0
    buffer_store_dwordx4 v[48:51], v239, s[20:23], s67 offen nt
    v_mfma_f32_16x16x32_bf16 v[88:91], a[86:89], a[28:31], v[88:91]
    v_accvgpr_write_b32 a20, v72
    v_accvgpr_write_b32 a21, v73
    v_accvgpr_write_b32 a22, v76
    v_mfma_f32_16x16x32_bf16 v[92:95], a[80:83], a[28:31], 0
    v_accvgpr_write_b32 a23, v77
    v_cvt_pk_bf16_f32 v80, v80, v81
    v_cvt_pk_bf16_f32 v81, v82, v83
    v_mfma_f32_16x16x32_bf16 v[92:95], a[84:87], a[28:31], v[92:95]
    v_cvt_pk_bf16_f32 v84, v84, v85
    v_cvt_pk_bf16_f32 v85, v86, v87
    v_accvgpr_write_b32 a24, v80
    v_mfma_f32_16x16x32_bf16 v[128:131], a[96:99], a[0:3], 0
    v_accvgpr_write_b32 a25, v81
    v_accvgpr_write_b32 a26, v84
    v_accvgpr_write_b32 a27, v85
    v_mfma_f32_16x16x32_bf16 v[128:131], a[100:103], a[4:7], v[128:131]
    v_cvt_pk_bf16_f32 v88, v88, v89
    v_cvt_pk_bf16_f32 v89, v90, v91
    v_cvt_pk_bf16_f32 v92, v92, v93
    v_mfma_f32_16x16x32_bf16 v[128:131], a[104:107], a[8:11], v[128:131]
    s_mov_b32 s70, s27
    buffer_store_dwordx4 v[52:55], v241, s[20:23], s67 offen nt
    v_mfma_f32_16x16x32_bf16 v[128:131], a[108:111], a[12:15], v[128:131]
    s_add_u32 s27, s27, 16640
    v_cvt_pk_bf16_f32 v93, v94, v95
    v_accvgpr_write_b32 a28, v88
    v_accvgpr_write_b32 a29, v89
    v_mfma_f32_16x16x32_bf16 v[132:135], a[112:115], a[0:3], 0
    s_cmp_eq_u32 s27, s29
    v_accvgpr_write_b32 a30, v92
    v_accvgpr_write_b32 a31, v93
    v_max3_f32 v176, v128, v129, v130
    v_mfma_f32_16x16x32_bf16 v[132:135], a[116:119], a[4:7], v[132:135]
    s_cselect_b32 s27, s28, s27
    v_mfma_f32_16x16x32_bf16 v[132:135], a[120:123], a[8:11], v[132:135]
    s_waitcnt vmcnt(18)
    v_mfma_f32_16x16x32_bf16 v[132:135], a[124:127], a[12:15], v[132:135]
    s_barrier
    v_add_u32 v231, s27, v233
    ds_read_b64_tr_b16 a[128:129], v231 offset:0
    ds_read_b64_tr_b16 a[130:131], v231 offset:512
    ds_read_b64_tr_b16 a[132:133], v231 offset:32
    buffer_store_dwordx4 v[56:59], v246, s[20:23], s67 offen nt
    s_cmp_lg_u64 s[56:57], 0
    ds_read_b64_tr_b16 a[134:135], v231 offset:544
    ds_read_b64_tr_b16 a[136:137], v231 offset:64
    s_cselect_b32 s6, 1, 0
    ds_read_b64_tr_b16 a[138:139], v231 offset:576
    ds_read_b64_tr_b16 a[140:141], v231 offset:96
    s_lshl_b32 s6, s6, s59
    ds_read_b64_tr_b16 a[142:143], v231 offset:608
    ds_read_b64_tr_b16 a[144:145], v231 offset:128
    s_or_b32 s58, s58, s6
    ds_read_b64_tr_b16 a[146:147], v231 offset:640
    ds_read_b64_tr_b16 a[148:149], v231 offset:160
    s_mov_b64 s[56:57], 0
    ds_read_b64_tr_b16 a[150:151], v231 offset:672
    ds_read_b64_tr_b16 a[152:153], v231 offset:192
    s_add_u32 s59, s59, 1
    ds_read_b64_tr_b16 a[154:155], v231 offset:704
    ds_read_b64_tr_b16 a[156:157], v231 offset:224
    ds_read_b64_tr_b16 a[158:159], v231 offset:736
    s_waitcnt vmcnt(34)
    ds_read_b128 a[32:35], v238 offset:8704
    v_max3_f32 v177, v132, v133, v134
    v_max3_f32 v176, v176, v131, v135
    v_max_f32 v176, v176, v177
    v_mov_b32 v177, v176
    v_add_u32 v230, s27, v232
    s_waitcnt lgkmcnt(0)
    v_mfma_f32_16x16x32_bf16 v[64:67], a[82:85], a[32:35], 0
    buffer_store_dwordx4 v[60:63], v247, s[20:23], s67 offen nt
    v_mfma_f32_16x16x32_bf16 v[64:67], a[86:89], a[32:35], v[64:67]
    ds_read_b128 a[36:39], v238 offset:8768
    ds_read_b128 a[40:43], v238 offset:8832
    ds_read_b128 a[44:47], v238 offset:8896
    v_mfma_f32_16x16x32_bf16 v[68:71], a[80:83], a[32:35], 0
    v_permlane32_swap_b32 v177, v176
    v_max_f32 v176, v176, v177
    v_mov_b32 v177, v176
    v_mfma_f32_16x16x32_bf16 v[68:71], a[84:87], a[32:35], v[68:71]
    s_waitcnt lgkmcnt(2)
    v_permlane16_swap_b32 v177, v176
    v_max_f32 v176, v176, v177
    v_sub_f32 v200, 0, v176
    v_mfma_f32_16x16x32_bf16 v[72:75], a[82:85], a[36:39], 0
    v_sub_f32 v201, 0, v176
    v_sub_f32 v202, 0, v176
    v_sub_f32 v203, 0, v176
    v_mfma_f32_16x16x32_bf16 v[72:75], a[86:89], a[36:39], v[72:75]
    v_sub_f32 v128, v128, v176
    v_sub_f32 v129, v129, v176
    v_sub_f32 v130, v130, v176
    v_mfma_f32_16x16x32_bf16 v[76:79], a[80:83], a[36:39], 0
    v_sub_f32 v131, v131, v176
    v_sub_f32 v132, v132, v176
    v_sub_f32 v133, v133, v176
    v_mfma_f32_16x16x32_bf16 v[76:79], a[84:87], a[36:39], v[76:79]
    s_waitcnt lgkmcnt(0)
    v_sub_f32 v134, v134, v176
    v_sub_f32 v135, v135, v176
    v_cvt_pk_bf16_f32 v64, v64, v65
    v_mfma_f32_16x16x32_bf16 v[80:83], a[82:85], a[40:43], 0
    v_exp_f32 v128, v128
    v_cvt_pk_bf16_f32 v65, v66, v67
    v_mfma_f32_16x16x32_bf16 v[80:83], a[86:89], a[40:43], v[80:83]
    v_exp_f32 v129, v129
    v_cvt_pk_bf16_f32 v68, v68, v69
    v_mfma_f32_16x16x32_bf16 v[84:87], a[80:83], a[40:43], 0
    v_cvt_pk_bf16_f32 v176, v128, v129
    v_exp_f32 v130, v130
    v_mfma_f32_16x16x32_bf16 v[84:87], a[84:87], a[40:43], v[84:87]
    v_exp_f32 v131, v131
    v_cvt_pk_bf16_f32 v69, v70, v71
    v_mfma_f32_16x16x32_bf16 v[88:91], a[82:85], a[44:47], 0
    v_cvt_pk_bf16_f32 v177, v130, v131
    v_exp_f32 v132, v132
    v_mfma_f32_16x16x32_bf16 v[88:91], a[86:89], a[44:47], v[88:91]
    v_exp_f32 v133, v133
    v_accvgpr_write_b32 a32, v64
    v_mfma_f32_16x16x32_bf16 v[92:95], a[80:83], a[44:47], 0
    s_waitcnt vmcnt(34)
    v_cvt_pk_bf16_f32 v178, v132, v133
    v_exp_f32 v134, v134
    v_mfma_f32_16x16x32_bf16 v[92:95], a[84:87], a[44:47], v[92:95]
    ds_read_b128 a[48:51], v238 offset:13056
    ds_read_b128 a[52:55], v238 offset:13120
    v_accvgpr_write_b32 a33, v65
    v_mfma_f32_16x16x32_bf16 v[136:139], a[96:99], a[16:19], 0
    s_mov_b32 m0, s70
    ds_read_b128 a[56:59], v238 offset:13184
    ds_read_b128 a[60:63], v238 offset:13248
    v_accvgpr_write_b32 a34, v68
    v_mfma_f32_16x16x32_bf16 v[136:139], a[100:103], a[20:23], v[136:139]
    buffer_load_dwordx4 v236, s[12:15], s25 offen offset:2048 lds
    v_mfma_f32_16x16x32_bf16 v[136:139], a[104:107], a[24:27], v[136:139]
    v_exp_f32 v135, v135
    v_accvgpr_write_b32 a35, v69
    v_mfma_f32_16x16x32_bf16 v[136:139], a[108:111], a[28:31], v[136:139]
    v_cvt_pk_bf16_f32 v179, v134, v135
    v_cvt_pk_bf16_f32 v72, v72, v73
    v_cvt_pk_bf16_f32 v73, v74, v75
    v_mfma_f32_16x16x32_bf16 v[140:143], a[112:115], a[16:19], 0
    v_cvt_pk_bf16_f32 v76, v76, v77
    v_cvt_pk_bf16_f32 v77, v78, v79
    v_accvgpr_write_b32 a36, v72
    v_mfma_f32_16x16x32_bf16 v[140:143], a[116:119], a[20:23], v[140:143]
    v_max3_f32 v180, v136, v137, v138
    v_accvgpr_write_b32 a37, v73
    v_accvgpr_write_b32 a38, v76
    v_mfma_f32_16x16x32_bf16 v[140:143], a[120:123], a[24:27], v[140:143]
    v_accvgpr_write_b32 a39, v77
    v_cvt_pk_bf16_f32 v80, v80, v81
    v_cvt_pk_bf16_f32 v81, v82, v83
    v_mfma_f32_16x16x32_bf16 v[140:143], a[124:127], a[28:31], v[140:143]
    s_waitcnt lgkmcnt(0)
    v_cvt_pk_bf16_f32 v84, v84, v85
    v_cvt_pk_bf16_f32 v85, v86, v87
    v_accvgpr_write_b32 a40, v80
    v_mfma_f32_16x16x32_bf16 v[64:67], a[82:85], a[48:51], 0
    v_accvgpr_write_b32 a41, v81
    v_accvgpr_write_b32 a42, v84
    v_accvgpr_write_b32 a43, v85
    v_mfma_f32_16x16x32_bf16 v[64:67], a[86:89], a[48:51], v[64:67]
    v_max3_f32 v181, v140, v141, v142
    v_max3_f32 v180, v180, v139, v143
    v_max_f32 v180, v180, v181
    v_mfma_f32_16x16x32_bf16 v[68:71], a[80:83], a[48:51], 0
    v_mov_b32 v181, v180
    v_cvt_pk_bf16_f32 v88, v88, v89
    v_cvt_pk_bf16_f32 v89, v90, v91
    v_mfma_f32_16x16x32_bf16 v[68:71], a[84:87], a[48:51], v[68:71]
    v_permlane32_swap_b32 v181, v180
    v_max_f32 v180, v180, v181
    v_mov_b32 v181, v180
    v_mfma_f32_16x16x32_bf16 v[72:75], a[82:85], a[52:55], 0
    v_cvt_pk_bf16_f32 v92, v92, v93
    v_permlane16_swap_b32 v181, v180
    v_max_f32 v180, v180, v181
    v_mfma_f32_16x16x32_bf16 v[72:75], a[86:89], a[52:55], v[72:75]
    v_sub_f32 v204, 0, v180
    v_sub_f32 v205, 0, v180
    v_sub_f32 v206, 0, v180
    v_mfma_f32_16x16x32_bf16 v[76:79], a[80:83], a[52:55], 0
    v_sub_f32 v207, 0, v180
    v_sub_f32 v136, v136, v180
    v_sub_f32 v137, v137, v180
    v_mfma_f32_16x16x32_bf16 v[76:79], a[84:87], a[52:55], v[76:79]
    v_sub_f32 v138, v138, v180
    v_sub_f32 v139, v139, v180
    v_sub_f32 v140, v140, v180
    v_mfma_f32_16x16x32_bf16 v[80:83], a[82:85], a[56:59], 0
    v_sub_f32 v141, v141, v180
    v_sub_f32 v142, v142, v180
    v_sub_f32 v143, v143, v180
    v_mfma_f32_16x16x32_bf16 v[80:83], a[86:89], a[56:59], v[80:83]
    v_exp_f32 v136, v136
    v_cvt_pk_bf16_f32 v93, v94, v95
    v_mfma_f32_16x16x32_bf16 v[84:87], a[80:83], a[56:59], 0
    v_mov_b32 v225, v136
    v_exp_f32 v137, v137
    v_mfma_f32_16x16x32_bf16 v[84:87], a[84:87], a[56:59], v[84:87]
    v_add_f32 v225, v225, v137
    v_cvt_pk_bf16_f32 v180, v136, v137
    v_accvgpr_write_b32 a44, v88
    v_accvgpr_write_b32 a45, v89
    v_mfma_f32_16x16x32_bf16 v[88:91], a[82:85], a[60:63], 0
    v_exp_f32 v138, v138
    v_accvgpr_write_b32 a46, v92
    v_mfma_f32_16x16x32_bf16 v[88:91], a[86:89], a[60:63], v[88:91]
    v_add_f32 v225, v225, v138
    v_accvgpr_write_b32 a47, v93
    v_cvt_pk_bf16_f32 v64, v64, v65
    v_mfma_f32_16x16x32_bf16 v[92:95], a[80:83], a[60:63], 0
    v_exp_f32 v139, v139
    v_cvt_pk_bf16_f32 v65, v66, v67
    v_mfma_f32_16x16x32_bf16 v[92:95], a[84:87], a[60:63], v[92:95]
    v_add_f32 v225, v225, v139
    v_cvt_pk_bf16_f32 v181, v138, v139
    v_cvt_pk_bf16_f32 v68, v68, v69
    v_mfma_f32_16x16x32_bf16 v[144:147], a[96:99], a[32:35], 0
    v_exp_f32 v140, v140
    v_cvt_pk_bf16_f32 v69, v70, v71
    v_mfma_f32_16x16x32_bf16 v[144:147], a[100:103], a[36:39], v[144:147]
    v_add_f32 v225, v225, v140
    v_exp_f32 v141, v141
    v_mfma_f32_16x16x32_bf16 v[144:147], a[104:107], a[40:43], v[144:147]
    v_add_f32 v225, v225, v141
    v_cvt_pk_bf16_f32 v182, v140, v141
    v_accvgpr_write_b32 a48, v64
    v_mfma_f32_16x16x32_bf16 v[144:147], a[108:111], a[44:47], v[144:147]
    v_exp_f32 v142, v142
    v_accvgpr_write_b32 a49, v65
    v_mfma_f32_16x16x32_bf16 v[148:151], a[112:115], a[32:35], 0
    s_mov_b32 m0, s70
    v_add_f32 v225, v225, v142
    v_exp_f32 v143, v143
    v_mfma_f32_16x16x32_bf16 v[148:151], a[116:119], a[36:39], v[148:151]
    buffer_load_dwordx4 v237, s[12:15], s25 offen offset:3104 lds
    v_mfma_f32_16x16x32_bf16 v[148:151], a[120:123], a[40:43], v[148:151]
    s_add_u32 s14, s10, 4096
    v_add_f32 v225, v225, v143
    v_cvt_pk_bf16_f32 v183, v142, v143
    v_accvgpr_write_b32 a50, v68
    v_mfma_f32_16x16x32_bf16 v[148:151], a[124:127], a[44:47], v[148:151]
    s_mov_b32 s25, s24
    v_accvgpr_write_b32 a51, v69
    v_cvt_pk_bf16_f32 v72, v72, v73
    v_cvt_pk_bf16_f32 v73, v74, v75
    v_mfma_f32_16x16x32_bf16 v[152:155], a[96:99], a[48:51], 0
    s_mov_b32 m0, s70
    v_cvt_pk_bf16_f32 v76, v76, v77
    v_max3_f32 v184, v144, v145, v146
    v_cvt_pk_bf16_f32 v77, v78, v79
    v_accvgpr_write_b32 a52, v72
    v_accvgpr_write_b32 a53, v73
    v_accvgpr_write_b32 a54, v76
    v_accvgpr_write_b32 a55, v77
    v_max3_f32 v185, v148, v149, v150
    v_max3_f32 v184, v184, v147, v151
    v_mfma_f32_16x16x32_bf16 v[152:155], a[100:103], a[52:55], v[152:155]
    buffer_load_dwordx4 v234, s[8:11], s24 offen lds
    v_cvt_pk_bf16_f32 v80, v80, v81
    v_cvt_pk_bf16_f32 v81, v82, v83
    v_cvt_pk_bf16_f32 v84, v84, v85
    v_cvt_pk_bf16_f32 v85, v86, v87
    v_accvgpr_write_b32 a56, v80
    v_accvgpr_write_b32 a57, v81
    v_accvgpr_write_b32 a58, v84
    v_accvgpr_write_b32 a59, v85
    v_max_f32 v184, v184, v185
    v_mov_b32 v185, v184
    v_mfma_f32_16x16x32_bf16 v[152:155], a[104:107], a[56:59], v[152:155]
    ds_read_b128 a[96:99], v230 offset:0
    v_permlane32_swap_b32 v185, v184
    v_max_f32 v184, v184, v185
    v_cvt_pk_bf16_f32 v88, v88, v89
    v_cvt_pk_bf16_f32 v89, v90, v91
    v_cvt_pk_bf16_f32 v92, v92, v93
    v_cvt_pk_bf16_f32 v93, v94, v95
    v_accvgpr_write_b32 a60, v88
    v_accvgpr_write_b32 a61, v89
    v_accvgpr_write_b32 a62, v92
    v_accvgpr_write_b32 a63, v93
    v_mov_b32 v185, v184
    s_nop 0
    v_mfma_f32_16x16x32_bf16 v[152:155], a[108:111], a[60:63], v[152:155]
    ds_read_b128 a[100:103], v230 offset:64
    v_permlane16_swap_b32 v185, v184
    v_max_f32 v184, v184, v185
    v_mfma_f32_16x16x32_bf16 v[156:159], a[112:115], a[48:51], 0
    v_sub_f32 v208, 0, v184
    v_sub_f32 v209, 0, v184
    v_sub_f32 v210, 0, v184
    v_mfma_f32_16x16x32_bf16 v[156:159], a[116:119], a[52:55], v[156:159]
    v_sub_f32 v211, 0, v184
    v_sub_f32 v144, v144, v184
    v_sub_f32 v145, v145, v184
    v_mfma_f32_16x16x32_bf16 v[156:159], a[120:123], a[56:59], v[156:159]
    v_sub_f32 v146, v146, v184
    v_sub_f32 v147, v147, v184
    v_sub_f32 v148, v148, v184
    v_mfma_f32_16x16x32_bf16 v[156:159], a[124:127], a[60:63], v[156:159]
    v_sub_f32 v149, v149, v184
    v_sub_f32 v150, v150, v184
    v_sub_f32 v151, v151, v184
    v_mfma_f32_16x16x32_bf16 v[0:3], a[128:131], v[176:179], 0
    ds_read_b128 a[104:107], v230 offset:128
    v_exp_f32 v144, v144
    v_mfma_f32_16x16x32_bf16 v[32:35], a[128:131], v[180:183], 0
    v_exp_f32 v145, v145
    v_max3_f32 v188, v152, v153, v154
    v_mfma_f32_16x16x32_bf16 a[228:231], a[224:227], v[176:179], 0
    s_mov_b32 m0, s70
    v_cvt_pk_bf16_f32 v184, v144, v145
    v_exp_f32 v146, v146
    v_mfma_f32_16x16x32_bf16 v[4:7], a[132:135], v[176:179], 0
    buffer_load_dwordx4 v235, s[8:11], s24 offen offset:1024 lds
    v_mfma_f32_16x16x32_bf16 v[36:39], a[132:135], v[180:183], 0
    s_add_u32 s24, s24, 131072
    ds_read_b128 a[108:111], v230 offset:192
    v_exp_f32 v147, v147
    v_mfma_f32_16x16x32_bf16 v[8:11], a[136:139], v[176:179], 0
    s_sub_u32 s3, s3, 1
    v_cvt_pk_bf16_f32 v185, v146, v147
    v_exp_f32 v148, v148
    v_mfma_f32_16x16x32_bf16 v[40:43], a[136:139], v[180:183], 0
    v_exp_f32 v149, v149
    v_max3_f32 v189, v156, v157, v158
    v_mfma_f32_16x16x32_bf16 v[12:15], a[140:143], v[176:179], 0
    v_cvt_pk_bf16_f32 v186, v148, v149
    v_exp_f32 v150, v150
    v_mfma_f32_16x16x32_bf16 v[44:47], a[140:143], v[180:183], 0
    ds_read_b128 a[112:115], v230 offset:1024
    v_exp_f32 v151, v151
    v_mfma_f32_16x16x32_bf16 v[16:19], a[144:147], v[176:179], 0
    ds_read_b128 a[116:119], v230 offset:1088
    v_cvt_pk_bf16_f32 v187, v150, v151
    v_max3_f32 v188, v188, v155, v159
    v_mfma_f32_16x16x32_bf16 v[48:51], a[144:147], v[180:183], 0
    ds_read_b128 a[120:123], v230 offset:1152
    v_max_f32 v188, v188, v189
    v_mov_b32 v189, v188
    v_mfma_f32_16x16x32_bf16 v[20:23], a[148:151], v[176:179], 0
    ds_read_b128 a[124:127], v230 offset:1216
    v_permlane32_swap_b32 v189, v188
    v_max_f32 v188, v188, v189
    v_mfma_f32_16x16x32_bf16 v[52:55], a[148:151], v[180:183], 0
    v_mov_b32 v189, v188
    v_mfma_f32_16x16x32_bf16 v[24:27], a[152:155], v[176:179], 0
    v_mfma_f32_16x16x32_bf16 v[56:59], a[152:155], v[180:183], 0
    v_permlane16_swap_b32 v189, v188
    v_max_f32 v188, v188, v189
    v_sub_f32 v212, 0, v188
    v_mfma_f32_16x16x32_bf16 v[28:31], a[156:159], v[176:179], 0
    v_sub_f32 v213, 0, v188
    v_sub_f32 v214, 0, v188
    v_sub_f32 v215, 0, v188
    v_mfma_f32_16x16x32_bf16 v[60:63], a[156:159], v[180:183], 0
    s_waitcnt lgkmcnt(1)
    v_sub_f32 v152, v152, v188
    v_sub_f32 v153, v153, v188
    v_sub_f32 v154, v154, v188
    v_mfma_f32_16x16x32_bf16 v[128:131], a[96:99], a[0:3], v[200:203]
    v_sub_f32 v155, v155, v188
    v_sub_f32 v156, v156, v188
    v_sub_f32 v157, v157, v188
    v_mfma_f32_16x16x32_bf16 v[128:131], a[100:103], a[4:7], v[128:131]
    v_sub_f32 v158, v158, v188
    v_sub_f32 v159, v159, v188
    v_mfma_f32_16x16x32_bf16 v[128:131], a[104:107], a[8:11], v[128:131]
    s_mov_b32 s70, s27
    v_exp_f32 v152, v152
    v_mfma_f32_16x16x32_bf16 v[128:131], a[108:111], a[12:15], v[128:131]
    s_add_u32 s27, s27, 16640
    v_mov_b32 v227, v152
    v_exp_f32 v153, v153
    v_mfma_f32_16x16x32_bf16 v[132:135], a[112:115], a[0:3], v[200:203]
    s_cmp_eq_u32 s27, s29
    v_add_f32 v227, v227, v153
    v_cvt_pk_bf16_f32 v188, v152, v153
    v_mfma_f32_16x16x32_bf16 v[132:135], a[116:119], a[4:7], v[132:135]
    s_cselect_b32 s27, s28, s27
    v_exp_f32 v154, v154
    v_mfma_f32_16x16x32_bf16 v[132:135], a[120:123], a[8:11], v[132:135]
    s_waitcnt lgkmcnt(0)
    v_add_f32 v227, v227, v154
    v_exp_f32 v155, v155
    v_mfma_f32_16x16x32_bf16 v[132:135], a[124:127], a[12:15], v[132:135]
    s_waitcnt vmcnt(20)
    v_add_f32 v227, v227, v155
    v_cvt_pk_bf16_f32 v189, v154, v155
    v_mfma_f32_16x16x32_bf16 v[136:139], a[96:99], a[16:19], v[204:207]
    s_barrier
    v_mfma_f32_16x16x32_bf16 v[136:139], a[100:103], a[20:23], v[136:139]
    s_mov_b32 m0, s70
    v_exp_f32 v156, v156
    v_add_u32 v231, s27, v233
    v_mfma_f32_16x16x32_bf16 v[136:139], a[104:107], a[24:27], v[136:139]
    buffer_load_dwordx4 v236, s[12:15], s25 offen offset:2048 lds
    v_mfma_f32_16x16x32_bf16 v[136:139], a[108:111], a[28:31], v[136:139]
    v_add_f32 v227, v227, v156
    v_exp_f32 v157, v157
    v_mfma_f32_16x16x32_bf16 v[140:143], a[112:115], a[16:19], v[204:207]
    v_add_f32 v227, v227, v157
    v_cvt_pk_bf16_f32 v190, v156, v157
    v_add_u32 v230, s27, v232
    v_mfma_f32_16x16x32_bf16 v[140:143], a[116:119], a[20:23], v[140:143]
    v_exp_f32 v158, v158
    v_mfma_f32_16x16x32_bf16 v[140:143], a[120:123], a[24:27], v[140:143]
    v_add_f32 v227, v227, v158
    v_exp_f32 v159, v159
    v_mfma_f32_16x16x32_bf16 v[140:143], a[124:127], a[28:31], v[140:143]
    v_add_f32 v227, v227, v159
    v_cvt_pk_bf16_f32 v191, v158, v159
    v_mfma_f32_16x16x32_bf16 v[64:67], a[128:131], v[184:187], 0
    v_exp_f32 v128, v128
    v_mfma_f32_16x16x32_bf16 v[96:99], a[128:131], v[188:191], 0
    ds_read_b64_tr_b16 a[128:129], v231 offset:0
    v_exp_f32 v129, v129
    v_mfma_f32_16x16x32_bf16 a[236:239], a[224:227], v[184:187], 0
    v_cvt_pk_bf16_f32 v176, v128, v129
    v_exp_f32 v131, v131
    v_mfma_f32_16x16x32_bf16 v[68:71], a[132:135], v[184:187], 0
    v_exp_f32 v130, v130
    v_mfma_f32_16x16x32_bf16 v[100:103], a[132:135], v[188:191], 0
    v_exp_f32 v132, v132
    v_mfma_f32_16x16x32_bf16 v[72:75], a[136:139], v[184:187], 0
    ds_read_b64_tr_b16 a[130:131], v231 offset:512
    v_cvt_pk_bf16_f32 v177, v130, v131
    v_mfma_f32_16x16x32_bf16 v[104:107], a[136:139], v[188:191], 0
    s_mov_b32 m0, s70
    v_exp_f32 v133, v133
    v_mfma_f32_16x16x32_bf16 v[76:79], a[140:143], v[184:187], 0
    buffer_load_dwordx4 v237, s[12:15], s25 offen offset:3104 lds
    v_mfma_f32_16x16x32_bf16 v[108:111], a[140:143], v[188:191], 0
    s_add_u32 s14, s10, 4096
    ds_read_b64_tr_b16 a[132:133], v231 offset:32
    v_cvt_pk_bf16_f32 v178, v132, v133
    v_mfma_f32_16x16x32_bf16 v[80:83], a[144:147], v[184:187], 0
    s_mov_b32 s25, s24
    ds_read_b64_tr_b16 a[134:135], v231 offset:544
    v_exp_f32 v134, v134
    v_mfma_f32_16x16x32_bf16 v[112:115], a[144:147], v[188:191], 0
    s_mov_b32 s22, s4
    v_exp_f32 v135, v135
    v_mfma_f32_16x16x32_bf16 v[84:87], a[148:151], v[184:187], 0
    s_mov_b32 s33, s5
    ds_read_b64_tr_b16 a[136:137], v231 offset:64
    v_cvt_pk_bf16_f32 v179, v134, v135
    v_mfma_f32_16x16x32_bf16 v[116:119], a[148:151], v[188:191], 0
    v_exp_f32 v136, v136
    v_mfma_f32_16x16x32_bf16 v[88:91], a[152:155], v[184:187], 0
    ds_read_b64_tr_b16 a[138:139], v231 offset:576
    v_add_f32 v225, v225, v136
    v_mfma_f32_16x16x32_bf16 v[120:123], a[152:155], v[188:191], 0
    v_exp_f32 v137, v137
    v_mfma_f32_16x16x32_bf16 v[92:95], a[156:159], v[184:187], 0
    s_mov_b32 m0, s70
    v_cvt_pk_bf16_f32 v180, v136, v137
    v_add_f32 v225, v225, v137
    v_mfma_f32_16x16x32_bf16 v[124:127], a[156:159], v[188:191], 0
    v_exp_f32 v138, v138
    ds_read_b64_tr_b16 a[140:141], v231 offset:96
    ds_read_b64_tr_b16 a[142:143], v231 offset:608
    ds_read_b64_tr_b16 a[144:145], v231 offset:128
    ds_read_b64_tr_b16 a[146:147], v231 offset:640
    v_add_f32 v225, v225, v138
    v_exp_f32 v139, v139
    v_exp_f32 v140, v140
    v_add_f32 v225, v225, v139
    v_cvt_pk_bf16_f32 v181, v138, v139
    v_exp_f32 v141, v141
    s_branch L_loop4
L_tail2_12e:
.p2align 3
L_loop3:
    v_mfma_f32_16x16x32_bf16 v[136:139], a[96:99], a[16:19], v[204:207]
    ds_read_b64_tr_b16 a[142:143], v231 offset:608
    v_cvt_pk_bf16_f32 v179, v134, v135
    v_mfma_f32_16x16x32_bf16 v[136:139], a[100:103], a[20:23], v[136:139]
    ds_read_b64_tr_b16 a[144:145], v231 offset:128
    ds_read_b64_tr_b16 a[146:147], v231 offset:640
    v_mfma_f32_16x16x32_bf16 v[136:139], a[104:107], a[24:27], v[136:139]
    buffer_load_dwordx4 v234, s[8:11], s24 offen lds
    v_mfma_f32_16x16x32_bf16 v[136:139], a[108:111], a[28:31], v[136:139]
    ds_read_b64_tr_b16 a[148:149], v231 offset:160
    ds_read_b64_tr_b16 a[150:151], v231 offset:672
    v_mfma_f32_16x16x32_bf16 v[140:143], a[112:115], a[16:19], v[204:207]
    ds_read_b64_tr_b16 a[152:153], v231 offset:192
    ds_read_b64_tr_b16 a[154:155], v231 offset:704
    v_mfma_f32_16x16x32_bf16 v[140:143], a[116:119], a[20:23], v[140:143]
    ds_read_b64_tr_b16 a[156:157], v231 offset:224
    ds_read_b64_tr_b16 a[158:159], v231 offset:736
    v_mfma_f32_16x16x32_bf16 v[140:143], a[120:123], a[24:27], v[140:143]
    v_exp_f32 v136, v136
    v_mfma_f32_16x16x32_bf16 v[140:143], a[124:127], a[28:31], v[140:143]
    v_exp_f32 v137, v137
    v_mfma_f32_16x16x32_bf16 v[144:147], a[96:99], a[32:35], v[208:211]
    ds_read_b128 a[96:99], v230 offset:0
    v_cvt_pk_bf16_f32 v180, v136, v137
    v_mfma_f32_16x16x32_bf16 v[144:147], a[100:103], a[36:39], v[144:147]
    v_exp_f32 v138, v138
    v_mfma_f32_16x16x32_bf16 v[144:147], a[104:107], a[40:43], v[144:147]
    v_exp_f32 v139, v139
    v_mfma_f32_16x16x32_bf16 v[144:147], a[108:111], a[44:47], v[144:147]
    ds_read_b128 a[100:103], v230 offset:64
    v_cvt_pk_bf16_f32 v181, v138, v139
    v_mfma_f32_16x16x32_bf16 v[148:151], a[112:115], a[32:35], v[208:211]
    ds_read_b128 a[104:107], v230 offset:128
    ds_read_b128 a[108:111], v230 offset:192
    v_mfma_f32_16x16x32_bf16 v[148:151], a[116:119], a[36:39], v[148:151]
    buffer_load_dwordx4 v235, s[8:11], s24 offen offset:1024 lds
    v_mfma_f32_16x16x32_bf16 v[148:151], a[120:123], a[40:43], v[148:151]
    s_add_u32 s24, s24, 131072
    v_exp_f32 v140, v140
    v_mfma_f32_16x16x32_bf16 v[148:151], a[124:127], a[44:47], v[148:151]
    s_sub_u32 s3, s3, 1
    v_exp_f32 v141, v141
    v_mfma_f32_16x16x32_bf16 a[228:231], a[224:227], v[176:179], a[228:231]
    s_waitcnt lgkmcnt(3)
    ds_read_b128 a[112:115], v230 offset:1024
    s_cselect_b32 s24, s30, s24
    v_mfma_f32_16x16x32_bf16 v[0:3], a[128:131], v[176:179], v[0:3]
    s_cselect_b32 s10, s31, s10
    ds_read_b128 a[116:119], v230 offset:1088
    v_cvt_pk_bf16_f32 v182, v140, v141
    v_mfma_f32_16x16x32_bf16 v[4:7], a[132:135], v[176:179], v[4:7]
    v_exp_f32 v142, v142
    v_mfma_f32_16x16x32_bf16 v[8:11], a[136:139], v[176:179], v[8:11]
    v_exp_f32 v143, v143
    v_mfma_f32_16x16x32_bf16 v[12:15], a[140:143], v[176:179], v[12:15]
    ds_read_b128 a[120:123], v230 offset:1152
    v_cvt_pk_bf16_f32 v183, v142, v143
    v_mfma_f32_16x16x32_bf16 v[16:19], a[144:147], v[176:179], v[16:19]
    v_exp_f32 v144, v144
    v_mfma_f32_16x16x32_bf16 v[20:23], a[148:151], v[176:179], v[20:23]
    v_exp_f32 v145, v145
    v_mfma_f32_16x16x32_bf16 v[24:27], a[152:155], v[176:179], v[24:27]
    ds_read_b128 a[124:127], v230 offset:1216
    v_cvt_pk_bf16_f32 v184, v144, v145
    v_mfma_f32_16x16x32_bf16 v[28:31], a[156:159], v[176:179], v[28:31]
    v_exp_f32 v146, v146
    v_mfma_f32_16x16x32_bf16 v[128:131], a[96:99], a[0:3], v[200:203]
    s_waitcnt lgkmcnt(2)
    v_exp_f32 v147, v147
    v_mfma_f32_16x16x32_bf16 v[128:131], a[100:103], a[4:7], v[128:131]
    v_exp_f32 v148, v148
    v_mfma_f32_16x16x32_bf16 v[128:131], a[104:107], a[8:11], v[128:131]
    s_mov_b32 m0, s27
    v_exp_f32 v149, v149
    v_mfma_f32_16x16x32_bf16 v[128:131], a[108:111], a[12:15], v[128:131]
    s_add_u32 s27, s27, 16640
    v_cvt_pk_bf16_f32 v185, v146, v147
    v_cvt_pk_bf16_f32 v186, v148, v149
    v_mfma_f32_16x16x32_bf16 v[132:135], a[112:115], a[0:3], v[200:203]
    s_cmp_eq_u32 s27, s29
    v_exp_f32 v150, v150
    v_mfma_f32_16x16x32_bf16 v[132:135], a[116:119], a[4:7], v[132:135]
    s_waitcnt lgkmcnt(0)
    s_cselect_b32 s27, s28, s27
    v_mfma_f32_16x16x32_bf16 v[132:135], a[120:123], a[8:11], v[132:135]
    s_waitcnt vmcnt(12)
    v_exp_f32 v151, v151
    v_mfma_f32_16x16x32_bf16 v[132:135], a[124:127], a[12:15], v[132:135]
    s_barrier
    v_mfma_f32_16x16x32_bf16 a[232:235], a[224:227], v[180:183], a[232:235]
    v_add_u32 v231, s27, v233
    v_mfma_f32_16x16x32_bf16 v[32:35], a[128:131], v[180:183], v[32:35]
    buffer_load_dwordx4 v236, s[12:15], s25 offen offset:2048 lds
    v_mfma_f32_16x16x32_bf16 v[36:39], a[132:135], v[180:183], v[36:39]
    v_add_u32 v230, s27, v232
    v_cvt_pk_bf16_f32 v187, v150, v151
    v_mfma_f32_16x16x32_bf16 v[40:43], a[136:139], v[180:183], v[40:43]
    v_exp_f32 v128, v128
    v_mfma_f32_16x16x32_bf16 v[44:47], a[140:143], v[180:183], v[44:47]
    v_exp_f32 v129, v129
    v_mfma_f32_16x16x32_bf16 v[48:51], a[144:147], v[180:183], v[48:51]
    v_exp_f32 v130, v130
    v_mfma_f32_16x16x32_bf16 v[52:55], a[148:151], v[180:183], v[52:55]
    v_exp_f32 v131, v131
    v_mfma_f32_16x16x32_bf16 v[56:59], a[152:155], v[180:183], v[56:59]
    v_cvt_pk_bf16_f32 v176, v128, v129
    v_cvt_pk_bf16_f32 v177, v130, v131
    v_mfma_f32_16x16x32_bf16 v[60:63], a[156:159], v[180:183], v[60:63]
    v_exp_f32 v132, v132
    v_mfma_f32_16x16x32_bf16 a[236:239], a[224:227], v[184:187], a[236:239]
    v_exp_f32 v133, v133
    v_mfma_f32_16x16x32_bf16 v[64:67], a[128:131], v[184:187], v[64:67]
    ds_read_b64_tr_b16 a[128:129], v231 offset:0
    ds_read_b64_tr_b16 a[130:131], v231 offset:512
    v_mfma_f32_16x16x32_bf16 v[68:71], a[132:135], v[184:187], v[68:71]
    buffer_load_dwordx4 v237, s[12:15], s25 offen offset:3104 lds
    v_mfma_f32_16x16x32_bf16 v[72:75], a[136:139], v[184:187], v[72:75]
    s_add_u32 s14, s10, 4096
    ds_read_b64_tr_b16 a[132:133], v231 offset:32
    ds_read_b64_tr_b16 a[134:135], v231 offset:544
    v_mfma_f32_16x16x32_bf16 v[76:79], a[140:143], v[184:187], v[76:79]
    s_mov_b32 s25, s24
    ds_read_b64_tr_b16 a[136:137], v231 offset:64
    v_cvt_pk_bf16_f32 v178, v132, v133
    v_mfma_f32_16x16x32_bf16 v[80:83], a[144:147], v[184:187], v[80:83]
    s_sub_u32 s26, s26, 1
    v_exp_f32 v134, v134
    v_mfma_f32_16x16x32_bf16 v[84:87], a[148:151], v[184:187], v[84:87]
    v_exp_f32 v135, v135
    v_mfma_f32_16x16x32_bf16 v[88:91], a[152:155], v[184:187], v[88:91]
    ds_read_b64_tr_b16 a[138:139], v231 offset:576
    ds_read_b64_tr_b16 a[140:141], v231 offset:96
    v_mfma_f32_16x16x32_bf16 v[92:95], a[156:159], v[184:187], v[92:95]
    s_cbranch_scc0 L_loop3
    s_cmp_eq_u32 s91, 0
    s_cbranch_scc1 L_out3
    s_mov_b32 s26, s94
L_lq3:
    v_mfma_f32_16x16x32_bf16 v[136:139], a[96:99], a[16:19], v[204:207]
    s_mov_b32 s70, m0
    ds_read_b64_tr_b16 a[142:143], v231 offset:608
    v_cvt_pk_bf16_f32 v179, v134, v135
    v_mfma_f32_16x16x32_bf16 v[136:139], a[100:103], a[20:23], v[136:139]
    s_mov_b32 m0, s70
    ds_read_b64_tr_b16 a[144:145], v231 offset:128
    ds_read_b64_tr_b16 a[146:147], v231 offset:640
    v_mfma_f32_16x16x32_bf16 v[136:139], a[104:107], a[24:27], v[136:139]
    buffer_load_dwordx4 v234, s[8:11], s24 offen lds
    v_mfma_f32_16x16x32_bf16 v[136:139], a[108:111], a[28:31], v[136:139]
    ds_read_b64_tr_b16 a[148:149], v231 offset:160
    ds_read_b64_tr_b16 a[150:151], v231 offset:672
    v_mfma_f32_16x16x32_bf16 v[140:143], a[112:115], a[16:19], v[204:207]
    ds_read_b64_tr_b16 a[152:153], v231 offset:192
    ds_read_b64_tr_b16 a[154:155], v231 offset:704
    v_mfma_f32_16x16x32_bf16 v[140:143], a[116:119], a[20:23], v[140:143]
    ds_read_b64_tr_b16 a[156:157], v231 offset:224
    ds_read_b64_tr_b16 a[158:159], v231 offset:736
    v_mfma_f32_16x16x32_bf16 v[140:143], a[120:123], a[24:27], v[140:143]
    s_mov_b32 m0, s92
    v_exp_f32 v136, v136
    v_mfma_f32_16x16x32_bf16 v[140:143], a[124:127], a[28:31], v[140:143]
    buffer_load_dwordx4 v234, s[16:19], s93 offen lds
    v_mfma_f32_16x16x32_bf16 v[144:147], a[96:99], a[32:35], v[208:211]
    s_add_u32 s92, s92, 1088
    v_exp_f32 v137, v137
    v_mfma_f32_16x16x32_bf16 v[144:147], a[100:103], a[36:39], v[144:147]
    s_add_u32 s93, s93, 16384
    ds_read_b128 a[96:99], v230 offset:0
    v_cvt_pk_bf16_f32 v180, v136, v137
    v_mfma_f32_16x16x32_bf16 v[144:147], a[104:107], a[40:43], v[144:147]
    v_exp_f32 v138, v138
    v_mfma_f32_16x16x32_bf16 v[144:147], a[108:111], a[44:47], v[144:147]
    v_exp_f32 v139, v139
    v_mfma_f32_16x16x32_bf16 v[148:151], a[112:115], a[32:35], v[208:211]
    s_mov_b32 m0, s70
    ds_read_b128 a[100:103], v230 offset:64
    ds_read_b128 a[104:107], v230 offset:128
    v_mfma_f32_16x16x32_bf16 v[148:151], a[116:119], a[36:39], v[148:151]
    buffer_load_dwordx4 v235, s[8:11], s24 offen offset:1024 lds
    v_mfma_f32_16x16x32_bf16 v[148:151], a[120:123], a[40:43], v[148:151]
    s_add_u32 s24, s24, 131072
    ds_read_b128 a[108:111], v230 offset:192
    v_cvt_pk_bf16_f32 v181, v138, v139
    v_mfma_f32_16x16x32_bf16 v[148:151], a[124:127], a[44:47], v[148:151]
    s_sub_u32 s3, s3, 1
    v_exp_f32 v140, v140
    v_mfma_f32_16x16x32_bf16 a[228:231], a[224:227], v[176:179], a[228:231]
    s_waitcnt lgkmcnt(3)
    v_exp_f32 v141, v141
    v_mfma_f32_16x16x32_bf16 v[0:3], a[128:131], v[176:179], v[0:3]
    s_cselect_b32 s24, s30, s24
    ds_read_b128 a[112:115], v230 offset:1024
    s_cselect_b32 s10, s31, s10
    v_mfma_f32_16x16x32_bf16 v[4:7], a[132:135], v[176:179], v[4:7]
    ds_read_b128 a[116:119], v230 offset:1088
    v_cvt_pk_bf16_f32 v182, v140, v141
    v_mfma_f32_16x16x32_bf16 v[8:11], a[136:139], v[176:179], v[8:11]
    v_exp_f32 v142, v142
    v_mfma_f32_16x16x32_bf16 v[12:15], a[140:143], v[176:179], v[12:15]
    v_exp_f32 v143, v143
    v_mfma_f32_16x16x32_bf16 v[16:19], a[144:147], v[176:179], v[16:19]
    ds_read_b128 a[120:123], v230 offset:1152
    v_cvt_pk_bf16_f32 v183, v142, v143
    v_mfma_f32_16x16x32_bf16 v[20:23], a[148:151], v[176:179], v[20:23]
    s_mov_b32 m0, s92
    ds_read_b128 a[124:127], v230 offset:1216
    v_mfma_f32_16x16x32_bf16 v[24:27], a[152:155], v[176:179], v[24:27]
    buffer_load_dwordx4 v234, s[16:19], s93 offen lds
    v_mfma_f32_16x16x32_bf16 v[28:31], a[156:159], v[176:179], v[28:31]
    s_add_u32 s92, s92, 1088
    v_exp_f32 v144, v144
    v_mfma_f32_16x16x32_bf16 v[128:131], a[96:99], a[0:3], v[200:203]
    s_waitcnt lgkmcnt(2)
    v_exp_f32 v145, v145
    v_mfma_f32_16x16x32_bf16 v[128:131], a[100:103], a[4:7], v[128:131]
    s_add_u32 s93, s93, 16384
    v_exp_f32 v146, v146
    v_mfma_f32_16x16x32_bf16 v[128:131], a[104:107], a[8:11], v[128:131]
    s_mov_b32 s70, s27
    v_exp_f32 v147, v147
    v_mfma_f32_16x16x32_bf16 v[128:131], a[108:111], a[12:15], v[128:131]
    s_add_u32 s27, s27, 16640
    v_cvt_pk_bf16_f32 v184, v144, v145
    v_cvt_pk_bf16_f32 v185, v146, v147
    v_mfma_f32_16x16x32_bf16 v[132:135], a[112:115], a[0:3], v[200:203]
    s_cmp_eq_u32 s27, s29
    v_exp_f32 v148, v148
    v_mfma_f32_16x16x32_bf16 v[132:135], a[116:119], a[4:7], v[132:135]
    s_waitcnt lgkmcnt(0)
    s_cselect_b32 s27, s28, s27
    v_mfma_f32_16x16x32_bf16 v[132:135], a[120:123], a[8:11], v[132:135]
    s_waitcnt vmcnt(14)
    v_exp_f32 v149, v149
    v_mfma_f32_16x16x32_bf16 v[132:135], a[124:127], a[12:15], v[132:135]
    s_barrier
    v_mfma_f32_16x16x32_bf16 a[232:235], a[224:227], v[180:183], a[232:235]
    s_mov_b32 m0, s70
    v_add_u32 v231, s27, v233
    v_mfma_f32_16x16x32_bf16 v[32:35], a[128:131], v[180:183], v[32:35]
    buffer_load_dwordx4 v236, s[12:15], s25 offen offset:2048 lds
    v_mfma_f32_16x16x32_bf16 v[36:39], a[132:135], v[180:183], v[36:39]
    v_cvt_pk_bf16_f32 v186, v148, v149
    v_add_u32 v230, s27, v232
    v_mfma_f32_16x16x32_bf16 v[40:43], a[136:139], v[180:183], v[40:43]
    v_exp_f32 v150, v150
    v_mfma_f32_16x16x32_bf16 v[44:47], a[140:143], v[180:183], v[44:47]
    v_exp_f32 v151, v151
    v_mfma_f32_16x16x32_bf16 v[48:51], a[144:147], v[180:183], v[48:51]
    v_exp_f32 v128, v128
    v_mfma_f32_16x16x32_bf16 v[52:55], a[148:151], v[180:183], v[52:55]
    v_exp_f32 v129, v129
    v_mfma_f32_16x16x32_bf16 v[56:59], a[152:155], v[180:183], v[56:59]
    v_cvt_pk_bf16_f32 v187, v150, v151
    v_cvt_pk_bf16_f32 v176, v128, v129
    v_mfma_f32_16x16x32_bf16 v[60:63], a[156:159], v[180:183], v[60:63]
    v_exp_f32 v130, v130
    v_mfma_f32_16x16x32_bf16 a[236:239], a[224:227], v[184:187], a[236:239]
    v_exp_f32 v131, v131
    v_mfma_f32_16x16x32_bf16 v[64:67], a[128:131], v[184:187], v[64:67]
    s_mov_b32 m0, s70
    ds_read_b64_tr_b16 a[128:129], v231 offset:0
    ds_read_b64_tr_b16 a[130:131], v231 offset:512
    v_mfma_f32_16x16x32_bf16 v[68:71], a[132:135], v[184:187], v[68:71]
    buffer_load_dwordx4 v237, s[12:15], s25 offen offset:3104 lds
    v_mfma_f32_16x16x32_bf16 v[72:75], a[136:139], v[184:187], v[72:75]
    s_add_u32 s14, s10, 4096
    ds_read_b64_tr_b16 a[132:133], v231 offset:32
    v_cvt_pk_bf16_f32 v177, v130, v131
    v_mfma_f32_16x16x32_bf16 v[76:79], a[140:143], v[184:187], v[76:79]
    s_mov_b32 s25, s24
    v_exp_f32 v132, v132
    v_mfma_f32_16x16x32_bf16 v[80:83], a[144:147], v[184:187], v[80:83]
    s_mov_b32 m0, s70
    v_exp_f32 v133, v133
    v_mfma_f32_16x16x32_bf16 v[84:87], a[148:151], v[184:187], v[84:87]
    s_sub_u32 s26, s26, 1
    ds_read_b64_tr_b16 a[134:135], v231 offset:544
    v_cvt_pk_bf16_f32 v178, v132, v133
    v_mfma_f32_16x16x32_bf16 v[88:91], a[152:155], v[184:187], v[88:91]
    v_exp_f32 v134, v134
    v_mfma_f32_16x16x32_bf16 v[92:95], a[156:159], v[184:187], v[92:95]
    v_exp_f32 v135, v135
    ds_read_b64_tr_b16 a[136:137], v231 offset:64
    ds_read_b64_tr_b16 a[138:139], v231 offset:576
    ds_read_b64_tr_b16 a[140:141], v231 offset:96
    s_cbranch_scc0 L_lq3
    s_sub_u32 s26, s91, 1
    s_mov_b32 s91, 0
    s_branch L_loop3
L_out3:
    s_cmp_eq_u32 s71, 12
    s_cbranch_scc1 L_tail3_12
L_tail3_4:
    v_mfma_f32_16x16x32_bf16 v[136:139], a[96:99], a[16:19], v[204:207]
    s_mov_b32 s70, m0
    ds_read_b64_tr_b16 a[142:143], v231 offset:608
    v_cvt_pk_bf16_f32 v179, v134, v135
    v_mfma_f32_16x16x32_bf16 v[136:139], a[100:103], a[20:23], v[136:139]
    s_mov_b32 m0, s70
    ds_read_b64_tr_b16 a[144:145], v231 offset:128
    ds_read_b64_tr_b16 a[146:147], v231 offset:640
    v_mfma_f32_16x16x32_bf16 v[136:139], a[104:107], a[24:27], v[136:139]
    buffer_load_dwordx4 v234, s[8:11], s24 offen lds
    v_mfma_f32_16x16x32_bf16 v[136:139], a[108:111], a[28:31], v[136:139]
    ds_read_b64_tr_b16 a[148:149], v231 offset:160
    ds_read_b64_tr_b16 a[150:151], v231 offset:672
    v_mfma_f32_16x16x32_bf16 v[140:143], a[112:115], a[16:19], v[204:207]
    ds_read_b64_tr_b16 a[152:153], v231 offset:192
    ds_read_b64_tr_b16 a[154:155], v231 offset:704
    v_mfma_f32_16x16x32_bf16 v[140:143], a[116:119], a[20:23], v[140:143]
    ds_read_b64_tr_b16 a[156:157], v231 offset:224
    ds_read_b64_tr_b16 a[158:159], v231 offset:736
    v_mfma_f32_16x16x32_bf16 v[140:143], a[120:123], a[24:27], v[140:143]
    v_exp_f32 v136, v136
    v_sub_u32 v244, s38, v240
    v_mfma_f32_16x16x32_bf16 v[140:143], a[124:127], a[28:31], v[140:143]
    v_exp_f32 v137, v137
    v_mfma_f32_16x16x32_bf16 v[144:147], a[96:99], a[32:35], v[208:211]
    ds_read_b128 a[96:99], v230 offset:0
    v_cvt_pk_bf16_f32 v180, v136, v137
    v_mfma_f32_16x16x32_bf16 v[144:147], a[100:103], a[36:39], v[144:147]
    v_exp_f32 v138, v138
    v_mfma_f32_16x16x32_bf16 v[144:147], a[104:107], a[40:43], v[144:147]
    v_exp_f32 v139, v139
    v_mfma_f32_16x16x32_bf16 v[144:147], a[108:111], a[44:47], v[144:147]
    ds_read_b128 a[100:103], v230 offset:64
    v_cvt_pk_bf16_f32 v181, v138, v139
    v_mfma_f32_16x16x32_bf16 v[148:151], a[112:115], a[32:35], v[208:211]
    s_mov_b32 m0, s70
    v_exp_f32 v140, v140
    v_mfma_f32_16x16x32_bf16 v[148:151], a[116:119], a[36:39], v[148:151]
    buffer_load_dwordx4 v235, s[8:11], s24 offen offset:1024 lds
    v_mfma_f32_16x16x32_bf16 v[148:151], a[120:123], a[40:43], v[148:151]
    s_add_u32 s24, s24, 131072
    v_exp_f32 v141, v141
    v_mfma_f32_16x16x32_bf16 v[148:151], a[124:127], a[44:47], v[148:151]
    s_sub_u32 s3, s3, 1
    ds_read_b128 a[104:107], v230 offset:128
    ds_read_b128 a[108:111], v230 offset:192
    v_cvt_pk_bf16_f32 v182, v140, v141
    v_mfma_f32_16x16x32_bf16 a[228:231], a[224:227], v[176:179], a[228:231]
    s_waitcnt lgkmcnt(3)
    v_exp_f32 v142, v142
    v_mfma_f32_16x16x32_bf16 v[0:3], a[128:131], v[176:179], v[0:3]
    v_exp_f32 v143, v143
    v_mfma_f32_16x16x32_bf16 v[4:7], a[132:135], v[176:179], v[4:7]
    ds_read_b128 a[112:115], v230 offset:1024
    v_cvt_pk_bf16_f32 v183, v142, v143
    v_mfma_f32_16x16x32_bf16 v[8:11], a[136:139], v[176:179], v[8:11]
    v_exp_f32 v144, v144
    v_mfma_f32_16x16x32_bf16 v[12:15], a[140:143], v[176:179], v[12:15]
    v_exp_f32 v145, v145
    v_mfma_f32_16x16x32_bf16 v[16:19], a[144:147], v[176:179], v[16:19]
    ds_read_b128 a[116:119], v230 offset:1088
    ds_read_b128 a[120:123], v230 offset:1152
    v_mfma_f32_16x16x32_bf16 v[20:23], a[148:151], v[176:179], v[20:23]
    ds_read_b128 a[124:127], v230 offset:1216
    v_cvt_pk_bf16_f32 v184, v144, v145
    v_mfma_f32_16x16x32_bf16 v[24:27], a[152:155], v[176:179], v[24:27]
    v_exp_f32 v146, v146
    v_mfma_f32_16x16x32_bf16 v[28:31], a[156:159], v[176:179], v[28:31]
    v_exp_f32 v147, v147
    v_mfma_f32_16x16x32_bf16 v[128:131], a[96:99], a[0:3], v[200:203]
    s_waitcnt lgkmcnt(3)
    v_exp_f32 v148, v148
    v_mfma_f32_16x16x32_bf16 v[128:131], a[100:103], a[4:7], v[128:131]
    v_exp_f32 v149, v149
    v_mfma_f32_16x16x32_bf16 v[128:131], a[104:107], a[8:11], v[128:131]
    s_mov_b32 s70, s27
    v_cvt_pk_bf16_f32 v185, v146, v147
    v_cvt_pk_bf16_f32 v186, v148, v149
    v_mfma_f32_16x16x32_bf16 v[128:131], a[108:111], a[12:15], v[128:131]
    s_add_u32 s27, s27, 16640
    v_exp_f32 v150, v150
    v_mfma_f32_16x16x32_bf16 v[132:135], a[112:115], a[0:3], v[200:203]
    s_waitcnt lgkmcnt(0)
    s_cmp_eq_u32 s27, s29
    v_exp_f32 v151, v151
    v_mfma_f32_16x16x32_bf16 v[132:135], a[116:119], a[4:7], v[132:135]
    s_cselect_b32 s27, s28, s27
    v_exp_f32 v128, v128
    v_mfma_f32_16x16x32_bf16 v[132:135], a[120:123], a[8:11], v[132:135]
    s_waitcnt vmcnt(12)
    v_cvt_pk_bf16_f32 v187, v150, v151
    v_cndmask_b32 v128, 0, v128, s[40:41]
    v_mfma_f32_16x16x32_bf16 v[132:135], a[124:127], a[12:15], v[132:135]
    s_barrier
    v_mfma_f32_16x16x32_bf16 a[232:235], a[224:227], v[180:183], a[232:235]
    s_mov_b32 m0, s70
    v_add_u32 v231, s27, v233
    v_add_u32 v230, s27, v232
    v_mfma_f32_16x16x32_bf16 v[32:35], a[128:131], v[180:183], v[32:35]
    buffer_load_dwordx4 v236, s[12:15], s25 offen offset:2048 lds
    v_mfma_f32_16x16x32_bf16 v[36:39], a[132:135], v[180:183], v[36:39]
    v_exp_f32 v129, v129
    v_mfma_f32_16x16x32_bf16 v[40:43], a[136:139], v[180:183], v[40:43]
    v_exp_f32 v130, v130
    v_mfma_f32_16x16x32_bf16 v[44:47], a[140:143], v[180:183], v[44:47]
    v_cndmask_b32 v129, 0, v129, s[42:43]
    v_cvt_pk_bf16_f32 v176, v128, v129
    v_mfma_f32_16x16x32_bf16 v[48:51], a[144:147], v[180:183], v[48:51]
    v_exp_f32 v131, v131
    v_mfma_f32_16x16x32_bf16 v[52:55], a[148:151], v[180:183], v[52:55]
    v_cndmask_b32 v130, 0, v130, s[44:45]
    v_cndmask_b32 v131, 0, v131, s[46:47]
    v_mfma_f32_16x16x32_bf16 v[56:59], a[152:155], v[180:183], v[56:59]
    v_exp_f32 v132, v132
    v_mfma_f32_16x16x32_bf16 v[60:63], a[156:159], v[180:183], v[60:63]
    v_cvt_pk_bf16_f32 v177, v130, v131
    v_cndmask_b32 v132, 0, v132, s[48:49]
    v_mfma_f32_16x16x32_bf16 a[236:239], a[224:227], v[184:187], a[236:239]
    v_exp_f32 v133, v133
    v_mfma_f32_16x16x32_bf16 v[64:67], a[128:131], v[184:187], v[64:67]
    s_mov_b32 m0, s70
    ds_read_b64_tr_b16 a[128:129], v231 offset:0
    ds_read_b64_tr_b16 a[130:131], v231 offset:512
    v_mfma_f32_16x16x32_bf16 v[68:71], a[132:135], v[184:187], v[68:71]
    buffer_load_dwordx4 v237, s[12:15], s25 offen offset:3104 lds
    v_mfma_f32_16x16x32_bf16 v[72:75], a[136:139], v[184:187], v[72:75]
    s_add_u32 s14, s10, 4096
    ds_read_b64_tr_b16 a[132:133], v231 offset:32
    ds_read_b64_tr_b16 a[134:135], v231 offset:544
    ds_read_b64_tr_b16 a[136:137], v231 offset:64
    v_mfma_f32_16x16x32_bf16 v[76:79], a[140:143], v[184:187], v[76:79]
    s_mov_b32 s25, s24
    ds_read_b64_tr_b16 a[138:139], v231 offset:576
    ds_read_b64_tr_b16 a[140:141], v231 offset:96
    v_mfma_f32_16x16x32_bf16 v[80:83], a[144:147], v[184:187], v[80:83]
    ds_read_b64_tr_b16 a[142:143], v231 offset:608
    ds_read_b64_tr_b16 a[144:145], v231 offset:128
    v_mfma_f32_16x16x32_bf16 v[84:87], a[148:151], v[184:187], v[84:87]
    ds_read_b64_tr_b16 a[146:147], v231 offset:640
    ds_read_b64_tr_b16 a[148:149], v231 offset:160
    v_mfma_f32_16x16x32_bf16 v[88:91], a[152:155], v[184:187], v[88:91]
    ds_read_b64_tr_b16 a[150:151], v231 offset:672
    v_cndmask_b32 v133, 0, v133, s[50:51]
    v_mfma_f32_16x16x32_bf16 v[92:95], a[156:159], v[184:187], v[92:95]
    ds_read_b64_tr_b16 a[152:153], v231 offset:192
    v_cvt_pk_bf16_f32 v178, v132, v133
    v_mfma_f32_16x16x32_bf16 v[136:139], a[96:99], a[16:19], v[204:207]
    v_exp_f32 v134, v134
    v_mfma_f32_16x16x32_bf16 v[136:139], a[100:103], a[20:23], v[136:139]
    s_mov_b32 m0, s70
    ds_read_b64_tr_b16 a[154:155], v231 offset:704
    ds_read_b64_tr_b16 a[156:157], v231 offset:224
    v_mfma_f32_16x16x32_bf16 v[136:139], a[104:107], a[24:27], v[136:139]
    buffer_load_dwordx4 v234, s[8:11], s24 offen lds
    v_mfma_f32_16x16x32_bf16 v[136:139], a[108:111], a[28:31], v[136:139]
    ds_read_b64_tr_b16 a[158:159], v231 offset:736
    v_cndmask_b32 v134, 0, v134, s[52:53]
    v_mfma_f32_16x16x32_bf16 v[140:143], a[112:115], a[16:19], v[204:207]
    v_exp_f32 v135, v135
    v_mfma_f32_16x16x32_bf16 v[140:143], a[116:119], a[20:23], v[140:143]
    v_cndmask_b32 v135, 0, v135, s[54:55]
    v_cvt_pk_bf16_f32 v179, v134, v135
    v_mfma_f32_16x16x32_bf16 v[140:143], a[120:123], a[24:27], v[140:143]
    v_exp_f32 v136, v136
    v_mfma_f32_16x16x32_bf16 v[140:143], a[124:127], a[28:31], v[140:143]
    v_cndmask_b32 v136, 0, v136, s[40:41]
    v_exp_f32 v137, v137
    v_mfma_f32_16x16x32_bf16 v[144:147], a[96:99], a[32:35], v[208:211]
    ds_read_b128 a[96:99], v230 offset:0
    v_cndmask_b32 v137, 0, v137, s[42:43]
    v_cvt_pk_bf16_f32 v180, v136, v137
    v_mfma_f32_16x16x32_bf16 v[144:147], a[100:103], a[36:39], v[144:147]
    ds_read_b128 a[100:103], v230 offset:64
    v_exp_f32 v138, v138
    v_mfma_f32_16x16x32_bf16 v[144:147], a[104:107], a[40:43], v[144:147]
    ds_read_b128 a[104:107], v230 offset:128
    v_cndmask_b32 v138, 0, v138, s[44:45]
    v_mfma_f32_16x16x32_bf16 v[144:147], a[108:111], a[44:47], v[144:147]
    ds_read_b128 a[108:111], v230 offset:192
    v_exp_f32 v139, v139
    v_mfma_f32_16x16x32_bf16 v[148:151], a[112:115], a[32:35], v[208:211]
    ds_read_b128 a[112:115], v230 offset:1024
    v_cndmask_b32 v139, 0, v139, s[46:47]
    v_cvt_pk_bf16_f32 v181, v138, v139
    v_mfma_f32_16x16x32_bf16 v[148:151], a[116:119], a[36:39], v[148:151]
    s_mov_b32 m0, s70
    ds_read_b128 a[116:119], v230 offset:1088
    v_exp_f32 v140, v140
    v_mfma_f32_16x16x32_bf16 v[148:151], a[120:123], a[40:43], v[148:151]
    buffer_load_dwordx4 v235, s[8:11], s24 offen offset:1024 lds
    v_mfma_f32_16x16x32_bf16 v[148:151], a[124:127], a[44:47], v[148:151]
    s_add_u32 s24, s24, 131072
    ds_read_b128 a[120:123], v230 offset:1152
    ds_read_b128 a[124:127], v230 offset:1216
    s_sub_u32 s3, s3, 1
    v_mfma_f32_16x16x32_bf16 a[228:231], a[224:227], v[176:179], a[228:231]
    s_waitcnt lgkmcnt(5)
    s_add_u32 s66, s33, 0
    s_add_u32 s67, s33, 65536
    s_add_u32 s74, s33, 131072
    v_mfma_f32_16x16x32_bf16 v[0:3], a[128:131], v[176:179], v[0:3]
    s_sub_u32 s26, s37, 4
    s_mov_b32 s91, 0
    s_mov_b32 s4, s31
    s_lshl_b32 s5, s64, 14
    v_mfma_f32_16x16x32_bf16 v[4:7], a[132:135], v[176:179], v[4:7]
    s_add_u32 s5, s5, s34
    s_cmp_le_u32 s38, 16
    s_cselect_b32 s71, 8, 0
    s_mov_b32 s36, 0
    v_mfma_f32_16x16x32_bf16 v[8:11], a[136:139], v[176:179], v[8:11]
    s_mov_b32 s30, 0x40000000
    v_accvgpr_read_b32 v224, a228
    s_mov_b32 s31, 0
    v_cmp_nle_f32 s[68:69], v224, s63
    v_mfma_f32_16x16x32_bf16 v[12:15], a[140:143], v[176:179], v[12:15]
    s_or_b64 s[56:57], s[56:57], s[68:69]
    s_waitcnt vmcnt(29)
    v_rcp_f32 v200, v224
    v_mfma_f32_16x16x32_bf16 v[16:19], a[144:147], v[176:179], v[16:19]
    ds_read_b128 a[0:3], v238 offset:0
    ds_read_b128 a[4:7], v238 offset:64
    ds_read_b128 a[8:11], v238 offset:128
    v_mfma_f32_16x16x32_bf16 v[20:23], a[148:151], v[176:179], v[20:23]
    ds_read_b128 a[12:15], v238 offset:192
    v_cndmask_b32 v140, 0, v140, s[48:49]
    v_mfma_f32_16x16x32_bf16 v[24:27], a[152:155], v[176:179], v[24:27]
    v_exp_f32 v141, v141
    v_mfma_f32_16x16x32_bf16 v[28:31], a[156:159], v[176:179], v[28:31]
    v_pk_mul_f32 v[0:1], v[0:1], v[200:201] op_sel_hi:[1,0]
    v_pk_mul_f32 v[2:3], v[2:3], v[200:201] op_sel_hi:[1,0]
    v_cvt_pk_bf16_f32 v0, v0, v1
    v_pk_mul_f32 v[4:5], v[4:5], v[200:201] op_sel_hi:[1,0]
    v_pk_mul_f32 v[6:7], v[6:7], v[200:201] op_sel_hi:[1,0]
    v_pk_mul_f32 v[8:9], v[8:9], v[200:201] op_sel_hi:[1,0]
    v_pk_mul_f32 v[10:11], v[10:11], v[200:201] op_sel_hi:[1,0]
    v_pk_mul_f32 v[12:13], v[12:13], v[200:201] op_sel_hi:[1,0]
    v_pk_mul_f32 v[14:15], v[14:15], v[200:201] op_sel_hi:[1,0]
    v_pk_mul_f32 v[16:17], v[16:17], v[200:201] op_sel_hi:[1,0]
    v_pk_mul_f32 v[18:19], v[18:19], v[200:201] op_sel_hi:[1,0]
    v_pk_mul_f32 v[20:21], v[20:21], v[200:201] op_sel_hi:[1,0]
    v_pk_mul_f32 v[22:23], v[22:23], v[200:201] op_sel_hi:[1,0]
    v_cndmask_b32 v141, 0, v141, s[50:51]
    v_pk_mul_f32 v[24:25], v[24:25], v[200:201] op_sel_hi:[1,0]
    v_pk_mul_f32 v[26:27], v[26:27], v[200:201] op_sel_hi:[1,0]
    v_cvt_pk_bf16_f32 v182, v140, v141
    v_exp_f32 v142, v142
    v_pk_mul_f32 v[28:29], v[28:29], v[200:201] op_sel_hi:[1,0]
    v_pk_mul_f32 v[30:31], v[30:31], v[200:201] op_sel_hi:[1,0]
    v_cndmask_b32 v142, 0, v142, s[52:53]
    v_exp_f32 v143, v143
    v_cvt_pk_bf16_f32 v1, v2, v3
    v_cndmask_b32 v143, 0, v143, s[54:55]
    v_cvt_pk_bf16_f32 v183, v142, v143
    v_cvt_pk_bf16_f32 v2, v4, v5
    v_cvt_pk_bf16_f32 v3, v6, v7
    v_mfma_f32_16x16x32_bf16 a[232:235], a[224:227], v[180:183], a[232:235]
    ds_write_b64 v242, v[0:1] offset:0
    ds_write_b64 v242, v[2:3] offset:32
    v_cvt_pk_bf16_f32 v4, v8, v9
    v_mfma_f32_16x16x32_bf16 v[32:35], a[128:131], v[180:183], v[32:35]
    v_cvt_pk_bf16_f32 v5, v10, v11
    v_cvt_pk_bf16_f32 v6, v12, v13
    v_cvt_pk_bf16_f32 v7, v14, v15
    v_mfma_f32_16x16x32_bf16 v[36:39], a[132:135], v[180:183], v[36:39]
    ds_write_b64 v242, v[4:5] offset:64
    ds_write_b64 v242, v[6:7] offset:96
    v_cvt_pk_bf16_f32 v8, v16, v17
    v_mfma_f32_16x16x32_bf16 v[40:43], a[136:139], v[180:183], v[40:43]
    v_cvt_pk_bf16_f32 v9, v18, v19
    v_cvt_pk_bf16_f32 v10, v20, v21
    v_cvt_pk_bf16_f32 v11, v22, v23
    v_mfma_f32_16x16x32_bf16 v[44:47], a[140:143], v[180:183], v[44:47]
    ds_write_b64 v242, v[8:9] offset:128
    ds_write_b64 v242, v[10:11] offset:160
    v_cvt_pk_bf16_f32 v12, v24, v25
    v_mfma_f32_16x16x32_bf16 v[48:51], a[144:147], v[180:183], v[48:51]
    v_cvt_pk_bf16_f32 v13, v26, v27
    v_cvt_pk_bf16_f32 v14, v28, v29
    v_cvt_pk_bf16_f32 v15, v30, v31
    v_mfma_f32_16x16x32_bf16 v[52:55], a[148:151], v[180:183], v[52:55]
    ds_write_b64 v242, v[12:13] offset:192
    ds_write_b64 v242, v[14:15] offset:224
    ds_read_b64 v[16:17], v243 offset:0
    v_mfma_f32_16x16x32_bf16 v[56:59], a[152:155], v[180:183], v[56:59]
    ds_read_b64 v[18:19], v245 offset:0
    v_exp_f32 v144, v144
    v_mfma_f32_16x16x32_bf16 v[60:63], a[156:159], v[180:183], v[60:63]
    ds_read_b64 v[20:21], v243 offset:1056
    v_accvgpr_read_b32 v225, a232
    v_cndmask_b32 v144, 0, v144, s[40:41]
    v_exp_f32 v145, v145
    v_exp_f32 v146, v146
    v_cndmask_b32 v145, 0, v145, s[42:43]
    v_cvt_pk_bf16_f32 v184, v144, v145
    v_cndmask_b32 v146, 0, v146, s[44:45]
    v_exp_f32 v147, v147
    v_exp_f32 v148, v148
    v_cndmask_b32 v147, 0, v147, s[46:47]
    v_cvt_pk_bf16_f32 v185, v146, v147
    v_cndmask_b32 v148, 0, v148, s[48:49]
    v_exp_f32 v149, v149
    v_exp_f32 v150, v150
    v_cndmask_b32 v149, 0, v149, s[50:51]
    v_cvt_pk_bf16_f32 v186, v148, v149
    v_cndmask_b32 v150, 0, v150, s[52:53]
    v_exp_f32 v151, v151
    v_rcp_f32 v204, v225
    v_cndmask_b32 v151, 0, v151, s[54:55]
    v_cvt_pk_bf16_f32 v187, v150, v151
    v_cmp_gt_i32 s[40:41], v244, 0
    v_cmp_gt_i32 s[42:43], v244, 1
    v_mfma_f32_16x16x32_bf16 a[236:239], a[224:227], v[184:187], a[236:239]
    s_waitcnt lgkmcnt(1)
    buffer_store_dwordx4 v[16:19], v239, s[20:23], s66 offen nt
    v_mfma_f32_16x16x32_bf16 v[64:67], a[128:131], v[184:187], v[64:67]
    ds_read_b64 v[22:23], v245 offset:1056
    ds_read_b64 v[24:25], v243 offset:2112
    ds_read_b64 v[26:27], v245 offset:2112
    v_mfma_f32_16x16x32_bf16 v[68:71], a[132:135], v[184:187], v[68:71]
    ds_read_b64 v[28:29], v243 offset:3168
    ds_read_b64 v[30:31], v245 offset:3168
    v_cmp_gt_i32 s[44:45], v244, 2
    v_mfma_f32_16x16x32_bf16 v[72:75], a[136:139], v[184:187], v[72:75]
    v_accvgpr_read_b32 v226, a236
    v_cmp_gt_i32 s[46:47], v244, 3
    v_cmp_gt_i32 s[48:49], v244, 16
    v_mfma_f32_16x16x32_bf16 v[76:79], a[140:143], v[184:187], v[76:79]
    v_rcp_f32 v208, v226
    v_cmp_gt_i32 s[50:51], v244, 17
    v_mfma_f32_16x16x32_bf16 v[80:83], a[144:147], v[184:187], v[80:83]
    v_cmp_gt_i32 s[52:53], v244, 18
    v_cmp_gt_i32 s[54:55], v244, 19
    v_cmp_nle_f32 s[68:69], v225, s63
    v_mfma_f32_16x16x32_bf16 v[84:87], a[148:151], v[184:187], v[84:87]
    s_or_b64 s[56:57], s[56:57], s[68:69]
    v_cmp_nle_f32 s[68:69], v226, s63
    v_mfma_f32_16x16x32_bf16 v[88:91], a[152:155], v[184:187], v[88:91]
    s_or_b64 s[56:57], s[56:57], s[68:69]
    s_waitcnt vmcnt(29)
    v_mfma_f32_16x16x32_bf16 v[92:95], a[156:159], v[184:187], v[92:95]
    s_waitcnt lgkmcnt(0)
    buffer_store_dwordx4 v[20:23], v241, s[20:23], s66 offen nt
    v_pk_mul_f32 v[32:33], v[32:33], v[204:205] op_sel_hi:[1,0]
    v_pk_mul_f32 v[34:35], v[34:35], v[204:205] op_sel_hi:[1,0]
    v_pk_mul_f32 v[36:37], v[36:37], v[204:205] op_sel_hi:[1,0]
    v_pk_mul_f32 v[38:39], v[38:39], v[204:205] op_sel_hi:[1,0]
    v_pk_mul_f32 v[40:41], v[40:41], v[204:205] op_sel_hi:[1,0]
    v_pk_mul_f32 v[42:43], v[42:43], v[204:205] op_sel_hi:[1,0]
    v_pk_mul_f32 v[44:45], v[44:45], v[204:205] op_sel_hi:[1,0]
    v_pk_mul_f32 v[46:47], v[46:47], v[204:205] op_sel_hi:[1,0]
    v_pk_mul_f32 v[48:49], v[48:49], v[204:205] op_sel_hi:[1,0]
    v_pk_mul_f32 v[50:51], v[50:51], v[204:205] op_sel_hi:[1,0]
    v_pk_mul_f32 v[52:53], v[52:53], v[204:205] op_sel_hi:[1,0]
    v_pk_mul_f32 v[54:55], v[54:55], v[204:205] op_sel_hi:[1,0]
    v_pk_mul_f32 v[56:57], v[56:57], v[204:205] op_sel_hi:[1,0]
    v_pk_mul_f32 v[58:59], v[58:59], v[204:205] op_sel_hi:[1,0]
    v_pk_mul_f32 v[60:61], v[60:61], v[204:205] op_sel_hi:[1,0]
    v_pk_mul_f32 v[62:63], v[62:63], v[204:205] op_sel_hi:[1,0]
    v_pk_mul_f32 v[64:65], v[64:65], v[208:209] op_sel_hi:[1,0]
    v_pk_mul_f32 v[66:67], v[66:67], v[208:209] op_sel_hi:[1,0]
    v_pk_mul_f32 v[68:69], v[68:69], v[208:209] op_sel_hi:[1,0]
    v_pk_mul_f32 v[70:71], v[70:71], v[208:209] op_sel_hi:[1,0]
    v_pk_mul_f32 v[72:73], v[72:73], v[208:209] op_sel_hi:[1,0]
    v_pk_mul_f32 v[74:75], v[74:75], v[208:209] op_sel_hi:[1,0]
    v_pk_mul_f32 v[76:77], v[76:77], v[208:209] op_sel_hi:[1,0]
    v_pk_mul_f32 v[78:79], v[78:79], v[208:209] op_sel_hi:[1,0]
    v_pk_mul_f32 v[80:81], v[80:81], v[208:209] op_sel_hi:[1,0]
    buffer_store_dwordx4 v[24:27], v246, s[20:23], s66 offen nt
    v_pk_mul_f32 v[82:83], v[82:83], v[208:209] op_sel_hi:[1,0]
    v_pk_mul_f32 v[84:85], v[84:85], v[208:209] op_sel_hi:[1,0]
    v_pk_mul_f32 v[86:87], v[86:87], v[208:209] op_sel_hi:[1,0]
    v_pk_mul_f32 v[88:89], v[88:89], v[208:209] op_sel_hi:[1,0]
    v_pk_mul_f32 v[90:91], v[90:91], v[208:209] op_sel_hi:[1,0]
    v_pk_mul_f32 v[92:93], v[92:93], v[208:209] op_sel_hi:[1,0]
    v_pk_mul_f32 v[94:95], v[94:95], v[208:209] op_sel_hi:[1,0]
    v_mfma_f32_16x16x32_bf16 v[96:99], a[82:85], a[0:3], 0
    v_cvt_pk_bf16_f32 v32, v32, v33
    v_cvt_pk_bf16_f32 v33, v34, v35
    v_cvt_pk_bf16_f32 v34, v36, v37
    v_mfma_f32_16x16x32_bf16 v[96:99], a[86:89], a[0:3], v[96:99]
    ds_write_b64 v242, v[32:33] offset:0
    v_cvt_pk_bf16_f32 v35, v38, v39
    v_cvt_pk_bf16_f32 v36, v40, v41
    v_mfma_f32_16x16x32_bf16 v[100:103], a[80:83], a[0:3], 0
    ds_write_b64 v242, v[34:35] offset:32
    v_cvt_pk_bf16_f32 v37, v42, v43
    v_cvt_pk_bf16_f32 v38, v44, v45
    v_mfma_f32_16x16x32_bf16 v[100:103], a[84:87], a[0:3], v[100:103]
    ds_write_b64 v242, v[36:37] offset:64
    v_cvt_pk_bf16_f32 v39, v46, v47
    v_cvt_pk_bf16_f32 v40, v48, v49
    v_mfma_f32_16x16x32_bf16 v[104:107], a[82:85], a[4:7], 0
    buffer_store_dwordx4 v[28:31], v247, s[20:23], s66 offen nt
    v_mfma_f32_16x16x32_bf16 v[104:107], a[86:89], a[4:7], v[104:107]
    ds_write_b64 v242, v[38:39] offset:96
    v_cvt_pk_bf16_f32 v41, v50, v51
    v_cvt_pk_bf16_f32 v42, v52, v53
    v_mfma_f32_16x16x32_bf16 v[108:111], a[80:83], a[4:7], 0
    ds_write_b64 v242, v[40:41] offset:128
    v_cvt_pk_bf16_f32 v43, v54, v55
    v_cvt_pk_bf16_f32 v44, v56, v57
    v_mfma_f32_16x16x32_bf16 v[108:111], a[84:87], a[4:7], v[108:111]
    ds_write_b64 v242, v[42:43] offset:160
    v_cvt_pk_bf16_f32 v45, v58, v59
    v_cvt_pk_bf16_f32 v46, v60, v61
    v_mfma_f32_16x16x32_bf16 v[112:115], a[82:85], a[8:11], 0
    ds_write_b64 v242, v[44:45] offset:192
    v_cvt_pk_bf16_f32 v47, v62, v63
    v_cvt_pk_bf16_f32 v64, v64, v65
    v_mfma_f32_16x16x32_bf16 v[112:115], a[86:89], a[8:11], v[112:115]
    ds_write_b64 v242, v[46:47] offset:224
    ds_read_b64 v[48:49], v243 offset:0
    ds_read_b64 v[50:51], v245 offset:0
    v_mfma_f32_16x16x32_bf16 v[116:119], a[80:83], a[8:11], 0
    ds_read_b64 v[52:53], v243 offset:1056
    ds_read_b64 v[54:55], v245 offset:1056
    ds_read_b64 v[56:57], v243 offset:2112
    v_mfma_f32_16x16x32_bf16 v[116:119], a[84:87], a[8:11], v[116:119]
    ds_read_b64 v[58:59], v245 offset:2112
    ds_read_b64 v[60:61], v243 offset:3168
    ds_read_b64 v[62:63], v245 offset:3168
    v_mfma_f32_16x16x32_bf16 v[120:123], a[82:85], a[12:15], 0
    v_cvt_pk_bf16_f32 v65, v66, v67
    v_cvt_pk_bf16_f32 v66, v68, v69
    v_cvt_pk_bf16_f32 v67, v70, v71
    v_mfma_f32_16x16x32_bf16 v[120:123], a[86:89], a[12:15], v[120:123]
    ds_write_b64 v242, v[64:65] offset:0
    ds_write_b64 v242, v[66:67] offset:32
    v_cvt_pk_bf16_f32 v68, v72, v73
    v_mfma_f32_16x16x32_bf16 v[124:127], a[80:83], a[12:15], 0
    v_cvt_pk_bf16_f32 v69, v74, v75
    v_cvt_pk_bf16_f32 v70, v76, v77
    v_cvt_pk_bf16_f32 v71, v78, v79
    v_mfma_f32_16x16x32_bf16 v[124:127], a[84:87], a[12:15], v[124:127]
    ds_write_b64 v242, v[68:69] offset:64
    ds_write_b64 v242, v[70:71] offset:96
    v_cvt_pk_bf16_f32 v72, v80, v81
    s_waitcnt lgkmcnt(10)
    buffer_store_dwordx4 v[48:51], v239, s[20:23], s67 offen nt
    v_cvt_pk_bf16_f32 v73, v82, v83
    ds_write_b64 v242, v[72:73] offset:128
    v_cvt_pk_bf16_f32 v74, v84, v85
    v_cvt_pk_bf16_f32 v75, v86, v87
    ds_write_b64 v242, v[74:75] offset:160
    v_cvt_pk_bf16_f32 v76, v88, v89
    v_cvt_pk_bf16_f32 v77, v90, v91
    ds_write_b64 v242, v[76:77] offset:192
    v_cvt_pk_bf16_f32 v78, v92, v93
    v_cvt_pk_bf16_f32 v79, v94, v95
    ds_write_b64 v242, v[78:79] offset:224
    ds_read_b64 v[80:81], v243 offset:0
    ds_read_b64 v[82:83], v245 offset:0
    ds_read_b64 v[84:85], v243 offset:1056
    ds_read_b64 v[86:87], v245 offset:1056
    ds_read_b64 v[88:89], v243 offset:2112
    ds_read_b64 v[90:91], v245 offset:2112
    ds_read_b64 v[92:93], v243 offset:3168
    ds_read_b64 v[94:95], v245 offset:3168
    ds_read_b128 a[16:19], v238 offset:4352
    v_cvt_pk_bf16_f32 v96, v96, v97
    v_cvt_pk_bf16_f32 v97, v98, v99
    v_accvgpr_write_b32 a0, v96
    v_accvgpr_write_b32 a1, v97
    v_cvt_pk_bf16_f32 v100, v100, v101
    v_cvt_pk_bf16_f32 v101, v102, v103
    v_accvgpr_write_b32 a2, v100
    v_accvgpr_write_b32 a3, v101
    v_cvt_pk_bf16_f32 v104, v104, v105
    v_cvt_pk_bf16_f32 v105, v106, v107
    v_cvt_pk_bf16_f32 v108, v108, v109
    v_cvt_pk_bf16_f32 v109, v110, v111
    v_accvgpr_write_b32 a4, v104
    v_accvgpr_write_b32 a5, v105
    v_accvgpr_write_b32 a6, v108
    v_accvgpr_write_b32 a7, v109
    s_waitcnt lgkmcnt(0)
    v_mfma_f32_16x16x32_bf16 v[96:99], a[82:85], a[16:19], 0
    buffer_store_dwordx4 v[52:55], v241, s[20:23], s67 offen nt
    v_mfma_f32_16x16x32_bf16 v[96:99], a[86:89], a[16:19], v[96:99]
    ds_read_b128 a[20:23], v238 offset:4416
    ds_read_b128 a[24:27], v238 offset:4480
    ds_read_b128 a[28:31], v238 offset:4544
    v_mfma_f32_16x16x32_bf16 v[100:103], a[80:83], a[16:19], 0
    v_cvt_pk_bf16_f32 v112, v112, v113
    v_cvt_pk_bf16_f32 v113, v114, v115
    v_cvt_pk_bf16_f32 v116, v116, v117
    v_mfma_f32_16x16x32_bf16 v[100:103], a[84:87], a[16:19], v[100:103]
    s_waitcnt lgkmcnt(2)
    v_cvt_pk_bf16_f32 v117, v118, v119
    v_accvgpr_write_b32 a8, v112
    v_accvgpr_write_b32 a9, v113
    v_mfma_f32_16x16x32_bf16 v[104:107], a[82:85], a[20:23], 0
    v_accvgpr_write_b32 a10, v116
    v_accvgpr_write_b32 a11, v117
    v_cvt_pk_bf16_f32 v120, v120, v121
    v_mfma_f32_16x16x32_bf16 v[104:107], a[86:89], a[20:23], v[104:107]
    v_cvt_pk_bf16_f32 v121, v122, v123
    v_cvt_pk_bf16_f32 v124, v124, v125
    v_cvt_pk_bf16_f32 v125, v126, v127
    v_mfma_f32_16x16x32_bf16 v[108:111], a[80:83], a[20:23], 0
    buffer_store_dwordx4 v[56:59], v246, s[20:23], s67 offen nt
    v_mfma_f32_16x16x32_bf16 v[108:111], a[84:87], a[20:23], v[108:111]
    s_waitcnt lgkmcnt(0)
    v_accvgpr_write_b32 a12, v120
    v_accvgpr_write_b32 a13, v121
    v_accvgpr_write_b32 a14, v124
    v_mfma_f32_16x16x32_bf16 v[112:115], a[82:85], a[24:27], 0
    v_accvgpr_write_b32 a15, v125
    v_cvt_pk_bf16_f32 v96, v96, v97
    v_cvt_pk_bf16_f32 v97, v98, v99
    v_mfma_f32_16x16x32_bf16 v[112:115], a[86:89], a[24:27], v[112:115]
    v_cvt_pk_bf16_f32 v100, v100, v101
    v_cvt_pk_bf16_f32 v101, v102, v103
    v_accvgpr_write_b32 a16, v96
    v_mfma_f32_16x16x32_bf16 v[116:119], a[80:83], a[24:27], 0
    v_accvgpr_write_b32 a17, v97
    v_accvgpr_write_b32 a18, v100
    v_accvgpr_write_b32 a19, v101
    v_mfma_f32_16x16x32_bf16 v[116:119], a[84:87], a[24:27], v[116:119]
    v_cvt_pk_bf16_f32 v104, v104, v105
    v_cvt_pk_bf16_f32 v105, v106, v107
    v_cvt_pk_bf16_f32 v108, v108, v109
    v_mfma_f32_16x16x32_bf16 v[120:123], a[82:85], a[28:31], 0
    buffer_store_dwordx4 v[60:63], v247, s[20:23], s67 offen nt
    v_mfma_f32_16x16x32_bf16 v[120:123], a[86:89], a[28:31], v[120:123]
    v_cvt_pk_bf16_f32 v109, v110, v111
    v_accvgpr_write_b32 a20, v104
    v_accvgpr_write_b32 a21, v105
    v_mfma_f32_16x16x32_bf16 v[124:127], a[80:83], a[28:31], 0
    v_accvgpr_write_b32 a22, v108
    v_accvgpr_write_b32 a23, v109
    v_cvt_pk_bf16_f32 v112, v112, v113
    v_mfma_f32_16x16x32_bf16 v[124:127], a[84:87], a[28:31], v[124:127]
    v_cvt_pk_bf16_f32 v113, v114, v115
    v_cvt_pk_bf16_f32 v116, v116, v117
    v_cvt_pk_bf16_f32 v117, v118, v119
    v_mfma_f32_16x16x32_bf16 v[128:131], a[96:99], a[0:3], 0
    v_accvgpr_write_b32 a24, v112
    v_accvgpr_write_b32 a25, v113
    v_accvgpr_write_b32 a26, v116
    v_mfma_f32_16x16x32_bf16 v[128:131], a[100:103], a[4:7], v[128:131]
    v_accvgpr_write_b32 a27, v117
    v_cvt_pk_bf16_f32 v120, v120, v121
    v_cvt_pk_bf16_f32 v121, v122, v123
    v_mfma_f32_16x16x32_bf16 v[128:131], a[104:107], a[8:11], v[128:131]
    s_mov_b32 s70, s27
    buffer_store_dwordx4 v[80:83], v239, s[20:23], s74 offen nt
    v_mfma_f32_16x16x32_bf16 v[128:131], a[108:111], a[12:15], v[128:131]
    s_add_u32 s27, s27, 16640
    v_cvt_pk_bf16_f32 v124, v124, v125
    v_cvt_pk_bf16_f32 v125, v126, v127
    v_accvgpr_write_b32 a28, v120
    v_mfma_f32_16x16x32_bf16 v[132:135], a[112:115], a[0:3], 0
    s_cmp_eq_u32 s27, s29
    v_accvgpr_write_b32 a29, v121
    v_accvgpr_write_b32 a30, v124
    v_max3_f32 v176, v128, v129, v130
    v_mfma_f32_16x16x32_bf16 v[132:135], a[116:119], a[4:7], v[132:135]
    s_cselect_b32 s27, s28, s27
    v_accvgpr_write_b32 a31, v125
    v_mfma_f32_16x16x32_bf16 v[132:135], a[120:123], a[8:11], v[132:135]
    s_waitcnt vmcnt(21)
    v_mfma_f32_16x16x32_bf16 v[132:135], a[124:127], a[12:15], v[132:135]
    s_barrier
    v_add_u32 v231, s27, v233
    ds_read_b64_tr_b16 a[128:129], v231 offset:0
    ds_read_b64_tr_b16 a[130:131], v231 offset:512
    buffer_store_dwordx4 v[84:87], v241, s[20:23], s74 offen nt
    ds_read_b64_tr_b16 a[132:133], v231 offset:32
    s_cmp_lg_u64 s[56:57], 0
    ds_read_b64_tr_b16 a[134:135], v231 offset:544
    ds_read_b64_tr_b16 a[136:137], v231 offset:64
    s_cselect_b32 s6, 1, 0
    ds_read_b64_tr_b16 a[138:139], v231 offset:576
    ds_read_b64_tr_b16 a[140:141], v231 offset:96
    s_lshl_b32 s6, s6, s59
    ds_read_b64_tr_b16 a[142:143], v231 offset:608
    ds_read_b64_tr_b16 a[144:145], v231 offset:128
    s_or_b32 s58, s58, s6
    ds_read_b64_tr_b16 a[146:147], v231 offset:640
    ds_read_b64_tr_b16 a[148:149], v231 offset:160
    s_mov_b64 s[56:57], 0
    ds_read_b64_tr_b16 a[150:151], v231 offset:672
    ds_read_b64_tr_b16 a[152:153], v231 offset:192
    s_add_u32 s59, s59, 1
    ds_read_b64_tr_b16 a[154:155], v231 offset:704
    ds_read_b64_tr_b16 a[156:157], v231 offset:224
    ds_read_b64_tr_b16 a[158:159], v231 offset:736
    s_waitcnt vmcnt(37)
    ds_read_b128 a[32:35], v238 offset:8704
    v_max3_f32 v177, v132, v133, v134
    v_max3_f32 v176, v176, v131, v135
    v_max_f32 v176, v176, v177
    v_mov_b32 v177, v176
    v_add_u32 v230, s27, v232
    s_waitcnt lgkmcnt(0)
    v_mfma_f32_16x16x32_bf16 v[96:99], a[82:85], a[32:35], 0
    buffer_store_dwordx4 v[88:91], v246, s[20:23], s74 offen nt
    v_mfma_f32_16x16x32_bf16 v[96:99], a[86:89], a[32:35], v[96:99]
    ds_read_b128 a[36:39], v238 offset:8768
    ds_read_b128 a[40:43], v238 offset:8832
    ds_read_b128 a[44:47], v238 offset:8896
    v_mfma_f32_16x16x32_bf16 v[100:103], a[80:83], a[32:35], 0
    v_permlane32_swap_b32 v177, v176
    v_max_f32 v176, v176, v177
    v_mov_b32 v177, v176
    v_mfma_f32_16x16x32_bf16 v[100:103], a[84:87], a[32:35], v[100:103]
    s_waitcnt lgkmcnt(2)
    v_permlane16_swap_b32 v177, v176
    v_max_f32 v176, v176, v177
    v_sub_f32 v200, 0, v176
    v_mfma_f32_16x16x32_bf16 v[104:107], a[82:85], a[36:39], 0
    v_sub_f32 v201, 0, v176
    v_sub_f32 v202, 0, v176
    v_sub_f32 v203, 0, v176
    v_mfma_f32_16x16x32_bf16 v[104:107], a[86:89], a[36:39], v[104:107]
    v_sub_f32 v128, v128, v176
    v_sub_f32 v129, v129, v176
    v_sub_f32 v130, v130, v176
    v_mfma_f32_16x16x32_bf16 v[108:111], a[80:83], a[36:39], 0
    buffer_store_dwordx4 v[92:95], v247, s[20:23], s74 offen nt
    v_mfma_f32_16x16x32_bf16 v[108:111], a[84:87], a[36:39], v[108:111]
    s_waitcnt lgkmcnt(0)
    v_sub_f32 v131, v131, v176
    v_sub_f32 v132, v132, v176
    v_sub_f32 v133, v133, v176
    v_mfma_f32_16x16x32_bf16 v[112:115], a[82:85], a[40:43], 0
    v_sub_f32 v134, v134, v176
    v_sub_f32 v135, v135, v176
    v_cvt_pk_bf16_f32 v96, v96, v97
    v_mfma_f32_16x16x32_bf16 v[112:115], a[86:89], a[40:43], v[112:115]
    v_exp_f32 v128, v128
    v_cvt_pk_bf16_f32 v97, v98, v99
    v_mfma_f32_16x16x32_bf16 v[116:119], a[80:83], a[40:43], 0
    v_exp_f32 v129, v129
    v_cvt_pk_bf16_f32 v100, v100, v101
    v_mfma_f32_16x16x32_bf16 v[116:119], a[84:87], a[40:43], v[116:119]
    v_cvt_pk_bf16_f32 v176, v128, v129
    v_exp_f32 v130, v130
    v_mfma_f32_16x16x32_bf16 v[120:123], a[82:85], a[44:47], 0
    v_exp_f32 v131, v131
    v_cvt_pk_bf16_f32 v101, v102, v103
    v_mfma_f32_16x16x32_bf16 v[120:123], a[86:89], a[44:47], v[120:123]
    v_cvt_pk_bf16_f32 v177, v130, v131
    v_exp_f32 v132, v132
    v_mfma_f32_16x16x32_bf16 v[124:127], a[80:83], a[44:47], 0
    s_waitcnt vmcnt(38)
    v_exp_f32 v133, v133
    v_accvgpr_write_b32 a32, v96
    v_mfma_f32_16x16x32_bf16 v[124:127], a[84:87], a[44:47], v[124:127]
    ds_read_b128 a[48:51], v238 offset:13056
    ds_read_b128 a[52:55], v238 offset:13120
    v_cvt_pk_bf16_f32 v178, v132, v133
    v_mfma_f32_16x16x32_bf16 v[136:139], a[96:99], a[16:19], 0
    s_mov_b32 m0, s70
    ds_read_b128 a[56:59], v238 offset:13184
    ds_read_b128 a[60:63], v238 offset:13248
    v_accvgpr_write_b32 a33, v97
    v_mfma_f32_16x16x32_bf16 v[136:139], a[100:103], a[20:23], v[136:139]
    buffer_load_dwordx4 v236, s[12:15], s25 offen offset:2048 lds
    v_mfma_f32_16x16x32_bf16 v[136:139], a[104:107], a[24:27], v[136:139]
    v_exp_f32 v134, v134
    v_accvgpr_write_b32 a34, v100
    v_mfma_f32_16x16x32_bf16 v[136:139], a[108:111], a[28:31], v[136:139]
    v_exp_f32 v135, v135
    v_accvgpr_write_b32 a35, v101
    v_mfma_f32_16x16x32_bf16 v[140:143], a[112:115], a[16:19], 0
    v_cvt_pk_bf16_f32 v179, v134, v135
    v_cvt_pk_bf16_f32 v104, v104, v105
    v_cvt_pk_bf16_f32 v105, v106, v107
    v_mfma_f32_16x16x32_bf16 v[140:143], a[116:119], a[20:23], v[140:143]
    v_cvt_pk_bf16_f32 v108, v108, v109
    v_max3_f32 v180, v136, v137, v138
    v_cvt_pk_bf16_f32 v109, v110, v111
    v_mfma_f32_16x16x32_bf16 v[140:143], a[120:123], a[24:27], v[140:143]
    v_accvgpr_write_b32 a36, v104
    v_accvgpr_write_b32 a37, v105
    v_accvgpr_write_b32 a38, v108
    v_mfma_f32_16x16x32_bf16 v[140:143], a[124:127], a[28:31], v[140:143]
    s_waitcnt lgkmcnt(0)
    v_accvgpr_write_b32 a39, v109
    v_cvt_pk_bf16_f32 v112, v112, v113
    v_cvt_pk_bf16_f32 v113, v114, v115
    v_mfma_f32_16x16x32_bf16 v[96:99], a[82:85], a[48:51], 0
    v_cvt_pk_bf16_f32 v116, v116, v117
    v_cvt_pk_bf16_f32 v117, v118, v119
    v_accvgpr_write_b32 a40, v112
    v_mfma_f32_16x16x32_bf16 v[96:99], a[86:89], a[48:51], v[96:99]
    v_max3_f32 v181, v140, v141, v142
    v_max3_f32 v180, v180, v139, v143
    v_max_f32 v180, v180, v181
    v_mfma_f32_16x16x32_bf16 v[100:103], a[80:83], a[48:51], 0
    v_mov_b32 v181, v180
    v_accvgpr_write_b32 a41, v113
    v_accvgpr_write_b32 a42, v116
    v_mfma_f32_16x16x32_bf16 v[100:103], a[84:87], a[48:51], v[100:103]
    v_permlane32_swap_b32 v181, v180
    v_max_f32 v180, v180, v181
    v_mov_b32 v181, v180
    v_mfma_f32_16x16x32_bf16 v[104:107], a[82:85], a[52:55], 0
    v_accvgpr_write_b32 a43, v117
    v_permlane16_swap_b32 v181, v180
    v_max_f32 v180, v180, v181
    v_mfma_f32_16x16x32_bf16 v[104:107], a[86:89], a[52:55], v[104:107]
    v_sub_f32 v204, 0, v180
    v_sub_f32 v205, 0, v180
    v_sub_f32 v206, 0, v180
    v_mfma_f32_16x16x32_bf16 v[108:111], a[80:83], a[52:55], 0
    v_sub_f32 v207, 0, v180
    v_sub_f32 v136, v136, v180
    v_sub_f32 v137, v137, v180
    v_mfma_f32_16x16x32_bf16 v[108:111], a[84:87], a[52:55], v[108:111]
    v_sub_f32 v138, v138, v180
    v_sub_f32 v139, v139, v180
    v_sub_f32 v140, v140, v180
    v_mfma_f32_16x16x32_bf16 v[112:115], a[82:85], a[56:59], 0
    v_sub_f32 v141, v141, v180
    v_sub_f32 v142, v142, v180
    v_sub_f32 v143, v143, v180
    v_mfma_f32_16x16x32_bf16 v[112:115], a[86:89], a[56:59], v[112:115]
    v_exp_f32 v136, v136
    v_cvt_pk_bf16_f32 v120, v120, v121
    v_mfma_f32_16x16x32_bf16 v[116:119], a[80:83], a[56:59], 0
    v_mov_b32 v225, v136
    v_exp_f32 v137, v137
    v_mfma_f32_16x16x32_bf16 v[116:119], a[84:87], a[56:59], v[116:119]
    v_cvt_pk_bf16_f32 v121, v122, v123
    v_add_f32 v225, v225, v137
    v_cvt_pk_bf16_f32 v124, v124, v125
    v_accvgpr_write_b32 a44, v120
    v_accvgpr_write_b32 a45, v121
    v_mfma_f32_16x16x32_bf16 v[120:123], a[82:85], a[60:63], 0
    v_cvt_pk_bf16_f32 v180, v136, v137
    v_cvt_pk_bf16_f32 v125, v126, v127
    v_accvgpr_write_b32 a46, v124
    v_mfma_f32_16x16x32_bf16 v[120:123], a[86:89], a[60:63], v[120:123]
    v_exp_f32 v138, v138
    v_accvgpr_write_b32 a47, v125
    v_mfma_f32_16x16x32_bf16 v[124:127], a[80:83], a[60:63], 0
    v_add_f32 v225, v225, v138
    v_exp_f32 v139, v139
    v_mfma_f32_16x16x32_bf16 v[124:127], a[84:87], a[60:63], v[124:127]
    v_add_f32 v225, v225, v139
    v_cvt_pk_bf16_f32 v181, v138, v139
    v_cvt_pk_bf16_f32 v96, v96, v97
    v_mfma_f32_16x16x32_bf16 v[144:147], a[96:99], a[32:35], 0
    v_exp_f32 v140, v140
    v_cvt_pk_bf16_f32 v97, v98, v99
    v_mfma_f32_16x16x32_bf16 v[144:147], a[100:103], a[36:39], v[144:147]
    v_add_f32 v225, v225, v140
    v_exp_f32 v141, v141
    v_mfma_f32_16x16x32_bf16 v[144:147], a[104:107], a[40:43], v[144:147]
    v_add_f32 v225, v225, v141
    v_cvt_pk_bf16_f32 v182, v140, v141
    v_cvt_pk_bf16_f32 v100, v100, v101
    v_mfma_f32_16x16x32_bf16 v[144:147], a[108:111], a[44:47], v[144:147]
    v_exp_f32 v142, v142
    v_cvt_pk_bf16_f32 v101, v102, v103
    v_mfma_f32_16x16x32_bf16 v[148:151], a[112:115], a[32:35], 0
    s_mov_b32 m0, s70
    v_add_f32 v225, v225, v142
    v_exp_f32 v143, v143
    v_mfma_f32_16x16x32_bf16 v[148:151], a[116:119], a[36:39], v[148:151]
    buffer_load_dwordx4 v237, s[12:15], s25 offen offset:3104 lds
    v_mfma_f32_16x16x32_bf16 v[148:151], a[120:123], a[40:43], v[148:151]
    s_add_u32 s14, s10, 4096
    v_add_f32 v225, v225, v143
    v_cvt_pk_bf16_f32 v183, v142, v143
    v_accvgpr_write_b32 a48, v96
    v_mfma_f32_16x16x32_bf16 v[148:151], a[124:127], a[44:47], v[148:151]
    s_mov_b32 s25, s24
    v_accvgpr_write_b32 a49, v97
    v_accvgpr_write_b32 a50, v100
    v_accvgpr_write_b32 a51, v101
    v_cvt_pk_bf16_f32 v104, v104, v105
    v_cvt_pk_bf16_f32 v105, v106, v107
    v_mfma_f32_16x16x32_bf16 v[152:155], a[96:99], a[48:51], 0
    s_mov_b32 m0, s70
    v_cvt_pk_bf16_f32 v108, v108, v109
    v_max3_f32 v184, v144, v145, v146
    v_cvt_pk_bf16_f32 v109, v110, v111
    v_accvgpr_write_b32 a52, v104
    v_accvgpr_write_b32 a53, v105
    v_accvgpr_write_b32 a54, v108
    v_accvgpr_write_b32 a55, v109
    v_max3_f32 v185, v148, v149, v150
    v_max3_f32 v184, v184, v147, v151
    v_mfma_f32_16x16x32_bf16 v[152:155], a[100:103], a[52:55], v[152:155]
    buffer_load_dwordx4 v234, s[8:11], s24 offen lds
    v_cvt_pk_bf16_f32 v112, v112, v113
    v_cvt_pk_bf16_f32 v113, v114, v115
    v_cvt_pk_bf16_f32 v116, v116, v117
    v_cvt_pk_bf16_f32 v117, v118, v119
    v_accvgpr_write_b32 a56, v112
    v_accvgpr_write_b32 a57, v113
    v_accvgpr_write_b32 a58, v116
    v_accvgpr_write_b32 a59, v117
    v_max_f32 v184, v184, v185
    v_mov_b32 v185, v184
    v_mfma_f32_16x16x32_bf16 v[152:155], a[104:107], a[56:59], v[152:155]
    ds_read_b128 a[96:99], v230 offset:0
    v_permlane32_swap_b32 v185, v184
    v_max_f32 v184, v184, v185
    v_cvt_pk_bf16_f32 v120, v120, v121
    v_cvt_pk_bf16_f32 v121, v122, v123
    v_cvt_pk_bf16_f32 v124, v124, v125
    v_cvt_pk_bf16_f32 v125, v126, v127
    v_accvgpr_write_b32 a60, v120
    v_accvgpr_write_b32 a61, v121
    v_accvgpr_write_b32 a62, v124
    v_accvgpr_write_b32 a63, v125
    v_mov_b32 v185, v184
    s_nop 0
    v_mfma_f32_16x16x32_bf16 v[152:155], a[108:111], a[60:63], v[152:155]
    ds_read_b128 a[100:103], v230 offset:64
    v_permlane16_swap_b32 v185, v184
    v_max_f32 v184, v184, v185
    v_mfma_f32_16x16x32_bf16 v[156:159], a[112:115], a[48:51], 0
    v_sub_f32 v208, 0, v184
    v_sub_f32 v209, 0, v184
    v_sub_f32 v210, 0, v184
    v_mfma_f32_16x16x32_bf16 v[156:159], a[116:119], a[52:55], v[156:159]
    v_sub_f32 v211, 0, v184
    v_sub_f32 v144, v144, v184
    v_sub_f32 v145, v145, v184
    v_mfma_f32_16x16x32_bf16 v[156:159], a[120:123], a[56:59], v[156:159]
    v_sub_f32 v146, v146, v184
    v_sub_f32 v147, v147, v184
    v_sub_f32 v148, v148, v184
    v_mfma_f32_16x16x32_bf16 v[156:159], a[124:127], a[60:63], v[156:159]
    v_sub_f32 v149, v149, v184
    v_sub_f32 v150, v150, v184
    v_sub_f32 v151, v151, v184
    v_mfma_f32_16x16x32_bf16 v[0:3], a[128:131], v[176:179], 0
    ds_read_b128 a[104:107], v230 offset:128
    v_exp_f32 v144, v144
    v_mfma_f32_16x16x32_bf16 v[32:35], a[128:131], v[180:183], 0
    v_exp_f32 v145, v145
    v_max3_f32 v188, v152, v153, v154
    v_mfma_f32_16x16x32_bf16 a[228:231], a[224:227], v[176:179], 0
    s_mov_b32 m0, s70
    v_cvt_pk_bf16_f32 v184, v144, v145
    v_exp_f32 v146, v146
    v_mfma_f32_16x16x32_bf16 v[4:7], a[132:135], v[176:179], 0
    buffer_load_dwordx4 v235, s[8:11], s24 offen offset:1024 lds
    v_mfma_f32_16x16x32_bf16 v[36:39], a[132:135], v[180:183], 0
    s_add_u32 s24, s24, 131072
    ds_read_b128 a[108:111], v230 offset:192
    v_exp_f32 v147, v147
    v_mfma_f32_16x16x32_bf16 v[8:11], a[136:139], v[176:179], 0
    s_sub_u32 s3, s3, 1
    v_cvt_pk_bf16_f32 v185, v146, v147
    v_exp_f32 v148, v148
    v_mfma_f32_16x16x32_bf16 v[40:43], a[136:139], v[180:183], 0
    v_exp_f32 v149, v149
    v_max3_f32 v189, v156, v157, v158
    v_mfma_f32_16x16x32_bf16 v[12:15], a[140:143], v[176:179], 0
    v_cvt_pk_bf16_f32 v186, v148, v149
    v_exp_f32 v150, v150
    v_mfma_f32_16x16x32_bf16 v[44:47], a[140:143], v[180:183], 0
    ds_read_b128 a[112:115], v230 offset:1024
    v_exp_f32 v151, v151
    v_mfma_f32_16x16x32_bf16 v[16:19], a[144:147], v[176:179], 0
    ds_read_b128 a[116:119], v230 offset:1088
    v_cvt_pk_bf16_f32 v187, v150, v151
    v_max3_f32 v188, v188, v155, v159
    v_mfma_f32_16x16x32_bf16 v[48:51], a[144:147], v[180:183], 0
    ds_read_b128 a[120:123], v230 offset:1152
    v_max_f32 v188, v188, v189
    v_mov_b32 v189, v188
    v_mfma_f32_16x16x32_bf16 v[20:23], a[148:151], v[176:179], 0
    ds_read_b128 a[124:127], v230 offset:1216
    v_permlane32_swap_b32 v189, v188
    v_max_f32 v188, v188, v189
    v_mfma_f32_16x16x32_bf16 v[52:55], a[148:151], v[180:183], 0
    v_mov_b32 v189, v188
    v_mfma_f32_16x16x32_bf16 v[24:27], a[152:155], v[176:179], 0
    v_mfma_f32_16x16x32_bf16 v[56:59], a[152:155], v[180:183], 0
    v_permlane16_swap_b32 v189, v188
    v_max_f32 v188, v188, v189
    v_sub_f32 v212, 0, v188
    v_mfma_f32_16x16x32_bf16 v[28:31], a[156:159], v[176:179], 0
    v_sub_f32 v213, 0, v188
    v_sub_f32 v214, 0, v188
    v_sub_f32 v215, 0, v188
    v_mfma_f32_16x16x32_bf16 v[60:63], a[156:159], v[180:183], 0
    s_waitcnt lgkmcnt(1)
    v_sub_f32 v152, v152, v188
    v_sub_f32 v153, v153, v188
    v_sub_f32 v154, v154, v188
    v_mfma_f32_16x16x32_bf16 v[128:131], a[96:99], a[0:3], v[200:203]
    v_sub_f32 v155, v155, v188
    v_sub_f32 v156, v156, v188
    v_sub_f32 v157, v157, v188
    v_mfma_f32_16x16x32_bf16 v[128:131], a[100:103], a[4:7], v[128:131]
    v_sub_f32 v158, v158, v188
    v_sub_f32 v159, v159, v188
    v_mfma_f32_16x16x32_bf16 v[128:131], a[104:107], a[8:11], v[128:131]
    s_mov_b32 s70, s27
    v_exp_f32 v152, v152
    v_mfma_f32_16x16x32_bf16 v[128:131], a[108:111], a[12:15], v[128:131]
    s_add_u32 s27, s27, 16640
    v_mov_b32 v227, v152
    v_exp_f32 v153, v153
    v_mfma_f32_16x16x32_bf16 v[132:135], a[112:115], a[0:3], v[200:203]
    s_cmp_eq_u32 s27, s29
    v_add_f32 v227, v227, v153
    v_cvt_pk_bf16_f32 v188, v152, v153
    v_mfma_f32_16x16x32_bf16 v[132:135], a[116:119], a[4:7], v[132:135]
    s_cselect_b32 s27, s28, s27
    v_exp_f32 v154, v154
    v_mfma_f32_16x16x32_bf16 v[132:135], a[120:123], a[8:11], v[132:135]
    s_waitcnt lgkmcnt(0)
    v_add_f32 v227, v227, v154
    v_exp_f32 v155, v155
    v_mfma_f32_16x16x32_bf16 v[132:135], a[124:127], a[12:15], v[132:135]
    s_waitcnt vmcnt(24)
    v_add_f32 v227, v227, v155
    v_cvt_pk_bf16_f32 v189, v154, v155
    v_mfma_f32_16x16x32_bf16 v[136:139], a[96:99], a[16:19], v[204:207]
    s_barrier
    v_mfma_f32_16x16x32_bf16 v[136:139], a[100:103], a[20:23], v[136:139]
    s_mov_b32 m0, s70
    v_exp_f32 v156, v156
    v_add_u32 v231, s27, v233
    v_mfma_f32_16x16x32_bf16 v[136:139], a[104:107], a[24:27], v[136:139]
    buffer_load_dwordx4 v236, s[12:15], s25 offen offset:2048 lds
    v_mfma_f32_16x16x32_bf16 v[136:139], a[108:111], a[28:31], v[136:139]
    v_add_f32 v227, v227, v156
    v_exp_f32 v157, v157
    v_mfma_f32_16x16x32_bf16 v[140:143], a[112:115], a[16:19], v[204:207]
    v_add_f32 v227, v227, v157
    v_cvt_pk_bf16_f32 v190, v156, v157
    v_add_u32 v230, s27, v232
    v_mfma_f32_16x16x32_bf16 v[140:143], a[116:119], a[20:23], v[140:143]
    v_exp_f32 v158, v158
    v_mfma_f32_16x16x32_bf16 v[140:143], a[120:123], a[24:27], v[140:143]
    v_add_f32 v227, v227, v158
    v_exp_f32 v159, v159
    v_mfma_f32_16x16x32_bf16 v[140:143], a[124:127], a[28:31], v[140:143]
    v_add_f32 v227, v227, v159
    v_cvt_pk_bf16_f32 v191, v158, v159
    v_mfma_f32_16x16x32_bf16 v[64:67], a[128:131], v[184:187], 0
    v_exp_f32 v128, v128
    v_mfma_f32_16x16x32_bf16 v[96:99], a[128:131], v[188:191], 0
    ds_read_b64_tr_b16 a[128:129], v231 offset:0
    v_exp_f32 v129, v129
    v_mfma_f32_16x16x32_bf16 a[236:239], a[224:227], v[184:187], 0
    v_cvt_pk_bf16_f32 v176, v128, v129
    v_exp_f32 v131, v131
    v_mfma_f32_16x16x32_bf16 v[68:71], a[132:135], v[184:187], 0
    v_exp_f32 v130, v130
    v_mfma_f32_16x16x32_bf16 v[100:103], a[132:135], v[188:191], 0
    v_exp_f32 v132, v132
    v_mfma_f32_16x16x32_bf16 v[72:75], a[136:139], v[184:187], 0
    ds_read_b64_tr_b16 a[130:131], v231 offset:512
    v_cvt_pk_bf16_f32 v177, v130, v131
    v_mfma_f32_16x16x32_bf16 v[104:107], a[136:139], v[188:191], 0
    s_mov_b32 m0, s70
    v_exp_f32 v133, v133
    v_mfma_f32_16x16x32_bf16 v[76:79], a[140:143], v[184:187], 0
    buffer_load_dwordx4 v237, s[12:15], s25 offen offset:3104 lds
    v_mfma_f32_16x16x32_bf16 v[108:111], a[140:143], v[188:191], 0
    s_add_u32 s14, s10, 4096
    ds_read_b64_tr_b16 a[132:133], v231 offset:32
    v_cvt_pk_bf16_f32 v178, v132, v133
    v_mfma_f32_16x16x32_bf16 v[80:83], a[144:147], v[184:187], 0
    s_mov_b32 s25, s24
    ds_read_b64_tr_b16 a[134:135], v231 offset:544
    v_exp_f32 v134, v134
    v_mfma_f32_16x16x32_bf16 v[112:115], a[144:147], v[188:191], 0
    s_mov_b32 s22, s4
    v_exp_f32 v135, v135
    v_mfma_f32_16x16x32_bf16 v[84:87], a[148:151], v[184:187], 0
    s_mov_b32 s33, s5
    ds_read_b64_tr_b16 a[136:137], v231 offset:64
    v_cvt_pk_bf16_f32 v179, v134, v135
    v_mfma_f32_16x16x32_bf16 v[116:119], a[148:151], v[188:191], 0
    v_exp_f32 v136, v136
    v_mfma_f32_16x16x32_bf16 v[88:91], a[152:155], v[184:187], 0
    ds_read_b64_tr_b16 a[138:139], v231 offset:576
    v_add_f32 v225, v225, v136
    v_mfma_f32_16x16x32_bf16 v[120:123], a[152:155], v[188:191], 0
    v_exp_f32 v137, v137
    v_mfma_f32_16x16x32_bf16 v[92:95], a[156:159], v[184:187], 0
    s_mov_b32 m0, s70
    v_cvt_pk_bf16_f32 v180, v136, v137
    v_add_f32 v225, v225, v137
    v_mfma_f32_16x16x32_bf16 v[124:127], a[156:159], v[188:191], 0
    v_exp_f32 v138, v138
    ds_read_b64_tr_b16 a[140:141], v231 offset:96
    ds_read_b64_tr_b16 a[142:143], v231 offset:608
    ds_read_b64_tr_b16 a[144:145], v231 offset:128
    ds_read_b64_tr_b16 a[146:147], v231 offset:640
    v_add_f32 v225, v225, v138
    v_exp_f32 v139, v139
    v_exp_f32 v140, v140
    v_add_f32 v225, v225, v139
    v_cvt_pk_bf16_f32 v181, v138, v139
    v_exp_f32 v141, v141
    s_branch L_loop4
L_tail3_4e:
L_tail3_12:
    v_mfma_f32_16x16x32_bf16 v[136:139], a[96:99], a[16:19], v[204:207]
    s_mov_b32 s70, m0
    ds_read_b64_tr_b16 a[142:143], v231 offset:608
    s_mov_b32 m0, s70
    v_mfma_f32_16x16x32_bf16 v[136:139], a[100:103], a[20:23], v[136:139]
    buffer_load_dwordx4 v234, s[8:11], s24 offen lds
    v_mfma_f32_16x16x32_bf16 v[136:139], a[104:107], a[24:27], v[136:139]
    ds_read_b64_tr_b16 a[144:145], v231 offset:128
    v_cvt_pk_bf16_f32 v179, v134, v135
    v_mfma_f32_16x16x32_bf16 v[136:139], a[108:111], a[28:31], v[136:139]
    ds_read_b64_tr_b16 a[146:147], v231 offset:640
    ds_read_b64_tr_b16 a[148:149], v231 offset:160
    v_mfma_f32_16x16x32_bf16 v[140:143], a[112:115], a[16:19], v[204:207]
    ds_read_b64_tr_b16 a[150:151], v231 offset:672
    ds_read_b64_tr_b16 a[152:153], v231 offset:192
    v_mfma_f32_16x16x32_bf16 v[140:143], a[116:119], a[20:23], v[140:143]
    ds_read_b64_tr_b16 a[154:155], v231 offset:704
    ds_read_b64_tr_b16 a[156:157], v231 offset:224
    v_mfma_f32_16x16x32_bf16 v[140:143], a[120:123], a[24:27], v[140:143]
    ds_read_b64_tr_b16 a[158:159], v231 offset:736
    v_exp_f32 v136, v136
    v_mfma_f32_16x16x32_bf16 v[140:143], a[124:127], a[28:31], v[140:143]
    v_exp_f32 v137, v137
    v_mfma_f32_16x16x32_bf16 v[144:147], a[96:99], a[32:35], v[208:211]
    ds_read_b128 a[96:99], v230 offset:0
    v_cvt_pk_bf16_f32 v180, v136, v137
    v_mfma_f32_16x16x32_bf16 v[144:147], a[100:103], a[36:39], v[144:147]
    v_exp_f32 v138, v138
    v_mfma_f32_16x16x32_bf16 v[144:147], a[104:107], a[40:43], v[144:147]
    s_mov_b32 m0, s70
    ds_read_b128 a[100:103], v230 offset:64
    ds_read_b128 a[104:107], v230 offset:128
    v_mfma_f32_16x16x32_bf16 v[144:147], a[108:111], a[44:47], v[144:147]
    buffer_load_dwordx4 v235, s[8:11], s24 offen offset:1024 lds
    v_mfma_f32_16x16x32_bf16 v[148:151], a[112:115], a[32:35], v[208:211]
    s_add_u32 s24, s24, 131072
    ds_read_b128 a[108:111], v230 offset:192
    s_sub_u32 s3, s3, 1
    v_sub_u32 v244, s38, v240
    v_mfma_f32_16x16x32_bf16 v[148:151], a[116:119], a[36:39], v[148:151]
    v_exp_f32 v139, v139
    v_cmp_gt_i32 s[48:49], v244, 16
    v_mfma_f32_16x16x32_bf16 v[148:151], a[120:123], a[40:43], v[148:151]
    v_cvt_pk_bf16_f32 v181, v138, v139
    v_exp_f32 v140, v140
    v_mfma_f32_16x16x32_bf16 v[148:151], a[124:127], a[44:47], v[148:151]
    v_exp_f32 v141, v141
    v_cmp_gt_i32 s[50:51], v244, 17
    v_mfma_f32_16x16x32_bf16 a[228:231], a[224:227], v[176:179], a[228:231]
    s_waitcnt lgkmcnt(1)
    v_cvt_pk_bf16_f32 v182, v140, v141
    v_cmp_gt_i32 s[52:53], v244, 18
    v_mfma_f32_16x16x32_bf16 v[0:3], a[128:131], v[176:179], v[0:3]
    v_exp_f32 v142, v142
    v_mfma_f32_16x16x32_bf16 v[4:7], a[132:135], v[176:179], v[4:7]
    v_exp_f32 v143, v143
    v_mfma_f32_16x16x32_bf16 v[8:11], a[136:139], v[176:179], v[8:11]
    v_cvt_pk_bf16_f32 v183, v142, v143
    v_cmp_gt_i32 s[54:55], v244, 19
    v_mfma_f32_16x16x32_bf16 v[12:15], a[140:143], v[176:179], v[12:15]
    v_exp_f32 v144, v144
    v_mfma_f32_16x16x32_bf16 v[16:19], a[144:147], v[176:179], v[16:19]
    v_exp_f32 v145, v145
    v_mfma_f32_16x16x32_bf16 v[20:23], a[148:151], v[176:179], v[20:23]
    v_exp_f32 v146, v146
    v_mfma_f32_16x16x32_bf16 v[24:27], a[152:155], v[176:179], v[24:27]
    s_mov_b32 s70, s27
    v_exp_f32 v147, v147
    v_mfma_f32_16x16x32_bf16 v[28:31], a[156:159], v[176:179], v[28:31]
    s_add_u32 s27, s27, 16640
    v_cvt_pk_bf16_f32 v184, v144, v145
    v_cvt_pk_bf16_f32 v185, v146, v147
    v_mfma_f32_16x16x32_bf16 v[128:131], a[96:99], a[0:3], v[200:203]
    s_cmp_eq_u32 s27, s29
    v_exp_f32 v148, v148
    v_mfma_f32_16x16x32_bf16 v[128:131], a[100:103], a[4:7], v[128:131]
    s_cselect_b32 s27, s28, s27
    v_exp_f32 v149, v149
    v_mfma_f32_16x16x32_bf16 v[128:131], a[104:107], a[8:11], v[128:131]
    s_waitcnt lgkmcnt(0)
    s_waitcnt vmcnt(12)
    v_cvt_pk_bf16_f32 v186, v148, v149
    v_mov_b32 v178, 0
    v_mfma_f32_16x16x32_bf16 v[128:131], a[108:111], a[12:15], v[128:131]
    s_barrier
    v_mfma_f32_16x16x32_bf16 a[232:235], a[224:227], v[180:183], a[232:235]
    s_mov_b32 m0, s70
    v_add_u32 v231, s27, v233
    v_add_u32 v230, s27, v232
    v_mfma_f32_16x16x32_bf16 v[32:35], a[128:131], v[180:183], v[32:35]
    buffer_load_dwordx4 v236, s[12:15], s25 offen offset:2048 lds
    v_mfma_f32_16x16x32_bf16 v[36:39], a[132:135], v[180:183], v[36:39]
    v_exp_f32 v150, v150
    v_mfma_f32_16x16x32_bf16 v[40:43], a[136:139], v[180:183], v[40:43]
    v_exp_f32 v151, v151
    v_mfma_f32_16x16x32_bf16 v[44:47], a[140:143], v[180:183], v[44:47]
    v_cvt_pk_bf16_f32 v187, v150, v151
    v_mov_b32 v179, 0
    v_mfma_f32_16x16x32_bf16 v[48:51], a[144:147], v[180:183], v[48:51]
    v_exp_f32 v128, v128
    v_mfma_f32_16x16x32_bf16 v[52:55], a[148:151], v[180:183], v[52:55]
    v_exp_f32 v129, v129
    v_mfma_f32_16x16x32_bf16 v[56:59], a[152:155], v[180:183], v[56:59]
    v_cndmask_b32 v128, 0, v128, s[40:41]
    v_cndmask_b32 v129, 0, v129, s[42:43]
    v_mfma_f32_16x16x32_bf16 v[60:63], a[156:159], v[180:183], v[60:63]
    v_cvt_pk_bf16_f32 v176, v128, v129
    v_mov_b32 v182, 0
    v_mfma_f32_16x16x32_bf16 a[236:239], a[224:227], v[184:187], a[236:239]
    v_exp_f32 v130, v130
    v_mfma_f32_16x16x32_bf16 v[64:67], a[128:131], v[184:187], v[64:67]
    s_mov_b32 m0, s70
    ds_read_b64_tr_b16 a[128:129], v231 offset:0
    ds_read_b64_tr_b16 a[130:131], v231 offset:512
    v_cndmask_b32 v130, 0, v130, s[44:45]
    v_mfma_f32_16x16x32_bf16 v[68:71], a[132:135], v[184:187], v[68:71]
    buffer_load_dwordx4 v237, s[12:15], s25 offen offset:3104 lds
    v_mfma_f32_16x16x32_bf16 v[72:75], a[136:139], v[184:187], v[72:75]
    s_add_u32 s14, s10, 4096
    ds_read_b64_tr_b16 a[132:133], v231 offset:32
    ds_read_b64_tr_b16 a[134:135], v231 offset:544
    ds_read_b64_tr_b16 a[136:137], v231 offset:64
    v_mfma_f32_16x16x32_bf16 v[76:79], a[140:143], v[184:187], v[76:79]
    s_mov_b32 s25, s24
    ds_read_b64_tr_b16 a[138:139], v231 offset:576
    ds_read_b64_tr_b16 a[140:141], v231 offset:96
    ds_read_b64_tr_b16 a[142:143], v231 offset:608
    v_mfma_f32_16x16x32_bf16 v[80:83], a[144:147], v[184:187], v[80:83]
    ds_read_b64_tr_b16 a[144:145], v231 offset:128
    ds_read_b64_tr_b16 a[146:147], v231 offset:640
    v_mov_b32 v183, 0
    v_mfma_f32_16x16x32_bf16 v[84:87], a[148:151], v[184:187], v[84:87]
    ds_read_b64_tr_b16 a[148:149], v231 offset:160
    ds_read_b64_tr_b16 a[150:151], v231 offset:672
    v_mfma_f32_16x16x32_bf16 v[88:91], a[152:155], v[184:187], v[88:91]
    ds_read_b64_tr_b16 a[152:153], v231 offset:192
    ds_read_b64_tr_b16 a[154:155], v231 offset:704
    v_mfma_f32_16x16x32_bf16 v[92:95], a[156:159], v[184:187], v[92:95]
    ds_read_b64_tr_b16 a[156:157], v231 offset:224
    ds_read_b64_tr_b16 a[158:159], v231 offset:736
    v_mov_b32 v186, 0
    v_mfma_f32_16x16x32_bf16 v[136:139], a[96:99], a[16:19], v[204:207]
    v_exp_f32 v131, v131
    v_mov_b32 v187, 0
    v_mfma_f32_16x16x32_bf16 v[136:139], a[100:103], a[20:23], v[136:139]
    s_mov_b32 m0, s70
    v_cndmask_b32 v131, 0, v131, s[46:47]
    v_cvt_pk_bf16_f32 v177, v130, v131
    v_mfma_f32_16x16x32_bf16 v[136:139], a[104:107], a[24:27], v[136:139]
    buffer_load_dwordx4 v234, s[8:11], s24 offen lds
    v_mfma_f32_16x16x32_bf16 v[136:139], a[108:111], a[28:31], v[136:139]
    v_mfma_f32_16x16x32_bf16 v[144:147], a[96:99], a[32:35], v[208:211]
    ds_read_b128 a[96:99], v230 offset:0
    v_mfma_f32_16x16x32_bf16 v[144:147], a[100:103], a[36:39], v[144:147]
    ds_read_b128 a[100:103], v230 offset:64
    v_mfma_f32_16x16x32_bf16 v[144:147], a[104:107], a[40:43], v[144:147]
    ds_read_b128 a[104:107], v230 offset:128
    v_mfma_f32_16x16x32_bf16 v[144:147], a[108:111], a[44:47], v[144:147]
    ds_read_b128 a[108:111], v230 offset:192
    ds_read_b128 a[112:115], v230 offset:1024
    ds_read_b128 a[116:119], v230 offset:1088
    v_mfma_f32_16x16x32_bf16 a[228:231], a[224:227], v[176:179], a[228:231]
    s_waitcnt lgkmcnt(6)
    ds_read_b128 a[120:123], v230 offset:1152
    ds_read_b128 a[124:127], v230 offset:1216
    v_mfma_f32_16x16x32_bf16 v[0:3], a[128:131], v[176:179], v[0:3]
    v_exp_f32 v136, v136
    v_mfma_f32_16x16x32_bf16 v[4:7], a[132:135], v[176:179], v[4:7]
    v_cndmask_b32 v136, 0, v136, s[40:41]
    v_exp_f32 v137, v137
    v_mfma_f32_16x16x32_bf16 v[8:11], a[136:139], v[176:179], v[8:11]
    v_accvgpr_read_b32 v224, a228
    v_cmp_nle_f32 s[68:69], v224, s63
    v_cndmask_b32 v137, 0, v137, s[42:43]
    v_mfma_f32_16x16x32_bf16 v[12:15], a[140:143], v[176:179], v[12:15]
    v_rcp_f32 v200, v224
    v_cvt_pk_bf16_f32 v180, v136, v137
    v_mfma_f32_16x16x32_bf16 v[16:19], a[144:147], v[176:179], v[16:19]
    s_mov_b32 m0, s70
    v_exp_f32 v138, v138
    v_mfma_f32_16x16x32_bf16 v[20:23], a[148:151], v[176:179], v[20:23]
    buffer_load_dwordx4 v235, s[8:11], s24 offen offset:1024 lds
    v_mfma_f32_16x16x32_bf16 v[24:27], a[152:155], v[176:179], v[24:27]
    s_add_u32 s24, s24, 131072
    s_sub_u32 s3, s3, 1
    s_add_u32 s66, s33, 0
    s_add_u32 s67, s33, 65536
    v_mfma_f32_16x16x32_bf16 v[28:31], a[156:159], v[176:179], v[28:31]
    s_add_u32 s74, s33, 131072
    s_sub_u32 s26, s37, 4
    s_mov_b32 s91, 0
    s_mov_b32 s4, s31
    v_pk_mul_f32 v[0:1], v[0:1], v[200:201] op_sel_hi:[1,0]
    v_pk_mul_f32 v[2:3], v[2:3], v[200:201] op_sel_hi:[1,0]
    v_pk_mul_f32 v[4:5], v[4:5], v[200:201] op_sel_hi:[1,0]
    v_pk_mul_f32 v[6:7], v[6:7], v[200:201] op_sel_hi:[1,0]
    v_pk_mul_f32 v[8:9], v[8:9], v[200:201] op_sel_hi:[1,0]
    v_pk_mul_f32 v[10:11], v[10:11], v[200:201] op_sel_hi:[1,0]
    v_pk_mul_f32 v[12:13], v[12:13], v[200:201] op_sel_hi:[1,0]
    v_pk_mul_f32 v[14:15], v[14:15], v[200:201] op_sel_hi:[1,0]
    v_pk_mul_f32 v[16:17], v[16:17], v[200:201] op_sel_hi:[1,0]
    v_pk_mul_f32 v[18:19], v[18:19], v[200:201] op_sel_hi:[1,0]
    v_pk_mul_f32 v[20:21], v[20:21], v[200:201] op_sel_hi:[1,0]
    v_pk_mul_f32 v[22:23], v[22:23], v[200:201] op_sel_hi:[1,0]
    v_pk_mul_f32 v[24:25], v[24:25], v[200:201] op_sel_hi:[1,0]
    v_pk_mul_f32 v[26:27], v[26:27], v[200:201] op_sel_hi:[1,0]
    v_pk_mul_f32 v[28:29], v[28:29], v[200:201] op_sel_hi:[1,0]
    v_pk_mul_f32 v[30:31], v[30:31], v[200:201] op_sel_hi:[1,0]
    v_cndmask_b32 v138, 0, v138, s[44:45]
    v_exp_f32 v139, v139
    v_cvt_pk_bf16_f32 v0, v0, v1
    v_cndmask_b32 v139, 0, v139, s[46:47]
    v_cvt_pk_bf16_f32 v181, v138, v139
    s_lshl_b32 s5, s64, 14
    s_add_u32 s5, s5, s34
    v_mfma_f32_16x16x32_bf16 a[232:235], a[224:227], v[180:183], a[232:235]
    s_cmp_le_u32 s38, 16
    s_cselect_b32 s71, 8, 0
    s_mov_b32 s36, 0
    s_mov_b32 s30, 0x40000000
    v_mfma_f32_16x16x32_bf16 v[32:35], a[128:131], v[180:183], v[32:35]
    s_mov_b32 s31, 0
    s_or_b64 s[56:57], s[56:57], s[68:69]
    s_waitcnt vmcnt(29)
    v_cvt_pk_bf16_f32 v1, v2, v3
    v_mfma_f32_16x16x32_bf16 v[36:39], a[132:135], v[180:183], v[36:39]
    ds_read_b128 a[0:3], v238 offset:0
    ds_read_b128 a[4:7], v238 offset:64
    ds_read_b128 a[8:11], v238 offset:128
    v_mfma_f32_16x16x32_bf16 v[40:43], a[136:139], v[180:183], v[40:43]
    ds_read_b128 a[12:15], v238 offset:192
    ds_write_b64 v242, v[0:1] offset:0
    v_cvt_pk_bf16_f32 v2, v4, v5
    v_mfma_f32_16x16x32_bf16 v[44:47], a[140:143], v[180:183], v[44:47]
    v_cvt_pk_bf16_f32 v3, v6, v7
    v_cvt_pk_bf16_f32 v4, v8, v9
    v_cvt_pk_bf16_f32 v5, v10, v11
    v_mfma_f32_16x16x32_bf16 v[48:51], a[144:147], v[180:183], v[48:51]
    ds_write_b64 v242, v[2:3] offset:32
    ds_write_b64 v242, v[4:5] offset:64
    v_cvt_pk_bf16_f32 v6, v12, v13
    v_mfma_f32_16x16x32_bf16 v[52:55], a[148:151], v[180:183], v[52:55]
    v_cvt_pk_bf16_f32 v7, v14, v15
    v_cvt_pk_bf16_f32 v8, v16, v17
    v_cvt_pk_bf16_f32 v9, v18, v19
    v_mfma_f32_16x16x32_bf16 v[56:59], a[152:155], v[180:183], v[56:59]
    ds_write_b64 v242, v[6:7] offset:96
    ds_write_b64 v242, v[8:9] offset:128
    v_cvt_pk_bf16_f32 v10, v20, v21
    v_mfma_f32_16x16x32_bf16 v[60:63], a[156:159], v[180:183], v[60:63]
    v_cvt_pk_bf16_f32 v11, v22, v23
    v_cvt_pk_bf16_f32 v12, v24, v25
    v_cvt_pk_bf16_f32 v13, v26, v27
    v_exp_f32 v144, v144
    v_exp_f32 v145, v145
    v_cndmask_b32 v144, 0, v144, s[40:41]
    v_cndmask_b32 v145, 0, v145, s[42:43]
    v_cvt_pk_bf16_f32 v184, v144, v145
    v_exp_f32 v146, v146
    v_exp_f32 v147, v147
    v_cndmask_b32 v146, 0, v146, s[44:45]
    v_cndmask_b32 v147, 0, v147, s[46:47]
    v_cvt_pk_bf16_f32 v185, v146, v147
    v_cvt_pk_bf16_f32 v14, v28, v29
    v_cvt_pk_bf16_f32 v15, v30, v31
    v_mfma_f32_16x16x32_bf16 a[236:239], a[224:227], v[184:187], a[236:239]
    ds_write_b64 v242, v[10:11] offset:160
    ds_write_b64 v242, v[12:13] offset:192
    ds_write_b64 v242, v[14:15] offset:224
    v_mfma_f32_16x16x32_bf16 v[64:67], a[128:131], v[184:187], v[64:67]
    ds_read_b64 v[16:17], v243 offset:0
    ds_read_b64 v[18:19], v245 offset:0
    ds_read_b64 v[20:21], v243 offset:1056
    v_mfma_f32_16x16x32_bf16 v[68:71], a[132:135], v[184:187], v[68:71]
    ds_read_b64 v[22:23], v245 offset:1056
    v_accvgpr_read_b32 v225, a232
    v_cmp_gt_i32 s[40:41], v244, 0
    v_mfma_f32_16x16x32_bf16 v[72:75], a[136:139], v[184:187], v[72:75]
    ds_read_b64 v[24:25], v243 offset:2112
    v_rcp_f32 v204, v225
    v_mfma_f32_16x16x32_bf16 v[76:79], a[140:143], v[184:187], v[76:79]
    ds_read_b64 v[26:27], v245 offset:2112
    ds_read_b64 v[28:29], v243 offset:3168
    ds_read_b64 v[30:31], v245 offset:3168
    v_mfma_f32_16x16x32_bf16 v[80:83], a[144:147], v[184:187], v[80:83]
    v_cmp_gt_i32 s[42:43], v244, 1
    v_cmp_gt_i32 s[44:45], v244, 2
    v_accvgpr_read_b32 v226, a236
    v_mfma_f32_16x16x32_bf16 v[84:87], a[148:151], v[184:187], v[84:87]
    v_cmp_gt_i32 s[46:47], v244, 3
    v_rcp_f32 v208, v226
    v_mfma_f32_16x16x32_bf16 v[88:91], a[152:155], v[184:187], v[88:91]
    v_cmp_nle_f32 s[68:69], v225, s63
    v_mfma_f32_16x16x32_bf16 v[92:95], a[156:159], v[184:187], v[92:95]
    s_waitcnt lgkmcnt(4)
    buffer_store_dwordx4 v[16:19], v239, s[20:23], s66 offen nt
    v_pk_mul_f32 v[32:33], v[32:33], v[204:205] op_sel_hi:[1,0]
    v_pk_mul_f32 v[34:35], v[34:35], v[204:205] op_sel_hi:[1,0]
    v_pk_mul_f32 v[36:37], v[36:37], v[204:205] op_sel_hi:[1,0]
    v_pk_mul_f32 v[38:39], v[38:39], v[204:205] op_sel_hi:[1,0]
    v_pk_mul_f32 v[40:41], v[40:41], v[204:205] op_sel_hi:[1,0]
    v_pk_mul_f32 v[42:43], v[42:43], v[204:205] op_sel_hi:[1,0]
    v_pk_mul_f32 v[44:45], v[44:45], v[204:205] op_sel_hi:[1,0]
    v_pk_mul_f32 v[46:47], v[46:47], v[204:205] op_sel_hi:[1,0]
    v_pk_mul_f32 v[48:49], v[48:49], v[204:205] op_sel_hi:[1,0]
    v_pk_mul_f32 v[50:51], v[50:51], v[204:205] op_sel_hi:[1,0]
    v_pk_mul_f32 v[52:53], v[52:53], v[204:205] op_sel_hi:[1,0]
    v_pk_mul_f32 v[54:55], v[54:55], v[204:205] op_sel_hi:[1,0]
    v_pk_mul_f32 v[56:57], v[56:57], v[204:205] op_sel_hi:[1,0]
    v_pk_mul_f32 v[58:59], v[58:59], v[204:205] op_sel_hi:[1,0]
    v_pk_mul_f32 v[60:61], v[60:61], v[204:205] op_sel_hi:[1,0]
    v_pk_mul_f32 v[62:63], v[62:63], v[204:205] op_sel_hi:[1,0]
    v_pk_mul_f32 v[64:65], v[64:65], v[208:209] op_sel_hi:[1,0]
    v_pk_mul_f32 v[66:67], v[66:67], v[208:209] op_sel_hi:[1,0]
    v_pk_mul_f32 v[68:69], v[68:69], v[208:209] op_sel_hi:[1,0]
    v_pk_mul_f32 v[70:71], v[70:71], v[208:209] op_sel_hi:[1,0]
    v_pk_mul_f32 v[72:73], v[72:73], v[208:209] op_sel_hi:[1,0]
    v_pk_mul_f32 v[74:75], v[74:75], v[208:209] op_sel_hi:[1,0]
    v_pk_mul_f32 v[76:77], v[76:77], v[208:209] op_sel_hi:[1,0]
    v_pk_mul_f32 v[78:79], v[78:79], v[208:209] op_sel_hi:[1,0]
    v_pk_mul_f32 v[80:81], v[80:81], v[208:209] op_sel_hi:[1,0]
    buffer_store_dwordx4 v[20:23], v241, s[20:23], s66 offen nt
    v_pk_mul_f32 v[82:83], v[82:83], v[208:209] op_sel_hi:[1,0]
    v_pk_mul_f32 v[84:85], v[84:85], v[208:209] op_sel_hi:[1,0]
    v_pk_mul_f32 v[86:87], v[86:87], v[208:209] op_sel_hi:[1,0]
    v_pk_mul_f32 v[88:89], v[88:89], v[208:209] op_sel_hi:[1,0]
    v_pk_mul_f32 v[90:91], v[90:91], v[208:209] op_sel_hi:[1,0]
    v_pk_mul_f32 v[92:93], v[92:93], v[208:209] op_sel_hi:[1,0]
    v_pk_mul_f32 v[94:95], v[94:95], v[208:209] op_sel_hi:[1,0]
    v_mfma_f32_16x16x32_bf16 v[96:99], a[82:85], a[0:3], 0
    s_or_b64 s[56:57], s[56:57], s[68:69]
    v_cvt_pk_bf16_f32 v32, v32, v33
    v_cvt_pk_bf16_f32 v33, v34, v35
    v_cvt_pk_bf16_f32 v34, v36, v37
    v_mfma_f32_16x16x32_bf16 v[96:99], a[86:89], a[0:3], v[96:99]
    ds_write_b64 v242, v[32:33] offset:0
    v_cvt_pk_bf16_f32 v35, v38, v39
    v_cvt_pk_bf16_f32 v36, v40, v41
    v_mfma_f32_16x16x32_bf16 v[100:103], a[80:83], a[0:3], 0
    ds_write_b64 v242, v[34:35] offset:32
    v_cvt_pk_bf16_f32 v37, v42, v43
    v_cvt_pk_bf16_f32 v38, v44, v45
    v_mfma_f32_16x16x32_bf16 v[100:103], a[84:87], a[0:3], v[100:103]
    s_waitcnt lgkmcnt(2)
    buffer_store_dwordx4 v[24:27], v246, s[20:23], s66 offen nt
    v_mfma_f32_16x16x32_bf16 v[104:107], a[82:85], a[4:7], 0
    ds_write_b64 v242, v[36:37] offset:64
    v_cvt_pk_bf16_f32 v39, v46, v47
    v_cvt_pk_bf16_f32 v40, v48, v49
    v_mfma_f32_16x16x32_bf16 v[104:107], a[86:89], a[4:7], v[104:107]
    ds_write_b64 v242, v[38:39] offset:96
    v_cvt_pk_bf16_f32 v41, v50, v51
    v_cvt_pk_bf16_f32 v42, v52, v53
    v_mfma_f32_16x16x32_bf16 v[108:111], a[80:83], a[4:7], 0
    ds_write_b64 v242, v[40:41] offset:128
    v_cvt_pk_bf16_f32 v43, v54, v55
    v_cvt_pk_bf16_f32 v44, v56, v57
    v_mfma_f32_16x16x32_bf16 v[108:111], a[84:87], a[4:7], v[108:111]
    ds_write_b64 v242, v[42:43] offset:160
    v_cvt_pk_bf16_f32 v45, v58, v59
    v_cvt_pk_bf16_f32 v46, v60, v61
    v_mfma_f32_16x16x32_bf16 v[112:115], a[82:85], a[8:11], 0
    ds_write_b64 v242, v[44:45] offset:192
    v_cvt_pk_bf16_f32 v47, v62, v63
    v_cvt_pk_bf16_f32 v64, v64, v65
    v_mfma_f32_16x16x32_bf16 v[112:115], a[86:89], a[8:11], v[112:115]
    buffer_store_dwordx4 v[28:31], v247, s[20:23], s66 offen nt
    v_mfma_f32_16x16x32_bf16 v[116:119], a[80:83], a[8:11], 0
    ds_write_b64 v242, v[46:47] offset:224
    ds_read_b64 v[48:49], v243 offset:0
    ds_read_b64 v[50:51], v245 offset:0
    v_mfma_f32_16x16x32_bf16 v[116:119], a[84:87], a[8:11], v[116:119]
    ds_read_b64 v[52:53], v243 offset:1056
    ds_read_b64 v[54:55], v245 offset:1056
    ds_read_b64 v[56:57], v243 offset:2112
    v_mfma_f32_16x16x32_bf16 v[120:123], a[82:85], a[12:15], 0
    ds_read_b64 v[58:59], v245 offset:2112
    ds_read_b64 v[60:61], v243 offset:3168
    ds_read_b64 v[62:63], v245 offset:3168
    v_mfma_f32_16x16x32_bf16 v[120:123], a[86:89], a[12:15], v[120:123]
    v_cvt_pk_bf16_f32 v65, v66, v67
    v_cvt_pk_bf16_f32 v66, v68, v69
    v_cvt_pk_bf16_f32 v67, v70, v71
    v_mfma_f32_16x16x32_bf16 v[124:127], a[80:83], a[12:15], 0
    ds_write_b64 v242, v[64:65] offset:0
    ds_write_b64 v242, v[66:67] offset:32
    v_cvt_pk_bf16_f32 v68, v72, v73
    v_mfma_f32_16x16x32_bf16 v[124:127], a[84:87], a[12:15], v[124:127]
    v_cvt_pk_bf16_f32 v69, v74, v75
    v_cvt_pk_bf16_f32 v70, v76, v77
    v_cvt_pk_bf16_f32 v71, v78, v79
    ds_write_b64 v242, v[68:69] offset:64
    ds_write_b64 v242, v[70:71] offset:96
    v_cvt_pk_bf16_f32 v72, v80, v81
    v_cvt_pk_bf16_f32 v73, v82, v83
    s_waitcnt lgkmcnt(10)
    buffer_store_dwordx4 v[48:51], v239, s[20:23], s67 offen nt
    ds_write_b64 v242, v[72:73] offset:128
    v_cvt_pk_bf16_f32 v74, v84, v85
    v_cvt_pk_bf16_f32 v75, v86, v87
    ds_write_b64 v242, v[74:75] offset:160
    v_cvt_pk_bf16_f32 v76, v88, v89
    v_cvt_pk_bf16_f32 v77, v90, v91
    ds_write_b64 v242, v[76:77] offset:192
    v_cvt_pk_bf16_f32 v78, v92, v93
    v_cvt_pk_bf16_f32 v79, v94, v95
    ds_write_b64 v242, v[78:79] offset:224
    ds_read_b64 v[80:81], v243 offset:0
    ds_read_b64 v[82:83], v245 offset:0
    ds_read_b64 v[84:85], v243 offset:1056
    ds_read_b64 v[86:87], v245 offset:1056
    ds_read_b64 v[88:89], v243 offset:2112
    ds_read_b64 v[90:91], v245 offset:2112
    ds_read_b64 v[92:93], v243 offset:3168
    ds_read_b64 v[94:95], v245 offset:3168
    v_cmp_nle_f32 s[68:69], v226, s63
    v_cvt_pk_bf16_f32 v96, v96, v97
    s_or_b64 s[56:57], s[56:57], s[68:69]
    s_waitcnt vmcnt(33)
    ds_read_b128 a[16:19], v238 offset:4352
    v_cvt_pk_bf16_f32 v97, v98, v99
    v_accvgpr_write_b32 a0, v96
    s_waitcnt lgkmcnt(14)
    buffer_store_dwordx4 v[52:55], v241, s[20:23], s67 offen nt
    v_accvgpr_write_b32 a1, v97
    v_cvt_pk_bf16_f32 v100, v100, v101
    v_cvt_pk_bf16_f32 v101, v102, v103
    v_accvgpr_write_b32 a2, v100
    v_accvgpr_write_b32 a3, v101
    v_cvt_pk_bf16_f32 v104, v104, v105
    v_cvt_pk_bf16_f32 v105, v106, v107
    v_cvt_pk_bf16_f32 v108, v108, v109
    v_cvt_pk_bf16_f32 v109, v110, v111
    v_accvgpr_write_b32 a4, v104
    v_accvgpr_write_b32 a5, v105
    v_accvgpr_write_b32 a6, v108
    s_waitcnt lgkmcnt(0)
    v_mfma_f32_16x16x32_bf16 v[96:99], a[82:85], a[16:19], 0
    ds_read_b128 a[20:23], v238 offset:4416
    ds_read_b128 a[24:27], v238 offset:4480
    ds_read_b128 a[28:31], v238 offset:4544
    v_mfma_f32_16x16x32_bf16 v[96:99], a[86:89], a[16:19], v[96:99]
    v_accvgpr_write_b32 a7, v109
    v_cvt_pk_bf16_f32 v112, v112, v113
    v_cvt_pk_bf16_f32 v113, v114, v115
    v_mfma_f32_16x16x32_bf16 v[100:103], a[80:83], a[16:19], 0
    buffer_store_dwordx4 v[56:59], v246, s[20:23], s67 offen nt
    v_mfma_f32_16x16x32_bf16 v[100:103], a[84:87], a[16:19], v[100:103]
    s_waitcnt lgkmcnt(2)
    v_cvt_pk_bf16_f32 v116, v116, v117
    v_cvt_pk_bf16_f32 v117, v118, v119
    v_accvgpr_write_b32 a8, v112
    v_mfma_f32_16x16x32_bf16 v[104:107], a[82:85], a[20:23], 0
    v_accvgpr_write_b32 a9, v113
    v_accvgpr_write_b32 a10, v116
    v_accvgpr_write_b32 a11, v117
    v_mfma_f32_16x16x32_bf16 v[104:107], a[86:89], a[20:23], v[104:107]
    v_cvt_pk_bf16_f32 v120, v120, v121
    v_cvt_pk_bf16_f32 v121, v122, v123
    v_cvt_pk_bf16_f32 v124, v124, v125
    v_mfma_f32_16x16x32_bf16 v[108:111], a[80:83], a[20:23], 0
    v_cvt_pk_bf16_f32 v125, v126, v127
    v_accvgpr_write_b32 a12, v120
    v_accvgpr_write_b32 a13, v121
    v_mfma_f32_16x16x32_bf16 v[108:111], a[84:87], a[20:23], v[108:111]
    s_waitcnt lgkmcnt(0)
    v_accvgpr_write_b32 a14, v124
    v_accvgpr_write_b32 a15, v125
    v_cvt_pk_bf16_f32 v96, v96, v97
    v_mfma_f32_16x16x32_bf16 v[112:115], a[82:85], a[24:27], 0
    buffer_store_dwordx4 v[60:63], v247, s[20:23], s67 offen nt
    v_mfma_f32_16x16x32_bf16 v[112:115], a[86:89], a[24:27], v[112:115]
    v_cvt_pk_bf16_f32 v97, v98, v99
    v_cvt_pk_bf16_f32 v100, v100, v101
    v_cvt_pk_bf16_f32 v101, v102, v103
    v_mfma_f32_16x16x32_bf16 v[116:119], a[80:83], a[24:27], 0
    v_accvgpr_write_b32 a16, v96
    v_accvgpr_write_b32 a17, v97
    v_accvgpr_write_b32 a18, v100
    v_mfma_f32_16x16x32_bf16 v[116:119], a[84:87], a[24:27], v[116:119]
    v_accvgpr_write_b32 a19, v101
    v_cvt_pk_bf16_f32 v104, v104, v105
    v_cvt_pk_bf16_f32 v105, v106, v107
    v_mfma_f32_16x16x32_bf16 v[120:123], a[82:85], a[28:31], 0
    v_cvt_pk_bf16_f32 v108, v108, v109
    v_cvt_pk_bf16_f32 v109, v110, v111
    v_accvgpr_write_b32 a20, v104
    v_mfma_f32_16x16x32_bf16 v[120:123], a[86:89], a[28:31], v[120:123]
    v_accvgpr_write_b32 a21, v105
    v_accvgpr_write_b32 a22, v108
    v_accvgpr_write_b32 a23, v109
    v_mfma_f32_16x16x32_bf16 v[124:127], a[80:83], a[28:31], 0
    buffer_store_dwordx4 v[80:83], v239, s[20:23], s74 offen nt
    v_mfma_f32_16x16x32_bf16 v[124:127], a[84:87], a[28:31], v[124:127]
    v_cvt_pk_bf16_f32 v112, v112, v113
    v_cvt_pk_bf16_f32 v113, v114, v115
    v_cvt_pk_bf16_f32 v116, v116, v117
    v_mfma_f32_16x16x32_bf16 v[128:131], a[96:99], a[0:3], 0
    v_cvt_pk_bf16_f32 v117, v118, v119
    v_accvgpr_write_b32 a24, v112
    v_accvgpr_write_b32 a25, v113
    v_mfma_f32_16x16x32_bf16 v[128:131], a[100:103], a[4:7], v[128:131]
    v_accvgpr_write_b32 a26, v116
    v_accvgpr_write_b32 a27, v117
    v_cvt_pk_bf16_f32 v120, v120, v121
    v_mfma_f32_16x16x32_bf16 v[128:131], a[104:107], a[8:11], v[128:131]
    s_mov_b32 s70, s27
    v_cvt_pk_bf16_f32 v121, v122, v123
    v_cvt_pk_bf16_f32 v124, v124, v125
    v_cvt_pk_bf16_f32 v125, v126, v127
    v_mfma_f32_16x16x32_bf16 v[128:131], a[108:111], a[12:15], v[128:131]
    s_add_u32 s27, s27, 16640
    v_accvgpr_write_b32 a28, v120
    v_accvgpr_write_b32 a29, v121
    v_accvgpr_write_b32 a30, v124
    v_mfma_f32_16x16x32_bf16 v[132:135], a[112:115], a[0:3], 0
    s_cmp_eq_u32 s27, s29
    buffer_store_dwordx4 v[84:87], v241, s[20:23], s74 offen nt
    v_mfma_f32_16x16x32_bf16 v[132:135], a[116:119], a[4:7], v[132:135]
    s_cselect_b32 s27, s28, s27
    v_max3_f32 v176, v128, v129, v130
    v_accvgpr_write_b32 a31, v125
    v_mfma_f32_16x16x32_bf16 v[132:135], a[120:123], a[8:11], v[132:135]
    s_waitcnt vmcnt(22)
    v_mfma_f32_16x16x32_bf16 v[132:135], a[124:127], a[12:15], v[132:135]
    s_barrier
    v_add_u32 v231, s27, v233
    ds_read_b64_tr_b16 a[128:129], v231 offset:0
    ds_read_b64_tr_b16 a[130:131], v231 offset:512
    ds_read_b64_tr_b16 a[132:133], v231 offset:32
    s_cmp_lg_u64 s[56:57], 0
    ds_read_b64_tr_b16 a[134:135], v231 offset:544
    ds_read_b64_tr_b16 a[136:137], v231 offset:64
    s_cselect_b32 s6, 1, 0
    ds_read_b64_tr_b16 a[138:139], v231 offset:576
    ds_read_b64_tr_b16 a[140:141], v231 offset:96
    s_lshl_b32 s6, s6, s59
    ds_read_b64_tr_b16 a[142:143], v231 offset:608
    ds_read_b64_tr_b16 a[144:145], v231 offset:128
    s_or_b32 s58, s58, s6
    buffer_store_dwordx4 v[88:91], v246, s[20:23], s74 offen nt
    ds_read_b64_tr_b16 a[146:147], v231 offset:640
    ds_read_b64_tr_b16 a[148:149], v231 offset:160
    s_mov_b64 s[56:57], 0
    ds_read_b64_tr_b16 a[150:151], v231 offset:672
    ds_read_b64_tr_b16 a[152:153], v231 offset:192
    s_add_u32 s59, s59, 1
    ds_read_b64_tr_b16 a[154:155], v231 offset:704
    ds_read_b64_tr_b16 a[156:157], v231 offset:224
    ds_read_b64_tr_b16 a[158:159], v231 offset:736
    s_waitcnt vmcnt(38)
    ds_read_b128 a[32:35], v238 offset:8704
    v_max3_f32 v177, v132, v133, v134
    v_max3_f32 v176, v176, v131, v135
    v_max_f32 v176, v176, v177
    v_mov_b32 v177, v176
    v_add_u32 v230, s27, v232
    s_waitcnt lgkmcnt(0)
    v_mfma_f32_16x16x32_bf16 v[96:99], a[82:85], a[32:35], 0
    ds_read_b128 a[36:39], v238 offset:8768
    ds_read_b128 a[40:43], v238 offset:8832
    ds_read_b128 a[44:47], v238 offset:8896
    v_mfma_f32_16x16x32_bf16 v[96:99], a[86:89], a[32:35], v[96:99]
    v_permlane32_swap_b32 v177, v176
    v_max_f32 v176, v176, v177
    v_mov_b32 v177, v176
    v_mfma_f32_16x16x32_bf16 v[100:103], a[80:83], a[32:35], 0
    buffer_store_dwordx4 v[92:95], v247, s[20:23], s74 offen nt
    v_mfma_f32_16x16x32_bf16 v[100:103], a[84:87], a[32:35], v[100:103]
    s_waitcnt lgkmcnt(2)
    v_permlane16_swap_b32 v177, v176
    v_max_f32 v176, v176, v177
    v_sub_f32 v200, 0, v176
    v_mfma_f32_16x16x32_bf16 v[104:107], a[82:85], a[36:39], 0
    v_sub_f32 v201, 0, v176
    v_sub_f32 v202, 0, v176
    v_sub_f32 v203, 0, v176
    v_mfma_f32_16x16x32_bf16 v[104:107], a[86:89], a[36:39], v[104:107]
    v_sub_f32 v128, v128, v176
    v_sub_f32 v129, v129, v176
    v_sub_f32 v130, v130, v176
    v_mfma_f32_16x16x32_bf16 v[108:111], a[80:83], a[36:39], 0
    v_sub_f32 v131, v131, v176
    v_sub_f32 v132, v132, v176
    v_sub_f32 v133, v133, v176
    v_mfma_f32_16x16x32_bf16 v[108:111], a[84:87], a[36:39], v[108:111]
    s_waitcnt lgkmcnt(0)
    v_sub_f32 v134, v134, v176
    v_sub_f32 v135, v135, v176
    v_cvt_pk_bf16_f32 v96, v96, v97
    v_mfma_f32_16x16x32_bf16 v[112:115], a[82:85], a[40:43], 0
    v_exp_f32 v128, v128
    v_cvt_pk_bf16_f32 v97, v98, v99
    v_mfma_f32_16x16x32_bf16 v[112:115], a[86:89], a[40:43], v[112:115]
    v_exp_f32 v129, v129
    v_cvt_pk_bf16_f32 v100, v100, v101
    v_mfma_f32_16x16x32_bf16 v[116:119], a[80:83], a[40:43], 0
    v_cvt_pk_bf16_f32 v176, v128, v129
    v_exp_f32 v130, v130
    v_mfma_f32_16x16x32_bf16 v[116:119], a[84:87], a[40:43], v[116:119]
    v_exp_f32 v131, v131
    v_cvt_pk_bf16_f32 v101, v102, v103
    v_mfma_f32_16x16x32_bf16 v[120:123], a[82:85], a[44:47], 0
    v_cvt_pk_bf16_f32 v177, v130, v131
    v_exp_f32 v132, v132
    v_mfma_f32_16x16x32_bf16 v[120:123], a[86:89], a[44:47], v[120:123]
    v_exp_f32 v133, v133
    v_accvgpr_write_b32 a32, v96
    v_mfma_f32_16x16x32_bf16 v[124:127], a[80:83], a[44:47], 0
    s_waitcnt vmcnt(38)
    v_cvt_pk_bf16_f32 v178, v132, v133
    v_exp_f32 v134, v134
    v_mfma_f32_16x16x32_bf16 v[124:127], a[84:87], a[44:47], v[124:127]
    ds_read_b128 a[48:51], v238 offset:13056
    ds_read_b128 a[52:55], v238 offset:13120
    v_accvgpr_write_b32 a33, v97
    v_mfma_f32_16x16x32_bf16 v[136:139], a[96:99], a[16:19], 0
    s_mov_b32 m0, s70
    ds_read_b128 a[56:59], v238 offset:13184
    ds_read_b128 a[60:63], v238 offset:13248
    v_accvgpr_write_b32 a34, v100
    v_mfma_f32_16x16x32_bf16 v[136:139], a[100:103], a[20:23], v[136:139]
    buffer_load_dwordx4 v236, s[12:15], s25 offen offset:2048 lds
    v_mfma_f32_16x16x32_bf16 v[136:139], a[104:107], a[24:27], v[136:139]
    v_exp_f32 v135, v135
    v_accvgpr_write_b32 a35, v101
    v_mfma_f32_16x16x32_bf16 v[136:139], a[108:111], a[28:31], v[136:139]
    v_cvt_pk_bf16_f32 v179, v134, v135
    v_cvt_pk_bf16_f32 v104, v104, v105
    v_cvt_pk_bf16_f32 v105, v106, v107
    v_mfma_f32_16x16x32_bf16 v[140:143], a[112:115], a[16:19], 0
    v_cvt_pk_bf16_f32 v108, v108, v109
    v_cvt_pk_bf16_f32 v109, v110, v111
    v_accvgpr_write_b32 a36, v104
    v_mfma_f32_16x16x32_bf16 v[140:143], a[116:119], a[20:23], v[140:143]
    v_max3_f32 v180, v136, v137, v138
    v_accvgpr_write_b32 a37, v105
    v_accvgpr_write_b32 a38, v108
    v_mfma_f32_16x16x32_bf16 v[140:143], a[120:123], a[24:27], v[140:143]
    v_accvgpr_write_b32 a39, v109
    v_cvt_pk_bf16_f32 v112, v112, v113
    v_cvt_pk_bf16_f32 v113, v114, v115
    v_mfma_f32_16x16x32_bf16 v[140:143], a[124:127], a[28:31], v[140:143]
    s_waitcnt lgkmcnt(0)
    v_cvt_pk_bf16_f32 v116, v116, v117
    v_cvt_pk_bf16_f32 v117, v118, v119
    v_accvgpr_write_b32 a40, v112
    v_mfma_f32_16x16x32_bf16 v[96:99], a[82:85], a[48:51], 0
    v_accvgpr_write_b32 a41, v113
    v_accvgpr_write_b32 a42, v116
    v_accvgpr_write_b32 a43, v117
    v_mfma_f32_16x16x32_bf16 v[96:99], a[86:89], a[48:51], v[96:99]
    v_max3_f32 v181, v140, v141, v142
    v_max3_f32 v180, v180, v139, v143
    v_max_f32 v180, v180, v181
    v_mfma_f32_16x16x32_bf16 v[100:103], a[80:83], a[48:51], 0
    v_mov_b32 v181, v180
    v_cvt_pk_bf16_f32 v120, v120, v121
    v_cvt_pk_bf16_f32 v121, v122, v123
    v_mfma_f32_16x16x32_bf16 v[100:103], a[84:87], a[48:51], v[100:103]
    v_permlane32_swap_b32 v181, v180
    v_max_f32 v180, v180, v181
    v_mov_b32 v181, v180
    v_mfma_f32_16x16x32_bf16 v[104:107], a[82:85], a[52:55], 0
    v_cvt_pk_bf16_f32 v124, v124, v125
    v_permlane16_swap_b32 v181, v180
    v_max_f32 v180, v180, v181
    v_mfma_f32_16x16x32_bf16 v[104:107], a[86:89], a[52:55], v[104:107]
    v_sub_f32 v204, 0, v180
    v_sub_f32 v205, 0, v180
    v_sub_f32 v206, 0, v180
    v_mfma_f32_16x16x32_bf16 v[108:111], a[80:83], a[52:55], 0
    v_sub_f32 v207, 0, v180
    v_sub_f32 v136, v136, v180
    v_sub_f32 v137, v137, v180
    v_mfma_f32_16x16x32_bf16 v[108:111], a[84:87], a[52:55], v[108:111]
    v_sub_f32 v138, v138, v180
    v_sub_f32 v139, v139, v180
    v_sub_f32 v140, v140, v180
    v_mfma_f32_16x16x32_bf16 v[112:115], a[82:85], a[56:59], 0
    v_sub_f32 v141, v141, v180
    v_sub_f32 v142, v142, v180
    v_sub_f32 v143, v143, v180
    v_mfma_f32_16x16x32_bf16 v[112:115], a[86:89], a[56:59], v[112:115]
    v_exp_f32 v136, v136
    v_cvt_pk_bf16_f32 v125, v126, v127
    v_mfma_f32_16x16x32_bf16 v[116:119], a[80:83], a[56:59], 0
    v_mov_b32 v225, v136
    v_exp_f32 v137, v137
    v_mfma_f32_16x16x32_bf16 v[116:119], a[84:87], a[56:59], v[116:119]
    v_add_f32 v225, v225, v137
    v_cvt_pk_bf16_f32 v180, v136, v137
    v_accvgpr_write_b32 a44, v120
    v_accvgpr_write_b32 a45, v121
    v_mfma_f32_16x16x32_bf16 v[120:123], a[82:85], a[60:63], 0
    v_exp_f32 v138, v138
    v_accvgpr_write_b32 a46, v124
    v_mfma_f32_16x16x32_bf16 v[120:123], a[86:89], a[60:63], v[120:123]
    v_add_f32 v225, v225, v138
    v_accvgpr_write_b32 a47, v125
    v_cvt_pk_bf16_f32 v96, v96, v97
    v_mfma_f32_16x16x32_bf16 v[124:127], a[80:83], a[60:63], 0
    v_exp_f32 v139, v139
    v_cvt_pk_bf16_f32 v97, v98, v99
    v_mfma_f32_16x16x32_bf16 v[124:127], a[84:87], a[60:63], v[124:127]
    v_add_f32 v225, v225, v139
    v_cvt_pk_bf16_f32 v181, v138, v139
    v_cvt_pk_bf16_f32 v100, v100, v101
    v_mfma_f32_16x16x32_bf16 v[144:147], a[96:99], a[32:35], 0
    v_exp_f32 v140, v140
    v_cvt_pk_bf16_f32 v101, v102, v103
    v_mfma_f32_16x16x32_bf16 v[144:147], a[100:103], a[36:39], v[144:147]
    v_add_f32 v225, v225, v140
    v_exp_f32 v141, v141
    v_mfma_f32_16x16x32_bf16 v[144:147], a[104:107], a[40:43], v[144:147]
    v_add_f32 v225, v225, v141
    v_cvt_pk_bf16_f32 v182, v140, v141
    v_accvgpr_write_b32 a48, v96
    v_mfma_f32_16x16x32_bf16 v[144:147], a[108:111], a[44:47], v[144:147]
    v_exp_f32 v142, v142
    v_accvgpr_write_b32 a49, v97
    v_mfma_f32_16x16x32_bf16 v[148:151], a[112:115], a[32:35], 0
    s_mov_b32 m0, s70
    v_add_f32 v225, v225, v142
    v_exp_f32 v143, v143
    v_mfma_f32_16x16x32_bf16 v[148:151], a[116:119], a[36:39], v[148:151]
    buffer_load_dwordx4 v237, s[12:15], s25 offen offset:3104 lds
    v_mfma_f32_16x16x32_bf16 v[148:151], a[120:123], a[40:43], v[148:151]
    s_add_u32 s14, s10, 4096
    v_add_f32 v225, v225, v143
    v_cvt_pk_bf16_f32 v183, v142, v143
    v_accvgpr_write_b32 a50, v100
    v_mfma_f32_16x16x32_bf16 v[148:151], a[124:127], a[44:47], v[148:151]
    s_mov_b32 s25, s24
    v_accvgpr_write_b32 a51, v101
    v_cvt_pk_bf16_f32 v104, v104, v105
    v_cvt_pk_bf16_f32 v105, v106, v107
    v_mfma_f32_16x16x32_bf16 v[152:155], a[96:99], a[48:51], 0
    s_mov_b32 m0, s70
    v_cvt_pk_bf16_f32 v108, v108, v109
    v_max3_f32 v184, v144, v145, v146
    v_cvt_pk_bf16_f32 v109, v110, v111
    v_accvgpr_write_b32 a52, v104
    v_accvgpr_write_b32 a53, v105
    v_accvgpr_write_b32 a54, v108
    v_accvgpr_write_b32 a55, v109
    v_max3_f32 v185, v148, v149, v150
    v_max3_f32 v184, v184, v147, v151
    v_mfma_f32_16x16x32_bf16 v[152:155], a[100:103], a[52:55], v[152:155]
    buffer_load_dwordx4 v234, s[8:11], s24 offen lds
    v_cvt_pk_bf16_f32 v112, v112, v113
    v_cvt_pk_bf16_f32 v113, v114, v115
    v_cvt_pk_bf16_f32 v116, v116, v117
    v_cvt_pk_bf16_f32 v117, v118, v119
    v_accvgpr_write_b32 a56, v112
    v_accvgpr_write_b32 a57, v113
    v_accvgpr_write_b32 a58, v116
    v_accvgpr_write_b32 a59, v117
    v_max_f32 v184, v184, v185
    v_mov_b32 v185, v184
    v_mfma_f32_16x16x32_bf16 v[152:155], a[104:107], a[56:59], v[152:155]
    ds_read_b128 a[96:99], v230 offset:0
    v_permlane32_swap_b32 v185, v184
    v_max_f32 v184, v184, v185
    v_cvt_pk_bf16_f32 v120, v120, v121
    v_cvt_pk_bf16_f32 v121, v122, v123
    v_cvt_pk_bf16_f32 v124, v124, v125
    v_cvt_pk_bf16_f32 v125, v126, v127
    v_accvgpr_write_b32 a60, v120
    v_accvgpr_write_b32 a61, v121
    v_accvgpr_write_b32 a62, v124
    v_accvgpr_write_b32 a63, v125
    v_mov_b32 v185, v184
    s_nop 0
    v_mfma_f32_16x16x32_bf16 v[152:155], a[108:111], a[60:63], v[152:155]
    ds_read_b128 a[100:103], v230 offset:64
    v_permlane16_swap_b32 v185, v184
    v_max_f32 v184, v184, v185
    v_mfma_f32_16x16x32_bf16 v[156:159], a[112:115], a[48:51], 0
    v_sub_f32 v208, 0, v184
    v_sub_f32 v209, 0, v184
    v_sub_f32 v210, 0, v184
    v_mfma_f32_16x16x32_bf16 v[156:159], a[116:119], a[52:55], v[156:159]
    v_sub_f32 v211, 0, v184
    v_sub_f32 v144, v144, v184
    v_sub_f32 v145, v145, v184
    v_mfma_f32_16x16x32_bf16 v[156:159], a[120:123], a[56:59], v[156:159]
    v_sub_f32 v146, v146, v184
    v_sub_f32 v147, v147, v184
    v_sub_f32 v148, v148, v184
    v_mfma_f32_16x16x32_bf16 v[156:159], a[124:127], a[60:63], v[156:159]
    v_sub_f32 v149, v149, v184
    v_sub_f32 v150, v150, v184
    v_sub_f32 v151, v151, v184
    v_mfma_f32_16x16x32_bf16 v[0:3], a[128:131], v[176:179], 0
    ds_read_b128 a[104:107], v230 offset:128
    v_exp_f32 v144, v144
    v_mfma_f32_16x16x32_bf16 v[32:35], a[128:131], v[180:183], 0
    v_exp_f32 v145, v145
    v_max3_f32 v188, v152, v153, v154
    v_mfma_f32_16x16x32_bf16 a[228:231], a[224:227], v[176:179], 0
    s_mov_b32 m0, s70
    v_cvt_pk_bf16_f32 v184, v144, v145
    v_exp_f32 v146, v146
    v_mfma_f32_16x16x32_bf16 v[4:7], a[132:135], v[176:179], 0
    buffer_load_dwordx4 v235, s[8:11], s24 offen offset:1024 lds
    v_mfma_f32_16x16x32_bf16 v[36:39], a[132:135], v[180:183], 0
    s_add_u32 s24, s24, 131072
    ds_read_b128 a[108:111], v230 offset:192
    v_exp_f32 v147, v147
    v_mfma_f32_16x16x32_bf16 v[8:11], a[136:139], v[176:179], 0
    s_sub_u32 s3, s3, 1
    v_cvt_pk_bf16_f32 v185, v146, v147
    v_exp_f32 v148, v148
    v_mfma_f32_16x16x32_bf16 v[40:43], a[136:139], v[180:183], 0
    v_exp_f32 v149, v149
    v_max3_f32 v189, v156, v157, v158
    v_mfma_f32_16x16x32_bf16 v[12:15], a[140:143], v[176:179], 0
    v_cvt_pk_bf16_f32 v186, v148, v149
    v_exp_f32 v150, v150
    v_mfma_f32_16x16x32_bf16 v[44:47], a[140:143], v[180:183], 0
    ds_read_b128 a[112:115], v230 offset:1024
    v_exp_f32 v151, v151
    v_mfma_f32_16x16x32_bf16 v[16:19], a[144:147], v[176:179], 0
    ds_read_b128 a[116:119], v230 offset:1088
    v_cvt_pk_bf16_f32 v187, v150, v151
    v_max3_f32 v188, v188, v155, v159
    v_mfma_f32_16x16x32_bf16 v[48:51], a[144:147], v[180:183], 0
    ds_read_b128 a[120:123], v230 offset:1152
    v_max_f32 v188, v188, v189
    v_mov_b32 v189, v188
    v_mfma_f32_16x16x32_bf16 v[20:23], a[148:151], v[176:179], 0
    ds_read_b128 a[124:127], v230 offset:1216
    v_permlane32_swap_b32 v189, v188
    v_max_f32 v188, v188, v189
    v_mfma_f32_16x16x32_bf16 v[52:55], a[148:151], v[180:183], 0
    v_mov_b32 v189, v188
    v_mfma_f32_16x16x32_bf16 v[24:27], a[152:155], v[176:179], 0
    v_mfma_f32_16x16x32_bf16 v[56:59], a[152:155], v[180:183], 0
    v_permlane16_swap_b32 v189, v188
    v_max_f32 v188, v188, v189
    v_sub_f32 v212, 0, v188
    v_mfma_f32_16x16x32_bf16 v[28:31], a[156:159], v[176:179], 0
    v_sub_f32 v213, 0, v188
    v_sub_f32 v214, 0, v188
    v_sub_f32 v215, 0, v188
    v_mfma_f32_16x16x32_bf16 v[60:63], a[156:159], v[180:183], 0
    s_waitcnt lgkmcnt(1)
    v_sub_f32 v152, v152, v188
    v_sub_f32 v153, v153, v188
    v_sub_f32 v154, v154, v188
    v_mfma_f32_16x16x32_bf16 v[128:131], a[96:99], a[0:3], v[200:203]
    v_sub_f32 v155, v155, v188
    v_sub_f32 v156, v156, v188
    v_sub_f32 v157, v157, v188
    v_mfma_f32_16x16x32_bf16 v[128:131], a[100:103], a[4:7], v[128:131]
    v_sub_f32 v158, v158, v188
    v_sub_f32 v159, v159, v188
    v_mfma_f32_16x16x32_bf16 v[128:131], a[104:107], a[8:11], v[128:131]
    s_mov_b32 s70, s27
    v_exp_f32 v152, v152
    v_mfma_f32_16x16x32_bf16 v[128:131], a[108:111], a[12:15], v[128:131]
    s_add_u32 s27, s27, 16640
    v_mov_b32 v227, v152
    v_exp_f32 v153, v153
    v_mfma_f32_16x16x32_bf16 v[132:135], a[112:115], a[0:3], v[200:203]
    s_cmp_eq_u32 s27, s29
    v_add_f32 v227, v227, v153
    v_cvt_pk_bf16_f32 v188, v152, v153
    v_mfma_f32_16x16x32_bf16 v[132:135], a[116:119], a[4:7], v[132:135]
    s_cselect_b32 s27, s28, s27
    v_exp_f32 v154, v154
    v_mfma_f32_16x16x32_bf16 v[132:135], a[120:123], a[8:11], v[132:135]
    s_waitcnt lgkmcnt(0)
    v_add_f32 v227, v227, v154
    v_exp_f32 v155, v155
    v_mfma_f32_16x16x32_bf16 v[132:135], a[124:127], a[12:15], v[132:135]
    s_waitcnt vmcnt(24)
    v_add_f32 v227, v227, v155
    v_cvt_pk_bf16_f32 v189, v154, v155
    v_mfma_f32_16x16x32_bf16 v[136:139], a[96:99], a[16:19], v[204:207]
    s_barrier
    v_mfma_f32_16x16x32_bf16 v[136:139], a[100:103], a[20:23], v[136:139]
    s_mov_b32 m0, s70
    v_exp_f32 v156, v156
    v_add_u32 v231, s27, v233
    v_mfma_f32_16x16x32_bf16 v[136:139], a[104:107], a[24:27], v[136:139]
    buffer_load_dwordx4 v236, s[12:15], s25 offen offset:2048 lds
    v_mfma_f32_16x16x32_bf16 v[136:139], a[108:111], a[28:31], v[136:139]
    v_add_f32 v227, v227, v156
    v_exp_f32 v157, v157
    v_mfma_f32_16x16x32_bf16 v[140:143], a[112:115], a[16:19], v[204:207]
    v_add_f32 v227, v227, v157
    v_cvt_pk_bf16_f32 v190, v156, v157
    v_add_u32 v230, s27, v232
    v_mfma_f32_16x16x32_bf16 v[140:143], a[116:119], a[20:23], v[140:143]
    v_exp_f32 v158, v158
    v_mfma_f32_16x16x32_bf16 v[140:143], a[120:123], a[24:27], v[140:143]
    v_add_f32 v227, v227, v158
    v_exp_f32 v159, v159
    v_mfma_f32_16x16x32_bf16 v[140:143], a[124:127], a[28:31], v[140:143]
    v_add_f32 v227, v227, v159
    v_cvt_pk_bf16_f32 v191, v158, v159
    v_mfma_f32_16x16x32_bf16 v[64:67], a[128:131], v[184:187], 0
    v_exp_f32 v128, v128
    v_mfma_f32_16x16x32_bf16 v[96:99], a[128:131], v[188:191], 0
    ds_read_b64_tr_b16 a[128:129], v231 offset:0
    v_exp_f32 v129, v129
    v_mfma_f32_16x16x32_bf16 a[236:239], a[224:227], v[184:187], 0
    v_cvt_pk_bf16_f32 v176, v128, v129
    v_exp_f32 v131, v131
    v_mfma_f32_16x16x32_bf16 v[68:71], a[132:135], v[184:187], 0
    v_exp_f32 v130, v130
    v_mfma_f32_16x16x32_bf16 v[100:103], a[132:135], v[188:191], 0
    v_exp_f32 v132, v132
    v_mfma_f32_16x16x32_bf16 v[72:75], a[136:139], v[184:187], 0
    ds_read_b64_tr_b16 a[130:131], v231 offset:512
    v_cvt_pk_bf16_f32 v177, v130, v131
    v_mfma_f32_16x16x32_bf16 v[104:107], a[136:139], v[188:191], 0
    s_mov_b32 m0, s70
    v_exp_f32 v133, v133
    v_mfma_f32_16x16x32_bf16 v[76:79], a[140:143], v[184:187], 0
    buffer_load_dwordx4 v237, s[12:15], s25 offen offset:3104 lds
    v_mfma_f32_16x16x32_bf16 v[108:111], a[140:143], v[188:191], 0
    s_add_u32 s14, s10, 4096
    ds_read_b64_tr_b16 a[132:133], v231 offset:32
    v_cvt_pk_bf16_f32 v178, v132, v133
    v_mfma_f32_16x16x32_bf16 v[80:83], a[144:147], v[184:187], 0
    s_mov_b32 s25, s24
    ds_read_b64_tr_b16 a[134:135], v231 offset:544
    v_exp_f32 v134, v134
    v_mfma_f32_16x16x32_bf16 v[112:115], a[144:147], v[188:191], 0
    s_mov_b32 s22, s4
    v_exp_f32 v135, v135
    v_mfma_f32_16x16x32_bf16 v[84:87], a[148:151], v[184:187], 0
    s_mov_b32 s33, s5
    ds_read_b64_tr_b16 a[136:137], v231 offset:64
    v_cvt_pk_bf16_f32 v179, v134, v135
    v_mfma_f32_16x16x32_bf16 v[116:119], a[148:151], v[188:191], 0
    v_exp_f32 v136, v136
    v_mfma_f32_16x16x32_bf16 v[88:91], a[152:155], v[184:187], 0
    ds_read_b64_tr_b16 a[138:139], v231 offset:576
    v_add_f32 v225, v225, v136
    v_mfma_f32_16x16x32_bf16 v[120:123], a[152:155], v[188:191], 0
    v_exp_f32 v137, v137
    v_mfma_f32_16x16x32_bf16 v[92:95], a[156:159], v[184:187], 0
    s_mov_b32 m0, s70
    v_cvt_pk_bf16_f32 v180, v136, v137
    v_add_f32 v225, v225, v137
    v_mfma_f32_16x16x32_bf16 v[124:127], a[156:159], v[188:191], 0
    v_exp_f32 v138, v138
    ds_read_b64_tr_b16 a[140:141], v231 offset:96
    ds_read_b64_tr_b16 a[142:143], v231 offset:608
    ds_read_b64_tr_b16 a[144:145], v231 offset:128
    ds_read_b64_tr_b16 a[146:147], v231 offset:640
    v_add_f32 v225, v225, v138
    v_exp_f32 v139, v139
    v_exp_f32 v140, v140
    v_add_f32 v225, v225, v139
    v_cvt_pk_bf16_f32 v181, v138, v139
    v_exp_f32 v141, v141
    s_branch L_loop4
L_tail3_12e:
.p2align 3
L_loop4:
    v_mfma_f32_16x16x32_bf16 v[144:147], a[96:99], a[32:35], v[208:211]
    ds_read_b64_tr_b16 a[148:149], v231 offset:160
    v_add_f32 v225, v225, v140
    v_mfma_f32_16x16x32_bf16 v[144:147], a[100:103], a[36:39], v[144:147]
    ds_read_b64_tr_b16 a[150:151], v231 offset:672
    v_add_f32 v225, v225, v141
    v_mfma_f32_16x16x32_bf16 v[144:147], a[104:107], a[40:43], v[144:147]
    ds_read_b64_tr_b16 a[152:153], v231 offset:192
    ds_read_b64_tr_b16 a[154:155], v231 offset:704
    v_mfma_f32_16x16x32_bf16 v[144:147], a[108:111], a[44:47], v[144:147]
    buffer_load_dwordx4 v234, s[8:11], s24 offen lds
    v_mfma_f32_16x16x32_bf16 v[148:151], a[112:115], a[32:35], v[208:211]
    v_exp_f32 v142, v142
    v_mfma_f32_16x16x32_bf16 v[148:151], a[116:119], a[36:39], v[148:151]
    ds_read_b64_tr_b16 a[156:157], v231 offset:224
    v_cvt_pk_bf16_f32 v182, v140, v141
    v_mfma_f32_16x16x32_bf16 v[148:151], a[120:123], a[40:43], v[148:151]
    ds_read_b64_tr_b16 a[158:159], v231 offset:736
    v_add_f32 v225, v225, v142
    v_mfma_f32_16x16x32_bf16 v[148:151], a[124:127], a[44:47], v[148:151]
    v_exp_f32 v143, v143
    v_mfma_f32_16x16x32_bf16 v[152:155], a[96:99], a[48:51], v[212:215]
    ds_read_b128 a[96:99], v230 offset:0
    v_add_f32 v225, v225, v143
    v_mfma_f32_16x16x32_bf16 v[152:155], a[100:103], a[52:55], v[152:155]
    ds_read_b128 a[100:103], v230 offset:64
    v_cvt_pk_bf16_f32 v183, v142, v143
    v_mfma_f32_16x16x32_bf16 v[152:155], a[104:107], a[56:59], v[152:155]
    v_exp_f32 v144, v144
    v_mfma_f32_16x16x32_bf16 v[152:155], a[108:111], a[60:63], v[152:155]
    v_exp_f32 v145, v145
    v_mfma_f32_16x16x32_bf16 v[156:159], a[112:115], a[48:51], v[212:215]
    ds_read_b128 a[104:107], v230 offset:128
    v_cvt_pk_bf16_f32 v184, v144, v145
    v_mfma_f32_16x16x32_bf16 v[156:159], a[116:119], a[52:55], v[156:159]
    v_exp_f32 v146, v146
    v_mfma_f32_16x16x32_bf16 v[156:159], a[120:123], a[56:59], v[156:159]
    v_exp_f32 v147, v147
    v_mfma_f32_16x16x32_bf16 v[156:159], a[124:127], a[60:63], v[156:159]
    s_waitcnt lgkmcnt(1)
    ds_read_b128 a[108:111], v230 offset:192
    v_cvt_pk_bf16_f32 v185, v146, v147
    v_mfma_f32_16x16x32_bf16 v[0:3], a[128:131], v[176:179], v[0:3]
    v_exp_f32 v148, v148
    v_mfma_f32_16x16x32_bf16 v[32:35], a[128:131], v[180:183], v[32:35]
    v_exp_f32 v149, v149
    v_mfma_f32_16x16x32_bf16 a[228:231], a[224:227], v[176:179], a[228:231]
    ds_read_b128 a[112:115], v230 offset:1024
    ds_read_b128 a[116:119], v230 offset:1088
    v_mfma_f32_16x16x32_bf16 v[4:7], a[132:135], v[176:179], v[4:7]
    buffer_load_dwordx4 v235, s[8:11], s24 offen offset:1024 lds
    v_mfma_f32_16x16x32_bf16 v[36:39], a[132:135], v[180:183], v[36:39]
    s_add_u32 s24, s24, 131072
    v_exp_f32 v150, v150
    v_mfma_f32_16x16x32_bf16 v[8:11], a[136:139], v[176:179], v[8:11]
    s_sub_u32 s3, s3, 1
    ds_read_b128 a[120:123], v230 offset:1152
    v_cvt_pk_bf16_f32 v186, v148, v149
    v_mfma_f32_16x16x32_bf16 v[40:43], a[136:139], v[180:183], v[40:43]
    s_cselect_b32 s24, s30, s24
    v_exp_f32 v151, v151
    v_mfma_f32_16x16x32_bf16 v[12:15], a[140:143], v[176:179], v[12:15]
    s_cselect_b32 s10, s31, s10
    ds_read_b128 a[124:127], v230 offset:1216
    v_cvt_pk_bf16_f32 v187, v150, v151
    v_mfma_f32_16x16x32_bf16 v[44:47], a[140:143], v[180:183], v[44:47]
    v_exp_f32 v152, v152
    v_mfma_f32_16x16x32_bf16 v[16:19], a[144:147], v[176:179], v[16:19]
    v_exp_f32 v153, v153
    v_mfma_f32_16x16x32_bf16 v[48:51], a[144:147], v[180:183], v[48:51]
    v_add_f32 v227, v227, v152
    v_add_f32 v227, v227, v153
    v_mfma_f32_16x16x32_bf16 v[20:23], a[148:151], v[176:179], v[20:23]
    v_exp_f32 v154, v154
    v_mfma_f32_16x16x32_bf16 v[52:55], a[148:151], v[180:183], v[52:55]
    v_cvt_pk_bf16_f32 v188, v152, v153
    v_add_f32 v227, v227, v154
    v_mfma_f32_16x16x32_bf16 v[24:27], a[152:155], v[176:179], v[24:27]
    v_exp_f32 v155, v155
    v_mfma_f32_16x16x32_bf16 v[56:59], a[152:155], v[180:183], v[56:59]
    v_cvt_pk_bf16_f32 v189, v154, v155
    v_add_f32 v227, v227, v155
    v_mfma_f32_16x16x32_bf16 v[28:31], a[156:159], v[176:179], v[28:31]
    v_exp_f32 v156, v156
    v_mfma_f32_16x16x32_bf16 v[60:63], a[156:159], v[180:183], v[60:63]
    v_exp_f32 v157, v157
    v_mfma_f32_16x16x32_bf16 v[128:131], a[96:99], a[0:3], v[200:203]
    v_add_f32 v227, v227, v156
    v_add_f32 v227, v227, v157
    v_mfma_f32_16x16x32_bf16 v[128:131], a[100:103], a[4:7], v[128:131]
    s_waitcnt lgkmcnt(0)
    v_exp_f32 v158, v158
    v_mfma_f32_16x16x32_bf16 v[128:131], a[104:107], a[8:11], v[128:131]
    s_mov_b32 m0, s27
    v_cvt_pk_bf16_f32 v190, v156, v157
    v_add_f32 v227, v227, v158
    v_mfma_f32_16x16x32_bf16 v[128:131], a[108:111], a[12:15], v[128:131]
    s_add_u32 s27, s27, 16640
    v_exp_f32 v159, v159
    v_mfma_f32_16x16x32_bf16 v[132:135], a[112:115], a[0:3], v[200:203]
    s_cmp_eq_u32 s27, s29
    v_cvt_pk_bf16_f32 v191, v158, v159
    v_add_f32 v227, v227, v159
    v_mfma_f32_16x16x32_bf16 v[132:135], a[116:119], a[4:7], v[132:135]
    s_cselect_b32 s27, s28, s27
    v_exp_f32 v128, v128
    v_mfma_f32_16x16x32_bf16 v[132:135], a[120:123], a[8:11], v[132:135]
    s_waitcnt vmcnt(12)
    v_exp_f32 v129, v129
    v_mfma_f32_16x16x32_bf16 v[132:135], a[124:127], a[12:15], v[132:135]
    s_barrier
    v_mfma_f32_16x16x32_bf16 v[136:139], a[96:99], a[16:19], v[204:207]
    buffer_load_dwordx4 v236, s[12:15], s25 offen offset:2048 lds
    v_mfma_f32_16x16x32_bf16 v[136:139], a[100:103], a[20:23], v[136:139]
    v_add_u32 v231, s27, v233
    v_add_u32 v230, s27, v232
    v_mfma_f32_16x16x32_bf16 v[136:139], a[104:107], a[24:27], v[136:139]
    v_exp_f32 v131, v131
    v_mfma_f32_16x16x32_bf16 v[136:139], a[108:111], a[28:31], v[136:139]
    v_exp_f32 v130, v130
    v_mfma_f32_16x16x32_bf16 v[140:143], a[112:115], a[16:19], v[204:207]
    v_cvt_pk_bf16_f32 v176, v128, v129
    v_cvt_pk_bf16_f32 v177, v130, v131
    v_mfma_f32_16x16x32_bf16 v[140:143], a[116:119], a[20:23], v[140:143]
    v_exp_f32 v132, v132
    v_mfma_f32_16x16x32_bf16 v[140:143], a[120:123], a[24:27], v[140:143]
    v_exp_f32 v133, v133
    v_mfma_f32_16x16x32_bf16 v[140:143], a[124:127], a[28:31], v[140:143]
    v_exp_f32 v134, v134
    v_mfma_f32_16x16x32_bf16 v[64:67], a[128:131], v[184:187], v[64:67]
    v_exp_f32 v135, v135
    v_mfma_f32_16x16x32_bf16 v[96:99], a[128:131], v[188:191], v[96:99]
    ds_read_b64_tr_b16 a[128:129], v231 offset:0
    ds_read_b64_tr_b16 a[130:131], v231 offset:512
    v_mfma_f32_16x16x32_bf16 a[236:239], a[224:227], v[184:187], a[236:239]
    v_cvt_pk_bf16_f32 v178, v132, v133
    v_cvt_pk_bf16_f32 v179, v134, v135
    v_mfma_f32_16x16x32_bf16 v[68:71], a[132:135], v[184:187], v[68:71]
    v_exp_f32 v136, v136
    v_mfma_f32_16x16x32_bf16 v[100:103], a[132:135], v[188:191], v[100:103]
    ds_read_b64_tr_b16 a[132:133], v231 offset:32
    ds_read_b64_tr_b16 a[134:135], v231 offset:544
    v_mfma_f32_16x16x32_bf16 v[72:75], a[136:139], v[184:187], v[72:75]
    v_exp_f32 v137, v137
    v_mfma_f32_16x16x32_bf16 v[104:107], a[136:139], v[188:191], v[104:107]
    ds_read_b64_tr_b16 a[136:137], v231 offset:64
    ds_read_b64_tr_b16 a[138:139], v231 offset:576
    v_mfma_f32_16x16x32_bf16 v[76:79], a[140:143], v[184:187], v[76:79]
    buffer_load_dwordx4 v237, s[12:15], s25 offen offset:3104 lds
    v_mfma_f32_16x16x32_bf16 v[108:111], a[140:143], v[188:191], v[108:111]
    s_add_u32 s14, s10, 4096
    v_add_f32 v225, v225, v136
    v_cvt_pk_bf16_f32 v180, v136, v137
    v_mfma_f32_16x16x32_bf16 v[80:83], a[144:147], v[184:187], v[80:83]
    s_mov_b32 s25, s24
    ds_read_b64_tr_b16 a[140:141], v231 offset:96
    v_add_f32 v225, v225, v137
    v_mfma_f32_16x16x32_bf16 v[112:115], a[144:147], v[188:191], v[112:115]
    s_sub_u32 s26, s26, 1
    v_exp_f32 v138, v138
    v_mfma_f32_16x16x32_bf16 v[84:87], a[148:151], v[184:187], v[84:87]
    ds_read_b64_tr_b16 a[142:143], v231 offset:608
    v_add_f32 v225, v225, v138
    v_mfma_f32_16x16x32_bf16 v[116:119], a[148:151], v[188:191], v[116:119]
    v_exp_f32 v139, v139
    v_mfma_f32_16x16x32_bf16 v[88:91], a[152:155], v[184:187], v[88:91]
    v_add_f32 v225, v225, v139
    v_cvt_pk_bf16_f32 v181, v138, v139
    v_mfma_f32_16x16x32_bf16 v[120:123], a[152:155], v[188:191], v[120:123]
    v_exp_f32 v140, v140
    v_mfma_f32_16x16x32_bf16 v[92:95], a[156:159], v[184:187], v[92:95]
    v_exp_f32 v141, v141
    v_mfma_f32_16x16x32_bf16 v[124:127], a[156:159], v[188:191], v[124:127]
    ds_read_b64_tr_b16 a[144:145], v231 offset:128
    ds_read_b64_tr_b16 a[146:147], v231 offset:640
    s_cbranch_scc0 L_loop4
    s_cmp_eq_u32 s91, 0
    s_cbranch_scc1 L_out4
    s_mov_b32 s26, s94
L_lq4:
    v_mfma_f32_16x16x32_bf16 v[144:147], a[96:99], a[32:35], v[208:211]
    s_mov_b32 s70, m0
    ds_read_b64_tr_b16 a[148:149], v231 offset:160
    v_add_f32 v225, v225, v140
    v_mfma_f32_16x16x32_bf16 v[144:147], a[100:103], a[36:39], v[144:147]
    ds_read_b64_tr_b16 a[150:151], v231 offset:672
    v_add_f32 v225, v225, v141
    v_mfma_f32_16x16x32_bf16 v[144:147], a[104:107], a[40:43], v[144:147]
    s_mov_b32 m0, s70
    ds_read_b64_tr_b16 a[152:153], v231 offset:192
    ds_read_b64_tr_b16 a[154:155], v231 offset:704
    v_mfma_f32_16x16x32_bf16 v[144:147], a[108:111], a[44:47], v[144:147]
    buffer_load_dwordx4 v234, s[8:11], s24 offen lds
    v_mfma_f32_16x16x32_bf16 v[148:151], a[112:115], a[32:35], v[208:211]
    v_exp_f32 v142, v142
    v_mfma_f32_16x16x32_bf16 v[148:151], a[116:119], a[36:39], v[148:151]
    ds_read_b64_tr_b16 a[156:157], v231 offset:224
    v_cvt_pk_bf16_f32 v182, v140, v141
    v_mfma_f32_16x16x32_bf16 v[148:151], a[120:123], a[40:43], v[148:151]
    ds_read_b64_tr_b16 a[158:159], v231 offset:736
    v_add_f32 v225, v225, v142
    v_mfma_f32_16x16x32_bf16 v[148:151], a[124:127], a[44:47], v[148:151]
    v_exp_f32 v143, v143
    v_mfma_f32_16x16x32_bf16 v[152:155], a[96:99], a[48:51], v[212:215]
    ds_read_b128 a[96:99], v230 offset:0
    v_add_f32 v225, v225, v143
    v_mfma_f32_16x16x32_bf16 v[152:155], a[100:103], a[52:55], v[152:155]
    ds_read_b128 a[100:103], v230 offset:64
    v_cvt_pk_bf16_f32 v183, v142, v143
    v_mfma_f32_16x16x32_bf16 v[152:155], a[104:107], a[56:59], v[152:155]
    s_mov_b32 m0, s92
    ds_read_b128 a[104:107], v230 offset:128
    v_mfma_f32_16x16x32_bf16 v[152:155], a[108:111], a[60:63], v[152:155]
    buffer_load_dwordx4 v234, s[16:19], s93 offen lds
    v_mfma_f32_16x16x32_bf16 v[156:159], a[112:115], a[48:51], v[212:215]
    s_add_u32 s92, s92, 1088
    v_exp_f32 v144, v144
    v_mfma_f32_16x16x32_bf16 v[156:159], a[116:119], a[52:55], v[156:159]
    s_add_u32 s93, s93, 16384
    v_exp_f32 v145, v145
    v_mfma_f32_16x16x32_bf16 v[156:159], a[120:123], a[56:59], v[156:159]
    ds_read_b128 a[108:111], v230 offset:192
    v_cvt_pk_bf16_f32 v184, v144, v145
    v_mfma_f32_16x16x32_bf16 v[156:159], a[124:127], a[60:63], v[156:159]
    s_waitcnt lgkmcnt(2)
    v_exp_f32 v146, v146
    v_mfma_f32_16x16x32_bf16 v[0:3], a[128:131], v[176:179], v[0:3]
    v_exp_f32 v147, v147
    v_mfma_f32_16x16x32_bf16 v[32:35], a[128:131], v[180:183], v[32:35]
    ds_read_b128 a[112:115], v230 offset:1024
    v_cvt_pk_bf16_f32 v185, v146, v147
    v_mfma_f32_16x16x32_bf16 a[228:231], a[224:227], v[176:179], a[228:231]
    s_mov_b32 m0, s70
    ds_read_b128 a[116:119], v230 offset:1088
    ds_read_b128 a[120:123], v230 offset:1152
    v_mfma_f32_16x16x32_bf16 v[4:7], a[132:135], v[176:179], v[4:7]
    buffer_load_dwordx4 v235, s[8:11], s24 offen offset:1024 lds
    v_mfma_f32_16x16x32_bf16 v[36:39], a[132:135], v[180:183], v[36:39]
    s_add_u32 s24, s24, 131072
    v_exp_f32 v148, v148
    v_mfma_f32_16x16x32_bf16 v[8:11], a[136:139], v[176:179], v[8:11]
    s_sub_u32 s3, s3, 1
    v_exp_f32 v149, v149
    v_mfma_f32_16x16x32_bf16 v[40:43], a[136:139], v[180:183], v[40:43]
    s_cselect_b32 s24, s30, s24
    v_exp_f32 v150, v150
    v_mfma_f32_16x16x32_bf16 v[12:15], a[140:143], v[176:179], v[12:15]
    s_cselect_b32 s10, s31, s10
    ds_read_b128 a[124:127], v230 offset:1216
    v_cvt_pk_bf16_f32 v186, v148, v149
    v_mfma_f32_16x16x32_bf16 v[44:47], a[140:143], v[180:183], v[44:47]
    v_exp_f32 v151, v151
    v_mfma_f32_16x16x32_bf16 v[16:19], a[144:147], v[176:179], v[16:19]
    v_exp_f32 v152, v152
    v_mfma_f32_16x16x32_bf16 v[48:51], a[144:147], v[180:183], v[48:51]
    v_cvt_pk_bf16_f32 v187, v150, v151
    v_add_f32 v227, v227, v152
    v_mfma_f32_16x16x32_bf16 v[20:23], a[148:151], v[176:179], v[20:23]
    v_exp_f32 v153, v153
    v_mfma_f32_16x16x32_bf16 v[52:55], a[148:151], v[180:183], v[52:55]
    v_add_f32 v227, v227, v153
    v_cvt_pk_bf16_f32 v188, v152, v153
    v_mfma_f32_16x16x32_bf16 v[24:27], a[152:155], v[176:179], v[24:27]
    s_mov_b32 m0, s92
    v_exp_f32 v154, v154
    v_mfma_f32_16x16x32_bf16 v[56:59], a[152:155], v[180:183], v[56:59]
    buffer_load_dwordx4 v234, s[16:19], s93 offen lds
    v_mfma_f32_16x16x32_bf16 v[28:31], a[156:159], v[176:179], v[28:31]
    s_add_u32 s92, s92, 1088
    v_exp_f32 v155, v155
    v_mfma_f32_16x16x32_bf16 v[60:63], a[156:159], v[180:183], v[60:63]
    s_add_u32 s93, s93, 16384
    v_add_f32 v227, v227, v154
    v_cvt_pk_bf16_f32 v189, v154, v155
    v_mfma_f32_16x16x32_bf16 v[128:131], a[96:99], a[0:3], v[200:203]
    v_exp_f32 v156, v156
    v_mfma_f32_16x16x32_bf16 v[128:131], a[100:103], a[4:7], v[128:131]
    s_waitcnt lgkmcnt(0)
    v_exp_f32 v157, v157
    v_mfma_f32_16x16x32_bf16 v[128:131], a[104:107], a[8:11], v[128:131]
    s_mov_b32 s70, s27
    v_add_f32 v227, v227, v155
    v_add_f32 v227, v227, v156
    v_mfma_f32_16x16x32_bf16 v[128:131], a[108:111], a[12:15], v[128:131]
    s_add_u32 s27, s27, 16640
    v_add_f32 v227, v227, v157
    v_cvt_pk_bf16_f32 v190, v156, v157
    v_mfma_f32_16x16x32_bf16 v[132:135], a[112:115], a[0:3], v[200:203]
    s_cmp_eq_u32 s27, s29
    v_exp_f32 v158, v158
    v_mfma_f32_16x16x32_bf16 v[132:135], a[116:119], a[4:7], v[132:135]
    s_cselect_b32 s27, s28, s27
    v_exp_f32 v159, v159
    v_mfma_f32_16x16x32_bf16 v[132:135], a[120:123], a[8:11], v[132:135]
    s_waitcnt vmcnt(14)
    v_add_f32 v227, v227, v158
    v_cvt_pk_bf16_f32 v191, v158, v159
    v_mfma_f32_16x16x32_bf16 v[132:135], a[124:127], a[12:15], v[132:135]
    s_barrier
    v_mfma_f32_16x16x32_bf16 v[136:139], a[96:99], a[16:19], v[204:207]
    s_mov_b32 m0, s70
    v_add_u32 v231, s27, v233
    v_add_u32 v230, s27, v232
    v_mfma_f32_16x16x32_bf16 v[136:139], a[100:103], a[20:23], v[136:139]
    buffer_load_dwordx4 v236, s[12:15], s25 offen offset:2048 lds
    v_mfma_f32_16x16x32_bf16 v[136:139], a[104:107], a[24:27], v[136:139]
    v_exp_f32 v128, v128
    v_mfma_f32_16x16x32_bf16 v[136:139], a[108:111], a[28:31], v[136:139]
    v_exp_f32 v129, v129
    v_mfma_f32_16x16x32_bf16 v[140:143], a[112:115], a[16:19], v[204:207]
    v_add_f32 v227, v227, v159
    v_cvt_pk_bf16_f32 v176, v128, v129
    v_mfma_f32_16x16x32_bf16 v[140:143], a[116:119], a[20:23], v[140:143]
    v_exp_f32 v131, v131
    v_mfma_f32_16x16x32_bf16 v[140:143], a[120:123], a[24:27], v[140:143]
    v_exp_f32 v130, v130
    v_mfma_f32_16x16x32_bf16 v[140:143], a[124:127], a[28:31], v[140:143]
    v_exp_f32 v132, v132
    v_mfma_f32_16x16x32_bf16 v[64:67], a[128:131], v[184:187], v[64:67]
    v_exp_f32 v133, v133
    v_mfma_f32_16x16x32_bf16 v[96:99], a[128:131], v[188:191], v[96:99]
    ds_read_b64_tr_b16 a[128:129], v231 offset:0
    v_cvt_pk_bf16_f32 v177, v130, v131
    v_mfma_f32_16x16x32_bf16 a[236:239], a[224:227], v[184:187], a[236:239]
    ds_read_b64_tr_b16 a[130:131], v231 offset:512
    v_cvt_pk_bf16_f32 v178, v132, v133
    v_mfma_f32_16x16x32_bf16 v[68:71], a[132:135], v[184:187], v[68:71]
    v_exp_f32 v134, v134
    v_mfma_f32_16x16x32_bf16 v[100:103], a[132:135], v[188:191], v[100:103]
    v_exp_f32 v135, v135
    v_mfma_f32_16x16x32_bf16 v[72:75], a[136:139], v[184:187], v[72:75]
    ds_read_b64_tr_b16 a[132:133], v231 offset:32
    v_cvt_pk_bf16_f32 v179, v134, v135
    v_mfma_f32_16x16x32_bf16 v[104:107], a[136:139], v[188:191], v[104:107]
    s_mov_b32 m0, s70
    ds_read_b64_tr_b16 a[134:135], v231 offset:544
    ds_read_b64_tr_b16 a[136:137], v231 offset:64
    v_mfma_f32_16x16x32_bf16 v[76:79], a[140:143], v[184:187], v[76:79]
    buffer_load_dwordx4 v237, s[12:15], s25 offen offset:3104 lds
    v_mfma_f32_16x16x32_bf16 v[108:111], a[140:143], v[188:191], v[108:111]
    s_add_u32 s14, s10, 4096
    v_exp_f32 v136, v136
    v_mfma_f32_16x16x32_bf16 v[80:83], a[144:147], v[184:187], v[80:83]
    s_mov_b32 s25, s24
    ds_read_b64_tr_b16 a[138:139], v231 offset:576
    v_add_f32 v225, v225, v136
    v_mfma_f32_16x16x32_bf16 v[112:115], a[144:147], v[188:191], v[112:115]
    s_mov_b32 m0, s70
    v_exp_f32 v137, v137
    v_mfma_f32_16x16x32_bf16 v[84:87], a[148:151], v[184:187], v[84:87]
    s_sub_u32 s26, s26, 1
    v_cvt_pk_bf16_f32 v180, v136, v137
    v_add_f32 v225, v225, v137
    v_mfma_f32_16x16x32_bf16 v[116:119], a[148:151], v[188:191], v[116:119]
    v_exp_f32 v138, v138
    v_mfma_f32_16x16x32_bf16 v[88:91], a[152:155], v[184:187], v[88:91]
    ds_read_b64_tr_b16 a[140:141], v231 offset:96
    v_add_f32 v225, v225, v138
    v_mfma_f32_16x16x32_bf16 v[120:123], a[152:155], v[188:191], v[120:123]
    v_exp_f32 v139, v139
    v_mfma_f32_16x16x32_bf16 v[92:95], a[156:159], v[184:187], v[92:95]
    ds_read_b64_tr_b16 a[142:143], v231 offset:608
    v_add_f32 v225, v225, v139
    v_mfma_f32_16x16x32_bf16 v[124:127], a[156:159], v[188:191], v[124:127]
    ds_read_b64_tr_b16 a[144:145], v231 offset:128
    v_cvt_pk_bf16_f32 v181, v138, v139
    ds_read_b64_tr_b16 a[146:147], v231 offset:640
    v_exp_f32 v140, v140
    v_exp_f32 v141, v141
    s_cbranch_scc0 L_lq4
    s_sub_u32 s26, s91, 1
    s_mov_b32 s91, 0
    s_branch L_loop4
L_out4:
    s_cmp_eq_u32 s71, 8
    s_cbranch_scc1 L_tail4_8
    s_cmp_eq_u32 s71, 10
    s_cbranch_scc1 L_tail4_10
L_tail4_0:
    v_mfma_f32_16x16x32_bf16 v[144:147], a[96:99], a[32:35], v[208:211]
    ds_read_b64_tr_b16 a[148:149], v231 offset:160
    v_add_f32 v225, v225, v140
    v_mfma_f32_16x16x32_bf16 v[144:147], a[100:103], a[36:39], v[144:147]
    ds_read_b64_tr_b16 a[150:151], v231 offset:672
    v_add_f32 v225, v225, v141
    v_mfma_f32_16x16x32_bf16 v[144:147], a[104:107], a[40:43], v[144:147]
    ds_read_b64_tr_b16 a[152:153], v231 offset:192
    ds_read_b64_tr_b16 a[154:155], v231 offset:704
    v_mfma_f32_16x16x32_bf16 v[144:147], a[108:111], a[44:47], v[144:147]
    v_exp_f32 v142, v142
    v_mfma_f32_16x16x32_bf16 v[148:151], a[112:115], a[32:35], v[208:211]
    ds_read_b64_tr_b16 a[156:157], v231 offset:224
    v_cvt_pk_bf16_f32 v182, v140, v141
    v_mfma_f32_16x16x32_bf16 v[148:151], a[116:119], a[36:39], v[148:151]
    ds_read_b64_tr_b16 a[158:159], v231 offset:736
    v_add_f32 v225, v225, v142
    v_mfma_f32_16x16x32_bf16 v[148:151], a[120:123], a[40:43], v[148:151]
    v_exp_f32 v143, v143
    v_mfma_f32_16x16x32_bf16 v[148:151], a[124:127], a[44:47], v[148:151]
    v_add_f32 v225, v225, v143
    v_cvt_pk_bf16_f32 v183, v142, v143
    v_mfma_f32_16x16x32_bf16 v[152:155], a[96:99], a[48:51], v[212:215]
    v_exp_f32 v144, v144
    v_mfma_f32_16x16x32_bf16 v[152:155], a[100:103], a[52:55], v[152:155]
    v_exp_f32 v145, v145
    v_mfma_f32_16x16x32_bf16 v[152:155], a[104:107], a[56:59], v[152:155]
    ds_read_b128 a[96:99], v230 offset:0
    ds_read_b128 a[100:103], v230 offset:64
    v_mfma_f32_16x16x32_bf16 v[152:155], a[108:111], a[60:63], v[152:155]
    ds_read_b128 a[104:107], v230 offset:128
    v_cvt_pk_bf16_f32 v184, v144, v145
    v_mfma_f32_16x16x32_bf16 v[156:159], a[112:115], a[48:51], v[212:215]
    v_exp_f32 v146, v146
    v_mfma_f32_16x16x32_bf16 v[156:159], a[116:119], a[52:55], v[156:159]
    v_exp_f32 v147, v147
    v_mfma_f32_16x16x32_bf16 v[156:159], a[120:123], a[56:59], v[156:159]
    ds_read_b128 a[108:111], v230 offset:192
    v_cvt_pk_bf16_f32 v185, v146, v147
    v_mfma_f32_16x16x32_bf16 v[156:159], a[124:127], a[60:63], v[156:159]
    s_waitcnt lgkmcnt(4)
    v_exp_f32 v148, v148
    v_mfma_f32_16x16x32_bf16 v[0:3], a[128:131], v[176:179], v[0:3]
    v_exp_f32 v149, v149
    v_mfma_f32_16x16x32_bf16 v[32:35], a[128:131], v[180:183], v[32:35]
    ds_read_b128 a[112:115], v230 offset:1024
    v_cvt_pk_bf16_f32 v186, v148, v149
    v_mfma_f32_16x16x32_bf16 a[228:231], a[224:227], v[176:179], a[228:231]
    v_exp_f32 v150, v150
    v_mfma_f32_16x16x32_bf16 v[4:7], a[132:135], v[176:179], v[4:7]
    v_exp_f32 v151, v151
    v_mfma_f32_16x16x32_bf16 v[36:39], a[132:135], v[180:183], v[36:39]
    ds_read_b128 a[116:119], v230 offset:1088
    v_cvt_pk_bf16_f32 v187, v150, v151
    v_mfma_f32_16x16x32_bf16 v[8:11], a[136:139], v[176:179], v[8:11]
    v_exp_f32 v152, v152
    v_mfma_f32_16x16x32_bf16 v[40:43], a[136:139], v[180:183], v[40:43]
    ds_read_b128 a[120:123], v230 offset:1152
    v_add_f32 v227, v227, v152
    v_mfma_f32_16x16x32_bf16 v[12:15], a[140:143], v[176:179], v[12:15]
    v_exp_f32 v153, v153
    v_mfma_f32_16x16x32_bf16 v[44:47], a[140:143], v[180:183], v[44:47]
    ds_read_b128 a[124:127], v230 offset:1216
    v_add_f32 v227, v227, v153
    v_mfma_f32_16x16x32_bf16 v[16:19], a[144:147], v[176:179], v[16:19]
    v_exp_f32 v154, v154
    v_mfma_f32_16x16x32_bf16 v[48:51], a[144:147], v[180:183], v[48:51]
    v_cvt_pk_bf16_f32 v188, v152, v153
    v_add_f32 v227, v227, v154
    v_mfma_f32_16x16x32_bf16 v[20:23], a[148:151], v[176:179], v[20:23]
    v_exp_f32 v155, v155
    v_mfma_f32_16x16x32_bf16 v[52:55], a[148:151], v[180:183], v[52:55]
    v_cvt_pk_bf16_f32 v189, v154, v155
    v_add_f32 v227, v227, v155
    v_mfma_f32_16x16x32_bf16 v[24:27], a[152:155], v[176:179], v[24:27]
    v_exp_f32 v156, v156
    v_mfma_f32_16x16x32_bf16 v[56:59], a[152:155], v[180:183], v[56:59]
    v_exp_f32 v157, v157
    v_mfma_f32_16x16x32_bf16 v[28:31], a[156:159], v[176:179], v[28:31]
    v_add_f32 v227, v227, v156
    v_add_f32 v227, v227, v157
    v_mfma_f32_16x16x32_bf16 v[60:63], a[156:159], v[180:183], v[60:63]
    s_waitcnt lgkmcnt(0)
    v_exp_f32 v158, v158
    v_mfma_f32_16x16x32_bf16 v[128:131], a[96:99], a[0:3], v[200:203]
    v_cvt_pk_bf16_f32 v190, v156, v157
    v_add_f32 v227, v227, v158
    v_mfma_f32_16x16x32_bf16 v[128:131], a[100:103], a[4:7], v[128:131]
    v_exp_f32 v159, v159
    v_mfma_f32_16x16x32_bf16 v[128:131], a[104:107], a[8:11], v[128:131]
    s_mov_b32 m0, s27
    v_cvt_pk_bf16_f32 v191, v158, v159
    v_add_f32 v227, v227, v159
    v_mfma_f32_16x16x32_bf16 v[128:131], a[108:111], a[12:15], v[128:131]
    s_add_u32 s27, s27, 16640
    v_mfma_f32_16x16x32_bf16 v[132:135], a[112:115], a[0:3], v[200:203]
    s_cmp_eq_u32 s27, s29
    v_mfma_f32_16x16x32_bf16 v[132:135], a[116:119], a[4:7], v[132:135]
    s_cselect_b32 s27, s28, s27
    v_mfma_f32_16x16x32_bf16 v[132:135], a[120:123], a[8:11], v[132:135]
    s_waitcnt vmcnt(10)
    v_mfma_f32_16x16x32_bf16 v[132:135], a[124:127], a[12:15], v[132:135]
    s_barrier
    v_mfma_f32_16x16x32_bf16 v[136:139], a[96:99], a[16:19], v[204:207]
    s_add_u32 s66, s33, 0
    v_add_u32 v231, s27, v233
    v_add_u32 v230, s27, v232
    v_mfma_f32_16x16x32_bf16 v[136:139], a[100:103], a[20:23], v[136:139]
    s_add_u32 s67, s33, 65536
    v_exp_f32 v128, v128
    v_mfma_f32_16x16x32_bf16 v[136:139], a[104:107], a[24:27], v[136:139]
    s_add_u32 s74, s33, 131072
    v_exp_f32 v129, v129
    v_mfma_f32_16x16x32_bf16 v[136:139], a[108:111], a[28:31], v[136:139]
    s_add_u32 s75, s33, 196608
    v_cndmask_b32 v129, 0, v129, s[42:43]
    v_cndmask_b32 v128, 0, v128, s[40:41]
    v_mfma_f32_16x16x32_bf16 v[140:143], a[112:115], a[16:19], v[204:207]
    v_exp_f32 v131, v131
    v_mfma_f32_16x16x32_bf16 v[140:143], a[116:119], a[20:23], v[140:143]
    v_cvt_pk_bf16_f32 v176, v128, v129
    v_cndmask_b32 v131, 0, v131, s[46:47]
    v_mfma_f32_16x16x32_bf16 v[140:143], a[120:123], a[24:27], v[140:143]
    v_exp_f32 v130, v130
    v_mfma_f32_16x16x32_bf16 v[140:143], a[124:127], a[28:31], v[140:143]
    v_exp_f32 v132, v132
    v_mfma_f32_16x16x32_bf16 v[64:67], a[128:131], v[184:187], v[64:67]
    v_cndmask_b32 v130, 0, v130, s[44:45]
    v_cndmask_b32 v132, 0, v132, s[48:49]
    v_mfma_f32_16x16x32_bf16 v[96:99], a[128:131], v[188:191], v[96:99]
    ds_read_b64_tr_b16 a[128:129], v231 offset:0
    v_cvt_pk_bf16_f32 v177, v130, v131
    v_mfma_f32_16x16x32_bf16 a[236:239], a[224:227], v[184:187], a[236:239]
    v_exp_f32 v133, v133
    v_mfma_f32_16x16x32_bf16 v[68:71], a[132:135], v[184:187], v[68:71]
    ds_read_b64_tr_b16 a[130:131], v231 offset:512
    v_cndmask_b32 v133, 0, v133, s[50:51]
    v_mfma_f32_16x16x32_bf16 v[100:103], a[132:135], v[188:191], v[100:103]
    ds_read_b64_tr_b16 a[132:133], v231 offset:32
    v_cvt_pk_bf16_f32 v178, v132, v133
    v_mfma_f32_16x16x32_bf16 v[72:75], a[136:139], v[184:187], v[72:75]
    v_exp_f32 v134, v134
    v_mfma_f32_16x16x32_bf16 v[104:107], a[136:139], v[188:191], v[104:107]
    v_exp_f32 v135, v135
    v_mfma_f32_16x16x32_bf16 v[76:79], a[140:143], v[184:187], v[76:79]
    v_cndmask_b32 v134, 0, v134, s[52:53]
    v_cndmask_b32 v135, 0, v135, s[54:55]
    v_mfma_f32_16x16x32_bf16 v[108:111], a[140:143], v[188:191], v[108:111]
    ds_read_b64_tr_b16 a[134:135], v231 offset:544
    v_cvt_pk_bf16_f32 v179, v134, v135
    v_mfma_f32_16x16x32_bf16 v[80:83], a[144:147], v[184:187], v[80:83]
    v_exp_f32 v136, v136
    v_mfma_f32_16x16x32_bf16 v[112:115], a[144:147], v[188:191], v[112:115]
    ds_read_b64_tr_b16 a[136:137], v231 offset:64
    v_cndmask_b32 v136, 0, v136, s[40:41]
    v_mfma_f32_16x16x32_bf16 v[84:87], a[148:151], v[184:187], v[84:87]
    ds_read_b64_tr_b16 a[138:139], v231 offset:576
    v_add_f32 v225, v225, v136
    v_mfma_f32_16x16x32_bf16 v[116:119], a[148:151], v[188:191], v[116:119]
    v_exp_f32 v137, v137
    v_mfma_f32_16x16x32_bf16 v[88:91], a[152:155], v[184:187], v[88:91]
    ds_read_b64_tr_b16 a[140:141], v231 offset:96
    v_cndmask_b32 v137, 0, v137, s[42:43]
    v_mfma_f32_16x16x32_bf16 v[120:123], a[152:155], v[188:191], v[120:123]
    v_cvt_pk_bf16_f32 v180, v136, v137
    v_add_f32 v225, v225, v137
    v_mfma_f32_16x16x32_bf16 v[92:95], a[156:159], v[184:187], v[92:95]
    v_exp_f32 v138, v138
    v_mfma_f32_16x16x32_bf16 v[124:127], a[156:159], v[188:191], v[124:127]
    ds_read_b64_tr_b16 a[142:143], v231 offset:608
    v_cndmask_b32 v138, 0, v138, s[44:45]
    v_mfma_f32_16x16x32_bf16 v[144:147], a[96:99], a[32:35], v[208:211]
    ds_read_b64_tr_b16 a[144:145], v231 offset:128
    v_add_f32 v225, v225, v138
    v_mfma_f32_16x16x32_bf16 v[144:147], a[100:103], a[36:39], v[144:147]
    v_exp_f32 v139, v139
    v_mfma_f32_16x16x32_bf16 v[144:147], a[104:107], a[40:43], v[144:147]
    ds_read_b64_tr_b16 a[146:147], v231 offset:640
    v_cndmask_b32 v139, 0, v139, s[46:47]
    v_mfma_f32_16x16x32_bf16 v[144:147], a[108:111], a[44:47], v[144:147]
    v_add_f32 v225, v225, v139
    v_cvt_pk_bf16_f32 v181, v138, v139
    v_mfma_f32_16x16x32_bf16 v[148:151], a[112:115], a[32:35], v[208:211]
    v_exp_f32 v140, v140
    v_mfma_f32_16x16x32_bf16 v[148:151], a[116:119], a[36:39], v[148:151]
    ds_read_b64_tr_b16 a[148:149], v231 offset:160
    ds_read_b64_tr_b16 a[150:151], v231 offset:672
    v_mfma_f32_16x16x32_bf16 v[148:151], a[120:123], a[40:43], v[148:151]
    ds_read_b64_tr_b16 a[152:153], v231 offset:192
    ds_read_b64_tr_b16 a[154:155], v231 offset:704
    v_mfma_f32_16x16x32_bf16 v[148:151], a[124:127], a[44:47], v[148:151]
    ds_read_b64_tr_b16 a[156:157], v231 offset:224
    ds_read_b64_tr_b16 a[158:159], v231 offset:736
    v_cndmask_b32 v140, 0, v140, s[48:49]
    v_mfma_f32_16x16x32_bf16 v[152:155], a[96:99], a[48:51], v[212:215]
    v_exp_f32 v141, v141
    v_add_f32 v225, v225, v140
    v_mfma_f32_16x16x32_bf16 v[152:155], a[100:103], a[52:55], v[152:155]
    v_cndmask_b32 v141, 0, v141, s[50:51]
    v_add_f32 v225, v225, v141
    v_cvt_pk_bf16_f32 v182, v140, v141
    v_mfma_f32_16x16x32_bf16 v[152:155], a[104:107], a[56:59], v[152:155]
    v_exp_f32 v142, v142
    v_mfma_f32_16x16x32_bf16 v[152:155], a[108:111], a[60:63], v[152:155]
    v_cndmask_b32 v142, 0, v142, s[52:53]
    v_exp_f32 v143, v143
    v_mfma_f32_16x16x32_bf16 v[156:159], a[112:115], a[48:51], v[212:215]
    v_add_f32 v225, v225, v142
    v_cndmask_b32 v143, 0, v143, s[54:55]
    v_add_f32 v225, v225, v143
    v_mfma_f32_16x16x32_bf16 v[156:159], a[116:119], a[52:55], v[156:159]
    v_mov_b32 v205, v225
    v_cvt_pk_bf16_f32 v183, v142, v143
    v_mfma_f32_16x16x32_bf16 v[156:159], a[120:123], a[56:59], v[156:159]
    v_permlane32_swap_b32 v205, v225
    v_add_f32 v225, v225, v205
    v_mov_b32 v205, v225
    v_mfma_f32_16x16x32_bf16 v[156:159], a[124:127], a[60:63], v[156:159]
    s_waitcnt lgkmcnt(0)
    v_permlane16_swap_b32 v205, v225
    v_add_f32 v225, v225, v205
    v_mfma_f32_16x16x32_bf16 v[0:3], a[128:131], v[176:179], v[0:3]
    v_rcp_f32 v204, v225
    v_mfma_f32_16x16x32_bf16 v[32:35], a[128:131], v[180:183], v[32:35]
    v_exp_f32 v144, v144
    v_mfma_f32_16x16x32_bf16 a[228:231], a[224:227], v[176:179], a[228:231]
    v_cndmask_b32 v144, 0, v144, s[40:41]
    v_exp_f32 v145, v145
    v_mfma_f32_16x16x32_bf16 v[4:7], a[132:135], v[176:179], v[4:7]
    v_cndmask_b32 v145, 0, v145, s[42:43]
    v_cvt_pk_bf16_f32 v184, v144, v145
    v_mfma_f32_16x16x32_bf16 v[36:39], a[132:135], v[180:183], v[36:39]
    v_exp_f32 v146, v146
    v_mfma_f32_16x16x32_bf16 v[8:11], a[136:139], v[176:179], v[8:11]
    v_accvgpr_read_b32 v224, a228
    v_rcp_f32 v200, v224
    v_mfma_f32_16x16x32_bf16 v[40:43], a[136:139], v[180:183], v[40:43]
    v_cndmask_b32 v146, 0, v146, s[44:45]
    v_exp_f32 v147, v147
    v_mfma_f32_16x16x32_bf16 v[12:15], a[140:143], v[176:179], v[12:15]
    v_cndmask_b32 v147, 0, v147, s[46:47]
    v_cvt_pk_bf16_f32 v185, v146, v147
    v_cmp_nle_f32 s[68:69], v224, s63
    v_mfma_f32_16x16x32_bf16 v[44:47], a[140:143], v[180:183], v[44:47]
    s_or_b64 s[56:57], s[56:57], s[68:69]
    v_exp_f32 v148, v148
    v_cmp_nle_f32 s[68:69], v225, s63
    v_mfma_f32_16x16x32_bf16 v[16:19], a[144:147], v[176:179], v[16:19]
    s_or_b64 s[56:57], s[56:57], s[68:69]
    v_cndmask_b32 v148, 0, v148, s[48:49]
    v_exp_f32 v149, v149
    v_mfma_f32_16x16x32_bf16 v[48:51], a[144:147], v[180:183], v[48:51]
    v_cndmask_b32 v149, 0, v149, s[50:51]
    v_cvt_pk_bf16_f32 v186, v148, v149
    v_mfma_f32_16x16x32_bf16 v[20:23], a[148:151], v[176:179], v[20:23]
    v_exp_f32 v152, v152
    v_mfma_f32_16x16x32_bf16 v[52:55], a[148:151], v[180:183], v[52:55]
    v_exp_f32 v150, v150
    v_cndmask_b32 v152, 0, v152, s[40:41]
    v_mfma_f32_16x16x32_bf16 v[24:27], a[152:155], v[176:179], v[24:27]
    v_exp_f32 v153, v153
    v_cndmask_b32 v150, 0, v150, s[52:53]
    v_mfma_f32_16x16x32_bf16 v[56:59], a[152:155], v[180:183], v[56:59]
    v_add_f32 v227, v227, v152
    v_cndmask_b32 v153, 0, v153, s[42:43]
    v_add_f32 v227, v227, v153
    v_mfma_f32_16x16x32_bf16 v[28:31], a[156:159], v[176:179], v[28:31]
    v_exp_f32 v154, v154
    v_cvt_pk_bf16_f32 v188, v152, v153
    v_mfma_f32_16x16x32_bf16 v[60:63], a[156:159], v[180:183], v[60:63]
    v_pk_mul_f32 v[0:1], v[0:1], v[200:201] op_sel_hi:[1,0]
    v_pk_mul_f32 v[2:3], v[2:3], v[200:201] op_sel_hi:[1,0]
    v_cvt_pk_bf16_f32 v0, v0, v1
    v_pk_mul_f32 v[4:5], v[4:5], v[200:201] op_sel_hi:[1,0]
    v_pk_mul_f32 v[6:7], v[6:7], v[200:201] op_sel_hi:[1,0]
    v_pk_mul_f32 v[8:9], v[8:9], v[200:201] op_sel_hi:[1,0]
    v_pk_mul_f32 v[10:11], v[10:11], v[200:201] op_sel_hi:[1,0]
    v_pk_mul_f32 v[12:13], v[12:13], v[200:201] op_sel_hi:[1,0]
    v_pk_mul_f32 v[14:15], v[14:15], v[200:201] op_sel_hi:[1,0]
    v_pk_mul_f32 v[16:17], v[16:17], v[200:201] op_sel_hi:[1,0]
    v_pk_mul_f32 v[18:19], v[18:19], v[200:201] op_sel_hi:[1,0]
    v_pk_mul_f32 v[20:21], v[20:21], v[200:201] op_sel_hi:[1,0]
    v_pk_mul_f32 v[22:23], v[22:23], v[200:201] op_sel_hi:[1,0]
    v_pk_mul_f32 v[24:25], v[24:25], v[200:201] op_sel_hi:[1,0]
    v_pk_mul_f32 v[26:27], v[26:27], v[200:201] op_sel_hi:[1,0]
    v_pk_mul_f32 v[28:29], v[28:29], v[200:201] op_sel_hi:[1,0]
    v_pk_mul_f32 v[30:31], v[30:31], v[200:201] op_sel_hi:[1,0]
    v_pk_mul_f32 v[32:33], v[32:33], v[204:205] op_sel_hi:[1,0]
    v_pk_mul_f32 v[34:35], v[34:35], v[204:205] op_sel_hi:[1,0]
    v_pk_mul_f32 v[36:37], v[36:37], v[204:205] op_sel_hi:[1,0]
    v_pk_mul_f32 v[38:39], v[38:39], v[204:205] op_sel_hi:[1,0]
    v_pk_mul_f32 v[40:41], v[40:41], v[204:205] op_sel_hi:[1,0]
    v_pk_mul_f32 v[42:43], v[42:43], v[204:205] op_sel_hi:[1,0]
    v_pk_mul_f32 v[44:45], v[44:45], v[204:205] op_sel_hi:[1,0]
    v_pk_mul_f32 v[46:47], v[46:47], v[204:205] op_sel_hi:[1,0]
    v_pk_mul_f32 v[48:49], v[48:49], v[204:205] op_sel_hi:[1,0]
    v_pk_mul_f32 v[50:51], v[50:51], v[204:205] op_sel_hi:[1,0]
    v_pk_mul_f32 v[52:53], v[52:53], v[204:205] op_sel_hi:[1,0]
    v_pk_mul_f32 v[54:55], v[54:55], v[204:205] op_sel_hi:[1,0]
    v_pk_mul_f32 v[56:57], v[56:57], v[204:205] op_sel_hi:[1,0]
    v_pk_mul_f32 v[58:59], v[58:59], v[204:205] op_sel_hi:[1,0]
    v_pk_mul_f32 v[60:61], v[60:61], v[204:205] op_sel_hi:[1,0]
    v_pk_mul_f32 v[62:63], v[62:63], v[204:205] op_sel_hi:[1,0]
    v_exp_f32 v151, v151
    v_cvt_pk_bf16_f32 v1, v2, v3
    v_cndmask_b32 v151, 0, v151, s[54:55]
    v_cvt_pk_bf16_f32 v187, v150, v151
    v_cvt_pk_bf16_f32 v2, v4, v5
    v_cvt_pk_bf16_f32 v3, v6, v7
    v_mfma_f32_16x16x32_bf16 v[64:67], a[128:131], v[184:187], v[64:67]
    ds_write_b64 v242, v[0:1] offset:0
    ds_write_b64 v242, v[2:3] offset:32
    v_cvt_pk_bf16_f32 v4, v8, v9
    v_cndmask_b32 v154, 0, v154, s[44:45]
    v_exp_f32 v155, v155
    v_exp_f32 v156, v156
    v_cndmask_b32 v155, 0, v155, s[46:47]
    v_cndmask_b32 v156, 0, v156, s[48:49]
    v_exp_f32 v157, v157
    v_exp_f32 v158, v158
    v_cndmask_b32 v157, 0, v157, s[50:51]
    v_cndmask_b32 v158, 0, v158, s[52:53]
    v_exp_f32 v159, v159
    v_cvt_pk_bf16_f32 v189, v154, v155
    v_cndmask_b32 v159, 0, v159, s[54:55]
    v_cvt_pk_bf16_f32 v190, v156, v157
    v_cvt_pk_bf16_f32 v191, v158, v159
    v_cvt_pk_bf16_f32 v5, v10, v11
    v_cvt_pk_bf16_f32 v6, v12, v13
    v_mfma_f32_16x16x32_bf16 v[96:99], a[128:131], v[188:191], v[96:99]
    ds_write_b64 v242, v[4:5] offset:64
    v_cvt_pk_bf16_f32 v7, v14, v15
    v_cvt_pk_bf16_f32 v8, v16, v17
    v_mfma_f32_16x16x32_bf16 a[236:239], a[224:227], v[184:187], a[236:239]
    ds_write_b64 v242, v[6:7] offset:96
    v_cvt_pk_bf16_f32 v9, v18, v19
    v_cvt_pk_bf16_f32 v10, v20, v21
    v_mfma_f32_16x16x32_bf16 v[68:71], a[132:135], v[184:187], v[68:71]
    ds_write_b64 v242, v[8:9] offset:128
    v_cvt_pk_bf16_f32 v11, v22, v23
    v_cvt_pk_bf16_f32 v12, v24, v25
    v_mfma_f32_16x16x32_bf16 v[100:103], a[132:135], v[188:191], v[100:103]
    ds_write_b64 v242, v[10:11] offset:160
    v_cvt_pk_bf16_f32 v13, v26, v27
    v_cvt_pk_bf16_f32 v14, v28, v29
    v_mfma_f32_16x16x32_bf16 v[72:75], a[136:139], v[184:187], v[72:75]
    ds_write_b64 v242, v[12:13] offset:192
    v_cvt_pk_bf16_f32 v15, v30, v31
    v_cvt_pk_bf16_f32 v32, v32, v33
    v_mfma_f32_16x16x32_bf16 v[104:107], a[136:139], v[188:191], v[104:107]
    ds_write_b64 v242, v[14:15] offset:224
    ds_read_b64 v[16:17], v243 offset:0
    ds_read_b64 v[18:19], v245 offset:0
    v_mfma_f32_16x16x32_bf16 v[76:79], a[140:143], v[184:187], v[76:79]
    ds_read_b64 v[20:21], v243 offset:1056
    ds_read_b64 v[22:23], v245 offset:1056
    ds_read_b64 v[24:25], v243 offset:2112
    v_mfma_f32_16x16x32_bf16 v[108:111], a[140:143], v[188:191], v[108:111]
    ds_read_b64 v[26:27], v245 offset:2112
    ds_read_b64 v[28:29], v243 offset:3168
    ds_read_b64 v[30:31], v245 offset:3168
    v_mfma_f32_16x16x32_bf16 v[80:83], a[144:147], v[184:187], v[80:83]
    v_cvt_pk_bf16_f32 v33, v34, v35
    v_cvt_pk_bf16_f32 v34, v36, v37
    v_cvt_pk_bf16_f32 v35, v38, v39
    v_mfma_f32_16x16x32_bf16 v[112:115], a[144:147], v[188:191], v[112:115]
    ds_write_b64 v242, v[32:33] offset:0
    ds_write_b64 v242, v[34:35] offset:32
    v_cvt_pk_bf16_f32 v36, v40, v41
    v_mfma_f32_16x16x32_bf16 v[84:87], a[148:151], v[184:187], v[84:87]
    v_cvt_pk_bf16_f32 v37, v42, v43
    v_cvt_pk_bf16_f32 v38, v44, v45
    v_cvt_pk_bf16_f32 v39, v46, v47
    v_mfma_f32_16x16x32_bf16 v[116:119], a[148:151], v[188:191], v[116:119]
    ds_write_b64 v242, v[36:37] offset:64
    ds_write_b64 v242, v[38:39] offset:96
    v_cvt_pk_bf16_f32 v40, v48, v49
    v_mfma_f32_16x16x32_bf16 v[88:91], a[152:155], v[184:187], v[88:91]
    s_waitcnt lgkmcnt(7)
    buffer_store_dwordx4 v[16:19], v239, s[20:23], s66 offen nt
    v_mfma_f32_16x16x32_bf16 v[120:123], a[152:155], v[188:191], v[120:123]
    buffer_store_dwordx4 v[20:23], v241, s[20:23], s66 offen nt
    v_mfma_f32_16x16x32_bf16 v[92:95], a[156:159], v[184:187], v[92:95]
    s_waitcnt lgkmcnt(4)
    buffer_store_dwordx4 v[24:27], v246, s[20:23], s66 offen nt
    v_mfma_f32_16x16x32_bf16 v[124:127], a[156:159], v[188:191], v[124:127]
    buffer_store_dwordx4 v[28:31], v247, s[20:23], s66 offen nt
    v_cvt_pk_bf16_f32 v41, v50, v51
    ds_write_b64 v242, v[40:41] offset:128
    v_cvt_pk_bf16_f32 v42, v52, v53
    v_cvt_pk_bf16_f32 v43, v54, v55
    ds_write_b64 v242, v[42:43] offset:160
    v_cvt_pk_bf16_f32 v44, v56, v57
    v_cvt_pk_bf16_f32 v45, v58, v59
    ds_write_b64 v242, v[44:45] offset:192
    v_cvt_pk_bf16_f32 v46, v60, v61
    v_cvt_pk_bf16_f32 v47, v62, v63
    ds_write_b64 v242, v[46:47] offset:224
    ds_read_b64 v[48:49], v243 offset:0
    ds_read_b64 v[50:51], v245 offset:0
    ds_read_b64 v[52:53], v243 offset:1056
    v_accvgpr_read_b32 v226, a236
    ds_read_b64 v[54:55], v245 offset:1056
    ds_read_b64 v[56:57], v243 offset:2112
    v_rcp_f32 v208, v226
    ds_read_b64 v[58:59], v245 offset:2112
    v_pk_mul_f32 v[64:65], v[64:65], v[208:209] op_sel_hi:[1,0]
    ds_read_b64 v[60:61], v243 offset:3168
    v_pk_mul_f32 v[66:67], v[66:67], v[208:209] op_sel_hi:[1,0]
    v_cvt_pk_bf16_f32 v64, v64, v65
    v_add_f32 v227, v227, v154
    ds_read_b64 v[62:63], v245 offset:3168
    v_pk_mul_f32 v[68:69], v[68:69], v[208:209] op_sel_hi:[1,0]
    v_pk_mul_f32 v[70:71], v[70:71], v[208:209] op_sel_hi:[1,0]
    v_cvt_pk_bf16_f32 v65, v66, v67
    v_add_f32 v227, v227, v155
    v_pk_mul_f32 v[72:73], v[72:73], v[208:209] op_sel_hi:[1,0]
    v_pk_mul_f32 v[74:75], v[74:75], v[208:209] op_sel_hi:[1,0]
    ds_write_b64 v242, v[64:65] offset:0
    v_cvt_pk_bf16_f32 v66, v68, v69
    v_cvt_pk_bf16_f32 v67, v70, v71
    v_add_f32 v227, v227, v156
    v_pk_mul_f32 v[76:77], v[76:77], v[208:209] op_sel_hi:[1,0]
    v_pk_mul_f32 v[78:79], v[78:79], v[208:209] op_sel_hi:[1,0]
    ds_write_b64 v242, v[66:67] offset:32
    v_cvt_pk_bf16_f32 v68, v72, v73
    v_cvt_pk_bf16_f32 v69, v74, v75
    v_add_f32 v227, v227, v157
    v_pk_mul_f32 v[80:81], v[80:81], v[208:209] op_sel_hi:[1,0]
    v_pk_mul_f32 v[82:83], v[82:83], v[208:209] op_sel_hi:[1,0]
    ds_write_b64 v242, v[68:69] offset:64
    v_cvt_pk_bf16_f32 v70, v76, v77
    v_cvt_pk_bf16_f32 v71, v78, v79
    v_add_f32 v227, v227, v158
    v_pk_mul_f32 v[84:85], v[84:85], v[208:209] op_sel_hi:[1,0]
    v_pk_mul_f32 v[86:87], v[86:87], v[208:209] op_sel_hi:[1,0]
    ds_write_b64 v242, v[70:71] offset:96
    v_cvt_pk_bf16_f32 v72, v80, v81
    v_cvt_pk_bf16_f32 v73, v82, v83
    v_add_f32 v227, v227, v159
    v_pk_mul_f32 v[88:89], v[88:89], v[208:209] op_sel_hi:[1,0]
    v_pk_mul_f32 v[90:91], v[90:91], v[208:209] op_sel_hi:[1,0]
    ds_write_b64 v242, v[72:73] offset:128
    v_cvt_pk_bf16_f32 v74, v84, v85
    v_cvt_pk_bf16_f32 v75, v86, v87
    v_pk_mul_f32 v[92:93], v[92:93], v[208:209] op_sel_hi:[1,0]
    v_pk_mul_f32 v[94:95], v[94:95], v[208:209] op_sel_hi:[1,0]
    ds_write_b64 v242, v[74:75] offset:160
    v_cvt_pk_bf16_f32 v76, v88, v89
    v_cvt_pk_bf16_f32 v77, v90, v91
    v_mov_b32 v213, v227
    ds_write_b64 v242, v[76:77] offset:192
    v_cvt_pk_bf16_f32 v78, v92, v93
    v_cvt_pk_bf16_f32 v79, v94, v95
    v_permlane32_swap_b32 v213, v227
    ds_write_b64 v242, v[78:79] offset:224
    v_add_f32 v227, v227, v213
    ds_read_b64 v[80:81], v243 offset:0
    v_mov_b32 v213, v227
    ds_read_b64 v[82:83], v245 offset:0
    ds_read_b64 v[84:85], v243 offset:1056
    v_permlane16_swap_b32 v213, v227
    v_add_f32 v227, v227, v213
    ds_read_b64 v[86:87], v245 offset:1056
    ds_read_b64 v[88:89], v243 offset:2112
    v_rcp_f32 v212, v227
    ds_read_b64 v[90:91], v245 offset:2112
    v_pk_mul_f32 v[96:97], v[96:97], v[212:213] op_sel_hi:[1,0]
    ds_read_b64 v[92:93], v243 offset:3168
    v_pk_mul_f32 v[98:99], v[98:99], v[212:213] op_sel_hi:[1,0]
    v_cvt_pk_bf16_f32 v96, v96, v97
    s_waitcnt lgkmcnt(11)
    buffer_store_dwordx4 v[48:51], v239, s[20:23], s67 offen nt
    ds_read_b64 v[94:95], v245 offset:3168
    v_pk_mul_f32 v[100:101], v[100:101], v[212:213] op_sel_hi:[1,0]
    v_pk_mul_f32 v[102:103], v[102:103], v[212:213] op_sel_hi:[1,0]
    v_cvt_pk_bf16_f32 v97, v98, v99
    v_pk_mul_f32 v[104:105], v[104:105], v[212:213] op_sel_hi:[1,0]
    v_pk_mul_f32 v[106:107], v[106:107], v[212:213] op_sel_hi:[1,0]
    ds_write_b64 v242, v[96:97] offset:0
    v_cvt_pk_bf16_f32 v98, v100, v101
    v_cvt_pk_bf16_f32 v99, v102, v103
    v_pk_mul_f32 v[108:109], v[108:109], v[212:213] op_sel_hi:[1,0]
    v_pk_mul_f32 v[110:111], v[110:111], v[212:213] op_sel_hi:[1,0]
    ds_write_b64 v242, v[98:99] offset:32
    v_cvt_pk_bf16_f32 v100, v104, v105
    v_cvt_pk_bf16_f32 v101, v106, v107
    buffer_store_dwordx4 v[52:55], v241, s[20:23], s67 offen nt
    v_pk_mul_f32 v[112:113], v[112:113], v[212:213] op_sel_hi:[1,0]
    v_pk_mul_f32 v[114:115], v[114:115], v[212:213] op_sel_hi:[1,0]
    ds_write_b64 v242, v[100:101] offset:64
    v_cvt_pk_bf16_f32 v102, v108, v109
    v_cvt_pk_bf16_f32 v103, v110, v111
    v_pk_mul_f32 v[116:117], v[116:117], v[212:213] op_sel_hi:[1,0]
    v_pk_mul_f32 v[118:119], v[118:119], v[212:213] op_sel_hi:[1,0]
    ds_write_b64 v242, v[102:103] offset:96
    v_cvt_pk_bf16_f32 v104, v112, v113
    v_cvt_pk_bf16_f32 v105, v114, v115
    v_pk_mul_f32 v[120:121], v[120:121], v[212:213] op_sel_hi:[1,0]
    v_pk_mul_f32 v[122:123], v[122:123], v[212:213] op_sel_hi:[1,0]
    ds_write_b64 v242, v[104:105] offset:128
    v_cvt_pk_bf16_f32 v106, v116, v117
    v_cvt_pk_bf16_f32 v107, v118, v119
    buffer_store_dwordx4 v[56:59], v246, s[20:23], s67 offen nt
    v_pk_mul_f32 v[124:125], v[124:125], v[212:213] op_sel_hi:[1,0]
    v_pk_mul_f32 v[126:127], v[126:127], v[212:213] op_sel_hi:[1,0]
    ds_write_b64 v242, v[106:107] offset:160
    v_cvt_pk_bf16_f32 v108, v120, v121
    v_cvt_pk_bf16_f32 v109, v122, v123
    ds_write_b64 v242, v[108:109] offset:192
    v_cvt_pk_bf16_f32 v110, v124, v125
    v_cvt_pk_bf16_f32 v111, v126, v127
    ds_write_b64 v242, v[110:111] offset:224
    buffer_store_dwordx4 v[60:63], v247, s[20:23], s67 offen nt
    ds_read_b64 v[112:113], v243 offset:0
    ds_read_b64 v[114:115], v245 offset:0
    s_waitcnt lgkmcnt(8)
    buffer_store_dwordx4 v[80:83], v239, s[20:23], s74 offen nt
    ds_read_b64 v[116:117], v243 offset:1056
    ds_read_b64 v[118:119], v245 offset:1056
    buffer_store_dwordx4 v[84:87], v241, s[20:23], s74 offen nt
    ds_read_b64 v[120:121], v243 offset:2112
    ds_read_b64 v[122:123], v245 offset:2112
    v_cmp_nle_f32 s[68:69], v226, s63
    buffer_store_dwordx4 v[88:91], v246, s[20:23], s74 offen nt
    ds_read_b64 v[124:125], v243 offset:3168
    s_or_b64 s[56:57], s[56:57], s[68:69]
    ds_read_b64 v[126:127], v245 offset:3168
    v_cmp_nle_f32 s[68:69], v227, s63
    buffer_store_dwordx4 v[92:95], v247, s[20:23], s74 offen nt
    s_or_b64 s[56:57], s[56:57], s[68:69]
    s_cmp_lg_u64 s[56:57], 0
    s_cselect_b32 s6, 1, 0
    s_lshl_b32 s6, s6, s59
    s_or_b32 s58, s58, s6
    s_mov_b64 s[56:57], 0
    s_add_u32 s59, s59, 1
    s_waitcnt lgkmcnt(6)
    buffer_store_dwordx4 v[112:115], v239, s[20:23], s75 offen nt
    s_waitcnt lgkmcnt(4)
    buffer_store_dwordx4 v[116:119], v241, s[20:23], s75 offen nt
    s_waitcnt lgkmcnt(2)
    buffer_store_dwordx4 v[120:123], v246, s[20:23], s75 offen nt
    s_waitcnt lgkmcnt(0)
    buffer_store_dwordx4 v[124:127], v247, s[20:23], s75 offen nt
    s_branch L_fin
L_tail4_0e:
L_tail4_8:
    v_mfma_f32_16x16x32_bf16 v[144:147], a[96:99], a[32:35], v[208:211]
    ds_read_b64_tr_b16 a[148:149], v231 offset:160
    v_add_f32 v225, v225, v140
    v_mfma_f32_16x16x32_bf16 v[144:147], a[100:103], a[36:39], v[144:147]
    ds_read_b64_tr_b16 a[150:151], v231 offset:672
    v_add_f32 v225, v225, v141
    v_mfma_f32_16x16x32_bf16 v[144:147], a[104:107], a[40:43], v[144:147]
    ds_read_b64_tr_b16 a[152:153], v231 offset:192
    ds_read_b64_tr_b16 a[154:155], v231 offset:704
    v_mfma_f32_16x16x32_bf16 v[144:147], a[108:111], a[44:47], v[144:147]
    v_exp_f32 v142, v142
    v_mfma_f32_16x16x32_bf16 v[148:151], a[112:115], a[32:35], v[208:211]
    ds_read_b64_tr_b16 a[156:157], v231 offset:224
    v_cvt_pk_bf16_f32 v182, v140, v141
    v_mfma_f32_16x16x32_bf16 v[148:151], a[116:119], a[36:39], v[148:151]
    ds_read_b64_tr_b16 a[158:159], v231 offset:736
    v_add_f32 v225, v225, v142
    v_mfma_f32_16x16x32_bf16 v[148:151], a[120:123], a[40:43], v[148:151]
    v_exp_f32 v143, v143
    v_mfma_f32_16x16x32_bf16 v[148:151], a[124:127], a[44:47], v[148:151]
    v_add_f32 v225, v225, v143
    v_cvt_pk_bf16_f32 v183, v142, v143
    v_mfma_f32_16x16x32_bf16 v[152:155], a[96:99], a[48:51], v[212:215]
    v_exp_f32 v144, v144
    v_mfma_f32_16x16x32_bf16 v[152:155], a[100:103], a[52:55], v[152:155]
    v_exp_f32 v145, v145
    v_mfma_f32_16x16x32_bf16 v[152:155], a[104:107], a[56:59], v[152:155]
    ds_read_b128 a[96:99], v230 offset:0
    ds_read_b128 a[100:103], v230 offset:64
    v_mfma_f32_16x16x32_bf16 v[152:155], a[108:111], a[60:63], v[152:155]
    ds_read_b128 a[104:107], v230 offset:128
    v_cvt_pk_bf16_f32 v184, v144, v145
    v_mfma_f32_16x16x32_bf16 v[156:159], a[112:115], a[48:51], v[212:215]
    v_exp_f32 v146, v146
    v_mfma_f32_16x16x32_bf16 v[156:159], a[116:119], a[52:55], v[156:159]
    v_exp_f32 v147, v147
    v_mfma_f32_16x16x32_bf16 v[156:159], a[120:123], a[56:59], v[156:159]
    ds_read_b128 a[108:111], v230 offset:192
    v_cvt_pk_bf16_f32 v185, v146, v147
    v_mfma_f32_16x16x32_bf16 v[156:159], a[124:127], a[60:63], v[156:159]
    s_waitcnt lgkmcnt(4)
    v_exp_f32 v148, v148
    v_mfma_f32_16x16x32_bf16 v[0:3], a[128:131], v[176:179], v[0:3]
    v_exp_f32 v149, v149
    v_mfma_f32_16x16x32_bf16 v[32:35], a[128:131], v[180:183], v[32:35]
    v_exp_f32 v150, v150
    v_mfma_f32_16x16x32_bf16 a[228:231], a[224:227], v[176:179], a[228:231]
    v_exp_f32 v151, v151
    v_mfma_f32_16x16x32_bf16 v[4:7], a[132:135], v[176:179], v[4:7]
    v_cvt_pk_bf16_f32 v186, v148, v149
    v_cvt_pk_bf16_f32 v187, v150, v151
    v_mfma_f32_16x16x32_bf16 v[36:39], a[132:135], v[180:183], v[36:39]
    v_exp_f32 v152, v152
    v_mfma_f32_16x16x32_bf16 v[8:11], a[136:139], v[176:179], v[8:11]
    v_exp_f32 v153, v153
    v_mfma_f32_16x16x32_bf16 v[40:43], a[136:139], v[180:183], v[40:43]
    v_add_f32 v227, v227, v152
    v_add_f32 v227, v227, v153
    v_mfma_f32_16x16x32_bf16 v[12:15], a[140:143], v[176:179], v[12:15]
    v_exp_f32 v154, v154
    v_mfma_f32_16x16x32_bf16 v[44:47], a[140:143], v[180:183], v[44:47]
    v_add_f32 v227, v227, v154
    v_cvt_pk_bf16_f32 v188, v152, v153
    v_mfma_f32_16x16x32_bf16 v[16:19], a[144:147], v[176:179], v[16:19]
    v_exp_f32 v155, v155
    v_mfma_f32_16x16x32_bf16 v[48:51], a[144:147], v[180:183], v[48:51]
    v_cvt_pk_bf16_f32 v189, v154, v155
    v_add_f32 v227, v227, v155
    v_mfma_f32_16x16x32_bf16 v[20:23], a[148:151], v[176:179], v[20:23]
    v_exp_f32 v156, v156
    v_mfma_f32_16x16x32_bf16 v[52:55], a[148:151], v[180:183], v[52:55]
    v_exp_f32 v157, v157
    v_mfma_f32_16x16x32_bf16 v[24:27], a[152:155], v[176:179], v[24:27]
    v_add_f32 v227, v227, v156
    v_add_f32 v227, v227, v157
    v_mfma_f32_16x16x32_bf16 v[56:59], a[152:155], v[180:183], v[56:59]
    v_exp_f32 v158, v158
    v_mfma_f32_16x16x32_bf16 v[28:31], a[156:159], v[176:179], v[28:31]
    s_mov_b32 m0, s27
    v_cvt_pk_bf16_f32 v190, v156, v157
    v_add_f32 v227, v227, v158
    v_mfma_f32_16x16x32_bf16 v[60:63], a[156:159], v[180:183], v[60:63]
    s_waitcnt lgkmcnt(0)
    s_add_u32 s27, s27, 16640
    v_mov_b32 v178, 0
    v_mfma_f32_16x16x32_bf16 v[128:131], a[96:99], a[0:3], v[200:203]
    s_cmp_eq_u32 s27, s29
    v_exp_f32 v159, v159
    v_mfma_f32_16x16x32_bf16 v[128:131], a[100:103], a[4:7], v[128:131]
    s_cselect_b32 s27, s28, s27
    v_cvt_pk_bf16_f32 v191, v158, v159
    v_add_f32 v227, v227, v159
    v_mfma_f32_16x16x32_bf16 v[128:131], a[104:107], a[8:11], v[128:131]
    s_waitcnt vmcnt(10)
    v_mov_b32 v179, 0
    v_mov_b32 v182, 0
    v_mfma_f32_16x16x32_bf16 v[128:131], a[108:111], a[12:15], v[128:131]
    s_barrier
    v_mfma_f32_16x16x32_bf16 v[136:139], a[96:99], a[16:19], v[204:207]
    s_add_u32 s66, s33, 0
    v_add_u32 v231, s27, v233
    v_add_u32 v230, s27, v232
    v_mfma_f32_16x16x32_bf16 v[136:139], a[100:103], a[20:23], v[136:139]
    s_add_u32 s67, s33, 65536
    v_mov_b32 v183, 0
    v_mfma_f32_16x16x32_bf16 v[136:139], a[104:107], a[24:27], v[136:139]
    s_add_u32 s74, s33, 131072
    v_exp_f32 v128, v128
    v_mfma_f32_16x16x32_bf16 v[136:139], a[108:111], a[28:31], v[136:139]
    s_add_u32 s75, s33, 196608
    v_exp_f32 v129, v129
    v_mfma_f32_16x16x32_bf16 v[64:67], a[128:131], v[184:187], v[64:67]
    v_cndmask_b32 v129, 0, v129, s[42:43]
    v_cndmask_b32 v128, 0, v128, s[40:41]
    v_mfma_f32_16x16x32_bf16 v[96:99], a[128:131], v[188:191], v[96:99]
    ds_read_b64_tr_b16 a[128:129], v231 offset:0
    v_cvt_pk_bf16_f32 v176, v128, v129
    v_mfma_f32_16x16x32_bf16 a[236:239], a[224:227], v[184:187], a[236:239]
    v_exp_f32 v131, v131
    v_mfma_f32_16x16x32_bf16 v[68:71], a[132:135], v[184:187], v[68:71]
    ds_read_b64_tr_b16 a[130:131], v231 offset:512
    v_cndmask_b32 v131, 0, v131, s[46:47]
    v_mfma_f32_16x16x32_bf16 v[100:103], a[132:135], v[188:191], v[100:103]
    v_exp_f32 v130, v130
    v_mfma_f32_16x16x32_bf16 v[72:75], a[136:139], v[184:187], v[72:75]
    ds_read_b64_tr_b16 a[132:133], v231 offset:32
    v_cndmask_b32 v130, 0, v130, s[44:45]
    v_mfma_f32_16x16x32_bf16 v[104:107], a[136:139], v[188:191], v[104:107]
    ds_read_b64_tr_b16 a[134:135], v231 offset:544
    v_cvt_pk_bf16_f32 v177, v130, v131
    v_mfma_f32_16x16x32_bf16 v[76:79], a[140:143], v[184:187], v[76:79]
    v_exp_f32 v136, v136
    v_mfma_f32_16x16x32_bf16 v[108:111], a[140:143], v[188:191], v[108:111]
    ds_read_b64_tr_b16 a[136:137], v231 offset:64
    ds_read_b64_tr_b16 a[138:139], v231 offset:576
    v_mfma_f32_16x16x32_bf16 v[80:83], a[144:147], v[184:187], v[80:83]
    ds_read_b64_tr_b16 a[140:141], v231 offset:96
    ds_read_b64_tr_b16 a[142:143], v231 offset:608
    v_mfma_f32_16x16x32_bf16 v[112:115], a[144:147], v[188:191], v[112:115]
    ds_read_b64_tr_b16 a[144:145], v231 offset:128
    ds_read_b64_tr_b16 a[146:147], v231 offset:640
    v_mfma_f32_16x16x32_bf16 v[84:87], a[148:151], v[184:187], v[84:87]
    v_exp_f32 v137, v137
    v_mfma_f32_16x16x32_bf16 v[116:119], a[148:151], v[188:191], v[116:119]
    ds_read_b64_tr_b16 a[148:149], v231 offset:160
    ds_read_b64_tr_b16 a[150:151], v231 offset:672
    v_mfma_f32_16x16x32_bf16 v[88:91], a[152:155], v[184:187], v[88:91]
    v_cndmask_b32 v136, 0, v136, s[40:41]
    v_add_f32 v225, v225, v136
    v_mfma_f32_16x16x32_bf16 v[120:123], a[152:155], v[188:191], v[120:123]
    ds_read_b64_tr_b16 a[152:153], v231 offset:192
    ds_read_b64_tr_b16 a[154:155], v231 offset:704
    v_mfma_f32_16x16x32_bf16 v[92:95], a[156:159], v[184:187], v[92:95]
    v_cndmask_b32 v137, 0, v137, s[42:43]
    v_cvt_pk_bf16_f32 v180, v136, v137
    v_mfma_f32_16x16x32_bf16 v[124:127], a[156:159], v[188:191], v[124:127]
    ds_read_b64_tr_b16 a[156:157], v231 offset:224
    ds_read_b64_tr_b16 a[158:159], v231 offset:736
    v_add_f32 v225, v225, v137
    v_mfma_f32_16x16x32_bf16 v[144:147], a[96:99], a[32:35], v[208:211]
    v_exp_f32 v138, v138
    v_mfma_f32_16x16x32_bf16 v[144:147], a[100:103], a[36:39], v[144:147]
    v_cndmask_b32 v138, 0, v138, s[44:45]
    v_exp_f32 v139, v139
    v_mfma_f32_16x16x32_bf16 v[144:147], a[104:107], a[40:43], v[144:147]
    v_add_f32 v225, v225, v138
    v_cndmask_b32 v139, 0, v139, s[46:47]
    v_add_f32 v225, v225, v139
    v_mfma_f32_16x16x32_bf16 v[144:147], a[108:111], a[44:47], v[144:147]
    v_mov_b32 v205, v225
    v_cvt_pk_bf16_f32 v181, v138, v139
    v_mov_b32 v186, 0
    v_mfma_f32_16x16x32_bf16 v[152:155], a[96:99], a[48:51], v[212:215]
    v_permlane32_swap_b32 v205, v225
    v_add_f32 v225, v225, v205
    v_mov_b32 v205, v225
    v_mfma_f32_16x16x32_bf16 v[152:155], a[100:103], a[52:55], v[152:155]
    v_mov_b32 v187, 0
    v_permlane16_swap_b32 v205, v225
    v_add_f32 v225, v225, v205
    v_mfma_f32_16x16x32_bf16 v[152:155], a[104:107], a[56:59], v[152:155]
    v_rcp_f32 v204, v225
    v_mov_b32 v190, 0
    v_mfma_f32_16x16x32_bf16 v[152:155], a[108:111], a[60:63], v[152:155]
    s_waitcnt lgkmcnt(0)
    v_exp_f32 v144, v144
    v_mfma_f32_16x16x32_bf16 v[0:3], a[128:131], v[176:179], v[0:3]
    v_cndmask_b32 v144, 0, v144, s[40:41]
    v_mov_b32 v191, 0
    v_mfma_f32_16x16x32_bf16 v[32:35], a[128:131], v[180:183], v[32:35]
    v_exp_f32 v145, v145
    v_mfma_f32_16x16x32_bf16 a[228:231], a[224:227], v[176:179], a[228:231]
    v_exp_f32 v152, v152
    v_cndmask_b32 v145, 0, v145, s[42:43]
    v_mfma_f32_16x16x32_bf16 v[4:7], a[132:135], v[176:179], v[4:7]
    v_cndmask_b32 v152, 0, v152, s[40:41]
    v_exp_f32 v153, v153
    v_mfma_f32_16x16x32_bf16 v[36:39], a[132:135], v[180:183], v[36:39]
    v_add_f32 v227, v227, v152
    v_cndmask_b32 v153, 0, v153, s[42:43]
    v_accvgpr_read_b32 v224, a228
    v_mfma_f32_16x16x32_bf16 v[8:11], a[136:139], v[176:179], v[8:11]
    v_rcp_f32 v200, v224
    v_add_f32 v227, v227, v153
    v_mfma_f32_16x16x32_bf16 v[40:43], a[136:139], v[180:183], v[40:43]
    v_exp_f32 v154, v154
    v_mfma_f32_16x16x32_bf16 v[12:15], a[140:143], v[176:179], v[12:15]
    v_cndmask_b32 v154, 0, v154, s[44:45]
    v_add_f32 v227, v227, v154
    v_mfma_f32_16x16x32_bf16 v[44:47], a[140:143], v[180:183], v[44:47]
    v_exp_f32 v155, v155
    v_mfma_f32_16x16x32_bf16 v[16:19], a[144:147], v[176:179], v[16:19]
    v_cndmask_b32 v155, 0, v155, s[46:47]
    v_cvt_pk_bf16_f32 v184, v144, v145
    v_mfma_f32_16x16x32_bf16 v[48:51], a[144:147], v[180:183], v[48:51]
    v_add_f32 v227, v227, v155
    v_exp_f32 v146, v146
    v_mfma_f32_16x16x32_bf16 v[20:23], a[148:151], v[176:179], v[20:23]
    v_mov_b32 v213, v227
    v_cndmask_b32 v146, 0, v146, s[44:45]
    v_cvt_pk_bf16_f32 v188, v152, v153
    v_mfma_f32_16x16x32_bf16 v[52:55], a[148:151], v[180:183], v[52:55]
    v_permlane32_swap_b32 v213, v227
    v_exp_f32 v147, v147
    v_mfma_f32_16x16x32_bf16 v[24:27], a[152:155], v[176:179], v[24:27]
    v_add_f32 v227, v227, v213
    v_cndmask_b32 v147, 0, v147, s[46:47]
    v_mov_b32 v213, v227
    v_mfma_f32_16x16x32_bf16 v[56:59], a[152:155], v[180:183], v[56:59]
    v_cvt_pk_bf16_f32 v185, v146, v147
    v_permlane16_swap_b32 v213, v227
    v_add_f32 v227, v227, v213
    v_mfma_f32_16x16x32_bf16 v[28:31], a[156:159], v[176:179], v[28:31]
    v_rcp_f32 v212, v227
    v_cvt_pk_bf16_f32 v189, v154, v155
    v_mfma_f32_16x16x32_bf16 v[60:63], a[156:159], v[180:183], v[60:63]
    v_pk_mul_f32 v[0:1], v[0:1], v[200:201] op_sel_hi:[1,0]
    v_pk_mul_f32 v[2:3], v[2:3], v[200:201] op_sel_hi:[1,0]
    v_cvt_pk_bf16_f32 v0, v0, v1
    v_pk_mul_f32 v[4:5], v[4:5], v[200:201] op_sel_hi:[1,0]
    v_pk_mul_f32 v[6:7], v[6:7], v[200:201] op_sel_hi:[1,0]
    v_pk_mul_f32 v[8:9], v[8:9], v[200:201] op_sel_hi:[1,0]
    v_pk_mul_f32 v[10:11], v[10:11], v[200:201] op_sel_hi:[1,0]
    v_pk_mul_f32 v[12:13], v[12:13], v[200:201] op_sel_hi:[1,0]
    v_pk_mul_f32 v[14:15], v[14:15], v[200:201] op_sel_hi:[1,0]
    v_pk_mul_f32 v[16:17], v[16:17], v[200:201] op_sel_hi:[1,0]
    v_pk_mul_f32 v[18:19], v[18:19], v[200:201] op_sel_hi:[1,0]
    v_pk_mul_f32 v[20:21], v[20:21], v[200:201] op_sel_hi:[1,0]
    v_pk_mul_f32 v[22:23], v[22:23], v[200:201] op_sel_hi:[1,0]
    v_pk_mul_f32 v[24:25], v[24:25], v[200:201] op_sel_hi:[1,0]
    v_pk_mul_f32 v[26:27], v[26:27], v[200:201] op_sel_hi:[1,0]
    v_pk_mul_f32 v[28:29], v[28:29], v[200:201] op_sel_hi:[1,0]
    v_pk_mul_f32 v[30:31], v[30:31], v[200:201] op_sel_hi:[1,0]
    v_pk_mul_f32 v[32:33], v[32:33], v[204:205] op_sel_hi:[1,0]
    v_pk_mul_f32 v[34:35], v[34:35], v[204:205] op_sel_hi:[1,0]
    v_pk_mul_f32 v[36:37], v[36:37], v[204:205] op_sel_hi:[1,0]
    v_pk_mul_f32 v[38:39], v[38:39], v[204:205] op_sel_hi:[1,0]
    v_pk_mul_f32 v[40:41], v[40:41], v[204:205] op_sel_hi:[1,0]
    v_pk_mul_f32 v[42:43], v[42:43], v[204:205] op_sel_hi:[1,0]
    v_pk_mul_f32 v[44:45], v[44:45], v[204:205] op_sel_hi:[1,0]
    v_pk_mul_f32 v[46:47], v[46:47], v[204:205] op_sel_hi:[1,0]
    v_pk_mul_f32 v[48:49], v[48:49], v[204:205] op_sel_hi:[1,0]
    v_pk_mul_f32 v[50:51], v[50:51], v[204:205] op_sel_hi:[1,0]
    v_pk_mul_f32 v[52:53], v[52:53], v[204:205] op_sel_hi:[1,0]
    v_pk_mul_f32 v[54:55], v[54:55], v[204:205] op_sel_hi:[1,0]
    v_pk_mul_f32 v[56:57], v[56:57], v[204:205] op_sel_hi:[1,0]
    v_pk_mul_f32 v[58:59], v[58:59], v[204:205] op_sel_hi:[1,0]
    v_pk_mul_f32 v[60:61], v[60:61], v[204:205] op_sel_hi:[1,0]
    v_pk_mul_f32 v[62:63], v[62:63], v[204:205] op_sel_hi:[1,0]
    v_mfma_f32_16x16x32_bf16 v[64:67], a[128:131], v[184:187], v[64:67]
    v_cvt_pk_bf16_f32 v1, v2, v3
    v_cvt_pk_bf16_f32 v2, v4, v5
    v_cvt_pk_bf16_f32 v3, v6, v7
    v_mfma_f32_16x16x32_bf16 v[96:99], a[128:131], v[188:191], v[96:99]
    ds_write_b64 v242, v[0:1] offset:0
    ds_write_b64 v242, v[2:3] offset:32
    v_cvt_pk_bf16_f32 v4, v8, v9
    v_mfma_f32_16x16x32_bf16 a[236:239], a[224:227], v[184:187], a[236:239]
    v_cvt_pk_bf16_f32 v5, v10, v11
    v_cvt_pk_bf16_f32 v6, v12, v13
    v_cvt_pk_bf16_f32 v7, v14, v15
    v_mfma_f32_16x16x32_bf16 v[68:71], a[132:135], v[184:187], v[68:71]
    ds_write_b64 v242, v[4:5] offset:64
    ds_write_b64 v242, v[6:7] offset:96
    v_cvt_pk_bf16_f32 v8, v16, v17
    v_mfma_f32_16x16x32_bf16 v[100:103], a[132:135], v[188:191], v[100:103]
    v_cvt_pk_bf16_f32 v9, v18, v19
    v_cvt_pk_bf16_f32 v10, v20, v21
    v_cvt_pk_bf16_f32 v11, v22, v23
    v_mfma_f32_16x16x32_bf16 v[72:75], a[136:139], v[184:187], v[72:75]
    ds_write_b64 v242, v[8:9] offset:128
    ds_write_b64 v242, v[10:11] offset:160
    v_cvt_pk_bf16_f32 v12, v24, v25
    v_mfma_f32_16x16x32_bf16 v[104:107], a[136:139], v[188:191], v[104:107]
    v_cvt_pk_bf16_f32 v13, v26, v27
    v_cvt_pk_bf16_f32 v14, v28, v29
    v_cvt_pk_bf16_f32 v15, v30, v31
    v_mfma_f32_16x16x32_bf16 v[76:79], a[140:143], v[184:187], v[76:79]
    ds_write_b64 v242, v[12:13] offset:192
    ds_write_b64 v242, v[14:15] offset:224
    ds_read_b64 v[16:17], v243 offset:0
    v_mfma_f32_16x16x32_bf16 v[108:111], a[140:143], v[188:191], v[108:111]
    ds_read_b64 v[18:19], v245 offset:0
    ds_read_b64 v[20:21], v243 offset:1056
    ds_read_b64 v[22:23], v245 offset:1056
    v_mfma_f32_16x16x32_bf16 v[80:83], a[144:147], v[184:187], v[80:83]
    ds_read_b64 v[24:25], v243 offset:2112
    ds_read_b64 v[26:27], v245 offset:2112
    ds_read_b64 v[28:29], v243 offset:3168
    v_mfma_f32_16x16x32_bf16 v[112:115], a[144:147], v[188:191], v[112:115]
    ds_read_b64 v[30:31], v245 offset:3168
    v_cvt_pk_bf16_f32 v32, v32, v33
    v_cvt_pk_bf16_f32 v33, v34, v35
    v_mfma_f32_16x16x32_bf16 v[84:87], a[148:151], v[184:187], v[84:87]
    ds_write_b64 v242, v[32:33] offset:0
    v_cvt_pk_bf16_f32 v34, v36, v37
    v_cvt_pk_bf16_f32 v35, v38, v39
    v_mfma_f32_16x16x32_bf16 v[116:119], a[148:151], v[188:191], v[116:119]
    ds_write_b64 v242, v[34:35] offset:32
    v_cvt_pk_bf16_f32 v36, v40, v41
    v_cvt_pk_bf16_f32 v37, v42, v43
    v_mfma_f32_16x16x32_bf16 v[88:91], a[152:155], v[184:187], v[88:91]
    ds_write_b64 v242, v[36:37] offset:64
    v_cvt_pk_bf16_f32 v38, v44, v45
    v_cvt_pk_bf16_f32 v39, v46, v47
    v_mfma_f32_16x16x32_bf16 v[120:123], a[152:155], v[188:191], v[120:123]
    ds_write_b64 v242, v[38:39] offset:96
    v_cvt_pk_bf16_f32 v40, v48, v49
    v_cvt_pk_bf16_f32 v41, v50, v51
    v_mfma_f32_16x16x32_bf16 v[92:95], a[156:159], v[184:187], v[92:95]
    s_waitcnt lgkmcnt(5)
    buffer_store_dwordx4 v[16:19], v239, s[20:23], s66 offen nt
    v_mfma_f32_16x16x32_bf16 v[124:127], a[156:159], v[188:191], v[124:127]
    buffer_store_dwordx4 v[20:23], v241, s[20:23], s66 offen nt
    ds_write_b64 v242, v[40:41] offset:128
    v_cvt_pk_bf16_f32 v42, v52, v53
    v_cvt_pk_bf16_f32 v43, v54, v55
    ds_write_b64 v242, v[42:43] offset:160
    v_cvt_pk_bf16_f32 v44, v56, v57
    v_cvt_pk_bf16_f32 v45, v58, v59
    ds_write_b64 v242, v[44:45] offset:192
    v_cvt_pk_bf16_f32 v46, v60, v61
    v_cvt_pk_bf16_f32 v47, v62, v63
    ds_write_b64 v242, v[46:47] offset:224
    ds_read_b64 v[48:49], v243 offset:0
    ds_read_b64 v[50:51], v245 offset:0
    ds_read_b64 v[52:53], v243 offset:1056
    v_accvgpr_read_b32 v226, a236
    ds_read_b64 v[54:55], v245 offset:1056
    ds_read_b64 v[56:57], v243 offset:2112
    v_rcp_f32 v208, v226
    ds_read_b64 v[58:59], v245 offset:2112
    v_pk_mul_f32 v[64:65], v[64:65], v[208:209] op_sel_hi:[1,0]
    ds_read_b64 v[60:61], v243 offset:3168
    v_pk_mul_f32 v[66:67], v[66:67], v[208:209] op_sel_hi:[1,0]
    v_cvt_pk_bf16_f32 v64, v64, v65
    ds_read_b64 v[62:63], v245 offset:3168
    v_pk_mul_f32 v[68:69], v[68:69], v[208:209] op_sel_hi:[1,0]
    v_pk_mul_f32 v[70:71], v[70:71], v[208:209] op_sel_hi:[1,0]
    v_cvt_pk_bf16_f32 v65, v66, v67
    v_pk_mul_f32 v[72:73], v[72:73], v[208:209] op_sel_hi:[1,0]
    v_pk_mul_f32 v[74:75], v[74:75], v[208:209] op_sel_hi:[1,0]
    ds_write_b64 v242, v[64:65] offset:0
    v_cvt_pk_bf16_f32 v66, v68, v69
    v_cvt_pk_bf16_f32 v67, v70, v71
    v_pk_mul_f32 v[76:77], v[76:77], v[208:209] op_sel_hi:[1,0]
    v_pk_mul_f32 v[78:79], v[78:79], v[208:209] op_sel_hi:[1,0]
    ds_write_b64 v242, v[66:67] offset:32
    v_cvt_pk_bf16_f32 v68, v72, v73
    v_cvt_pk_bf16_f32 v69, v74, v75
    v_pk_mul_f32 v[80:81], v[80:81], v[208:209] op_sel_hi:[1,0]
    v_pk_mul_f32 v[82:83], v[82:83], v[208:209] op_sel_hi:[1,0]
    ds_write_b64 v242, v[68:69] offset:64
    v_cvt_pk_bf16_f32 v70, v76, v77
    v_cvt_pk_bf16_f32 v71, v78, v79
    v_pk_mul_f32 v[84:85], v[84:85], v[208:209] op_sel_hi:[1,0]
    v_pk_mul_f32 v[86:87], v[86:87], v[208:209] op_sel_hi:[1,0]
    ds_write_b64 v242, v[70:71] offset:96
    v_cvt_pk_bf16_f32 v72, v80, v81
    v_cvt_pk_bf16_f32 v73, v82, v83
    v_pk_mul_f32 v[88:89], v[88:89], v[208:209] op_sel_hi:[1,0]
    v_pk_mul_f32 v[90:91], v[90:91], v[208:209] op_sel_hi:[1,0]
    ds_write_b64 v242, v[72:73] offset:128
    v_cvt_pk_bf16_f32 v74, v84, v85
    v_cvt_pk_bf16_f32 v75, v86, v87
    v_pk_mul_f32 v[92:93], v[92:93], v[208:209] op_sel_hi:[1,0]
    v_pk_mul_f32 v[94:95], v[94:95], v[208:209] op_sel_hi:[1,0]
    ds_write_b64 v242, v[74:75] offset:160
    v_cvt_pk_bf16_f32 v76, v88, v89
    v_cvt_pk_bf16_f32 v77, v90, v91
    ds_write_b64 v242, v[76:77] offset:192
    v_cvt_pk_bf16_f32 v78, v92, v93
    v_cvt_pk_bf16_f32 v79, v94, v95
    ds_write_b64 v242, v[78:79] offset:224
    ds_read_b64 v[80:81], v243 offset:0
    buffer_store_dwordx4 v[24:27], v246, s[20:23], s66 offen nt
    ds_read_b64 v[82:83], v245 offset:0
    ds_read_b64 v[84:85], v243 offset:1056
    ds_read_b64 v[86:87], v245 offset:1056
    s_waitcnt lgkmcnt(10)
    buffer_store_dwordx4 v[28:31], v247, s[20:23], s66 offen nt
    ds_read_b64 v[88:89], v243 offset:2112
    ds_read_b64 v[90:91], v245 offset:2112
    v_pk_mul_f32 v[96:97], v[96:97], v[212:213] op_sel_hi:[1,0]
    ds_read_b64 v[92:93], v243 offset:3168
    v_pk_mul_f32 v[98:99], v[98:99], v[212:213] op_sel_hi:[1,0]
    v_cvt_pk_bf16_f32 v96, v96, v97
    buffer_store_dwordx4 v[48:51], v239, s[20:23], s67 offen nt
    ds_read_b64 v[94:95], v245 offset:3168
    v_pk_mul_f32 v[100:101], v[100:101], v[212:213] op_sel_hi:[1,0]
    v_pk_mul_f32 v[102:103], v[102:103], v[212:213] op_sel_hi:[1,0]
    v_cvt_pk_bf16_f32 v97, v98, v99
    v_pk_mul_f32 v[104:105], v[104:105], v[212:213] op_sel_hi:[1,0]
    v_pk_mul_f32 v[106:107], v[106:107], v[212:213] op_sel_hi:[1,0]
    ds_write_b64 v242, v[96:97] offset:0
    v_cvt_pk_bf16_f32 v98, v100, v101
    v_cvt_pk_bf16_f32 v99, v102, v103
    v_pk_mul_f32 v[108:109], v[108:109], v[212:213] op_sel_hi:[1,0]
    v_pk_mul_f32 v[110:111], v[110:111], v[212:213] op_sel_hi:[1,0]
    ds_write_b64 v242, v[98:99] offset:32
    v_cvt_pk_bf16_f32 v100, v104, v105
    v_cvt_pk_bf16_f32 v101, v106, v107
    buffer_store_dwordx4 v[52:55], v241, s[20:23], s67 offen nt
    v_pk_mul_f32 v[112:113], v[112:113], v[212:213] op_sel_hi:[1,0]
    v_pk_mul_f32 v[114:115], v[114:115], v[212:213] op_sel_hi:[1,0]
    ds_write_b64 v242, v[100:101] offset:64
    v_cvt_pk_bf16_f32 v102, v108, v109
    v_cvt_pk_bf16_f32 v103, v110, v111
    v_pk_mul_f32 v[116:117], v[116:117], v[212:213] op_sel_hi:[1,0]
    v_pk_mul_f32 v[118:119], v[118:119], v[212:213] op_sel_hi:[1,0]
    ds_write_b64 v242, v[102:103] offset:96
    v_cvt_pk_bf16_f32 v104, v112, v113
    v_cvt_pk_bf16_f32 v105, v114, v115
    v_pk_mul_f32 v[120:121], v[120:121], v[212:213] op_sel_hi:[1,0]
    v_pk_mul_f32 v[122:123], v[122:123], v[212:213] op_sel_hi:[1,0]
    ds_write_b64 v242, v[104:105] offset:128
    v_cvt_pk_bf16_f32 v106, v116, v117
    v_cvt_pk_bf16_f32 v107, v118, v119
    buffer_store_dwordx4 v[56:59], v246, s[20:23], s67 offen nt
    v_pk_mul_f32 v[124:125], v[124:125], v[212:213] op_sel_hi:[1,0]
    v_pk_mul_f32 v[126:127], v[126:127], v[212:213] op_sel_hi:[1,0]
    ds_write_b64 v242, v[106:107] offset:160
    v_cvt_pk_bf16_f32 v108, v120, v121
    v_cvt_pk_bf16_f32 v109, v122, v123
    v_cmp_nle_f32 s[68:69], v224, s63
    ds_write_b64 v242, v[108:109] offset:192
    v_cvt_pk_bf16_f32 v110, v124, v125
    v_cvt_pk_bf16_f32 v111, v126, v127
    ds_write_b64 v242, v[110:111] offset:224
    s_or_b64 s[56:57], s[56:57], s[68:69]
    buffer_store_dwordx4 v[60:63], v247, s[20:23], s67 offen nt
    ds_read_b64 v[112:113], v243 offset:0
    ds_read_b64 v[114:115], v245 offset:0
    s_waitcnt lgkmcnt(8)
    buffer_store_dwordx4 v[80:83], v239, s[20:23], s74 offen nt
    ds_read_b64 v[116:117], v243 offset:1056
    ds_read_b64 v[118:119], v245 offset:1056
    v_cmp_nle_f32 s[68:69], v225, s63
    buffer_store_dwordx4 v[84:87], v241, s[20:23], s74 offen nt
    ds_read_b64 v[120:121], v243 offset:2112
    s_or_b64 s[56:57], s[56:57], s[68:69]
    ds_read_b64 v[122:123], v245 offset:2112
    v_cmp_nle_f32 s[68:69], v226, s63
    buffer_store_dwordx4 v[88:91], v246, s[20:23], s74 offen nt
    ds_read_b64 v[124:125], v243 offset:3168
    s_or_b64 s[56:57], s[56:57], s[68:69]
    ds_read_b64 v[126:127], v245 offset:3168
    v_cmp_nle_f32 s[68:69], v227, s63
    buffer_store_dwordx4 v[92:95], v247, s[20:23], s74 offen nt
    s_or_b64 s[56:57], s[56:57], s[68:69]
    s_cmp_lg_u64 s[56:57], 0
    s_cselect_b32 s6, 1, 0
    s_lshl_b32 s6, s6, s59
    s_or_b32 s58, s58, s6
    s_mov_b64 s[56:57], 0
    s_add_u32 s59, s59, 1
    s_waitcnt lgkmcnt(6)
    buffer_store_dwordx4 v[112:115], v239, s[20:23], s75 offen nt
    s_waitcnt lgkmcnt(4)
    buffer_store_dwordx4 v[116:119], v241, s[20:23], s75 offen nt
    s_waitcnt lgkmcnt(2)
    buffer_store_dwordx4 v[120:123], v246, s[20:23], s75 offen nt
    s_waitcnt lgkmcnt(0)
    buffer_store_dwordx4 v[124:127], v247, s[20:23], s75 offen nt
    s_branch L_fin
L_tail4_8e:
L_tail4_10:
    v_mfma_f32_16x16x32_bf16 v[144:147], a[96:99], a[32:35], v[208:211]
    s_mov_b32 s70, m0
    ds_read_b64_tr_b16 a[148:149], v231 offset:160
    v_add_f32 v225, v225, v140
    v_mfma_f32_16x16x32_bf16 v[144:147], a[100:103], a[36:39], v[144:147]
    ds_read_b64_tr_b16 a[150:151], v231 offset:672
    v_add_f32 v225, v225, v141
    v_mfma_f32_16x16x32_bf16 v[144:147], a[104:107], a[40:43], v[144:147]
    s_mov_b32 m0, s70
    ds_read_b64_tr_b16 a[152:153], v231 offset:192
    ds_read_b64_tr_b16 a[154:155], v231 offset:704
    v_mfma_f32_16x16x32_bf16 v[144:147], a[108:111], a[44:47], v[144:147]
    buffer_load_dwordx4 v234, s[8:11], s24 offen lds
    v_mfma_f32_16x16x32_bf16 v[148:151], a[112:115], a[32:35], v[208:211]
    v_exp_f32 v142, v142
    v_mfma_f32_16x16x32_bf16 v[148:151], a[116:119], a[36:39], v[148:151]
    ds_read_b64_tr_b16 a[156:157], v231 offset:224
    v_cvt_pk_bf16_f32 v182, v140, v141
    v_mfma_f32_16x16x32_bf16 v[148:151], a[120:123], a[40:43], v[148:151]
    ds_read_b64_tr_b16 a[158:159], v231 offset:736
    v_add_f32 v225, v225, v142
    v_mfma_f32_16x16x32_bf16 v[148:151], a[124:127], a[44:47], v[148:151]
    v_exp_f32 v143, v143
    v_mfma_f32_16x16x32_bf16 v[152:155], a[96:99], a[48:51], v[212:215]
    ds_read_b128 a[96:99], v230 offset:0
    v_add_f32 v225, v225, v143
    v_mfma_f32_16x16x32_bf16 v[152:155], a[100:103], a[52:55], v[152:155]
    ds_read_b128 a[100:103], v230 offset:64
    v_cvt_pk_bf16_f32 v183, v142, v143
    v_mfma_f32_16x16x32_bf16 v[152:155], a[104:107], a[56:59], v[152:155]
    v_exp_f32 v144, v144
    v_mfma_f32_16x16x32_bf16 v[152:155], a[108:111], a[60:63], v[152:155]
    v_exp_f32 v145, v145
    v_mfma_f32_16x16x32_bf16 v[156:159], a[112:115], a[48:51], v[212:215]
    ds_read_b128 a[104:107], v230 offset:128
    v_cvt_pk_bf16_f32 v184, v144, v145
    v_mfma_f32_16x16x32_bf16 v[156:159], a[116:119], a[52:55], v[156:159]
    v_exp_f32 v146, v146
    v_mfma_f32_16x16x32_bf16 v[156:159], a[120:123], a[56:59], v[156:159]
    v_exp_f32 v147, v147
    v_mfma_f32_16x16x32_bf16 v[156:159], a[124:127], a[60:63], v[156:159]
    s_waitcnt lgkmcnt(1)
    ds_read_b128 a[108:111], v230 offset:192
    v_cvt_pk_bf16_f32 v185, v146, v147
    v_mfma_f32_16x16x32_bf16 v[0:3], a[128:131], v[176:179], v[0:3]
    s_mov_b32 m0, s70
    v_exp_f32 v148, v148
    v_mfma_f32_16x16x32_bf16 v[32:35], a[128:131], v[180:183], v[32:35]
    buffer_load_dwordx4 v235, s[8:11], s24 offen offset:1024 lds
    v_mfma_f32_16x16x32_bf16 a[228:231], a[224:227], v[176:179], a[228:231]
    s_add_u32 s24, s24, 131072
    s_sub_u32 s3, s3, 1
    v_sub_u32 v244, s38, v240
    v_mfma_f32_16x16x32_bf16 v[4:7], a[132:135], v[176:179], v[4:7]
    v_exp_f32 v149, v149
    v_mfma_f32_16x16x32_bf16 v[36:39], a[132:135], v[180:183], v[36:39]
    v_exp_f32 v150, v150
    v_mfma_f32_16x16x32_bf16 v[8:11], a[136:139], v[176:179], v[8:11]
    v_cvt_pk_bf16_f32 v186, v148, v149
    v_cmp_gt_i32 s[48:49], v244, 16
    v_mfma_f32_16x16x32_bf16 v[40:43], a[136:139], v[180:183], v[40:43]
    v_exp_f32 v151, v151
    v_mfma_f32_16x16x32_bf16 v[12:15], a[140:143], v[176:179], v[12:15]
    v_cvt_pk_bf16_f32 v187, v150, v151
    v_cmp_gt_i32 s[50:51], v244, 17
    v_mfma_f32_16x16x32_bf16 v[44:47], a[140:143], v[180:183], v[44:47]
    v_exp_f32 v152, v152
    v_mfma_f32_16x16x32_bf16 v[16:19], a[144:147], v[176:179], v[16:19]
    v_add_f32 v227, v227, v152
    v_cmp_gt_i32 s[52:53], v244, 18
    v_mfma_f32_16x16x32_bf16 v[48:51], a[144:147], v[180:183], v[48:51]
    v_exp_f32 v153, v153
    v_mfma_f32_16x16x32_bf16 v[20:23], a[148:151], v[176:179], v[20:23]
    v_add_f32 v227, v227, v153
    v_cvt_pk_bf16_f32 v188, v152, v153
    v_mfma_f32_16x16x32_bf16 v[52:55], a[148:151], v[180:183], v[52:55]
    v_exp_f32 v154, v154
    v_mfma_f32_16x16x32_bf16 v[24:27], a[152:155], v[176:179], v[24:27]
    v_add_f32 v227, v227, v154
    v_cmp_gt_i32 s[54:55], v244, 19
    v_mfma_f32_16x16x32_bf16 v[56:59], a[152:155], v[180:183], v[56:59]
    v_exp_f32 v155, v155
    v_mfma_f32_16x16x32_bf16 v[28:31], a[156:159], v[176:179], v[28:31]
    s_mov_b32 s70, s27
    v_cvt_pk_bf16_f32 v189, v154, v155
    v_add_f32 v227, v227, v155
    v_mfma_f32_16x16x32_bf16 v[60:63], a[156:159], v[180:183], v[60:63]
    s_add_u32 s27, s27, 16640
    v_exp_f32 v156, v156
    v_mfma_f32_16x16x32_bf16 v[128:131], a[96:99], a[0:3], v[200:203]
    s_cmp_eq_u32 s27, s29
    v_add_f32 v227, v227, v156
    v_mov_b32 v178, 0
    v_mfma_f32_16x16x32_bf16 v[128:131], a[100:103], a[4:7], v[128:131]
    s_waitcnt lgkmcnt(0)
    s_cselect_b32 s27, s28, s27
    v_exp_f32 v157, v157
    v_mfma_f32_16x16x32_bf16 v[128:131], a[104:107], a[8:11], v[128:131]
    s_waitcnt vmcnt(12)
    v_add_f32 v227, v227, v157
    v_cvt_pk_bf16_f32 v190, v156, v157
    v_mfma_f32_16x16x32_bf16 v[128:131], a[108:111], a[12:15], v[128:131]
    s_barrier
    v_mfma_f32_16x16x32_bf16 v[136:139], a[96:99], a[16:19], v[204:207]
    s_mov_b32 m0, s70
    v_add_u32 v231, s27, v233
    v_add_u32 v230, s27, v232
    v_mov_b32 v179, 0
    v_mfma_f32_16x16x32_bf16 v[136:139], a[100:103], a[20:23], v[136:139]
    buffer_load_dwordx4 v236, s[12:15], s25 offen offset:2048 lds
    v_mfma_f32_16x16x32_bf16 v[136:139], a[104:107], a[24:27], v[136:139]
    v_exp_f32 v158, v158
    v_mov_b32 v182, 0
    v_mfma_f32_16x16x32_bf16 v[136:139], a[108:111], a[28:31], v[136:139]
    v_add_f32 v227, v227, v158
    v_exp_f32 v159, v159
    v_mfma_f32_16x16x32_bf16 v[64:67], a[128:131], v[184:187], v[64:67]
    v_cvt_pk_bf16_f32 v191, v158, v159
    v_add_f32 v227, v227, v159
    v_mov_b32 v183, 0
    v_mfma_f32_16x16x32_bf16 v[96:99], a[128:131], v[188:191], v[96:99]
    v_exp_f32 v128, v128
    v_mfma_f32_16x16x32_bf16 a[236:239], a[224:227], v[184:187], a[236:239]
    ds_read_b64_tr_b16 a[128:129], v231 offset:0
    ds_read_b64_tr_b16 a[130:131], v231 offset:512
    v_mfma_f32_16x16x32_bf16 v[68:71], a[132:135], v[184:187], v[68:71]
    v_exp_f32 v129, v129
    v_cndmask_b32 v128, 0, v128, s[40:41]
    v_mfma_f32_16x16x32_bf16 v[100:103], a[132:135], v[188:191], v[100:103]
    ds_read_b64_tr_b16 a[132:133], v231 offset:32
    ds_read_b64_tr_b16 a[134:135], v231 offset:544
    v_cndmask_b32 v129, 0, v129, s[42:43]
    v_mfma_f32_16x16x32_bf16 v[72:75], a[136:139], v[184:187], v[72:75]
    v_cvt_pk_bf16_f32 v176, v128, v129
    v_exp_f32 v131, v131
    v_mfma_f32_16x16x32_bf16 v[104:107], a[136:139], v[188:191], v[104:107]
    ds_read_b64_tr_b16 a[136:137], v231 offset:64
    ds_read_b64_tr_b16 a[138:139], v231 offset:576
    v_cndmask_b32 v131, 0, v131, s[46:47]
    v_mfma_f32_16x16x32_bf16 v[76:79], a[140:143], v[184:187], v[76:79]
    v_exp_f32 v130, v130
    v_mfma_f32_16x16x32_bf16 v[108:111], a[140:143], v[188:191], v[108:111]
    s_mov_b32 m0, s70
    ds_read_b64_tr_b16 a[140:141], v231 offset:96
    ds_read_b64_tr_b16 a[142:143], v231 offset:608
    v_cndmask_b32 v130, 0, v130, s[44:45]
    v_mfma_f32_16x16x32_bf16 v[80:83], a[144:147], v[184:187], v[80:83]
    buffer_load_dwordx4 v237, s[12:15], s25 offen offset:3104 lds
    v_mfma_f32_16x16x32_bf16 v[112:115], a[144:147], v[188:191], v[112:115]
    s_add_u32 s14, s10, 4096
    ds_read_b64_tr_b16 a[144:145], v231 offset:128
    ds_read_b64_tr_b16 a[146:147], v231 offset:640
    s_mov_b32 s25, s24
    v_mfma_f32_16x16x32_bf16 v[84:87], a[148:151], v[184:187], v[84:87]
    v_exp_f32 v136, v136
    v_cvt_pk_bf16_f32 v177, v130, v131
    v_mfma_f32_16x16x32_bf16 v[116:119], a[148:151], v[188:191], v[116:119]
    ds_read_b64_tr_b16 a[148:149], v231 offset:160
    ds_read_b64_tr_b16 a[150:151], v231 offset:672
    v_cndmask_b32 v136, 0, v136, s[40:41]
    v_mfma_f32_16x16x32_bf16 v[88:91], a[152:155], v[184:187], v[88:91]
    v_exp_f32 v137, v137
    v_add_f32 v225, v225, v136
    v_mfma_f32_16x16x32_bf16 v[120:123], a[152:155], v[188:191], v[120:123]
    ds_read_b64_tr_b16 a[152:153], v231 offset:192
    ds_read_b64_tr_b16 a[154:155], v231 offset:704
    v_cndmask_b32 v137, 0, v137, s[42:43]
    v_mfma_f32_16x16x32_bf16 v[92:95], a[156:159], v[184:187], v[92:95]
    v_exp_f32 v138, v138
    v_add_f32 v225, v225, v137
    v_mfma_f32_16x16x32_bf16 v[124:127], a[156:159], v[188:191], v[124:127]
    ds_read_b64_tr_b16 a[156:157], v231 offset:224
    ds_read_b64_tr_b16 a[158:159], v231 offset:736
    v_cndmask_b32 v138, 0, v138, s[44:45]
    v_mfma_f32_16x16x32_bf16 v[144:147], a[96:99], a[32:35], v[208:211]
    v_exp_f32 v139, v139
    v_add_f32 v225, v225, v138
    v_mfma_f32_16x16x32_bf16 v[144:147], a[100:103], a[36:39], v[144:147]
    s_mov_b32 m0, s70
    v_cndmask_b32 v139, 0, v139, s[46:47]
    v_add_f32 v225, v225, v139
    v_mov_b32 v205, v225
    v_mfma_f32_16x16x32_bf16 v[144:147], a[104:107], a[40:43], v[144:147]
    buffer_load_dwordx4 v234, s[8:11], s24 offen lds
    v_mfma_f32_16x16x32_bf16 v[144:147], a[108:111], a[44:47], v[144:147]
    v_permlane32_swap_b32 v205, v225
    v_add_f32 v225, v225, v205
    v_mov_b32 v205, v225
    v_mfma_f32_16x16x32_bf16 v[152:155], a[96:99], a[48:51], v[212:215]
    ds_read_b128 a[96:99], v230 offset:0
    v_permlane16_swap_b32 v205, v225
    v_add_f32 v225, v225, v205
    v_mfma_f32_16x16x32_bf16 v[152:155], a[100:103], a[52:55], v[152:155]
    ds_read_b128 a[100:103], v230 offset:64
    v_cvt_pk_bf16_f32 v180, v136, v137
    v_cvt_pk_bf16_f32 v181, v138, v139
    v_mfma_f32_16x16x32_bf16 v[152:155], a[104:107], a[56:59], v[152:155]
    ds_read_b128 a[104:107], v230 offset:128
    v_rcp_f32 v204, v225
    v_mfma_f32_16x16x32_bf16 v[152:155], a[108:111], a[60:63], v[152:155]
    s_waitcnt lgkmcnt(3)
    ds_read_b128 a[108:111], v230 offset:192
    ds_read_b128 a[112:115], v230 offset:1024
    ds_read_b128 a[116:119], v230 offset:1088
    v_mfma_f32_16x16x32_bf16 v[0:3], a[128:131], v[176:179], v[0:3]
    ds_read_b128 a[120:123], v230 offset:1152
    ds_read_b128 a[124:127], v230 offset:1216
    v_mov_b32 v186, 0
    v_mfma_f32_16x16x32_bf16 v[32:35], a[128:131], v[180:183], v[32:35]
    v_exp_f32 v144, v144
    v_mfma_f32_16x16x32_bf16 a[228:231], a[224:227], v[176:179], a[228:231]
    v_exp_f32 v152, v152
    v_cndmask_b32 v144, 0, v144, s[40:41]
    v_mfma_f32_16x16x32_bf16 v[4:7], a[132:135], v[176:179], v[4:7]
    v_exp_f32 v145, v145
    v_cndmask_b32 v152, 0, v152, s[40:41]
    v_mfma_f32_16x16x32_bf16 v[36:39], a[132:135], v[180:183], v[36:39]
    v_exp_f32 v153, v153
    v_cndmask_b32 v145, 0, v145, s[42:43]
    v_mfma_f32_16x16x32_bf16 v[8:11], a[136:139], v[176:179], v[8:11]
    s_mov_b32 m0, s70
    v_accvgpr_read_b32 v224, a228
    v_cmp_nle_f32 s[68:69], v224, s63
    v_cndmask_b32 v153, 0, v153, s[42:43]
    v_mfma_f32_16x16x32_bf16 v[40:43], a[136:139], v[180:183], v[40:43]
    buffer_load_dwordx4 v235, s[8:11], s24 offen offset:1024 lds
    v_mfma_f32_16x16x32_bf16 v[12:15], a[140:143], v[176:179], v[12:15]
    s_add_u32 s24, s24, 131072
    s_sub_u32 s3, s3, 1
    s_add_u32 s66, s33, 0
    s_add_u32 s67, s33, 65536
    v_mfma_f32_16x16x32_bf16 v[44:47], a[140:143], v[180:183], v[44:47]
    s_add_u32 s74, s33, 131072
    s_add_u32 s75, s33, 196608
    s_sub_u32 s26, s37, 4
    s_mov_b32 s91, 0
    v_mfma_f32_16x16x32_bf16 v[16:19], a[144:147], v[176:179], v[16:19]
    s_mov_b32 s4, s31
    s_lshl_b32 s5, s64, 14
    s_add_u32 s5, s5, s34
    s_cmp_le_u32 s38, 16
    v_mfma_f32_16x16x32_bf16 v[48:51], a[144:147], v[180:183], v[48:51]
    s_cselect_b32 s71, 8, 0
    s_mov_b32 s36, 0
    s_mov_b32 s30, 0x40000000
    s_mov_b32 s31, 0
    v_mfma_f32_16x16x32_bf16 v[20:23], a[148:151], v[176:179], v[20:23]
    s_or_b64 s[56:57], s[56:57], s[68:69]
    v_cmp_nle_f32 s[68:69], v225, s63
    v_rcp_f32 v200, v224
    v_mfma_f32_16x16x32_bf16 v[52:55], a[148:151], v[180:183], v[52:55]
    s_or_b64 s[56:57], s[56:57], s[68:69]
    s_waitcnt vmcnt(29)
    v_exp_f32 v146, v146
    v_mfma_f32_16x16x32_bf16 v[24:27], a[152:155], v[176:179], v[24:27]
    ds_read_b128 a[0:3], v238 offset:0
    ds_read_b128 a[4:7], v238 offset:64
    ds_read_b128 a[8:11], v238 offset:128
    v_mfma_f32_16x16x32_bf16 v[56:59], a[152:155], v[180:183], v[56:59]
    ds_read_b128 a[12:15], v238 offset:192
    v_exp_f32 v154, v154
    v_mfma_f32_16x16x32_bf16 v[28:31], a[156:159], v[176:179], v[28:31]
    v_cmp_gt_i32 s[40:41], v244, 0
    v_cndmask_b32 v146, 0, v146, s[44:45]
    v_cndmask_b32 v154, 0, v154, s[44:45]
    v_mfma_f32_16x16x32_bf16 v[60:63], a[156:159], v[180:183], v[60:63]
    v_pk_mul_f32 v[0:1], v[0:1], v[200:201] op_sel_hi:[1,0]
    v_pk_mul_f32 v[2:3], v[2:3], v[200:201] op_sel_hi:[1,0]
    v_cvt_pk_bf16_f32 v0, v0, v1
    v_pk_mul_f32 v[4:5], v[4:5], v[200:201] op_sel_hi:[1,0]
    v_pk_mul_f32 v[6:7], v[6:7], v[200:201] op_sel_hi:[1,0]
    v_pk_mul_f32 v[8:9], v[8:9], v[200:201] op_sel_hi:[1,0]
    v_pk_mul_f32 v[10:11], v[10:11], v[200:201] op_sel_hi:[1,0]
    v_pk_mul_f32 v[12:13], v[12:13], v[200:201] op_sel_hi:[1,0]
    v_pk_mul_f32 v[14:15], v[14:15], v[200:201] op_sel_hi:[1,0]
    v_pk_mul_f32 v[16:17], v[16:17], v[200:201] op_sel_hi:[1,0]
    v_pk_mul_f32 v[18:19], v[18:19], v[200:201] op_sel_hi:[1,0]
    v_pk_mul_f32 v[20:21], v[20:21], v[200:201] op_sel_hi:[1,0]
    v_pk_mul_f32 v[22:23], v[22:23], v[200:201] op_sel_hi:[1,0]
    v_pk_mul_f32 v[24:25], v[24:25], v[200:201] op_sel_hi:[1,0]
    v_pk_mul_f32 v[26:27], v[26:27], v[200:201] op_sel_hi:[1,0]
    v_pk_mul_f32 v[28:29], v[28:29], v[200:201] op_sel_hi:[1,0]
    v_pk_mul_f32 v[30:31], v[30:31], v[200:201] op_sel_hi:[1,0]
    v_pk_mul_f32 v[32:33], v[32:33], v[204:205] op_sel_hi:[1,0]
    v_pk_mul_f32 v[34:35], v[34:35], v[204:205] op_sel_hi:[1,0]
    v_pk_mul_f32 v[36:37], v[36:37], v[204:205] op_sel_hi:[1,0]
    v_pk_mul_f32 v[38:39], v[38:39], v[204:205] op_sel_hi:[1,0]
    v_pk_mul_f32 v[40:41], v[40:41], v[204:205] op_sel_hi:[1,0]
    v_pk_mul_f32 v[42:43], v[42:43], v[204:205] op_sel_hi:[1,0]
    v_pk_mul_f32 v[44:45], v[44:45], v[204:205] op_sel_hi:[1,0]
    v_pk_mul_f32 v[46:47], v[46:47], v[204:205] op_sel_hi:[1,0]
    v_pk_mul_f32 v[48:49], v[48:49], v[204:205] op_sel_hi:[1,0]
    v_pk_mul_f32 v[50:51], v[50:51], v[204:205] op_sel_hi:[1,0]
    v_pk_mul_f32 v[52:53], v[52:53], v[204:205] op_sel_hi:[1,0]
    v_pk_mul_f32 v[54:55], v[54:55], v[204:205] op_sel_hi:[1,0]
    v_pk_mul_f32 v[56:57], v[56:57], v[204:205] op_sel_hi:[1,0]
    v_pk_mul_f32 v[58:59], v[58:59], v[204:205] op_sel_hi:[1,0]
    v_pk_mul_f32 v[60:61], v[60:61], v[204:205] op_sel_hi:[1,0]
    v_pk_mul_f32 v[62:63], v[62:63], v[204:205] op_sel_hi:[1,0]
    v_exp_f32 v147, v147
    v_mov_b32 v187, 0
    v_cndmask_b32 v147, 0, v147, s[46:47]
    v_cvt_pk_bf16_f32 v184, v144, v145
    v_cvt_pk_bf16_f32 v185, v146, v147
    v_cvt_pk_bf16_f32 v1, v2, v3
    v_cvt_pk_bf16_f32 v2, v4, v5
    v_mfma_f32_16x16x32_bf16 v[64:67], a[128:131], v[184:187], v[64:67]
    ds_write_b64 v242, v[0:1] offset:0
    v_cvt_pk_bf16_f32 v3, v6, v7
    v_cvt_pk_bf16_f32 v4, v8, v9
    v_exp_f32 v155, v155
    v_mov_b32 v190, 0
    v_cndmask_b32 v155, 0, v155, s[46:47]
    v_mov_b32 v191, 0
    v_cvt_pk_bf16_f32 v188, v152, v153
    v_cvt_pk_bf16_f32 v189, v154, v155
    v_cvt_pk_bf16_f32 v5, v10, v11
    v_cvt_pk_bf16_f32 v6, v12, v13
    v_mfma_f32_16x16x32_bf16 v[96:99], a[128:131], v[188:191], v[96:99]
    ds_write_b64 v242, v[2:3] offset:32
    ds_write_b64 v242, v[4:5] offset:64
    v_cvt_pk_bf16_f32 v7, v14, v15
    v_mfma_f32_16x16x32_bf16 a[236:239], a[224:227], v[184:187], a[236:239]
    ds_write_b64 v242, v[6:7] offset:96
    v_cvt_pk_bf16_f32 v8, v16, v17
    v_cvt_pk_bf16_f32 v9, v18, v19
    v_mfma_f32_16x16x32_bf16 v[68:71], a[132:135], v[184:187], v[68:71]
    ds_write_b64 v242, v[8:9] offset:128
    v_cvt_pk_bf16_f32 v10, v20, v21
    v_cvt_pk_bf16_f32 v11, v22, v23
    v_mfma_f32_16x16x32_bf16 v[100:103], a[132:135], v[188:191], v[100:103]
    ds_write_b64 v242, v[10:11] offset:160
    v_cvt_pk_bf16_f32 v12, v24, v25
    v_cvt_pk_bf16_f32 v13, v26, v27
    v_mfma_f32_16x16x32_bf16 v[72:75], a[136:139], v[184:187], v[72:75]
    ds_write_b64 v242, v[12:13] offset:192
    v_cvt_pk_bf16_f32 v14, v28, v29
    v_cvt_pk_bf16_f32 v15, v30, v31
    v_mfma_f32_16x16x32_bf16 v[104:107], a[136:139], v[188:191], v[104:107]
    ds_write_b64 v242, v[14:15] offset:224
    ds_read_b64 v[16:17], v243 offset:0
    ds_read_b64 v[18:19], v245 offset:0
    v_mfma_f32_16x16x32_bf16 v[76:79], a[140:143], v[184:187], v[76:79]
    ds_read_b64 v[20:21], v243 offset:1056
    ds_read_b64 v[22:23], v245 offset:1056
    ds_read_b64 v[24:25], v243 offset:2112
    v_mfma_f32_16x16x32_bf16 v[108:111], a[140:143], v[188:191], v[108:111]
    ds_read_b64 v[26:27], v245 offset:2112
    ds_read_b64 v[28:29], v243 offset:3168
    v_cvt_pk_bf16_f32 v32, v32, v33
    v_mfma_f32_16x16x32_bf16 v[80:83], a[144:147], v[184:187], v[80:83]
    ds_read_b64 v[30:31], v245 offset:3168
    v_cvt_pk_bf16_f32 v33, v34, v35
    v_cvt_pk_bf16_f32 v34, v36, v37
    v_mfma_f32_16x16x32_bf16 v[112:115], a[144:147], v[188:191], v[112:115]
    ds_write_b64 v242, v[32:33] offset:0
    v_cvt_pk_bf16_f32 v35, v38, v39
    v_cvt_pk_bf16_f32 v36, v40, v41
    v_mfma_f32_16x16x32_bf16 v[84:87], a[148:151], v[184:187], v[84:87]
    ds_write_b64 v242, v[34:35] offset:32
    v_cvt_pk_bf16_f32 v37, v42, v43
    v_cvt_pk_bf16_f32 v38, v44, v45
    v_mfma_f32_16x16x32_bf16 v[116:119], a[148:151], v[188:191], v[116:119]
    ds_write_b64 v242, v[36:37] offset:64
    v_cvt_pk_bf16_f32 v39, v46, v47
    v_cvt_pk_bf16_f32 v40, v48, v49
    v_mfma_f32_16x16x32_bf16 v[88:91], a[152:155], v[184:187], v[88:91]
    s_waitcnt lgkmcnt(6)
    buffer_store_dwordx4 v[16:19], v239, s[20:23], s66 offen nt
    v_mfma_f32_16x16x32_bf16 v[120:123], a[152:155], v[188:191], v[120:123]
    ds_write_b64 v242, v[38:39] offset:96
    v_cvt_pk_bf16_f32 v41, v50, v51
    v_cvt_pk_bf16_f32 v42, v52, v53
    v_mfma_f32_16x16x32_bf16 v[92:95], a[156:159], v[184:187], v[92:95]
    ds_write_b64 v242, v[40:41] offset:128
    v_cvt_pk_bf16_f32 v43, v54, v55
    v_cvt_pk_bf16_f32 v44, v56, v57
    v_mfma_f32_16x16x32_bf16 v[124:127], a[156:159], v[188:191], v[124:127]
    ds_write_b64 v242, v[42:43] offset:160
    v_cvt_pk_bf16_f32 v45, v58, v59
    v_cvt_pk_bf16_f32 v46, v60, v61
    v_accvgpr_read_b32 v226, a236
    v_rcp_f32 v208, v226
    v_add_f32 v227, v227, v152
    v_pk_mul_f32 v[64:65], v[64:65], v[208:209] op_sel_hi:[1,0]
    v_pk_mul_f32 v[66:67], v[66:67], v[208:209] op_sel_hi:[1,0]
    v_pk_mul_f32 v[68:69], v[68:69], v[208:209] op_sel_hi:[1,0]
    v_pk_mul_f32 v[70:71], v[70:71], v[208:209] op_sel_hi:[1,0]
    v_pk_mul_f32 v[72:73], v[72:73], v[208:209] op_sel_hi:[1,0]
    v_pk_mul_f32 v[74:75], v[74:75], v[208:209] op_sel_hi:[1,0]
    buffer_store_dwordx4 v[20:23], v241, s[20:23], s66 offen nt
    v_pk_mul_f32 v[76:77], v[76:77], v[208:209] op_sel_hi:[1,0]
    v_pk_mul_f32 v[78:79], v[78:79], v[208:209] op_sel_hi:[1,0]
    v_add_f32 v227, v227, v153
    v_pk_mul_f32 v[80:81], v[80:81], v[208:209] op_sel_hi:[1,0]
    v_pk_mul_f32 v[82:83], v[82:83], v[208:209] op_sel_hi:[1,0]
    v_add_f32 v227, v227, v154
    v_pk_mul_f32 v[84:85], v[84:85], v[208:209] op_sel_hi:[1,0]
    v_pk_mul_f32 v[86:87], v[86:87], v[208:209] op_sel_hi:[1,0]
    v_add_f32 v227, v227, v155
    v_pk_mul_f32 v[88:89], v[88:89], v[208:209] op_sel_hi:[1,0]
    v_pk_mul_f32 v[90:91], v[90:91], v[208:209] op_sel_hi:[1,0]
    v_pk_mul_f32 v[92:93], v[92:93], v[208:209] op_sel_hi:[1,0]
    v_pk_mul_f32 v[94:95], v[94:95], v[208:209] op_sel_hi:[1,0]
    v_mov_b32 v213, v227
    v_cvt_pk_bf16_f32 v47, v62, v63
    v_cmp_gt_i32 s[42:43], v244, 1
    v_permlane32_swap_b32 v213, v227
    v_add_f32 v227, v227, v213
    v_mov_b32 v213, v227
    v_cmp_gt_i32 s[44:45], v244, 2
    v_cmp_gt_i32 s[46:47], v244, 3
    v_permlane16_swap_b32 v213, v227
    v_add_f32 v227, v227, v213
    v_rcp_f32 v212, v227
    s_waitcnt lgkmcnt(0)
    buffer_store_dwordx4 v[24:27], v246, s[20:23], s66 offen nt
    v_pk_mul_f32 v[96:97], v[96:97], v[212:213] op_sel_hi:[1,0]
    v_pk_mul_f32 v[98:99], v[98:99], v[212:213] op_sel_hi:[1,0]
    v_pk_mul_f32 v[100:101], v[100:101], v[212:213] op_sel_hi:[1,0]
    v_pk_mul_f32 v[102:103], v[102:103], v[212:213] op_sel_hi:[1,0]
    v_pk_mul_f32 v[104:105], v[104:105], v[212:213] op_sel_hi:[1,0]
    v_pk_mul_f32 v[106:107], v[106:107], v[212:213] op_sel_hi:[1,0]
    v_pk_mul_f32 v[108:109], v[108:109], v[212:213] op_sel_hi:[1,0]
    v_pk_mul_f32 v[110:111], v[110:111], v[212:213] op_sel_hi:[1,0]
    v_pk_mul_f32 v[112:113], v[112:113], v[212:213] op_sel_hi:[1,0]
    v_pk_mul_f32 v[114:115], v[114:115], v[212:213] op_sel_hi:[1,0]
    v_pk_mul_f32 v[116:117], v[116:117], v[212:213] op_sel_hi:[1,0]
    v_pk_mul_f32 v[118:119], v[118:119], v[212:213] op_sel_hi:[1,0]
    v_pk_mul_f32 v[120:121], v[120:121], v[212:213] op_sel_hi:[1,0]
    v_pk_mul_f32 v[122:123], v[122:123], v[212:213] op_sel_hi:[1,0]
    v_pk_mul_f32 v[124:125], v[124:125], v[212:213] op_sel_hi:[1,0]
    v_pk_mul_f32 v[126:127], v[126:127], v[212:213] op_sel_hi:[1,0]
    v_mfma_f32_16x16x32_bf16 v[0:3], a[82:85], a[0:3], 0
    ds_write_b64 v242, v[44:45] offset:192
    ds_write_b64 v242, v[46:47] offset:224
    ds_read_b64 v[48:49], v243 offset:0
    v_mfma_f32_16x16x32_bf16 v[0:3], a[86:89], a[0:3], v[0:3]
    ds_read_b64 v[50:51], v245 offset:0
    ds_read_b64 v[52:53], v243 offset:1056
    ds_read_b64 v[54:55], v245 offset:1056
    v_mfma_f32_16x16x32_bf16 v[4:7], a[80:83], a[0:3], 0
    buffer_store_dwordx4 v[28:31], v247, s[20:23], s66 offen nt
    v_mfma_f32_16x16x32_bf16 v[4:7], a[84:87], a[0:3], v[4:7]
    ds_read_b64 v[56:57], v243 offset:2112
    ds_read_b64 v[58:59], v245 offset:2112
    ds_read_b64 v[60:61], v243 offset:3168
    v_mfma_f32_16x16x32_bf16 v[8:11], a[82:85], a[4:7], 0
    ds_read_b64 v[62:63], v245 offset:3168
    v_cvt_pk_bf16_f32 v64, v64, v65
    v_cvt_pk_bf16_f32 v65, v66, v67
    v_mfma_f32_16x16x32_bf16 v[8:11], a[86:89], a[4:7], v[8:11]
    ds_write_b64 v242, v[64:65] offset:0
    v_cvt_pk_bf16_f32 v66, v68, v69
    v_cvt_pk_bf16_f32 v67, v70, v71
    v_mfma_f32_16x16x32_bf16 v[12:15], a[80:83], a[4:7], 0
    ds_write_b64 v242, v[66:67] offset:32
    v_cvt_pk_bf16_f32 v68, v72, v73
    v_cvt_pk_bf16_f32 v69, v74, v75
    v_mfma_f32_16x16x32_bf16 v[12:15], a[84:87], a[4:7], v[12:15]
    ds_write_b64 v242, v[68:69] offset:64
    v_cvt_pk_bf16_f32 v70, v76, v77
    v_cvt_pk_bf16_f32 v71, v78, v79
    v_mfma_f32_16x16x32_bf16 v[16:19], a[82:85], a[8:11], 0
    s_waitcnt lgkmcnt(7)
    buffer_store_dwordx4 v[48:51], v239, s[20:23], s67 offen nt
    v_mfma_f32_16x16x32_bf16 v[16:19], a[86:89], a[8:11], v[16:19]
    ds_write_b64 v242, v[70:71] offset:96
    v_cvt_pk_bf16_f32 v72, v80, v81
    v_cvt_pk_bf16_f32 v73, v82, v83
    v_mfma_f32_16x16x32_bf16 v[20:23], a[80:83], a[8:11], 0
    ds_write_b64 v242, v[72:73] offset:128
    v_cvt_pk_bf16_f32 v74, v84, v85
    v_cvt_pk_bf16_f32 v75, v86, v87
    v_mfma_f32_16x16x32_bf16 v[20:23], a[84:87], a[8:11], v[20:23]
    ds_write_b64 v242, v[74:75] offset:160
    v_cvt_pk_bf16_f32 v76, v88, v89
    v_cvt_pk_bf16_f32 v77, v90, v91
    v_mfma_f32_16x16x32_bf16 v[24:27], a[82:85], a[12:15], 0
    ds_write_b64 v242, v[76:77] offset:192
    v_cvt_pk_bf16_f32 v78, v92, v93
    v_cvt_pk_bf16_f32 v79, v94, v95
    v_mfma_f32_16x16x32_bf16 v[24:27], a[86:89], a[12:15], v[24:27]
    ds_write_b64 v242, v[78:79] offset:224
    ds_read_b64 v[80:81], v243 offset:0
    ds_read_b64 v[82:83], v245 offset:0
    v_mfma_f32_16x16x32_bf16 v[28:31], a[80:83], a[12:15], 0
    buffer_store_dwordx4 v[52:55], v241, s[20:23], s67 offen nt
    v_mfma_f32_16x16x32_bf16 v[28:31], a[84:87], a[12:15], v[28:31]
    ds_read_b64 v[84:85], v243 offset:1056
    ds_read_b64 v[86:87], v245 offset:1056
    ds_read_b64 v[88:89], v243 offset:2112
    ds_read_b64 v[90:91], v245 offset:2112
    ds_read_b64 v[92:93], v243 offset:3168
    v_cvt_pk_bf16_f32 v96, v96, v97
    ds_read_b64 v[94:95], v245 offset:3168
    v_cvt_pk_bf16_f32 v97, v98, v99
    ds_write_b64 v242, v[96:97] offset:0
    v_cvt_pk_bf16_f32 v98, v100, v101
    v_cvt_pk_bf16_f32 v99, v102, v103
    ds_write_b64 v242, v[98:99] offset:32
    v_cvt_pk_bf16_f32 v100, v104, v105
    v_cvt_pk_bf16_f32 v101, v106, v107
    ds_write_b64 v242, v[100:101] offset:64
    v_cvt_pk_bf16_f32 v102, v108, v109
    v_cvt_pk_bf16_f32 v103, v110, v111
    ds_write_b64 v242, v[102:103] offset:96
    v_cvt_pk_bf16_f32 v104, v112, v113
    v_cvt_pk_bf16_f32 v105, v114, v115
    ds_write_b64 v242, v[104:105] offset:128
    v_cvt_pk_bf16_f32 v106, v116, v117
    v_cvt_pk_bf16_f32 v107, v118, v119
    s_waitcnt lgkmcnt(14)
    buffer_store_dwordx4 v[56:59], v246, s[20:23], s67 offen nt
    ds_write_b64 v242, v[106:107] offset:160
    v_cvt_pk_bf16_f32 v108, v120, v121
    v_cvt_pk_bf16_f32 v109, v122, v123
    ds_write_b64 v242, v[108:109] offset:192
    v_cvt_pk_bf16_f32 v110, v124, v125
    v_cvt_pk_bf16_f32 v111, v126, v127
    ds_write_b64 v242, v[110:111] offset:224
    ds_read_b64 v[112:113], v243 offset:0
    ds_read_b64 v[114:115], v245 offset:0
    ds_read_b64 v[116:117], v243 offset:1056
    ds_read_b64 v[118:119], v245 offset:1056
    ds_read_b64 v[120:121], v243 offset:2112
    ds_read_b64 v[122:123], v245 offset:2112
    ds_read_b64 v[124:125], v243 offset:3168
    ds_read_b64 v[126:127], v245 offset:3168
    v_cmp_nle_f32 s[68:69], v226, s63
    v_cvt_pk_bf16_f32 v0, v0, v1
    s_or_b64 s[56:57], s[56:57], s[68:69]
    v_cmp_nle_f32 s[68:69], v227, s63
    v_cvt_pk_bf16_f32 v1, v2, v3
    s_or_b64 s[56:57], s[56:57], s[68:69]
    s_waitcnt vmcnt(35)
    ds_read_b128 a[16:19], v238 offset:4352
    v_accvgpr_write_b32 a0, v0
    v_accvgpr_write_b32 a1, v1
    v_cvt_pk_bf16_f32 v4, v4, v5
    v_cvt_pk_bf16_f32 v5, v6, v7
    v_accvgpr_write_b32 a2, v4
    v_accvgpr_write_b32 a3, v5
    v_cvt_pk_bf16_f32 v8, v8, v9
    v_cvt_pk_bf16_f32 v9, v10, v11
    v_cvt_pk_bf16_f32 v12, v12, v13
    v_cvt_pk_bf16_f32 v13, v14, v15
    v_accvgpr_write_b32 a4, v8
    v_accvgpr_write_b32 a5, v9
    v_accvgpr_write_b32 a6, v12
    v_accvgpr_write_b32 a7, v13
    v_cvt_pk_bf16_f32 v16, v16, v17
    v_cvt_pk_bf16_f32 v17, v18, v19
    s_waitcnt lgkmcnt(0)
    v_mfma_f32_16x16x32_bf16 v[0:3], a[82:85], a[16:19], 0
    buffer_store_dwordx4 v[60:63], v247, s[20:23], s67 offen nt
    v_mfma_f32_16x16x32_bf16 v[0:3], a[86:89], a[16:19], v[0:3]
    ds_read_b128 a[20:23], v238 offset:4416
    ds_read_b128 a[24:27], v238 offset:4480
    ds_read_b128 a[28:31], v238 offset:4544
    v_mfma_f32_16x16x32_bf16 v[4:7], a[80:83], a[16:19], 0
    v_cvt_pk_bf16_f32 v20, v20, v21
    v_cvt_pk_bf16_f32 v21, v22, v23
    v_accvgpr_write_b32 a8, v16
    v_mfma_f32_16x16x32_bf16 v[4:7], a[84:87], a[16:19], v[4:7]
    s_waitcnt lgkmcnt(2)
    v_accvgpr_write_b32 a9, v17
    v_accvgpr_write_b32 a10, v20
    v_accvgpr_write_b32 a11, v21
    v_mfma_f32_16x16x32_bf16 v[8:11], a[82:85], a[20:23], 0
    v_cvt_pk_bf16_f32 v24, v24, v25
    v_cvt_pk_bf16_f32 v25, v26, v27
    v_cvt_pk_bf16_f32 v28, v28, v29
    v_mfma_f32_16x16x32_bf16 v[8:11], a[86:89], a[20:23], v[8:11]
    v_cvt_pk_bf16_f32 v29, v30, v31
    v_accvgpr_write_b32 a12, v24
    v_accvgpr_write_b32 a13, v25
    v_mfma_f32_16x16x32_bf16 v[12:15], a[80:83], a[20:23], 0
    buffer_store_dwordx4 v[80:83], v239, s[20:23], s74 offen nt
    v_mfma_f32_16x16x32_bf16 v[12:15], a[84:87], a[20:23], v[12:15]
    s_waitcnt lgkmcnt(0)
    v_accvgpr_write_b32 a14, v28
    v_accvgpr_write_b32 a15, v29
    v_cvt_pk_bf16_f32 v0, v0, v1
    v_mfma_f32_16x16x32_bf16 v[16:19], a[82:85], a[24:27], 0
    v_cvt_pk_bf16_f32 v1, v2, v3
    v_cvt_pk_bf16_f32 v4, v4, v5
    v_cvt_pk_bf16_f32 v5, v6, v7
    v_mfma_f32_16x16x32_bf16 v[16:19], a[86:89], a[24:27], v[16:19]
    v_accvgpr_write_b32 a16, v0
    v_accvgpr_write_b32 a17, v1
    v_accvgpr_write_b32 a18, v4
    v_mfma_f32_16x16x32_bf16 v[20:23], a[80:83], a[24:27], 0
    v_accvgpr_write_b32 a19, v5
    v_cvt_pk_bf16_f32 v8, v8, v9
    v_cvt_pk_bf16_f32 v9, v10, v11
    v_mfma_f32_16x16x32_bf16 v[20:23], a[84:87], a[24:27], v[20:23]
    v_cvt_pk_bf16_f32 v12, v12, v13
    v_cvt_pk_bf16_f32 v13, v14, v15
    v_accvgpr_write_b32 a20, v8
    v_mfma_f32_16x16x32_bf16 v[24:27], a[82:85], a[28:31], 0
    buffer_store_dwordx4 v[84:87], v241, s[20:23], s74 offen nt
    v_mfma_f32_16x16x32_bf16 v[24:27], a[86:89], a[28:31], v[24:27]
    v_accvgpr_write_b32 a21, v9
    v_accvgpr_write_b32 a22, v12
    v_accvgpr_write_b32 a23, v13
    v_mfma_f32_16x16x32_bf16 v[28:31], a[80:83], a[28:31], 0
    v_cvt_pk_bf16_f32 v16, v16, v17
    v_cvt_pk_bf16_f32 v17, v18, v19
    v_cvt_pk_bf16_f32 v20, v20, v21
    v_mfma_f32_16x16x32_bf16 v[28:31], a[84:87], a[28:31], v[28:31]
    v_cvt_pk_bf16_f32 v21, v22, v23
    v_accvgpr_write_b32 a24, v16
    v_accvgpr_write_b32 a25, v17
    v_mfma_f32_16x16x32_bf16 v[128:131], a[96:99], a[0:3], 0
    v_accvgpr_write_b32 a26, v20
    v_accvgpr_write_b32 a27, v21
    v_cvt_pk_bf16_f32 v24, v24, v25
    v_mfma_f32_16x16x32_bf16 v[128:131], a[100:103], a[4:7], v[128:131]
    v_cvt_pk_bf16_f32 v25, v26, v27
    v_cvt_pk_bf16_f32 v28, v28, v29
    v_cvt_pk_bf16_f32 v29, v30, v31
    v_mfma_f32_16x16x32_bf16 v[128:131], a[104:107], a[8:11], v[128:131]
    s_mov_b32 s70, s27
    buffer_store_dwordx4 v[88:91], v246, s[20:23], s74 offen nt
    v_mfma_f32_16x16x32_bf16 v[128:131], a[108:111], a[12:15], v[128:131]
    s_add_u32 s27, s27, 16640
    v_accvgpr_write_b32 a28, v24
    v_accvgpr_write_b32 a29, v25
    v_accvgpr_write_b32 a30, v28
    v_mfma_f32_16x16x32_bf16 v[132:135], a[112:115], a[0:3], 0
    s_cmp_eq_u32 s27, s29
    v_accvgpr_write_b32 a31, v29
    v_mfma_f32_16x16x32_bf16 v[132:135], a[116:119], a[4:7], v[132:135]
    s_cselect_b32 s27, s28, s27
    v_max3_f32 v176, v128, v129, v130
    v_mfma_f32_16x16x32_bf16 v[132:135], a[120:123], a[8:11], v[132:135]
    s_waitcnt vmcnt(23)
    v_mfma_f32_16x16x32_bf16 v[132:135], a[124:127], a[12:15], v[132:135]
    s_barrier
    v_mfma_f32_16x16x32_bf16 v[136:139], a[96:99], a[16:19], 0
    s_cmp_lg_u64 s[56:57], 0
    v_add_u32 v231, s27, v233
    s_cselect_b32 s6, 1, 0
    s_lshl_b32 s6, s6, s59
    v_mfma_f32_16x16x32_bf16 v[136:139], a[100:103], a[20:23], v[136:139]
    s_or_b32 s58, s58, s6
    buffer_store_dwordx4 v[92:95], v247, s[20:23], s74 offen nt
    v_mfma_f32_16x16x32_bf16 v[136:139], a[104:107], a[24:27], v[136:139]
    s_mov_b64 s[56:57], 0
    ds_read_b64_tr_b16 a[128:129], v231 offset:0
    ds_read_b64_tr_b16 a[130:131], v231 offset:512
    ds_read_b64_tr_b16 a[132:133], v231 offset:32
    v_mfma_f32_16x16x32_bf16 v[136:139], a[108:111], a[28:31], v[136:139]
    s_add_u32 s59, s59, 1
    ds_read_b64_tr_b16 a[134:135], v231 offset:544
    ds_read_b64_tr_b16 a[136:137], v231 offset:64
    ds_read_b64_tr_b16 a[138:139], v231 offset:576
    v_mfma_f32_16x16x32_bf16 v[140:143], a[112:115], a[16:19], 0
    s_mov_b32 m0, s70
    ds_read_b64_tr_b16 a[140:141], v231 offset:96
    ds_read_b64_tr_b16 a[142:143], v231 offset:608
    ds_read_b64_tr_b16 a[144:145], v231 offset:128
    v_mfma_f32_16x16x32_bf16 v[140:143], a[116:119], a[20:23], v[140:143]
    buffer_load_dwordx4 v236, s[12:15], s25 offen offset:2048 lds
    v_mfma_f32_16x16x32_bf16 v[140:143], a[120:123], a[24:27], v[140:143]
    s_mov_b32 m0, s70
    ds_read_b64_tr_b16 a[146:147], v231 offset:640
    ds_read_b64_tr_b16 a[148:149], v231 offset:160
    ds_read_b64_tr_b16 a[150:151], v231 offset:672
    v_mfma_f32_16x16x32_bf16 v[140:143], a[124:127], a[28:31], v[140:143]
    s_waitcnt lgkmcnt(10)
    buffer_store_dwordx4 v[112:115], v239, s[20:23], s75 offen nt
    v_max3_f32 v177, v132, v133, v134
    v_max3_f32 v176, v176, v131, v135
    v_max_f32 v176, v176, v177
    v_mov_b32 v177, v176
    v_add_u32 v230, s27, v232
    v_max3_f32 v180, v136, v137, v138
    v_permlane32_swap_b32 v177, v176
    v_max_f32 v176, v176, v177
    v_mov_b32 v177, v176
    v_max3_f32 v181, v140, v141, v142
    v_max3_f32 v180, v180, v139, v143
    v_permlane16_swap_b32 v177, v176
    v_max_f32 v176, v176, v177
    v_sub_f32 v200, 0, v176
    v_sub_f32 v201, 0, v176
    v_sub_f32 v202, 0, v176
    v_sub_f32 v203, 0, v176
    v_sub_f32 v128, v128, v176
    v_sub_f32 v129, v129, v176
    v_sub_f32 v130, v130, v176
    v_sub_f32 v131, v131, v176
    v_sub_f32 v132, v132, v176
    v_sub_f32 v133, v133, v176
    v_sub_f32 v134, v134, v176
    v_sub_f32 v135, v135, v176
    buffer_store_dwordx4 v[116:119], v241, s[20:23], s75 offen nt
    v_exp_f32 v128, v128
    v_exp_f32 v129, v129
    v_exp_f32 v130, v130
    v_cvt_pk_bf16_f32 v176, v128, v129
    v_exp_f32 v131, v131
    v_exp_f32 v132, v132
    v_cvt_pk_bf16_f32 v177, v130, v131
    v_exp_f32 v133, v133
    v_exp_f32 v134, v134
    v_cvt_pk_bf16_f32 v178, v132, v133
    v_exp_f32 v135, v135
    v_max_f32 v180, v180, v181
    v_cvt_pk_bf16_f32 v179, v134, v135
    v_mov_b32 v181, v180
    s_nop 0
    v_mfma_f32_16x16x32_bf16 v[0:3], a[128:131], v[176:179], 0
    buffer_store_dwordx4 v[120:123], v246, s[20:23], s75 offen nt
    v_mfma_f32_16x16x32_bf16 a[228:231], a[224:227], v[176:179], 0
    s_waitcnt lgkmcnt(0)
    buffer_load_dwordx4 v237, s[12:15], s25 offen offset:3104 lds
    v_mfma_f32_16x16x32_bf16 v[4:7], a[132:135], v[176:179], 0
    s_add_u32 s14, s10, 4096
    ds_read_b64_tr_b16 a[152:153], v231 offset:192
    ds_read_b64_tr_b16 a[154:155], v231 offset:704
    ds_read_b64_tr_b16 a[156:157], v231 offset:224
    v_mfma_f32_16x16x32_bf16 v[8:11], a[136:139], v[176:179], 0
    s_mov_b32 s25, s24
    ds_read_b64_tr_b16 a[158:159], v231 offset:736
    ds_read_b128 a[96:99], v230 offset:0
    ds_read_b128 a[100:103], v230 offset:64
    v_mfma_f32_16x16x32_bf16 v[12:15], a[140:143], v[176:179], 0
    s_mov_b32 m0, s70
    ds_read_b128 a[104:107], v230 offset:128
    ds_read_b128 a[108:111], v230 offset:192
    ds_read_b128 a[112:115], v230 offset:1024
    v_mfma_f32_16x16x32_bf16 v[16:19], a[144:147], v[176:179], 0
    buffer_load_dwordx4 v234, s[8:11], s24 offen lds
    v_mfma_f32_16x16x32_bf16 v[20:23], a[148:151], v[176:179], 0
    s_waitcnt lgkmcnt(7)
    buffer_store_dwordx4 v[124:127], v247, s[20:23], s75 offen nt
    v_mfma_f32_16x16x32_bf16 v[24:27], a[152:155], v[176:179], 0
    s_waitcnt lgkmcnt(5)
    ds_read_b128 a[116:119], v230 offset:1088
    ds_read_b128 a[120:123], v230 offset:1152
    ds_read_b128 a[124:127], v230 offset:1216
    v_mfma_f32_16x16x32_bf16 v[28:31], a[156:159], v[176:179], 0
    s_waitcnt lgkmcnt(7)
    v_permlane32_swap_b32 v181, v180
    v_max_f32 v180, v180, v181
    v_mov_b32 v181, v180
    v_mfma_f32_16x16x32_bf16 v[128:131], a[96:99], a[0:3], v[200:203]
    s_waitcnt lgkmcnt(6)
    v_permlane16_swap_b32 v181, v180
    v_max_f32 v180, v180, v181
    v_sub_f32 v204, 0, v180
    v_mfma_f32_16x16x32_bf16 v[128:131], a[100:103], a[4:7], v[128:131]
    s_waitcnt lgkmcnt(3)
    v_sub_f32 v205, 0, v180
    v_sub_f32 v206, 0, v180
    v_sub_f32 v207, 0, v180
    v_mfma_f32_16x16x32_bf16 v[128:131], a[104:107], a[8:11], v[128:131]
    s_mov_b32 m0, s70
    v_sub_f32 v136, v136, v180
    v_sub_f32 v137, v137, v180
    v_sub_f32 v138, v138, v180
    v_mfma_f32_16x16x32_bf16 v[128:131], a[108:111], a[12:15], v[128:131]
    buffer_load_dwordx4 v235, s[8:11], s24 offen offset:1024 lds
    v_mfma_f32_16x16x32_bf16 v[132:135], a[112:115], a[0:3], v[200:203]
    s_waitcnt lgkmcnt(0)
    v_sub_f32 v139, v139, v180
    v_sub_f32 v140, v140, v180
    v_sub_f32 v141, v141, v180
    v_mfma_f32_16x16x32_bf16 v[132:135], a[116:119], a[4:7], v[132:135]
    s_add_u32 s24, s24, 131072
    v_sub_f32 v142, v142, v180
    v_sub_f32 v143, v143, v180
    s_sub_u32 s3, s3, 1
    v_mfma_f32_16x16x32_bf16 v[132:135], a[120:123], a[8:11], v[132:135]
    s_mov_b32 s70, s27
    v_exp_f32 v136, v136
    s_add_u32 s27, s27, 16640
    v_mfma_f32_16x16x32_bf16 v[132:135], a[124:127], a[12:15], v[132:135]
    s_cmp_eq_u32 s27, s29
    v_exp_f32 v137, v137
    s_cselect_b32 s27, s28, s27
    v_cvt_pk_bf16_f32 v180, v136, v137
    v_exp_f32 v138, v138
    v_exp_f32 v139, v139
    v_exp_f32 v140, v140
    v_cvt_pk_bf16_f32 v181, v138, v139
    v_exp_f32 v141, v141
    v_exp_f32 v142, v142
    v_cvt_pk_bf16_f32 v182, v140, v141
    v_exp_f32 v143, v143
    v_exp_f32 v128, v128
    v_cvt_pk_bf16_f32 v183, v142, v143
    s_nop 1
    v_mfma_f32_16x16x32_bf16 v[32:35], a[128:131], v[180:183], 0
    s_waitcnt vmcnt(28)
    v_exp_f32 v129, v129
    v_mfma_f32_16x16x32_bf16 a[232:235], a[224:227], v[180:183], 0
    s_barrier
    v_mfma_f32_16x16x32_bf16 v[36:39], a[132:135], v[180:183], 0
    s_mov_b32 m0, s70
    v_add_u32 v231, s27, v233
    v_add_u32 v230, s27, v232
    v_cvt_pk_bf16_f32 v176, v128, v129
    v_mfma_f32_16x16x32_bf16 v[40:43], a[136:139], v[180:183], 0
    buffer_load_dwordx4 v236, s[12:15], s25 offen offset:2048 lds
    v_mfma_f32_16x16x32_bf16 v[44:47], a[140:143], v[180:183], 0
    s_mov_b32 m0, s70
    v_exp_f32 v130, v130
    v_mfma_f32_16x16x32_bf16 v[48:51], a[144:147], v[180:183], 0
    buffer_load_dwordx4 v237, s[12:15], s25 offen offset:3104 lds
    v_mfma_f32_16x16x32_bf16 v[52:55], a[148:151], v[180:183], 0
    s_add_u32 s14, s10, 4096
    ds_read_b64_tr_b16 a[128:129], v231 offset:0
    ds_read_b64_tr_b16 a[130:131], v231 offset:512
    ds_read_b64_tr_b16 a[132:133], v231 offset:32
    v_mfma_f32_16x16x32_bf16 v[56:59], a[152:155], v[180:183], 0
    s_mov_b32 s25, s24
    ds_read_b64_tr_b16 a[134:135], v231 offset:544
    ds_read_b64_tr_b16 a[136:137], v231 offset:64
    ds_read_b64_tr_b16 a[138:139], v231 offset:576
    v_mfma_f32_16x16x32_bf16 v[60:63], a[156:159], v[180:183], 0
    s_mov_b32 s22, s4
    ds_read_b64_tr_b16 a[140:141], v231 offset:96
    ds_read_b64_tr_b16 a[142:143], v231 offset:608
    ds_read_b64_tr_b16 a[144:145], v231 offset:128
    ds_read_b64_tr_b16 a[146:147], v231 offset:640
    ds_read_b64_tr_b16 a[148:149], v231 offset:160
    s_mov_b32 s33, s5
    s_mov_b32 m0, s70
    s_branch L_loop2
L_tail4_10e:
.p2align 3
L_loop5:
    v_mfma_f32_16x16x32_bf16 v[144:147], a[96:99], a[32:35], v[208:211]
    ds_read_b64_tr_b16 a[146:147], v231 offset:640
    v_add_f32 v225, v225, v142
    v_mfma_f32_16x16x32_bf16 v[144:147], a[100:103], a[36:39], v[144:147]
    v_exp_f32 v143, v143
    v_mfma_f32_16x16x32_bf16 v[144:147], a[104:107], a[40:43], v[144:147]
    v_add_f32 v225, v225, v143
    v_cvt_pk_bf16_f32 v183, v142, v143
    v_mfma_f32_16x16x32_bf16 v[144:147], a[108:111], a[44:47], v[144:147]
    ds_read_b64_tr_b16 a[148:149], v231 offset:160
    ds_read_b64_tr_b16 a[150:151], v231 offset:672
    v_mfma_f32_16x16x32_bf16 v[148:151], a[112:115], a[32:35], v[208:211]
    buffer_load_dwordx4 v234, s[8:11], s24 offen lds
    v_mfma_f32_16x16x32_bf16 v[148:151], a[116:119], a[36:39], v[148:151]
    ds_read_b64_tr_b16 a[152:153], v231 offset:192
    ds_read_b64_tr_b16 a[154:155], v231 offset:704
    v_mfma_f32_16x16x32_bf16 v[148:151], a[120:123], a[40:43], v[148:151]
    v_exp_f32 v144, v144
    v_mfma_f32_16x16x32_bf16 v[148:151], a[124:127], a[44:47], v[148:151]
    v_exp_f32 v145, v145
    v_mfma_f32_16x16x32_bf16 v[152:155], a[96:99], a[48:51], v[212:215]
    ds_read_b64_tr_b16 a[156:157], v231 offset:224
    v_cvt_pk_bf16_f32 v184, v144, v145
    v_mfma_f32_16x16x32_bf16 v[152:155], a[100:103], a[52:55], v[152:155]
    v_exp_f32 v146, v146
    v_mfma_f32_16x16x32_bf16 v[152:155], a[104:107], a[56:59], v[152:155]
    v_exp_f32 v147, v147
    v_mfma_f32_16x16x32_bf16 v[152:155], a[108:111], a[60:63], v[152:155]
    ds_read_b64_tr_b16 a[158:159], v231 offset:736
    v_cvt_pk_bf16_f32 v185, v146, v147
    v_mfma_f32_16x16x32_bf16 v[156:159], a[112:115], a[48:51], v[212:215]
    v_exp_f32 v148, v148
    v_mfma_f32_16x16x32_bf16 v[156:159], a[116:119], a[52:55], v[156:159]
    v_exp_f32 v149, v149
    v_mfma_f32_16x16x32_bf16 v[156:159], a[120:123], a[56:59], v[156:159]
    v_exp_f32 v150, v150
    v_mfma_f32_16x16x32_bf16 v[156:159], a[124:127], a[60:63], v[156:159]
    v_exp_f32 v151, v151
    v_mfma_f32_16x16x32_bf16 v[160:163], a[96:99], a[64:67], v[216:219]
    ds_read_b128 a[96:99], v230 offset:0
    v_cvt_pk_bf16_f32 v186, v148, v149
    v_mfma_f32_16x16x32_bf16 v[160:163], a[100:103], a[68:71], v[160:163]
    ds_read_b128 a[100:103], v230 offset:64
    v_cvt_pk_bf16_f32 v187, v150, v151
    v_mfma_f32_16x16x32_bf16 v[160:163], a[104:107], a[72:75], v[160:163]
    v_exp_f32 v152, v152
    v_mfma_f32_16x16x32_bf16 v[160:163], a[108:111], a[76:79], v[160:163]
    ds_read_b128 a[104:107], v230 offset:128
    v_add_f32 v227, v227, v152
    v_mfma_f32_16x16x32_bf16 v[164:167], a[112:115], a[64:67], v[216:219]
    v_exp_f32 v153, v153
    v_mfma_f32_16x16x32_bf16 v[164:167], a[116:119], a[68:71], v[164:167]
    ds_read_b128 a[108:111], v230 offset:192
    v_add_f32 v227, v227, v153
    v_mfma_f32_16x16x32_bf16 v[164:167], a[120:123], a[72:75], v[164:167]
    ds_read_b128 a[112:115], v230 offset:1024
    v_cvt_pk_bf16_f32 v188, v152, v153
    v_mfma_f32_16x16x32_bf16 v[164:167], a[124:127], a[76:79], v[164:167]
    s_waitcnt lgkmcnt(3)
    v_exp_f32 v154, v154
    v_mfma_f32_16x16x32_bf16 v[0:3], a[128:131], v[176:179], v[0:3]
    ds_read_b128 a[116:119], v230 offset:1088
    v_add_f32 v227, v227, v154
    v_mfma_f32_16x16x32_bf16 v[32:35], a[128:131], v[180:183], v[32:35]
    v_exp_f32 v155, v155
    v_mfma_f32_16x16x32_bf16 v[4:7], a[132:135], v[176:179], v[4:7]
    ds_read_b128 a[120:123], v230 offset:1152
    v_add_f32 v227, v227, v155
    v_mfma_f32_16x16x32_bf16 v[36:39], a[132:135], v[180:183], v[36:39]
    v_cvt_pk_bf16_f32 v189, v154, v155
    v_mfma_f32_16x16x32_bf16 v[8:11], a[136:139], v[176:179], v[8:11]
    buffer_load_dwordx4 v235, s[8:11], s24 offen offset:1024 lds
    v_mfma_f32_16x16x32_bf16 v[40:43], a[136:139], v[180:183], v[40:43]
    s_add_u32 s24, s24, 131072
    v_exp_f32 v156, v156
    v_mfma_f32_16x16x32_bf16 v[12:15], a[140:143], v[176:179], v[12:15]
    s_sub_u32 s3, s3, 1
    ds_read_b128 a[124:127], v230 offset:1216
    v_add_f32 v227, v227, v156
    v_mfma_f32_16x16x32_bf16 v[44:47], a[140:143], v[180:183], v[44:47]
    s_cselect_b32 s24, s30, s24
    v_exp_f32 v157, v157
    v_mfma_f32_16x16x32_bf16 v[16:19], a[144:147], v[176:179], v[16:19]
    s_cselect_b32 s10, s31, s10
    v_add_f32 v227, v227, v157
    v_cvt_pk_bf16_f32 v190, v156, v157
    v_mfma_f32_16x16x32_bf16 v[48:51], a[144:147], v[180:183], v[48:51]
    v_exp_f32 v158, v158
    v_mfma_f32_16x16x32_bf16 v[20:23], a[148:151], v[176:179], v[20:23]
    v_exp_f32 v159, v159
    v_mfma_f32_16x16x32_bf16 v[52:55], a[148:151], v[180:183], v[52:55]
    v_add_f32 v227, v227, v158
    v_add_f32 v227, v227, v159
    v_mfma_f32_16x16x32_bf16 v[24:27], a[152:155], v[176:179], v[24:27]
    v_exp_f32 v160, v160
    v_mfma_f32_16x16x32_bf16 v[56:59], a[152:155], v[180:183], v[56:59]
    v_exp_f32 v161, v161
    v_mfma_f32_16x16x32_bf16 v[28:31], a[156:159], v[176:179], v[28:31]
    v_cvt_pk_bf16_f32 v191, v158, v159
    v_cvt_pk_bf16_f32 v192, v160, v161
    v_mfma_f32_16x16x32_bf16 v[60:63], a[156:159], v[180:183], v[60:63]
    v_exp_f32 v162, v162
    v_mfma_f32_16x16x32_bf16 v[128:131], a[96:99], a[0:3], v[200:203]
    v_exp_f32 v163, v163
    v_mfma_f32_16x16x32_bf16 v[128:131], a[100:103], a[4:7], v[128:131]
    s_waitcnt lgkmcnt(0)
    v_exp_f32 v164, v164
    v_mfma_f32_16x16x32_bf16 v[128:131], a[104:107], a[8:11], v[128:131]
    s_mov_b32 m0, s27
    v_exp_f32 v165, v165
    v_mfma_f32_16x16x32_bf16 v[128:131], a[108:111], a[12:15], v[128:131]
    s_add_u32 s27, s27, 16640
    v_cvt_pk_bf16_f32 v193, v162, v163
    v_cvt_pk_bf16_f32 v194, v164, v165
    v_mfma_f32_16x16x32_bf16 v[132:135], a[112:115], a[0:3], v[200:203]
    s_cmp_eq_u32 s27, s29
    v_exp_f32 v166, v166
    v_mfma_f32_16x16x32_bf16 v[132:135], a[116:119], a[4:7], v[132:135]
    s_cselect_b32 s27, s28, s27
    v_exp_f32 v167, v167
    v_mfma_f32_16x16x32_bf16 v[132:135], a[120:123], a[8:11], v[132:135]
    s_waitcnt vmcnt(12)
    v_exp_f32 v128, v128
    v_mfma_f32_16x16x32_bf16 v[132:135], a[124:127], a[12:15], v[132:135]
    s_barrier
    v_mfma_f32_16x16x32_bf16 v[136:139], a[96:99], a[16:19], v[204:207]
    buffer_load_dwordx4 v236, s[12:15], s25 offen offset:2048 lds
    v_mfma_f32_16x16x32_bf16 v[136:139], a[100:103], a[20:23], v[136:139]
    v_add_u32 v231, s27, v233
    v_add_u32 v230, s27, v232
    v_mfma_f32_16x16x32_bf16 v[136:139], a[104:107], a[24:27], v[136:139]
    v_cvt_pk_bf16_f32 v195, v166, v167
    v_add_f32 v224, v224, v128
    v_mfma_f32_16x16x32_bf16 v[136:139], a[108:111], a[28:31], v[136:139]
    v_exp_f32 v129, v129
    v_mfma_f32_16x16x32_bf16 v[140:143], a[112:115], a[16:19], v[204:207]
    v_add_f32 v224, v224, v129
    v_cvt_pk_bf16_f32 v176, v128, v129
    v_mfma_f32_16x16x32_bf16 v[140:143], a[116:119], a[20:23], v[140:143]
    v_exp_f32 v130, v130
    v_mfma_f32_16x16x32_bf16 v[140:143], a[120:123], a[24:27], v[140:143]
    v_exp_f32 v131, v131
    v_mfma_f32_16x16x32_bf16 v[140:143], a[124:127], a[28:31], v[140:143]
    v_add_f32 v224, v224, v130
    v_add_f32 v224, v224, v131
    v_mfma_f32_16x16x32_bf16 v[64:67], a[128:131], v[184:187], v[64:67]
    v_exp_f32 v132, v132
    v_mfma_f32_16x16x32_bf16 v[96:99], a[128:131], v[188:191], v[96:99]
    v_cvt_pk_bf16_f32 v177, v130, v131
    v_add_f32 v224, v224, v132
    v_mfma_f32_16x16x32_bf16 a[160:163], a[128:131], v[192:195], a[160:163]
    v_exp_f32 v133, v133
    v_mfma_f32_16x16x32_bf16 a[236:239], a[224:227], v[184:187], a[236:239]
    ds_read_b64_tr_b16 a[128:129], v231 offset:0
    ds_read_b64_tr_b16 a[130:131], v231 offset:512
    v_mfma_f32_16x16x32_bf16 a[244:247], a[224:227], v[192:195], a[244:247]
    v_add_f32 v224, v224, v133
    v_cvt_pk_bf16_f32 v178, v132, v133
    v_mfma_f32_16x16x32_bf16 v[68:71], a[132:135], v[184:187], v[68:71]
    v_exp_f32 v134, v134
    v_mfma_f32_16x16x32_bf16 v[100:103], a[132:135], v[188:191], v[100:103]
    v_exp_f32 v135, v135
    v_mfma_f32_16x16x32_bf16 a[164:167], a[132:135], v[192:195], a[164:167]
    ds_read_b64_tr_b16 a[132:133], v231 offset:32
    v_add_f32 v224, v224, v134
    v_mfma_f32_16x16x32_bf16 v[72:75], a[136:139], v[184:187], v[72:75]
    ds_read_b64_tr_b16 a[134:135], v231 offset:544
    v_add_f32 v224, v224, v135
    v_mfma_f32_16x16x32_bf16 v[104:107], a[136:139], v[188:191], v[104:107]
    v_exp_f32 v136, v136
    v_mfma_f32_16x16x32_bf16 a[168:171], a[136:139], v[192:195], a[168:171]
    ds_read_b64_tr_b16 a[136:137], v231 offset:64
    v_cvt_pk_bf16_f32 v179, v134, v135
    v_mfma_f32_16x16x32_bf16 v[76:79], a[140:143], v[184:187], v[76:79]
    v_add_f32 v225, v225, v136
    v_mfma_f32_16x16x32_bf16 v[108:111], a[140:143], v[188:191], v[108:111]
    buffer_load_dwordx4 v237, s[12:15], s25 offen offset:3104 lds
    v_mfma_f32_16x16x32_bf16 a[172:175], a[140:143], v[192:195], a[172:175]
    s_add_u32 s14, s10, 4096
    v_exp_f32 v137, v137
    v_mfma_f32_16x16x32_bf16 v[80:83], a[144:147], v[184:187], v[80:83]
    s_mov_b32 s25, s24
    v_add_f32 v225, v225, v137
    v_cvt_pk_bf16_f32 v180, v136, v137
    v_mfma_f32_16x16x32_bf16 v[112:115], a[144:147], v[188:191], v[112:115]
    s_sub_u32 s26, s26, 1
    v_exp_f32 v138, v138
    v_mfma_f32_16x16x32_bf16 a[176:179], a[144:147], v[192:195], a[176:179]
    ds_read_b64_tr_b16 a[138:139], v231 offset:576
    v_add_f32 v225, v225, v138
    v_mfma_f32_16x16x32_bf16 v[84:87], a[148:151], v[184:187], v[84:87]
    v_exp_f32 v139, v139
    v_mfma_f32_16x16x32_bf16 v[116:119], a[148:151], v[188:191], v[116:119]
    ds_read_b64_tr_b16 a[140:141], v231 offset:96
    v_add_f32 v225, v225, v139
    v_mfma_f32_16x16x32_bf16 a[180:183], a[148:151], v[192:195], a[180:183]
    ds_read_b64_tr_b16 a[142:143], v231 offset:608
    v_cvt_pk_bf16_f32 v181, v138, v139
    v_mfma_f32_16x16x32_bf16 v[88:91], a[152:155], v[184:187], v[88:91]
    v_exp_f32 v140, v140
    v_mfma_f32_16x16x32_bf16 v[120:123], a[152:155], v[188:191], v[120:123]
    ds_read_b64_tr_b16 a[144:145], v231 offset:128
    v_add_f32 v225, v225, v140
    v_mfma_f32_16x16x32_bf16 a[184:187], a[152:155], v[192:195], a[184:187]
    v_exp_f32 v141, v141
    v_mfma_f32_16x16x32_bf16 v[92:95], a[156:159], v[184:187], v[92:95]
    v_add_f32 v225, v225, v141
    v_cvt_pk_bf16_f32 v182, v140, v141
    v_mfma_f32_16x16x32_bf16 v[124:127], a[156:159], v[188:191], v[124:127]
    v_exp_f32 v142, v142
    v_mfma_f32_16x16x32_bf16 a[188:191], a[156:159], v[192:195], a[188:191]
    s_cbranch_scc0 L_loop5
    s_cmp_eq_u32 s91, 0
    s_cbranch_scc1 L_out5
    s_mov_b32 s26, s94
L_lq5:
    v_mfma_f32_16x16x32_bf16 v[144:147], a[96:99], a[32:35], v[208:211]
    s_mov_b32 s70, m0
    ds_read_b64_tr_b16 a[146:147], v231 offset:640
    v_add_f32 v225, v225, v142
    v_mfma_f32_16x16x32_bf16 v[144:147], a[100:103], a[36:39], v[144:147]
    v_exp_f32 v143, v143
    v_mfma_f32_16x16x32_bf16 v[144:147], a[104:107], a[40:43], v[144:147]
    v_add_f32 v225, v225, v143
    v_cvt_pk_bf16_f32 v183, v142, v143
    v_mfma_f32_16x16x32_bf16 v[144:147], a[108:111], a[44:47], v[144:147]
    s_mov_b32 m0, s70
    ds_read_b64_tr_b16 a[148:149], v231 offset:160
    ds_read_b64_tr_b16 a[150:151], v231 offset:672
    v_mfma_f32_16x16x32_bf16 v[148:151], a[112:115], a[32:35], v[208:211]
    buffer_load_dwordx4 v234, s[8:11], s24 offen lds
    v_mfma_f32_16x16x32_bf16 v[148:151], a[116:119], a[36:39], v[148:151]
    ds_read_b64_tr_b16 a[152:153], v231 offset:192
    ds_read_b64_tr_b16 a[154:155], v231 offset:704
    v_mfma_f32_16x16x32_bf16 v[148:151], a[120:123], a[40:43], v[148:151]
    v_exp_f32 v144, v144
    v_mfma_f32_16x16x32_bf16 v[148:151], a[124:127], a[44:47], v[148:151]
    v_exp_f32 v145, v145
    v_mfma_f32_16x16x32_bf16 v[152:155], a[96:99], a[48:51], v[212:215]
    ds_read_b64_tr_b16 a[156:157], v231 offset:224
    v_cvt_pk_bf16_f32 v184, v144, v145
    v_mfma_f32_16x16x32_bf16 v[152:155], a[100:103], a[52:55], v[152:155]
    v_exp_f32 v146, v146
    v_mfma_f32_16x16x32_bf16 v[152:155], a[104:107], a[56:59], v[152:155]
    v_exp_f32 v147, v147
    v_mfma_f32_16x16x32_bf16 v[152:155], a[108:111], a[60:63], v[152:155]
    ds_read_b64_tr_b16 a[158:159], v231 offset:736
    v_cvt_pk_bf16_f32 v185, v146, v147
    v_mfma_f32_16x16x32_bf16 v[156:159], a[112:115], a[48:51], v[212:215]
    v_exp_f32 v148, v148
    v_mfma_f32_16x16x32_bf16 v[156:159], a[116:119], a[52:55], v[156:159]
    v_exp_f32 v149, v149
    v_mfma_f32_16x16x32_bf16 v[156:159], a[120:123], a[56:59], v[156:159]
    v_exp_f32 v150, v150
    v_mfma_f32_16x16x32_bf16 v[156:159], a[124:127], a[60:63], v[156:159]
    s_mov_b32 m0, s92
    v_cvt_pk_bf16_f32 v186, v148, v149
    v_mfma_f32_16x16x32_bf16 v[160:163], a[96:99], a[64:67], v[216:219]
    buffer_load_dwordx4 v234, s[16:19], s93 offen lds
    v_mfma_f32_16x16x32_bf16 v[160:163], a[100:103], a[68:71], v[160:163]
    s_add_u32 s92, s92, 1088
    v_exp_f32 v151, v151
    v_mfma_f32_16x16x32_bf16 v[160:163], a[104:107], a[72:75], v[160:163]
    s_add_u32 s93, s93, 16384
    ds_read_b128 a[96:99], v230 offset:0
    v_cvt_pk_bf16_f32 v187, v150, v151
    v_mfma_f32_16x16x32_bf16 v[160:163], a[108:111], a[76:79], v[160:163]
    v_exp_f32 v152, v152
    v_mfma_f32_16x16x32_bf16 v[164:167], a[112:115], a[64:67], v[216:219]
    ds_read_b128 a[100:103], v230 offset:64
    v_add_f32 v227, v227, v152
    v_mfma_f32_16x16x32_bf16 v[164:167], a[116:119], a[68:71], v[164:167]
    v_exp_f32 v153, v153
    v_mfma_f32_16x16x32_bf16 v[164:167], a[120:123], a[72:75], v[164:167]
    ds_read_b128 a[104:107], v230 offset:128
    v_add_f32 v227, v227, v153
    v_mfma_f32_16x16x32_bf16 v[164:167], a[124:127], a[76:79], v[164:167]
    s_waitcnt lgkmcnt(3)
    ds_read_b128 a[108:111], v230 offset:192
    v_cvt_pk_bf16_f32 v188, v152, v153
    v_mfma_f32_16x16x32_bf16 v[0:3], a[128:131], v[176:179], v[0:3]
    v_exp_f32 v154, v154
    v_mfma_f32_16x16x32_bf16 v[32:35], a[128:131], v[180:183], v[32:35]
    ds_read_b128 a[112:115], v230 offset:1024
    v_add_f32 v227, v227, v154
    v_mfma_f32_16x16x32_bf16 v[4:7], a[132:135], v[176:179], v[4:7]
    v_exp_f32 v155, v155
    v_mfma_f32_16x16x32_bf16 v[36:39], a[132:135], v[180:183], v[36:39]
    s_mov_b32 m0, s70
    v_add_f32 v227, v227, v155
    v_mfma_f32_16x16x32_bf16 v[8:11], a[136:139], v[176:179], v[8:11]
    buffer_load_dwordx4 v235, s[8:11], s24 offen offset:1024 lds
    v_mfma_f32_16x16x32_bf16 v[40:43], a[136:139], v[180:183], v[40:43]
    s_add_u32 s24, s24, 131072
    ds_read_b128 a[116:119], v230 offset:1088
    v_cvt_pk_bf16_f32 v189, v154, v155
    v_mfma_f32_16x16x32_bf16 v[12:15], a[140:143], v[176:179], v[12:15]
    s_sub_u32 s3, s3, 1
    v_exp_f32 v156, v156
    v_mfma_f32_16x16x32_bf16 v[44:47], a[140:143], v[180:183], v[44:47]
    s_cselect_b32 s24, s30, s24
    ds_read_b128 a[120:123], v230 offset:1152
    v_add_f32 v227, v227, v156
    v_mfma_f32_16x16x32_bf16 v[16:19], a[144:147], v[176:179], v[16:19]
    s_cselect_b32 s10, s31, s10
    v_exp_f32 v157, v157
    v_mfma_f32_16x16x32_bf16 v[48:51], a[144:147], v[180:183], v[48:51]
    ds_read_b128 a[124:127], v230 offset:1216
    v_add_f32 v227, v227, v157
    v_mfma_f32_16x16x32_bf16 v[20:23], a[148:151], v[176:179], v[20:23]
    v_exp_f32 v158, v158
    v_mfma_f32_16x16x32_bf16 v[52:55], a[148:151], v[180:183], v[52:55]
    v_cvt_pk_bf16_f32 v190, v156, v157
    v_add_f32 v227, v227, v158
    v_mfma_f32_16x16x32_bf16 v[24:27], a[152:155], v[176:179], v[24:27]
    v_exp_f32 v159, v159
    v_mfma_f32_16x16x32_bf16 v[56:59], a[152:155], v[180:183], v[56:59]
    s_mov_b32 m0, s92
    v_add_f32 v227, v227, v159
    v_mfma_f32_16x16x32_bf16 v[28:31], a[156:159], v[176:179], v[28:31]
    buffer_load_dwordx4 v234, s[16:19], s93 offen lds
    v_mfma_f32_16x16x32_bf16 v[60:63], a[156:159], v[180:183], v[60:63]
    s_waitcnt lgkmcnt(0)
    v_exp_f32 v160, v160
    v_mfma_f32_16x16x32_bf16 v[128:131], a[96:99], a[0:3], v[200:203]
    s_add_u32 s92, s92, 1088
    v_exp_f32 v161, v161
    v_mfma_f32_16x16x32_bf16 v[128:131], a[100:103], a[4:7], v[128:131]
    s_add_u32 s93, s93, 16384
    v_cvt_pk_bf16_f32 v191, v158, v159
    v_cvt_pk_bf16_f32 v192, v160, v161
    v_mfma_f32_16x16x32_bf16 v[128:131], a[104:107], a[8:11], v[128:131]
    s_mov_b32 s70, s27
    v_exp_f32 v162, v162
    v_mfma_f32_16x16x32_bf16 v[128:131], a[108:111], a[12:15], v[128:131]
    s_add_u32 s27, s27, 16640
    v_exp_f32 v163, v163
    v_mfma_f32_16x16x32_bf16 v[132:135], a[112:115], a[0:3], v[200:203]
    s_cmp_eq_u32 s27, s29
    v_exp_f32 v164, v164
    v_mfma_f32_16x16x32_bf16 v[132:135], a[116:119], a[4:7], v[132:135]
    s_cselect_b32 s27, s28, s27
    v_exp_f32 v165, v165
    v_mfma_f32_16x16x32_bf16 v[132:135], a[120:123], a[8:11], v[132:135]
    s_waitcnt vmcnt(14)
    v_cvt_pk_bf16_f32 v193, v162, v163
    v_cvt_pk_bf16_f32 v194, v164, v165
    v_mfma_f32_16x16x32_bf16 v[132:135], a[124:127], a[12:15], v[132:135]
    s_barrier
    v_mfma_f32_16x16x32_bf16 v[136:139], a[96:99], a[16:19], v[204:207]
    s_mov_b32 m0, s70
    v_add_u32 v231, s27, v233
    v_add_u32 v230, s27, v232
    v_mfma_f32_16x16x32_bf16 v[136:139], a[100:103], a[20:23], v[136:139]
    buffer_load_dwordx4 v236, s[12:15], s25 offen offset:2048 lds
    v_mfma_f32_16x16x32_bf16 v[136:139], a[104:107], a[24:27], v[136:139]
    v_exp_f32 v166, v166
    v_mfma_f32_16x16x32_bf16 v[136:139], a[108:111], a[28:31], v[136:139]
    v_exp_f32 v167, v167
    v_mfma_f32_16x16x32_bf16 v[140:143], a[112:115], a[16:19], v[204:207]
    v_exp_f32 v128, v128
    v_mfma_f32_16x16x32_bf16 v[140:143], a[116:119], a[20:23], v[140:143]
    v_cvt_pk_bf16_f32 v195, v166, v167
    v_add_f32 v224, v224, v128
    v_mfma_f32_16x16x32_bf16 v[140:143], a[120:123], a[24:27], v[140:143]
    v_exp_f32 v129, v129
    v_mfma_f32_16x16x32_bf16 v[140:143], a[124:127], a[28:31], v[140:143]
    v_add_f32 v224, v224, v129
    v_cvt_pk_bf16_f32 v176, v128, v129
    v_mfma_f32_16x16x32_bf16 v[64:67], a[128:131], v[184:187], v[64:67]
    v_exp_f32 v130, v130
    v_mfma_f32_16x16x32_bf16 v[96:99], a[128:131], v[188:191], v[96:99]
    v_exp_f32 v131, v131
    v_mfma_f32_16x16x32_bf16 a[160:163], a[128:131], v[192:195], a[160:163]
    ds_read_b64_tr_b16 a[128:129], v231 offset:0
    v_add_f32 v224, v224, v130
    v_mfma_f32_16x16x32_bf16 a[236:239], a[224:227], v[184:187], a[236:239]
    v_add_f32 v224, v224, v131
    v_cvt_pk_bf16_f32 v177, v130, v131
    v_mfma_f32_16x16x32_bf16 a[244:247], a[224:227], v[192:195], a[244:247]
    v_exp_f32 v132, v132
    v_mfma_f32_16x16x32_bf16 v[68:71], a[132:135], v[184:187], v[68:71]
    ds_read_b64_tr_b16 a[130:131], v231 offset:512
    v_add_f32 v224, v224, v132
    v_mfma_f32_16x16x32_bf16 v[100:103], a[132:135], v[188:191], v[100:103]
    v_exp_f32 v133, v133
    v_mfma_f32_16x16x32_bf16 a[164:167], a[132:135], v[192:195], a[164:167]
    v_add_f32 v224, v224, v133
    v_cvt_pk_bf16_f32 v178, v132, v133
    v_mfma_f32_16x16x32_bf16 v[72:75], a[136:139], v[184:187], v[72:75]
    v_exp_f32 v134, v134
    v_mfma_f32_16x16x32_bf16 v[104:107], a[136:139], v[188:191], v[104:107]
    ds_read_b64_tr_b16 a[132:133], v231 offset:32
    v_add_f32 v224, v224, v134
    v_mfma_f32_16x16x32_bf16 a[168:171], a[136:139], v[192:195], a[168:171]
    v_exp_f32 v135, v135
    v_mfma_f32_16x16x32_bf16 v[76:79], a[140:143], v[184:187], v[76:79]
    s_mov_b32 m0, s70
    v_add_f32 v224, v224, v135
    v_mfma_f32_16x16x32_bf16 v[108:111], a[140:143], v[188:191], v[108:111]
    buffer_load_dwordx4 v237, s[12:15], s25 offen offset:3104 lds
    v_mfma_f32_16x16x32_bf16 a[172:175], a[140:143], v[192:195], a[172:175]
    s_add_u32 s14, s10, 4096
    ds_read_b64_tr_b16 a[134:135], v231 offset:544
    v_cvt_pk_bf16_f32 v179, v134, v135
    v_mfma_f32_16x16x32_bf16 v[80:83], a[144:147], v[184:187], v[80:83]
    s_mov_b32 s25, s24
    v_exp_f32 v136, v136
    v_mfma_f32_16x16x32_bf16 v[112:115], a[144:147], v[188:191], v[112:115]
    s_mov_b32 m0, s70
    ds_read_b64_tr_b16 a[136:137], v231 offset:64
    v_add_f32 v225, v225, v136
    v_mfma_f32_16x16x32_bf16 a[176:179], a[144:147], v[192:195], a[176:179]
    s_sub_u32 s26, s26, 1
    v_exp_f32 v137, v137
    v_mfma_f32_16x16x32_bf16 v[84:87], a[148:151], v[184:187], v[84:87]
    v_add_f32 v225, v225, v137
    v_cvt_pk_bf16_f32 v180, v136, v137
    v_mfma_f32_16x16x32_bf16 v[116:119], a[148:151], v[188:191], v[116:119]
    v_exp_f32 v138, v138
    v_mfma_f32_16x16x32_bf16 a[180:183], a[148:151], v[192:195], a[180:183]
    ds_read_b64_tr_b16 a[138:139], v231 offset:576
    v_add_f32 v225, v225, v138
    v_mfma_f32_16x16x32_bf16 v[88:91], a[152:155], v[184:187], v[88:91]
    v_exp_f32 v139, v139
    v_mfma_f32_16x16x32_bf16 v[120:123], a[152:155], v[188:191], v[120:123]
    ds_read_b64_tr_b16 a[140:141], v231 offset:96
    v_add_f32 v225, v225, v139
    v_mfma_f32_16x16x32_bf16 a[184:187], a[152:155], v[192:195], a[184:187]
    ds_read_b64_tr_b16 a[142:143], v231 offset:608
    v_cvt_pk_bf16_f32 v181, v138, v139
    v_mfma_f32_16x16x32_bf16 v[92:95], a[156:159], v[184:187], v[92:95]
    v_exp_f32 v140, v140
    v_mfma_f32_16x16x32_bf16 v[124:127], a[156:159], v[188:191], v[124:127]
    ds_read_b64_tr_b16 a[144:145], v231 offset:128
    v_add_f32 v225, v225, v140
    v_mfma_f32_16x16x32_bf16 a[188:191], a[156:159], v[192:195], a[188:191]
    v_exp_f32 v141, v141
    v_exp_f32 v142, v142
    v_add_f32 v225, v225, v141
    v_cvt_pk_bf16_f32 v182, v140, v141
    s_cbranch_scc0 L_lq5
    s_sub_u32 s26, s91, 1
    s_mov_b32 s91, 0
    s_branch L_loop5
L_out5:
    s_cmp_eq_u32 s71, 8
    s_cbranch_scc1 L_tail5_8
L_tail5_2:
    v_mfma_f32_16x16x32_bf16 v[144:147], a[96:99], a[32:35], v[208:211]
    s_mov_b32 s70, m0
    ds_read_b64_tr_b16 a[146:147], v231 offset:640
    v_add_f32 v225, v225, v142
    v_mfma_f32_16x16x32_bf16 v[144:147], a[100:103], a[36:39], v[144:147]
    v_exp_f32 v143, v143
    v_mfma_f32_16x16x32_bf16 v[144:147], a[104:107], a[40:43], v[144:147]
    v_add_f32 v225, v225, v143
    v_cvt_pk_bf16_f32 v183, v142, v143
    v_mfma_f32_16x16x32_bf16 v[144:147], a[108:111], a[44:47], v[144:147]
    s_mov_b32 m0, s70
    ds_read_b64_tr_b16 a[148:149], v231 offset:160
    ds_read_b64_tr_b16 a[150:151], v231 offset:672
    v_mfma_f32_16x16x32_bf16 v[148:151], a[112:115], a[32:35], v[208:211]
    buffer_load_dwordx4 v234, s[8:11], s24 offen lds
    v_mfma_f32_16x16x32_bf16 v[148:151], a[116:119], a[36:39], v[148:151]
    ds_read_b64_tr_b16 a[152:153], v231 offset:192
    ds_read_b64_tr_b16 a[154:155], v231 offset:704
    v_mfma_f32_16x16x32_bf16 v[148:151], a[120:123], a[40:43], v[148:151]
    v_exp_f32 v144, v144
    v_mfma_f32_16x16x32_bf16 v[148:151], a[124:127], a[44:47], v[148:151]
    v_exp_f32 v145, v145
    v_mfma_f32_16x16x32_bf16 v[152:155], a[96:99], a[48:51], v[212:215]
    ds_read_b64_tr_b16 a[156:157], v231 offset:224
    v_cvt_pk_bf16_f32 v184, v144, v145
    v_mfma_f32_16x16x32_bf16 v[152:155], a[100:103], a[52:55], v[152:155]
    v_exp_f32 v146, v146
    v_mfma_f32_16x16x32_bf16 v[152:155], a[104:107], a[56:59], v[152:155]
    ds_read_b64_tr_b16 a[158:159], v231 offset:736
    v_sub_u32 v244, s38, v240
    v_mfma_f32_16x16x32_bf16 v[152:155], a[108:111], a[60:63], v[152:155]
    v_exp_f32 v147, v147
    v_mfma_f32_16x16x32_bf16 v[156:159], a[112:115], a[48:51], v[212:215]
    v_exp_f32 v148, v148
    v_mfma_f32_16x16x32_bf16 v[156:159], a[116:119], a[52:55], v[156:159]
    v_exp_f32 v149, v149
    v_mfma_f32_16x16x32_bf16 v[156:159], a[120:123], a[56:59], v[156:159]
    v_cvt_pk_bf16_f32 v185, v146, v147
    v_cvt_pk_bf16_f32 v186, v148, v149
    v_mfma_f32_16x16x32_bf16 v[156:159], a[124:127], a[60:63], v[156:159]
    v_exp_f32 v150, v150
    v_mfma_f32_16x16x32_bf16 v[160:163], a[96:99], a[64:67], v[216:219]
    v_exp_f32 v151, v151
    v_mfma_f32_16x16x32_bf16 v[160:163], a[100:103], a[68:71], v[160:163]
    ds_read_b128 a[96:99], v230 offset:0
    ds_read_b128 a[100:103], v230 offset:64
    v_mfma_f32_16x16x32_bf16 v[160:163], a[104:107], a[72:75], v[160:163]
    ds_read_b128 a[104:107], v230 offset:128
    v_cvt_pk_bf16_f32 v187, v150, v151
    v_mfma_f32_16x16x32_bf16 v[160:163], a[108:111], a[76:79], v[160:163]
    v_exp_f32 v152, v152
    v_mfma_f32_16x16x32_bf16 v[164:167], a[112:115], a[64:67], v[216:219]
    ds_read_b128 a[108:111], v230 offset:192
    v_add_f32 v227, v227, v152
    v_mfma_f32_16x16x32_bf16 v[164:167], a[116:119], a[68:71], v[164:167]
    v_exp_f32 v153, v153
    v_mfma_f32_16x16x32_bf16 v[164:167], a[120:123], a[72:75], v[164:167]
    ds_read_b128 a[112:115], v230 offset:1024
    v_add_f32 v227, v227, v153
    v_mfma_f32_16x16x32_bf16 v[164:167], a[124:127], a[76:79], v[164:167]
    s_waitcnt lgkmcnt(3)
    ds_read_b128 a[116:119], v230 offset:1088
    v_cvt_pk_bf16_f32 v188, v152, v153
    v_mfma_f32_16x16x32_bf16 v[0:3], a[128:131], v[176:179], v[0:3]
    v_exp_f32 v154, v154
    v_mfma_f32_16x16x32_bf16 v[32:35], a[128:131], v[180:183], v[32:35]
    ds_read_b128 a[120:123], v230 offset:1152
    v_add_f32 v227, v227, v154
    v_mfma_f32_16x16x32_bf16 v[4:7], a[132:135], v[176:179], v[4:7]
    v_exp_f32 v155, v155
    v_mfma_f32_16x16x32_bf16 v[36:39], a[132:135], v[180:183], v[36:39]
    s_mov_b32 m0, s70
    v_add_f32 v227, v227, v155
    v_cvt_pk_bf16_f32 v189, v154, v155
    v_mfma_f32_16x16x32_bf16 v[8:11], a[136:139], v[176:179], v[8:11]
    buffer_load_dwordx4 v235, s[8:11], s24 offen offset:1024 lds
    v_mfma_f32_16x16x32_bf16 v[40:43], a[136:139], v[180:183], v[40:43]
    s_add_u32 s24, s24, 131072
    v_exp_f32 v156, v156
    v_mfma_f32_16x16x32_bf16 v[12:15], a[140:143], v[176:179], v[12:15]
    s_sub_u32 s3, s3, 1
    ds_read_b128 a[124:127], v230 offset:1216
    v_add_f32 v227, v227, v156
    v_mfma_f32_16x16x32_bf16 v[44:47], a[140:143], v[180:183], v[44:47]
    v_exp_f32 v157, v157
    v_mfma_f32_16x16x32_bf16 v[16:19], a[144:147], v[176:179], v[16:19]
    v_add_f32 v227, v227, v157
    v_cvt_pk_bf16_f32 v190, v156, v157
    v_mfma_f32_16x16x32_bf16 v[48:51], a[144:147], v[180:183], v[48:51]
    v_exp_f32 v158, v158
    v_mfma_f32_16x16x32_bf16 v[20:23], a[148:151], v[176:179], v[20:23]
    v_exp_f32 v159, v159
    v_mfma_f32_16x16x32_bf16 v[52:55], a[148:151], v[180:183], v[52:55]
    v_add_f32 v227, v227, v158
    v_add_f32 v227, v227, v159
    v_mfma_f32_16x16x32_bf16 v[24:27], a[152:155], v[176:179], v[24:27]
    v_exp_f32 v160, v160
    v_mfma_f32_16x16x32_bf16 v[56:59], a[152:155], v[180:183], v[56:59]
    v_exp_f32 v161, v161
    v_mfma_f32_16x16x32_bf16 v[28:31], a[156:159], v[176:179], v[28:31]
    v_cvt_pk_bf16_f32 v191, v158, v159
    v_cvt_pk_bf16_f32 v192, v160, v161
    v_mfma_f32_16x16x32_bf16 v[60:63], a[156:159], v[180:183], v[60:63]
    v_exp_f32 v162, v162
    v_mfma_f32_16x16x32_bf16 v[128:131], a[96:99], a[0:3], v[200:203]
    v_exp_f32 v163, v163
    v_mfma_f32_16x16x32_bf16 v[128:131], a[100:103], a[4:7], v[128:131]
    s_waitcnt lgkmcnt(0)
    v_exp_f32 v164, v164
    v_mfma_f32_16x16x32_bf16 v[128:131], a[104:107], a[8:11], v[128:131]
    s_mov_b32 s70, s27
    v_exp_f32 v165, v165
    v_mfma_f32_16x16x32_bf16 v[128:131], a[108:111], a[12:15], v[128:131]
    s_add_u32 s27, s27, 16640
    v_cvt_pk_bf16_f32 v193, v162, v163
    v_cvt_pk_bf16_f32 v194, v164, v165
    v_mfma_f32_16x16x32_bf16 v[132:135], a[112:115], a[0:3], v[200:203]
    s_cmp_eq_u32 s27, s29
    v_exp_f32 v166, v166
    v_mfma_f32_16x16x32_bf16 v[132:135], a[116:119], a[4:7], v[132:135]
    s_cselect_b32 s27, s28, s27
    v_exp_f32 v167, v167
    v_mfma_f32_16x16x32_bf16 v[132:135], a[120:123], a[8:11], v[132:135]
    s_waitcnt vmcnt(12)
    v_exp_f32 v128, v128
    v_mfma_f32_16x16x32_bf16 v[132:135], a[124:127], a[12:15], v[132:135]
    s_barrier
    v_mfma_f32_16x16x32_bf16 v[136:139], a[96:99], a[16:19], v[204:207]
    s_mov_b32 m0, s70
    v_add_u32 v231, s27, v233
    v_add_u32 v230, s27, v232
    v_mfma_f32_16x16x32_bf16 v[136:139], a[100:103], a[20:23], v[136:139]
    buffer_load_dwordx4 v236, s[12:15], s25 offen offset:2048 lds
    v_mfma_f32_16x16x32_bf16 v[136:139], a[104:107], a[24:27], v[136:139]
    v_cvt_pk_bf16_f32 v195, v166, v167
    v_cndmask_b32 v128, 0, v128, s[40:41]
    v_mfma_f32_16x16x32_bf16 v[136:139], a[108:111], a[28:31], v[136:139]
    v_exp_f32 v129, v129
    v_mfma_f32_16x16x32_bf16 v[140:143], a[112:115], a[16:19], v[204:207]
    v_add_f32 v224, v224, v128
    v_cndmask_b32 v129, 0, v129, s[42:43]
    v_mfma_f32_16x16x32_bf16 v[140:143], a[116:119], a[20:23], v[140:143]
    v_add_f32 v224, v224, v129
    v_cvt_pk_bf16_f32 v176, v128, v129
    v_mfma_f32_16x16x32_bf16 v[140:143], a[120:123], a[24:27], v[140:143]
    v_exp_f32 v130, v130
    v_mfma_f32_16x16x32_bf16 v[140:143], a[124:127], a[28:31], v[140:143]
    v_exp_f32 v131, v131
    v_mfma_f32_16x16x32_bf16 v[64:67], a[128:131], v[184:187], v[64:67]
    v_cndmask_b32 v130, 0, v130, s[44:45]
    v_add_f32 v224, v224, v130
    v_mfma_f32_16x16x32_bf16 v[96:99], a[128:131], v[188:191], v[96:99]
    v_exp_f32 v132, v132
    v_mfma_f32_16x16x32_bf16 a[160:163], a[128:131], v[192:195], a[160:163]
    ds_read_b64_tr_b16 a[128:129], v231 offset:0
    v_cndmask_b32 v131, 0, v131, s[46:47]
    v_mfma_f32_16x16x32_bf16 a[236:239], a[224:227], v[184:187], a[236:239]
    v_add_f32 v224, v224, v131
    v_cvt_pk_bf16_f32 v177, v130, v131
    v_mfma_f32_16x16x32_bf16 a[244:247], a[224:227], v[192:195], a[244:247]
    ds_read_b64_tr_b16 a[130:131], v231 offset:512
    v_cndmask_b32 v132, 0, v132, s[48:49]
    v_mfma_f32_16x16x32_bf16 v[68:71], a[132:135], v[184:187], v[68:71]
    v_exp_f32 v133, v133
    v_mfma_f32_16x16x32_bf16 v[100:103], a[132:135], v[188:191], v[100:103]
    v_add_f32 v224, v224, v132
    v_cndmask_b32 v133, 0, v133, s[50:51]
    v_mfma_f32_16x16x32_bf16 a[164:167], a[132:135], v[192:195], a[164:167]
    v_add_f32 v224, v224, v133
    v_cvt_pk_bf16_f32 v178, v132, v133
    v_mfma_f32_16x16x32_bf16 v[72:75], a[136:139], v[184:187], v[72:75]
    v_exp_f32 v134, v134
    v_mfma_f32_16x16x32_bf16 v[104:107], a[136:139], v[188:191], v[104:107]
    ds_read_b64_tr_b16 a[132:133], v231 offset:32
    v_cndmask_b32 v134, 0, v134, s[52:53]
    v_mfma_f32_16x16x32_bf16 a[168:171], a[136:139], v[192:195], a[168:171]
    ds_read_b64_tr_b16 a[134:135], v231 offset:544
    v_add_f32 v224, v224, v134
    v_mfma_f32_16x16x32_bf16 v[76:79], a[140:143], v[184:187], v[76:79]
    s_mov_b32 m0, s70
    v_exp_f32 v135, v135
    v_mfma_f32_16x16x32_bf16 v[108:111], a[140:143], v[188:191], v[108:111]
    buffer_load_dwordx4 v237, s[12:15], s25 offen offset:3104 lds
    v_mfma_f32_16x16x32_bf16 a[172:175], a[140:143], v[192:195], a[172:175]
    s_add_u32 s14, s10, 4096
    ds_read_b64_tr_b16 a[136:137], v231 offset:64
    v_cndmask_b32 v135, 0, v135, s[54:55]
    v_mfma_f32_16x16x32_bf16 v[80:83], a[144:147], v[184:187], v[80:83]
    s_mov_b32 s25, s24
    v_add_f32 v224, v224, v135
    v_cvt_pk_bf16_f32 v179, v134, v135
    v_mfma_f32_16x16x32_bf16 v[112:115], a[144:147], v[188:191], v[112:115]
    v_exp_f32 v136, v136
    v_mfma_f32_16x16x32_bf16 a[176:179], a[144:147], v[192:195], a[176:179]
    ds_read_b64_tr_b16 a[138:139], v231 offset:576
    v_cndmask_b32 v136, 0, v136, s[40:41]
    v_mfma_f32_16x16x32_bf16 v[84:87], a[148:151], v[184:187], v[84:87]
    ds_read_b64_tr_b16 a[140:141], v231 offset:96
    v_add_f32 v225, v225, v136
    v_mfma_f32_16x16x32_bf16 v[116:119], a[148:151], v[188:191], v[116:119]
    v_exp_f32 v137, v137
    v_mfma_f32_16x16x32_bf16 a[180:183], a[148:151], v[192:195], a[180:183]
    ds_read_b64_tr_b16 a[142:143], v231 offset:608
    v_cndmask_b32 v137, 0, v137, s[42:43]
    v_mfma_f32_16x16x32_bf16 v[88:91], a[152:155], v[184:187], v[88:91]
    v_add_f32 v225, v225, v137
    v_cvt_pk_bf16_f32 v180, v136, v137
    v_mfma_f32_16x16x32_bf16 v[120:123], a[152:155], v[188:191], v[120:123]
    v_exp_f32 v138, v138
    v_mfma_f32_16x16x32_bf16 a[184:187], a[152:155], v[192:195], a[184:187]
    ds_read_b64_tr_b16 a[144:145], v231 offset:128
    v_cndmask_b32 v138, 0, v138, s[44:45]
    v_mfma_f32_16x16x32_bf16 v[92:95], a[156:159], v[184:187], v[92:95]
    ds_read_b64_tr_b16 a[146:147], v231 offset:640
    v_add_f32 v225, v225, v138
    v_mfma_f32_16x16x32_bf16 v[124:127], a[156:159], v[188:191], v[124:127]
    v_exp_f32 v139, v139
    v_mfma_f32_16x16x32_bf16 a[188:191], a[156:159], v[192:195], a[188:191]
    ds_read_b64_tr_b16 a[148:149], v231 offset:160
    v_cndmask_b32 v139, 0, v139, s[46:47]
    v_mfma_f32_16x16x32_bf16 v[144:147], a[96:99], a[32:35], v[208:211]
    v_add_f32 v225, v225, v139
    v_cvt_pk_bf16_f32 v181, v138, v139
    v_mfma_f32_16x16x32_bf16 v[144:147], a[100:103], a[36:39], v[144:147]
    s_mov_b32 m0, s70
    v_exp_f32 v140, v140
    v_mfma_f32_16x16x32_bf16 v[144:147], a[104:107], a[40:43], v[144:147]
    buffer_load_dwordx4 v234, s[8:11], s24 offen lds
    v_mfma_f32_16x16x32_bf16 v[144:147], a[108:111], a[44:47], v[144:147]
    v_cndmask_b32 v140, 0, v140, s[48:49]
    v_add_f32 v225, v225, v140
    v_mfma_f32_16x16x32_bf16 v[148:151], a[112:115], a[32:35], v[208:211]
    v_exp_f32 v141, v141
    v_mfma_f32_16x16x32_bf16 v[148:151], a[116:119], a[36:39], v[148:151]
    v_cndmask_b32 v141, 0, v141, s[50:51]
    v_add_f32 v225, v225, v141
    v_mfma_f32_16x16x32_bf16 v[148:151], a[120:123], a[40:43], v[148:151]
    v_exp_f32 v142, v142
    v_mfma_f32_16x16x32_bf16 v[148:151], a[124:127], a[44:47], v[148:151]
    ds_read_b64_tr_b16 a[150:151], v231 offset:672
    v_cndmask_b32 v142, 0, v142, s[52:53]
    v_mov_b32 v201, v224
    v_mfma_f32_16x16x32_bf16 v[152:155], a[96:99], a[48:51], v[212:215]
    ds_read_b64_tr_b16 a[152:153], v231 offset:192
    ds_read_b64_tr_b16 a[154:155], v231 offset:704
    v_cvt_pk_bf16_f32 v182, v140, v141
    v_mfma_f32_16x16x32_bf16 v[152:155], a[100:103], a[52:55], v[152:155]
    ds_read_b64_tr_b16 a[156:157], v231 offset:224
    ds_read_b64_tr_b16 a[158:159], v231 offset:736
    v_add_f32 v225, v225, v142
    v_mfma_f32_16x16x32_bf16 v[152:155], a[104:107], a[56:59], v[152:155]
    v_exp_f32 v143, v143
    v_permlane32_swap_b32 v201, v224
    v_mfma_f32_16x16x32_bf16 v[152:155], a[108:111], a[60:63], v[152:155]
    v_cndmask_b32 v143, 0, v143, s[54:55]
    v_add_f32 v225, v225, v143
    v_add_f32 v224, v224, v201
    v_mfma_f32_16x16x32_bf16 v[156:159], a[112:115], a[48:51], v[212:215]
    v_mov_b32 v201, v224
    v_mov_b32 v205, v225
    v_cvt_pk_bf16_f32 v183, v142, v143
    v_mfma_f32_16x16x32_bf16 v[156:159], a[116:119], a[52:55], v[156:159]
    v_permlane16_swap_b32 v201, v224
    v_permlane32_swap_b32 v205, v225
    v_add_f32 v224, v224, v201
    v_mfma_f32_16x16x32_bf16 v[156:159], a[120:123], a[56:59], v[156:159]
    v_add_f32 v225, v225, v205
    v_cmp_nle_f32 s[68:69], v224, s63
    v_mov_b32 v205, v225
    v_mfma_f32_16x16x32_bf16 v[156:159], a[124:127], a[60:63], v[156:159]
    v_exp_f32 v144, v144
    v_permlane16_swap_b32 v205, v225
    v_mfma_f32_16x16x32_bf16 v[160:163], a[96:99], a[64:67], v[216:219]
    ds_read_b128 a[96:99], v230 offset:0
    v_add_f32 v225, v225, v205
    v_cndmask_b32 v144, 0, v144, s[40:41]
    v_mfma_f32_16x16x32_bf16 v[160:163], a[100:103], a[68:71], v[160:163]
    ds_read_b128 a[100:103], v230 offset:64
    v_exp_f32 v145, v145
    v_mfma_f32_16x16x32_bf16 v[160:163], a[104:107], a[72:75], v[160:163]
    ds_read_b128 a[104:107], v230 offset:128
    v_cndmask_b32 v145, 0, v145, s[42:43]
    v_cvt_pk_bf16_f32 v184, v144, v145
    v_mfma_f32_16x16x32_bf16 v[160:163], a[108:111], a[76:79], v[160:163]
    ds_read_b128 a[108:111], v230 offset:192
    v_rcp_f32 v200, v224
    v_mfma_f32_16x16x32_bf16 v[164:167], a[112:115], a[64:67], v[216:219]
    ds_read_b128 a[112:115], v230 offset:1024
    v_exp_f32 v146, v146
    v_mfma_f32_16x16x32_bf16 v[164:167], a[116:119], a[68:71], v[164:167]
    s_mov_b32 m0, s70
    ds_read_b128 a[116:119], v230 offset:1088
    v_cndmask_b32 v146, 0, v146, s[44:45]
    v_mfma_f32_16x16x32_bf16 v[164:167], a[120:123], a[72:75], v[164:167]
    buffer_load_dwordx4 v235, s[8:11], s24 offen offset:1024 lds
    v_mfma_f32_16x16x32_bf16 v[164:167], a[124:127], a[76:79], v[164:167]
    s_waitcnt lgkmcnt(4)
    ds_read_b128 a[120:123], v230 offset:1152
    ds_read_b128 a[124:127], v230 offset:1216
    s_add_u32 s24, s24, 131072
    v_mfma_f32_16x16x32_bf16 v[0:3], a[128:131], v[176:179], v[0:3]
    s_sub_u32 s3, s3, 1
    s_add_u32 s66, s33, 0
    s_add_u32 s67, s33, 65536
    s_add_u32 s74, s33, 131072
    v_mfma_f32_16x16x32_bf16 v[32:35], a[128:131], v[180:183], v[32:35]
    s_add_u32 s75, s33, 196608
    s_add_u32 s35, s33, 262144
    s_sub_u32 s26, s37, 4
    s_mov_b32 s91, 0
    v_mfma_f32_16x16x32_bf16 v[4:7], a[132:135], v[176:179], v[4:7]
    s_mov_b32 s4, s31
    s_lshl_b32 s5, s64, 14
    s_add_u32 s5, s5, s34
    s_cmp_le_u32 s38, 16
    v_mfma_f32_16x16x32_bf16 v[36:39], a[132:135], v[180:183], v[36:39]
    s_cselect_b32 s71, 8, 0
    s_mov_b32 s36, 0
    s_mov_b32 s30, 0x40000000
    s_mov_b32 s31, 0
    v_mfma_f32_16x16x32_bf16 v[8:11], a[136:139], v[176:179], v[8:11]
    s_or_b64 s[56:57], s[56:57], s[68:69]
    v_cmp_nle_f32 s[68:69], v225, s63
    v_exp_f32 v147, v147
    v_mfma_f32_16x16x32_bf16 v[40:43], a[136:139], v[180:183], v[40:43]
    s_or_b64 s[56:57], s[56:57], s[68:69]
    s_waitcnt vmcnt(29)
    v_cndmask_b32 v147, 0, v147, s[46:47]
    v_cvt_pk_bf16_f32 v185, v146, v147
    v_mfma_f32_16x16x32_bf16 v[12:15], a[140:143], v[176:179], v[12:15]
    ds_read_b128 a[0:3], v238 offset:0
    ds_read_b128 a[4:7], v238 offset:64
    ds_read_b128 a[8:11], v238 offset:128
    v_mfma_f32_16x16x32_bf16 v[44:47], a[140:143], v[180:183], v[44:47]
    ds_read_b128 a[12:15], v238 offset:192
    v_exp_f32 v148, v148
    v_mfma_f32_16x16x32_bf16 v[16:19], a[144:147], v[176:179], v[16:19]
    v_cndmask_b32 v148, 0, v148, s[48:49]
    v_exp_f32 v149, v149
    v_mfma_f32_16x16x32_bf16 v[48:51], a[144:147], v[180:183], v[48:51]
    v_cndmask_b32 v149, 0, v149, s[50:51]
    v_cvt_pk_bf16_f32 v186, v148, v149
    v_mfma_f32_16x16x32_bf16 v[20:23], a[148:151], v[176:179], v[20:23]
    v_exp_f32 v150, v150
    v_mfma_f32_16x16x32_bf16 v[52:55], a[148:151], v[180:183], v[52:55]
    v_cndmask_b32 v150, 0, v150, s[52:53]
    v_exp_f32 v151, v151
    v_mfma_f32_16x16x32_bf16 v[24:27], a[152:155], v[176:179], v[24:27]
    v_cndmask_b32 v151, 0, v151, s[54:55]
    v_cvt_pk_bf16_f32 v187, v150, v151
    v_mfma_f32_16x16x32_bf16 v[56:59], a[152:155], v[180:183], v[56:59]
    v_exp_f32 v152, v152
    v_mfma_f32_16x16x32_bf16 v[28:31], a[156:159], v[176:179], v[28:31]
    v_cndmask_b32 v152, 0, v152, s[40:41]
    v_add_f32 v227, v227, v152
    v_mfma_f32_16x16x32_bf16 v[60:63], a[156:159], v[180:183], v[60:63]
    v_pk_mul_f32 v[0:1], v[0:1], v[200:201] op_sel_hi:[1,0]
    v_pk_mul_f32 v[2:3], v[2:3], v[200:201] op_sel_hi:[1,0]
    v_cvt_pk_bf16_f32 v0, v0, v1
    v_pk_mul_f32 v[4:5], v[4:5], v[200:201] op_sel_hi:[1,0]
    v_pk_mul_f32 v[6:7], v[6:7], v[200:201] op_sel_hi:[1,0]
    v_pk_mul_f32 v[8:9], v[8:9], v[200:201] op_sel_hi:[1,0]
    v_pk_mul_f32 v[10:11], v[10:11], v[200:201] op_sel_hi:[1,0]
    v_pk_mul_f32 v[12:13], v[12:13], v[200:201] op_sel_hi:[1,0]
    v_pk_mul_f32 v[14:15], v[14:15], v[200:201] op_sel_hi:[1,0]
    v_pk_mul_f32 v[16:17], v[16:17], v[200:201] op_sel_hi:[1,0]
    v_pk_mul_f32 v[18:19], v[18:19], v[200:201] op_sel_hi:[1,0]
    v_pk_mul_f32 v[20:21], v[20:21], v[200:201] op_sel_hi:[1,0]
    v_pk_mul_f32 v[22:23], v[22:23], v[200:201] op_sel_hi:[1,0]
    v_pk_mul_f32 v[24:25], v[24:25], v[200:201] op_sel_hi:[1,0]
    v_pk_mul_f32 v[26:27], v[26:27], v[200:201] op_sel_hi:[1,0]
    v_pk_mul_f32 v[28:29], v[28:29], v[200:201] op_sel_hi:[1,0]
    v_pk_mul_f32 v[30:31], v[30:31], v[200:201] op_sel_hi:[1,0]
    v_rcp_f32 v204, v225
    v_cvt_pk_bf16_f32 v1, v2, v3
    v_pk_mul_f32 v[32:33], v[32:33], v[204:205] op_sel_hi:[1,0]
    v_pk_mul_f32 v[34:35], v[34:35], v[204:205] op_sel_hi:[1,0]
    v_pk_mul_f32 v[36:37], v[36:37], v[204:205] op_sel_hi:[1,0]
    v_pk_mul_f32 v[38:39], v[38:39], v[204:205] op_sel_hi:[1,0]
    v_pk_mul_f32 v[40:41], v[40:41], v[204:205] op_sel_hi:[1,0]
    v_pk_mul_f32 v[42:43], v[42:43], v[204:205] op_sel_hi:[1,0]
    v_pk_mul_f32 v[44:45], v[44:45], v[204:205] op_sel_hi:[1,0]
    v_pk_mul_f32 v[46:47], v[46:47], v[204:205] op_sel_hi:[1,0]
    v_pk_mul_f32 v[48:49], v[48:49], v[204:205] op_sel_hi:[1,0]
    v_pk_mul_f32 v[50:51], v[50:51], v[204:205] op_sel_hi:[1,0]
    v_pk_mul_f32 v[52:53], v[52:53], v[204:205] op_sel_hi:[1,0]
    v_pk_mul_f32 v[54:55], v[54:55], v[204:205] op_sel_hi:[1,0]
    v_pk_mul_f32 v[56:57], v[56:57], v[204:205] op_sel_hi:[1,0]
    v_pk_mul_f32 v[58:59], v[58:59], v[204:205] op_sel_hi:[1,0]
    v_pk_mul_f32 v[60:61], v[60:61], v[204:205] op_sel_hi:[1,0]
    v_pk_mul_f32 v[62:63], v[62:63], v[204:205] op_sel_hi:[1,0]
    v_mfma_f32_16x16x32_bf16 v[64:67], a[128:131], v[184:187], v[64:67]
    ds_write_b64 v242, v[0:1] offset:0
    v_cvt_pk_bf16_f32 v2, v4, v5
    v_cvt_pk_bf16_f32 v3, v6, v7
    v_exp_f32 v153, v153
    v_exp_f32 v154, v154
    v_cndmask_b32 v153, 0, v153, s[42:43]
    v_cvt_pk_bf16_f32 v188, v152, v153
    v_cndmask_b32 v154, 0, v154, s[44:45]
    v_exp_f32 v155, v155
    v_exp_f32 v156, v156
    v_cndmask_b32 v155, 0, v155, s[46:47]
    v_cvt_pk_bf16_f32 v189, v154, v155
    v_cndmask_b32 v156, 0, v156, s[48:49]
    v_exp_f32 v157, v157
    v_exp_f32 v158, v158
    v_cndmask_b32 v157, 0, v157, s[50:51]
    v_cvt_pk_bf16_f32 v190, v156, v157
    v_cndmask_b32 v158, 0, v158, s[52:53]
    v_exp_f32 v159, v159
    v_cvt_pk_bf16_f32 v4, v8, v9
    v_cndmask_b32 v159, 0, v159, s[54:55]
    v_cvt_pk_bf16_f32 v191, v158, v159
    v_cvt_pk_bf16_f32 v5, v10, v11
    v_cvt_pk_bf16_f32 v6, v12, v13
    v_mfma_f32_16x16x32_bf16 v[96:99], a[128:131], v[188:191], v[96:99]
    ds_write_b64 v242, v[2:3] offset:32
    ds_write_b64 v242, v[4:5] offset:64
    v_cvt_pk_bf16_f32 v7, v14, v15
    v_exp_f32 v160, v160
    v_exp_f32 v161, v161
    v_cndmask_b32 v160, 0, v160, s[40:41]
    v_cndmask_b32 v161, 0, v161, s[42:43]
    v_exp_f32 v162, v162
    v_exp_f32 v163, v163
    v_cndmask_b32 v162, 0, v162, s[44:45]
    v_cndmask_b32 v163, 0, v163, s[46:47]
    v_exp_f32 v164, v164
    v_exp_f32 v165, v165
    v_cndmask_b32 v164, 0, v164, s[48:49]
    v_cndmask_b32 v165, 0, v165, s[50:51]
    v_exp_f32 v166, v166
    v_exp_f32 v167, v167
    v_cndmask_b32 v166, 0, v166, s[52:53]
    v_cndmask_b32 v167, 0, v167, s[54:55]
    v_cvt_pk_bf16_f32 v192, v160, v161
    v_cvt_pk_bf16_f32 v193, v162, v163
    v_cvt_pk_bf16_f32 v194, v164, v165
    v_cvt_pk_bf16_f32 v195, v166, v167
    v_cvt_pk_bf16_f32 v8, v16, v17
    v_cvt_pk_bf16_f32 v9, v18, v19
    v_mfma_f32_16x16x32_bf16 a[160:163], a[128:131], v[192:195], a[160:163]
    ds_write_b64 v242, v[6:7] offset:96
    ds_write_b64 v242, v[8:9] offset:128
    v_cvt_pk_bf16_f32 v10, v20, v21
    v_mfma_f32_16x16x32_bf16 a[236:239], a[224:227], v[184:187], a[236:239]
    v_cvt_pk_bf16_f32 v11, v22, v23
    v_cvt_pk_bf16_f32 v12, v24, v25
    v_cvt_pk_bf16_f32 v13, v26, v27
    v_mfma_f32_16x16x32_bf16 a[244:247], a[224:227], v[192:195], a[244:247]
    ds_write_b64 v242, v[10:11] offset:160
    ds_write_b64 v242, v[12:13] offset:192
    v_cvt_pk_bf16_f32 v14, v28, v29
    v_mfma_f32_16x16x32_bf16 v[68:71], a[132:135], v[184:187], v[68:71]
    v_cvt_pk_bf16_f32 v15, v30, v31
    v_add_f32 v227, v227, v153
    v_cvt_pk_bf16_f32 v32, v32, v33
    v_mfma_f32_16x16x32_bf16 v[100:103], a[132:135], v[188:191], v[100:103]
    ds_write_b64 v242, v[14:15] offset:224
    ds_read_b64 v[16:17], v243 offset:0
    ds_read_b64 v[18:19], v245 offset:0
    v_mfma_f32_16x16x32_bf16 a[164:167], a[132:135], v[192:195], a[164:167]
    ds_read_b64 v[20:21], v243 offset:1056
    ds_read_b64 v[22:23], v245 offset:1056
    ds_read_b64 v[24:25], v243 offset:2112
    v_mfma_f32_16x16x32_bf16 v[72:75], a[136:139], v[184:187], v[72:75]
    ds_read_b64 v[26:27], v245 offset:2112
    ds_read_b64 v[28:29], v243 offset:3168
    ds_read_b64 v[30:31], v245 offset:3168
    v_mfma_f32_16x16x32_bf16 v[104:107], a[136:139], v[188:191], v[104:107]
    v_cvt_pk_bf16_f32 v33, v34, v35
    v_cvt_pk_bf16_f32 v34, v36, v37
    v_cvt_pk_bf16_f32 v35, v38, v39
    v_mfma_f32_16x16x32_bf16 a[168:171], a[136:139], v[192:195], a[168:171]
    ds_write_b64 v242, v[32:33] offset:0
    v_add_f32 v227, v227, v154
    v_cvt_pk_bf16_f32 v36, v40, v41
    v_mfma_f32_16x16x32_bf16 v[76:79], a[140:143], v[184:187], v[76:79]
    ds_write_b64 v242, v[34:35] offset:32
    v_cvt_pk_bf16_f32 v37, v42, v43
    v_cvt_pk_bf16_f32 v38, v44, v45
    v_mfma_f32_16x16x32_bf16 v[108:111], a[140:143], v[188:191], v[108:111]
    ds_write_b64 v242, v[36:37] offset:64
    v_cvt_pk_bf16_f32 v39, v46, v47
    v_cvt_pk_bf16_f32 v40, v48, v49
    v_mfma_f32_16x16x32_bf16 a[172:175], a[140:143], v[192:195], a[172:175]
    s_waitcnt lgkmcnt(6)
    buffer_store_dwordx4 v[16:19], v239, s[20:23], s66 offen nt
    v_mfma_f32_16x16x32_bf16 v[80:83], a[144:147], v[184:187], v[80:83]
    ds_write_b64 v242, v[38:39] offset:96
    v_cvt_pk_bf16_f32 v41, v50, v51
    v_add_f32 v227, v227, v155
    v_mfma_f32_16x16x32_bf16 v[112:115], a[144:147], v[188:191], v[112:115]
    ds_write_b64 v242, v[40:41] offset:128
    v_cvt_pk_bf16_f32 v42, v52, v53
    v_cvt_pk_bf16_f32 v43, v54, v55
    v_mfma_f32_16x16x32_bf16 a[176:179], a[144:147], v[192:195], a[176:179]
    ds_write_b64 v242, v[42:43] offset:160
    v_cvt_pk_bf16_f32 v44, v56, v57
    v_cvt_pk_bf16_f32 v45, v58, v59
    v_mfma_f32_16x16x32_bf16 v[84:87], a[148:151], v[184:187], v[84:87]
    ds_write_b64 v242, v[44:45] offset:192
    v_cvt_pk_bf16_f32 v46, v60, v61
    v_cvt_pk_bf16_f32 v47, v62, v63
    v_mfma_f32_16x16x32_bf16 v[116:119], a[148:151], v[188:191], v[116:119]
    ds_write_b64 v242, v[46:47] offset:224
    v_add_f32 v227, v227, v156
    v_add_f32 v227, v227, v157
    v_mfma_f32_16x16x32_bf16 a[180:183], a[148:151], v[192:195], a[180:183]
    buffer_store_dwordx4 v[20:23], v241, s[20:23], s66 offen nt
    v_mfma_f32_16x16x32_bf16 v[88:91], a[152:155], v[184:187], v[88:91]
    ds_read_b64 v[48:49], v243 offset:0
    ds_read_b64 v[50:51], v245 offset:0
    v_cmp_gt_i32 s[40:41], v244, 0
    v_mfma_f32_16x16x32_bf16 v[120:123], a[152:155], v[188:191], v[120:123]
    ds_read_b64 v[52:53], v243 offset:1056
    v_accvgpr_read_b32 v226, a236
    v_cmp_gt_i32 s[42:43], v244, 1
    v_mfma_f32_16x16x32_bf16 a[184:187], a[152:155], v[192:195], a[184:187]
    ds_read_b64 v[54:55], v245 offset:1056
    v_cmp_gt_i32 s[44:45], v244, 2
    v_add_f32 v227, v227, v158
    v_mfma_f32_16x16x32_bf16 v[92:95], a[156:159], v[184:187], v[92:95]
    ds_read_b64 v[56:57], v243 offset:2112
    v_rcp_f32 v208, v226
    v_mfma_f32_16x16x32_bf16 v[124:127], a[156:159], v[188:191], v[124:127]
    ds_read_b64 v[58:59], v245 offset:2112
    v_cmp_gt_i32 s[46:47], v244, 3
    v_cmp_gt_i32 s[48:49], v244, 16
    v_mfma_f32_16x16x32_bf16 a[188:191], a[156:159], v[192:195], a[188:191]
    s_waitcnt lgkmcnt(6)
    buffer_store_dwordx4 v[24:27], v246, s[20:23], s66 offen nt
    v_pk_mul_f32 v[64:65], v[64:65], v[208:209] op_sel_hi:[1,0]
    v_pk_mul_f32 v[66:67], v[66:67], v[208:209] op_sel_hi:[1,0]
    v_add_f32 v227, v227, v159
    v_pk_mul_f32 v[68:69], v[68:69], v[208:209] op_sel_hi:[1,0]
    v_pk_mul_f32 v[70:71], v[70:71], v[208:209] op_sel_hi:[1,0]
    v_pk_mul_f32 v[72:73], v[72:73], v[208:209] op_sel_hi:[1,0]
    v_pk_mul_f32 v[74:75], v[74:75], v[208:209] op_sel_hi:[1,0]
    v_pk_mul_f32 v[76:77], v[76:77], v[208:209] op_sel_hi:[1,0]
    v_pk_mul_f32 v[78:79], v[78:79], v[208:209] op_sel_hi:[1,0]
    v_pk_mul_f32 v[80:81], v[80:81], v[208:209] op_sel_hi:[1,0]
    v_pk_mul_f32 v[82:83], v[82:83], v[208:209] op_sel_hi:[1,0]
    v_pk_mul_f32 v[84:85], v[84:85], v[208:209] op_sel_hi:[1,0]
    v_pk_mul_f32 v[86:87], v[86:87], v[208:209] op_sel_hi:[1,0]
    v_pk_mul_f32 v[88:89], v[88:89], v[208:209] op_sel_hi:[1,0]
    v_pk_mul_f32 v[90:91], v[90:91], v[208:209] op_sel_hi:[1,0]
    v_pk_mul_f32 v[92:93], v[92:93], v[208:209] op_sel_hi:[1,0]
    v_pk_mul_f32 v[94:95], v[94:95], v[208:209] op_sel_hi:[1,0]
    v_mov_b32 v213, v227
    v_accvgpr_read_b32 v228, a244
    v_rcp_f32 v216, v228
    v_permlane32_swap_b32 v213, v227
    v_add_f32 v227, v227, v213
    v_mov_b32 v213, v227
    v_accvgpr_read_b32 v0, a160
    buffer_store_dwordx4 v[28:31], v247, s[20:23], s66 offen nt
    v_permlane16_swap_b32 v213, v227
    v_add_f32 v227, v227, v213
    v_rcp_f32 v212, v227
    v_accvgpr_read_b32 v1, a161
    v_pk_mul_f32 v[96:97], v[96:97], v[212:213] op_sel_hi:[1,0]
    v_pk_mul_f32 v[98:99], v[98:99], v[212:213] op_sel_hi:[1,0]
    v_pk_mul_f32 v[100:101], v[100:101], v[212:213] op_sel_hi:[1,0]
    v_pk_mul_f32 v[102:103], v[102:103], v[212:213] op_sel_hi:[1,0]
    v_pk_mul_f32 v[104:105], v[104:105], v[212:213] op_sel_hi:[1,0]
    v_pk_mul_f32 v[106:107], v[106:107], v[212:213] op_sel_hi:[1,0]
    v_pk_mul_f32 v[108:109], v[108:109], v[212:213] op_sel_hi:[1,0]
    v_pk_mul_f32 v[110:111], v[110:111], v[212:213] op_sel_hi:[1,0]
    v_pk_mul_f32 v[112:113], v[112:113], v[212:213] op_sel_hi:[1,0]
    v_pk_mul_f32 v[114:115], v[114:115], v[212:213] op_sel_hi:[1,0]
    v_pk_mul_f32 v[116:117], v[116:117], v[212:213] op_sel_hi:[1,0]
    v_pk_mul_f32 v[118:119], v[118:119], v[212:213] op_sel_hi:[1,0]
    v_pk_mul_f32 v[120:121], v[120:121], v[212:213] op_sel_hi:[1,0]
    v_pk_mul_f32 v[122:123], v[122:123], v[212:213] op_sel_hi:[1,0]
    v_pk_mul_f32 v[124:125], v[124:125], v[212:213] op_sel_hi:[1,0]
    v_pk_mul_f32 v[126:127], v[126:127], v[212:213] op_sel_hi:[1,0]
    v_accvgpr_read_b32 v2, a162
    v_accvgpr_read_b32 v3, a163
    v_pk_mul_f32 v[0:1], v[0:1], v[216:217] op_sel_hi:[1,0]
    v_accvgpr_read_b32 v4, a164
    s_waitcnt lgkmcnt(0)
    buffer_store_dwordx4 v[48:51], v239, s[20:23], s67 offen nt
    v_accvgpr_read_b32 v5, a165
    v_accvgpr_read_b32 v6, a166
    v_accvgpr_read_b32 v7, a167
    v_pk_mul_f32 v[2:3], v[2:3], v[216:217] op_sel_hi:[1,0]
    v_accvgpr_read_b32 v8, a168
    v_accvgpr_read_b32 v9, a169
    v_accvgpr_read_b32 v10, a170
    v_accvgpr_read_b32 v11, a171
    v_pk_mul_f32 v[4:5], v[4:5], v[216:217] op_sel_hi:[1,0]
    v_pk_mul_f32 v[6:7], v[6:7], v[216:217] op_sel_hi:[1,0]
    v_accvgpr_read_b32 v12, a172
    v_accvgpr_read_b32 v13, a173
    v_accvgpr_read_b32 v14, a174
    v_accvgpr_read_b32 v15, a175
    v_pk_mul_f32 v[8:9], v[8:9], v[216:217] op_sel_hi:[1,0]
    v_pk_mul_f32 v[10:11], v[10:11], v[216:217] op_sel_hi:[1,0]
    v_accvgpr_read_b32 v16, a176
    v_accvgpr_read_b32 v17, a177
    v_accvgpr_read_b32 v18, a178
    v_accvgpr_read_b32 v19, a179
    v_pk_mul_f32 v[12:13], v[12:13], v[216:217] op_sel_hi:[1,0]
    v_pk_mul_f32 v[14:15], v[14:15], v[216:217] op_sel_hi:[1,0]
    v_accvgpr_read_b32 v20, a180
    v_accvgpr_read_b32 v21, a181
    v_accvgpr_read_b32 v22, a182
    buffer_store_dwordx4 v[52:55], v241, s[20:23], s67 offen nt
    v_accvgpr_read_b32 v23, a183
    v_pk_mul_f32 v[16:17], v[16:17], v[216:217] op_sel_hi:[1,0]
    v_pk_mul_f32 v[18:19], v[18:19], v[216:217] op_sel_hi:[1,0]
    v_accvgpr_read_b32 v24, a184
    v_accvgpr_read_b32 v25, a185
    v_accvgpr_read_b32 v26, a186
    v_accvgpr_read_b32 v27, a187
    v_pk_mul_f32 v[20:21], v[20:21], v[216:217] op_sel_hi:[1,0]
    v_pk_mul_f32 v[22:23], v[22:23], v[216:217] op_sel_hi:[1,0]
    v_accvgpr_read_b32 v28, a188
    v_accvgpr_read_b32 v29, a189
    v_accvgpr_read_b32 v30, a190
    v_accvgpr_read_b32 v31, a191
    v_pk_mul_f32 v[24:25], v[24:25], v[216:217] op_sel_hi:[1,0]
    v_pk_mul_f32 v[26:27], v[26:27], v[216:217] op_sel_hi:[1,0]
    v_pk_mul_f32 v[28:29], v[28:29], v[216:217] op_sel_hi:[1,0]
    v_pk_mul_f32 v[30:31], v[30:31], v[216:217] op_sel_hi:[1,0]
    v_mfma_f32_16x16x32_bf16 v[32:35], a[82:85], a[0:3], 0
    ds_read_b64 v[60:61], v243 offset:3168
    v_cvt_pk_bf16_f32 v64, v64, v65
    v_cmp_gt_i32 s[50:51], v244, 17
    v_mfma_f32_16x16x32_bf16 v[32:35], a[86:89], a[0:3], v[32:35]
    ds_read_b64 v[62:63], v245 offset:3168
    v_cvt_pk_bf16_f32 v65, v66, v67
    v_cmp_gt_i32 s[52:53], v244, 18
    v_mfma_f32_16x16x32_bf16 v[36:39], a[80:83], a[0:3], 0
    buffer_store_dwordx4 v[56:59], v246, s[20:23], s67 offen nt
    v_mfma_f32_16x16x32_bf16 v[36:39], a[84:87], a[0:3], v[36:39]
    ds_write_b64 v242, v[64:65] offset:0
    v_cvt_pk_bf16_f32 v66, v68, v69
    v_cvt_pk_bf16_f32 v67, v70, v71
    v_mfma_f32_16x16x32_bf16 v[40:43], a[82:85], a[4:7], 0
    ds_write_b64 v242, v[66:67] offset:32
    v_cmp_gt_i32 s[54:55], v244, 19
    v_cvt_pk_bf16_f32 v68, v72, v73
    v_mfma_f32_16x16x32_bf16 v[40:43], a[86:89], a[4:7], v[40:43]
    v_cvt_pk_bf16_f32 v69, v74, v75
    v_cvt_pk_bf16_f32 v70, v76, v77
    v_cvt_pk_bf16_f32 v71, v78, v79
    v_mfma_f32_16x16x32_bf16 v[44:47], a[80:83], a[4:7], 0
    ds_write_b64 v242, v[68:69] offset:64
    ds_write_b64 v242, v[70:71] offset:96
    v_cvt_pk_bf16_f32 v72, v80, v81
    v_mfma_f32_16x16x32_bf16 v[44:47], a[84:87], a[4:7], v[44:47]
    v_cvt_pk_bf16_f32 v73, v82, v83
    v_cvt_pk_bf16_f32 v74, v84, v85
    v_cvt_pk_bf16_f32 v75, v86, v87
    v_mfma_f32_16x16x32_bf16 v[48:51], a[82:85], a[8:11], 0
    s_waitcnt lgkmcnt(4)
    buffer_store_dwordx4 v[60:63], v247, s[20:23], s67 offen nt
    v_mfma_f32_16x16x32_bf16 v[48:51], a[86:89], a[8:11], v[48:51]
    ds_write_b64 v242, v[72:73] offset:128
    ds_write_b64 v242, v[74:75] offset:160
    v_cvt_pk_bf16_f32 v76, v88, v89
    v_mfma_f32_16x16x32_bf16 v[52:55], a[80:83], a[8:11], 0
    v_cvt_pk_bf16_f32 v77, v90, v91
    v_cvt_pk_bf16_f32 v78, v92, v93
    v_cvt_pk_bf16_f32 v79, v94, v95
    v_mfma_f32_16x16x32_bf16 v[52:55], a[84:87], a[8:11], v[52:55]
    ds_write_b64 v242, v[76:77] offset:192
    ds_write_b64 v242, v[78:79] offset:224
    ds_read_b64 v[80:81], v243 offset:0
    v_mfma_f32_16x16x32_bf16 v[56:59], a[82:85], a[12:15], 0
    ds_read_b64 v[82:83], v245 offset:0
    ds_read_b64 v[84:85], v243 offset:1056
    ds_read_b64 v[86:87], v245 offset:1056
    v_mfma_f32_16x16x32_bf16 v[56:59], a[86:89], a[12:15], v[56:59]
    ds_read_b64 v[88:89], v243 offset:2112
    ds_read_b64 v[90:91], v245 offset:2112
    ds_read_b64 v[92:93], v243 offset:3168
    v_mfma_f32_16x16x32_bf16 v[60:63], a[80:83], a[12:15], 0
    ds_read_b64 v[94:95], v245 offset:3168
    v_cvt_pk_bf16_f32 v96, v96, v97
    v_cvt_pk_bf16_f32 v97, v98, v99
    v_mfma_f32_16x16x32_bf16 v[60:63], a[84:87], a[12:15], v[60:63]
    ds_write_b64 v242, v[96:97] offset:0
    v_cvt_pk_bf16_f32 v98, v100, v101
    v_cvt_pk_bf16_f32 v99, v102, v103
    ds_write_b64 v242, v[98:99] offset:32
    v_cvt_pk_bf16_f32 v100, v104, v105
    v_cvt_pk_bf16_f32 v101, v106, v107
    ds_write_b64 v242, v[100:101] offset:64
    v_cvt_pk_bf16_f32 v102, v108, v109
    v_cvt_pk_bf16_f32 v103, v110, v111
    ds_write_b64 v242, v[102:103] offset:96
    v_cvt_pk_bf16_f32 v104, v112, v113
    v_cvt_pk_bf16_f32 v105, v114, v115
    ds_write_b64 v242, v[104:105] offset:128
    s_waitcnt lgkmcnt(11)
    buffer_store_dwordx4 v[80:83], v239, s[20:23], s74 offen nt
    v_cvt_pk_bf16_f32 v106, v116, v117
    v_cvt_pk_bf16_f32 v107, v118, v119
    ds_write_b64 v242, v[106:107] offset:160
    v_cvt_pk_bf16_f32 v108, v120, v121
    v_cvt_pk_bf16_f32 v109, v122, v123
    ds_write_b64 v242, v[108:109] offset:192
    v_cvt_pk_bf16_f32 v110, v124, v125
    v_cvt_pk_bf16_f32 v111, v126, v127
    ds_write_b64 v242, v[110:111] offset:224
    ds_read_b64 v[112:113], v243 offset:0
    ds_read_b64 v[114:115], v245 offset:0
    ds_read_b64 v[116:117], v243 offset:1056
    ds_read_b64 v[118:119], v245 offset:1056
    ds_read_b64 v[120:121], v243 offset:2112
    ds_read_b64 v[122:123], v245 offset:2112
    ds_read_b64 v[124:125], v243 offset:3168
    v_cvt_pk_bf16_f32 v0, v0, v1
    ds_read_b64 v[126:127], v245 offset:3168
    v_cvt_pk_bf16_f32 v1, v2, v3
    ds_write_b64 v242, v[0:1] offset:0
    v_cvt_pk_bf16_f32 v2, v4, v5
    v_cvt_pk_bf16_f32 v3, v6, v7
    ds_write_b64 v242, v[2:3] offset:32
    v_cvt_pk_bf16_f32 v4, v8, v9
    v_cvt_pk_bf16_f32 v5, v10, v11
    s_waitcnt lgkmcnt(14)
    buffer_store_dwordx4 v[84:87], v241, s[20:23], s74 offen nt
    ds_write_b64 v242, v[4:5] offset:64
    v_cvt_pk_bf16_f32 v6, v12, v13
    v_cvt_pk_bf16_f32 v7, v14, v15
    ds_write_b64 v242, v[6:7] offset:96
    v_cvt_pk_bf16_f32 v8, v16, v17
    v_cvt_pk_bf16_f32 v9, v18, v19
    ds_write_b64 v242, v[8:9] offset:128
    v_cvt_pk_bf16_f32 v10, v20, v21
    v_cvt_pk_bf16_f32 v11, v22, v23
    ds_write_b64 v242, v[10:11] offset:160
    v_cvt_pk_bf16_f32 v12, v24, v25
    v_cvt_pk_bf16_f32 v13, v26, v27
    ds_write_b64 v242, v[12:13] offset:192
    v_cvt_pk_bf16_f32 v14, v28, v29
    v_cvt_pk_bf16_f32 v15, v30, v31
    ds_write_b64 v242, v[14:15] offset:224
    ds_read_b64 v[16:17], v243 offset:0
    ds_read_b64 v[18:19], v245 offset:0
    ds_read_b64 v[20:21], v243 offset:1056
    ds_read_b64 v[22:23], v245 offset:1056
    ds_read_b64 v[24:25], v243 offset:2112
    ds_read_b64 v[26:27], v245 offset:2112
    ds_read_b64 v[28:29], v243 offset:3168
    v_cmp_nle_f32 s[68:69], v226, s63
    ds_read_b64 v[30:31], v245 offset:3168
    buffer_store_dwordx4 v[88:91], v246, s[20:23], s74 offen nt
    s_or_b64 s[56:57], s[56:57], s[68:69]
    v_cmp_nle_f32 s[68:69], v227, s63
    v_cvt_pk_bf16_f32 v32, v32, v33
    s_or_b64 s[56:57], s[56:57], s[68:69]
    v_cmp_nle_f32 s[68:69], v228, s63
    v_cvt_pk_bf16_f32 v33, v34, v35
    s_or_b64 s[56:57], s[56:57], s[68:69]
    s_waitcnt vmcnt(39)
    ds_read_b128 a[16:19], v238 offset:4352
    v_accvgpr_write_b32 a0, v32
    v_accvgpr_write_b32 a1, v33
    v_cvt_pk_bf16_f32 v36, v36, v37
    v_cvt_pk_bf16_f32 v37, v38, v39
    v_accvgpr_write_b32 a2, v36
    v_accvgpr_write_b32 a3, v37
    v_cvt_pk_bf16_f32 v40, v40, v41
    v_cvt_pk_bf16_f32 v41, v42, v43
    v_cvt_pk_bf16_f32 v44, v44, v45
    v_cvt_pk_bf16_f32 v45, v46, v47
    v_accvgpr_write_b32 a4, v40
    v_accvgpr_write_b32 a5, v41
    v_accvgpr_write_b32 a6, v44
    v_accvgpr_write_b32 a7, v45
    v_cvt_pk_bf16_f32 v48, v48, v49
    v_cvt_pk_bf16_f32 v49, v50, v51
    s_waitcnt lgkmcnt(0)
    v_mfma_f32_16x16x32_bf16 v[32:35], a[82:85], a[16:19], 0
    buffer_store_dwordx4 v[92:95], v247, s[20:23], s74 offen nt
    v_mfma_f32_16x16x32_bf16 v[32:35], a[86:89], a[16:19], v[32:35]
    ds_read_b128 a[20:23], v238 offset:4416
    ds_read_b128 a[24:27], v238 offset:4480
    ds_read_b128 a[28:31], v238 offset:4544
    v_mfma_f32_16x16x32_bf16 v[36:39], a[80:83], a[16:19], 0
    v_cvt_pk_bf16_f32 v52, v52, v53
    v_cvt_pk_bf16_f32 v53, v54, v55
    v_accvgpr_write_b32 a8, v48
    v_mfma_f32_16x16x32_bf16 v[36:39], a[84:87], a[16:19], v[36:39]
    s_waitcnt lgkmcnt(2)
    v_accvgpr_write_b32 a9, v49
    v_accvgpr_write_b32 a10, v52
    v_accvgpr_write_b32 a11, v53
    v_mfma_f32_16x16x32_bf16 v[40:43], a[82:85], a[20:23], 0
    v_cvt_pk_bf16_f32 v56, v56, v57
    v_cvt_pk_bf16_f32 v57, v58, v59
    v_cvt_pk_bf16_f32 v60, v60, v61
    v_mfma_f32_16x16x32_bf16 v[40:43], a[86:89], a[20:23], v[40:43]
    v_cvt_pk_bf16_f32 v61, v62, v63
    v_accvgpr_write_b32 a12, v56
    v_accvgpr_write_b32 a13, v57
    v_mfma_f32_16x16x32_bf16 v[44:47], a[80:83], a[20:23], 0
    buffer_store_dwordx4 v[112:115], v239, s[20:23], s75 offen nt
    v_mfma_f32_16x16x32_bf16 v[44:47], a[84:87], a[20:23], v[44:47]
    s_waitcnt lgkmcnt(0)
    v_accvgpr_write_b32 a14, v60
    v_accvgpr_write_b32 a15, v61
    v_cvt_pk_bf16_f32 v32, v32, v33
    v_mfma_f32_16x16x32_bf16 v[48:51], a[82:85], a[24:27], 0
    v_cvt_pk_bf16_f32 v33, v34, v35
    v_cvt_pk_bf16_f32 v36, v36, v37
    v_cvt_pk_bf16_f32 v37, v38, v39
    v_mfma_f32_16x16x32_bf16 v[48:51], a[86:89], a[24:27], v[48:51]
    v_accvgpr_write_b32 a16, v32
    v_accvgpr_write_b32 a17, v33
    v_accvgpr_write_b32 a18, v36
    v_mfma_f32_16x16x32_bf16 v[52:55], a[80:83], a[24:27], 0
    v_accvgpr_write_b32 a19, v37
    v_cvt_pk_bf16_f32 v40, v40, v41
    v_cvt_pk_bf16_f32 v41, v42, v43
    v_mfma_f32_16x16x32_bf16 v[52:55], a[84:87], a[24:27], v[52:55]
    v_cvt_pk_bf16_f32 v44, v44, v45
    v_cvt_pk_bf16_f32 v45, v46, v47
    v_accvgpr_write_b32 a20, v40
    v_mfma_f32_16x16x32_bf16 v[56:59], a[82:85], a[28:31], 0
    buffer_store_dwordx4 v[116:119], v241, s[20:23], s75 offen nt
    v_mfma_f32_16x16x32_bf16 v[56:59], a[86:89], a[28:31], v[56:59]
    v_accvgpr_write_b32 a21, v41
    v_accvgpr_write_b32 a22, v44
    v_accvgpr_write_b32 a23, v45
    v_mfma_f32_16x16x32_bf16 v[60:63], a[80:83], a[28:31], 0
    v_cvt_pk_bf16_f32 v48, v48, v49
    v_cvt_pk_bf16_f32 v49, v50, v51
    v_cvt_pk_bf16_f32 v52, v52, v53
    v_mfma_f32_16x16x32_bf16 v[60:63], a[84:87], a[28:31], v[60:63]
    v_cvt_pk_bf16_f32 v53, v54, v55
    v_accvgpr_write_b32 a24, v48
    v_accvgpr_write_b32 a25, v49
    v_mfma_f32_16x16x32_bf16 v[128:131], a[96:99], a[0:3], 0
    v_accvgpr_write_b32 a26, v52
    v_accvgpr_write_b32 a27, v53
    v_cvt_pk_bf16_f32 v56, v56, v57
    v_mfma_f32_16x16x32_bf16 v[128:131], a[100:103], a[4:7], v[128:131]
    v_cvt_pk_bf16_f32 v57, v58, v59
    v_cvt_pk_bf16_f32 v60, v60, v61
    v_cvt_pk_bf16_f32 v61, v62, v63
    v_mfma_f32_16x16x32_bf16 v[128:131], a[104:107], a[8:11], v[128:131]
    s_mov_b32 s70, s27
    buffer_store_dwordx4 v[120:123], v246, s[20:23], s75 offen nt
    v_mfma_f32_16x16x32_bf16 v[128:131], a[108:111], a[12:15], v[128:131]
    s_add_u32 s27, s27, 16640
    v_accvgpr_write_b32 a28, v56
    v_accvgpr_write_b32 a29, v57
    v_accvgpr_write_b32 a30, v60
    v_mfma_f32_16x16x32_bf16 v[132:135], a[112:115], a[0:3], 0
    s_cmp_eq_u32 s27, s29
    v_accvgpr_write_b32 a31, v61
    v_mfma_f32_16x16x32_bf16 v[132:135], a[116:119], a[4:7], v[132:135]
    s_cselect_b32 s27, s28, s27
    v_max3_f32 v176, v128, v129, v130
    v_mfma_f32_16x16x32_bf16 v[132:135], a[120:123], a[8:11], v[132:135]
    s_waitcnt vmcnt(27)
    v_mfma_f32_16x16x32_bf16 v[132:135], a[124:127], a[12:15], v[132:135]
    s_barrier
    v_mfma_f32_16x16x32_bf16 v[136:139], a[96:99], a[16:19], 0
    s_cmp_lg_u64 s[56:57], 0
    v_add_u32 v231, s27, v233
    s_cselect_b32 s6, 1, 0
    s_lshl_b32 s6, s6, s59
    v_mfma_f32_16x16x32_bf16 v[136:139], a[100:103], a[20:23], v[136:139]
    s_or_b32 s58, s58, s6
    buffer_store_dwordx4 v[124:127], v247, s[20:23], s75 offen nt
    v_mfma_f32_16x16x32_bf16 v[136:139], a[104:107], a[24:27], v[136:139]
    s_mov_b64 s[56:57], 0
    ds_read_b64_tr_b16 a[128:129], v231 offset:0
    ds_read_b64_tr_b16 a[130:131], v231 offset:512
    ds_read_b64_tr_b16 a[132:133], v231 offset:32
    v_mfma_f32_16x16x32_bf16 v[136:139], a[108:111], a[28:31], v[136:139]
    s_add_u32 s59, s59, 1
    ds_read_b64_tr_b16 a[134:135], v231 offset:544
    ds_read_b64_tr_b16 a[136:137], v231 offset:64
    ds_read_b64_tr_b16 a[138:139], v231 offset:576
    v_mfma_f32_16x16x32_bf16 v[140:143], a[112:115], a[16:19], 0
    s_mov_b32 m0, s70
    ds_read_b64_tr_b16 a[140:141], v231 offset:96
    ds_read_b64_tr_b16 a[142:143], v231 offset:608
    ds_read_b64_tr_b16 a[144:145], v231 offset:128
    v_mfma_f32_16x16x32_bf16 v[140:143], a[116:119], a[20:23], v[140:143]
    buffer_load_dwordx4 v236, s[12:15], s25 offen offset:2048 lds
    v_mfma_f32_16x16x32_bf16 v[140:143], a[120:123], a[24:27], v[140:143]
    s_mov_b32 m0, s70
    ds_read_b64_tr_b16 a[146:147], v231 offset:640
    ds_read_b64_tr_b16 a[148:149], v231 offset:160
    ds_read_b64_tr_b16 a[150:151], v231 offset:672
    v_mfma_f32_16x16x32_bf16 v[140:143], a[124:127], a[28:31], v[140:143]
    s_waitcnt lgkmcnt(10)
    buffer_store_dwordx4 v[16:19], v239, s[20:23], s35 offen nt
    v_max3_f32 v177, v132, v133, v134
    v_max3_f32 v176, v176, v131, v135
    v_max_f32 v176, v176, v177
    v_mov_b32 v177, v176
    v_add_u32 v230, s27, v232
    v_max3_f32 v180, v136, v137, v138
    v_permlane32_swap_b32 v177, v176
    v_max_f32 v176, v176, v177
    v_mov_b32 v177, v176
    v_max3_f32 v181, v140, v141, v142
    v_max3_f32 v180, v180, v139, v143
    v_permlane16_swap_b32 v177, v176
    v_max_f32 v176, v176, v177
    v_sub_f32 v200, 0, v176
    v_sub_f32 v201, 0, v176
    v_sub_f32 v202, 0, v176
    v_sub_f32 v203, 0, v176
    v_sub_f32 v128, v128, v176
    v_sub_f32 v129, v129, v176
    v_sub_f32 v130, v130, v176
    v_sub_f32 v131, v131, v176
    v_sub_f32 v132, v132, v176
    v_sub_f32 v133, v133, v176
    v_sub_f32 v134, v134, v176
    v_sub_f32 v135, v135, v176
    buffer_store_dwordx4 v[20:23], v241, s[20:23], s35 offen nt
    v_exp_f32 v128, v128
    v_exp_f32 v129, v129
    v_exp_f32 v130, v130
    v_cvt_pk_bf16_f32 v176, v128, v129
    v_exp_f32 v131, v131
    v_exp_f32 v132, v132
    v_cvt_pk_bf16_f32 v177, v130, v131
    v_exp_f32 v133, v133
    v_exp_f32 v134, v134
    v_cvt_pk_bf16_f32 v178, v132, v133
    v_exp_f32 v135, v135
    v_max_f32 v180, v180, v181
    v_cvt_pk_bf16_f32 v179, v134, v135
    v_mov_b32 v181, v180
    s_nop 0
    v_mfma_f32_16x16x32_bf16 v[0:3], a[128:131], v[176:179], 0
    buffer_store_dwordx4 v[24:27], v246, s[20:23], s35 offen nt
    v_mfma_f32_16x16x32_bf16 a[228:231], a[224:227], v[176:179], 0
    s_waitcnt lgkmcnt(0)
    buffer_load_dwordx4 v237, s[12:15], s25 offen offset:3104 lds
    v_mfma_f32_16x16x32_bf16 v[4:7], a[132:135], v[176:179], 0
    s_add_u32 s14, s10, 4096
    ds_read_b64_tr_b16 a[152:153], v231 offset:192
    ds_read_b64_tr_b16 a[154:155], v231 offset:704
    ds_read_b64_tr_b16 a[156:157], v231 offset:224
    v_mfma_f32_16x16x32_bf16 v[8:11], a[136:139], v[176:179], 0
    s_mov_b32 s25, s24
    ds_read_b64_tr_b16 a[158:159], v231 offset:736
    ds_read_b128 a[96:99], v230 offset:0
    ds_read_b128 a[100:103], v230 offset:64
    v_mfma_f32_16x16x32_bf16 v[12:15], a[140:143], v[176:179], 0
    s_mov_b32 m0, s70
    ds_read_b128 a[104:107], v230 offset:128
    ds_read_b128 a[108:111], v230 offset:192
    ds_read_b128 a[112:115], v230 offset:1024
    v_mfma_f32_16x16x32_bf16 v[16:19], a[144:147], v[176:179], 0
    buffer_load_dwordx4 v234, s[8:11], s24 offen lds
    v_mfma_f32_16x16x32_bf16 v[20:23], a[148:151], v[176:179], 0
    s_waitcnt lgkmcnt(7)
    buffer_store_dwordx4 v[28:31], v247, s[20:23], s35 offen nt
    v_mfma_f32_16x16x32_bf16 v[24:27], a[152:155], v[176:179], 0
    s_waitcnt lgkmcnt(5)
    ds_read_b128 a[116:119], v230 offset:1088
    ds_read_b128 a[120:123], v230 offset:1152
    ds_read_b128 a[124:127], v230 offset:1216
    v_mfma_f32_16x16x32_bf16 v[28:31], a[156:159], v[176:179], 0
    s_waitcnt lgkmcnt(7)
    v_permlane32_swap_b32 v181, v180
    v_max_f32 v180, v180, v181
    v_mov_b32 v181, v180
    v_mfma_f32_16x16x32_bf16 v[128:131], a[96:99], a[0:3], v[200:203]
    s_waitcnt lgkmcnt(6)
    v_permlane16_swap_b32 v181, v180
    v_max_f32 v180, v180, v181
    v_sub_f32 v204, 0, v180
    v_mfma_f32_16x16x32_bf16 v[128:131], a[100:103], a[4:7], v[128:131]
    s_waitcnt lgkmcnt(3)
    v_sub_f32 v205, 0, v180
    v_sub_f32 v206, 0, v180
    v_sub_f32 v207, 0, v180
    v_mfma_f32_16x16x32_bf16 v[128:131], a[104:107], a[8:11], v[128:131]
    s_mov_b32 m0, s70
    v_sub_f32 v136, v136, v180
    v_sub_f32 v137, v137, v180
    v_sub_f32 v138, v138, v180
    v_mfma_f32_16x16x32_bf16 v[128:131], a[108:111], a[12:15], v[128:131]
    buffer_load_dwordx4 v235, s[8:11], s24 offen offset:1024 lds
    v_mfma_f32_16x16x32_bf16 v[132:135], a[112:115], a[0:3], v[200:203]
    s_waitcnt lgkmcnt(0)
    v_sub_f32 v139, v139, v180
    v_sub_f32 v140, v140, v180
    v_sub_f32 v141, v141, v180
    v_mfma_f32_16x16x32_bf16 v[132:135], a[116:119], a[4:7], v[132:135]
    s_add_u32 s24, s24, 131072
    v_sub_f32 v142, v142, v180
    v_sub_f32 v143, v143, v180
    s_sub_u32 s3, s3, 1
    v_mfma_f32_16x16x32_bf16 v[132:135], a[120:123], a[8:11], v[132:135]
    s_mov_b32 s70, s27
    v_exp_f32 v136, v136
    s_add_u32 s27, s27, 16640
    v_mfma_f32_16x16x32_bf16 v[132:135], a[124:127], a[12:15], v[132:135]
    s_cmp_eq_u32 s27, s29
    v_exp_f32 v137, v137
    s_cselect_b32 s27, s28, s27
    v_cvt_pk_bf16_f32 v180, v136, v137
    v_exp_f32 v138, v138
    v_exp_f32 v139, v139
    v_exp_f32 v140, v140
    v_cvt_pk_bf16_f32 v181, v138, v139
    v_exp_f32 v141, v141
    v_exp_f32 v142, v142
    v_cvt_pk_bf16_f32 v182, v140, v141
    v_exp_f32 v143, v143
    v_exp_f32 v128, v128
    v_cvt_pk_bf16_f32 v183, v142, v143
    s_nop 1
    v_mfma_f32_16x16x32_bf16 v[32:35], a[128:131], v[180:183], 0
    s_waitcnt vmcnt(32)
    v_exp_f32 v129, v129
    v_mfma_f32_16x16x32_bf16 a[232:235], a[224:227], v[180:183], 0
    s_barrier
    v_mfma_f32_16x16x32_bf16 v[36:39], a[132:135], v[180:183], 0
    s_mov_b32 m0, s70
    v_add_u32 v231, s27, v233
    v_add_u32 v230, s27, v232
    v_cvt_pk_bf16_f32 v176, v128, v129
    v_mfma_f32_16x16x32_bf16 v[40:43], a[136:139], v[180:183], 0
    buffer_load_dwordx4 v236, s[12:15], s25 offen offset:2048 lds
    v_mfma_f32_16x16x32_bf16 v[44:47], a[140:143], v[180:183], 0
    s_mov_b32 m0, s70
    v_exp_f32 v130, v130
    v_mfma_f32_16x16x32_bf16 v[48:51], a[144:147], v[180:183], 0
    buffer_load_dwordx4 v237, s[12:15], s25 offen offset:3104 lds
    v_mfma_f32_16x16x32_bf16 v[52:55], a[148:151], v[180:183], 0
    s_add_u32 s14, s10, 4096
    ds_read_b64_tr_b16 a[128:129], v231 offset:0
    ds_read_b64_tr_b16 a[130:131], v231 offset:512
    ds_read_b64_tr_b16 a[132:133], v231 offset:32
    v_mfma_f32_16x16x32_bf16 v[56:59], a[152:155], v[180:183], 0
    s_mov_b32 s25, s24
    ds_read_b64_tr_b16 a[134:135], v231 offset:544
    ds_read_b64_tr_b16 a[136:137], v231 offset:64
    ds_read_b64_tr_b16 a[138:139], v231 offset:576
    v_mfma_f32_16x16x32_bf16 v[60:63], a[156:159], v[180:183], 0
    s_mov_b32 s22, s4
    ds_read_b64_tr_b16 a[140:141], v231 offset:96
    ds_read_b64_tr_b16 a[142:143], v231 offset:608
    ds_read_b64_tr_b16 a[144:145], v231 offset:128
    ds_read_b64_tr_b16 a[146:147], v231 offset:640
    ds_read_b64_tr_b16 a[148:149], v231 offset:160
    s_mov_b32 s33, s5
    s_mov_b32 m0, s70
    s_branch L_loop2
L_tail5_2e:
L_tail5_8:
    v_mfma_f32_16x16x32_bf16 v[144:147], a[96:99], a[32:35], v[208:211]
    ds_read_b64_tr_b16 a[146:147], v231 offset:640
    v_add_f32 v225, v225, v142
    v_mfma_f32_16x16x32_bf16 v[144:147], a[100:103], a[36:39], v[144:147]
    v_exp_f32 v143, v143
    v_mfma_f32_16x16x32_bf16 v[144:147], a[104:107], a[40:43], v[144:147]
    v_add_f32 v225, v225, v143
    v_cvt_pk_bf16_f32 v183, v142, v143
    v_mfma_f32_16x16x32_bf16 v[144:147], a[108:111], a[44:47], v[144:147]
    ds_read_b64_tr_b16 a[148:149], v231 offset:160
    ds_read_b64_tr_b16 a[150:151], v231 offset:672
    v_mfma_f32_16x16x32_bf16 v[148:151], a[112:115], a[32:35], v[208:211]
    ds_read_b64_tr_b16 a[152:153], v231 offset:192
    ds_read_b64_tr_b16 a[154:155], v231 offset:704
    v_mfma_f32_16x16x32_bf16 v[148:151], a[116:119], a[36:39], v[148:151]
    ds_read_b64_tr_b16 a[156:157], v231 offset:224
    ds_read_b64_tr_b16 a[158:159], v231 offset:736
    v_mfma_f32_16x16x32_bf16 v[148:151], a[120:123], a[40:43], v[148:151]
    v_exp_f32 v144, v144
    v_mfma_f32_16x16x32_bf16 v[148:151], a[124:127], a[44:47], v[148:151]
    v_exp_f32 v145, v145
    v_mfma_f32_16x16x32_bf16 v[152:155], a[96:99], a[48:51], v[212:215]
    v_exp_f32 v146, v146
    v_mfma_f32_16x16x32_bf16 v[152:155], a[100:103], a[52:55], v[152:155]
    v_exp_f32 v147, v147
    v_mfma_f32_16x16x32_bf16 v[152:155], a[104:107], a[56:59], v[152:155]
    v_cvt_pk_bf16_f32 v184, v144, v145
    v_cvt_pk_bf16_f32 v185, v146, v147
    v_mfma_f32_16x16x32_bf16 v[152:155], a[108:111], a[60:63], v[152:155]
    v_exp_f32 v148, v148
    v_mfma_f32_16x16x32_bf16 v[156:159], a[112:115], a[48:51], v[212:215]
    v_exp_f32 v149, v149
    v_mfma_f32_16x16x32_bf16 v[156:159], a[116:119], a[52:55], v[156:159]
    v_exp_f32 v150, v150
    v_mfma_f32_16x16x32_bf16 v[156:159], a[120:123], a[56:59], v[156:159]
    v_exp_f32 v151, v151
    v_mfma_f32_16x16x32_bf16 v[156:159], a[124:127], a[60:63], v[156:159]
    v_cvt_pk_bf16_f32 v186, v148, v149
    v_cvt_pk_bf16_f32 v187, v150, v151
    v_mfma_f32_16x16x32_bf16 v[160:163], a[96:99], a[64:67], v[216:219]
    v_exp_f32 v152, v152
    v_mfma_f32_16x16x32_bf16 v[160:163], a[100:103], a[68:71], v[160:163]
    ds_read_b128 a[96:99], v230 offset:0
    ds_read_b128 a[100:103], v230 offset:64
    v_mfma_f32_16x16x32_bf16 v[160:163], a[104:107], a[72:75], v[160:163]
    ds_read_b128 a[104:107], v230 offset:128
    v_add_f32 v227, v227, v152
    v_mfma_f32_16x16x32_bf16 v[160:163], a[108:111], a[76:79], v[160:163]
    v_exp_f32 v153, v153
    v_mfma_f32_16x16x32_bf16 v[164:167], a[112:115], a[64:67], v[216:219]
    ds_read_b128 a[108:111], v230 offset:192
    v_add_f32 v227, v227, v153
    v_mfma_f32_16x16x32_bf16 v[164:167], a[116:119], a[68:71], v[164:167]
    v_exp_f32 v154, v154
    v_mfma_f32_16x16x32_bf16 v[164:167], a[120:123], a[72:75], v[164:167]
    v_cvt_pk_bf16_f32 v188, v152, v153
    v_add_f32 v227, v227, v154
    v_mfma_f32_16x16x32_bf16 v[164:167], a[124:127], a[76:79], v[164:167]
    s_waitcnt lgkmcnt(2)
    v_exp_f32 v155, v155
    v_mfma_f32_16x16x32_bf16 v[0:3], a[128:131], v[176:179], v[0:3]
    v_add_f32 v227, v227, v155
    v_cvt_pk_bf16_f32 v189, v154, v155
    v_mfma_f32_16x16x32_bf16 v[32:35], a[128:131], v[180:183], v[32:35]
    v_exp_f32 v156, v156
    v_mfma_f32_16x16x32_bf16 v[4:7], a[132:135], v[176:179], v[4:7]
    v_exp_f32 v157, v157
    v_mfma_f32_16x16x32_bf16 v[36:39], a[132:135], v[180:183], v[36:39]
    v_add_f32 v227, v227, v156
    v_add_f32 v227, v227, v157
    v_mfma_f32_16x16x32_bf16 v[8:11], a[136:139], v[176:179], v[8:11]
    v_exp_f32 v158, v158
    v_mfma_f32_16x16x32_bf16 v[40:43], a[136:139], v[180:183], v[40:43]
    v_cvt_pk_bf16_f32 v190, v156, v157
    v_add_f32 v227, v227, v158
    v_mfma_f32_16x16x32_bf16 v[12:15], a[140:143], v[176:179], v[12:15]
    v_exp_f32 v159, v159
    v_mfma_f32_16x16x32_bf16 v[44:47], a[140:143], v[180:183], v[44:47]
    v_add_f32 v227, v227, v159
    v_cvt_pk_bf16_f32 v191, v158, v159
    v_mfma_f32_16x16x32_bf16 v[16:19], a[144:147], v[176:179], v[16:19]
    v_exp_f32 v160, v160
    v_mfma_f32_16x16x32_bf16 v[48:51], a[144:147], v[180:183], v[48:51]
    v_exp_f32 v161, v161
    v_mfma_f32_16x16x32_bf16 v[20:23], a[148:151], v[176:179], v[20:23]
    v_exp_f32 v162, v162
    v_mfma_f32_16x16x32_bf16 v[52:55], a[148:151], v[180:183], v[52:55]
    v_exp_f32 v163, v163
    v_mfma_f32_16x16x32_bf16 v[24:27], a[152:155], v[176:179], v[24:27]
    v_cvt_pk_bf16_f32 v192, v160, v161
    v_cvt_pk_bf16_f32 v193, v162, v163
    v_mfma_f32_16x16x32_bf16 v[56:59], a[152:155], v[180:183], v[56:59]
    v_exp_f32 v164, v164
    v_mfma_f32_16x16x32_bf16 v[28:31], a[156:159], v[176:179], v[28:31]
    s_mov_b32 m0, s27
    v_exp_f32 v165, v165
    v_mfma_f32_16x16x32_bf16 v[60:63], a[156:159], v[180:183], v[60:63]
    s_add_u32 s27, s27, 16640
    v_exp_f32 v166, v166
    v_mfma_f32_16x16x32_bf16 v[128:131], a[96:99], a[0:3], v[200:203]
    s_cmp_eq_u32 s27, s29
    v_exp_f32 v167, v167
    v_mfma_f32_16x16x32_bf16 v[128:131], a[100:103], a[4:7], v[128:131]
    s_waitcnt lgkmcnt(0)
    s_cselect_b32 s27, s28, s27
    v_cvt_pk_bf16_f32 v194, v164, v165
    v_mfma_f32_16x16x32_bf16 v[128:131], a[104:107], a[8:11], v[128:131]
    s_waitcnt vmcnt(10)
    v_cvt_pk_bf16_f32 v195, v166, v167
    v_mov_b32 v178, 0
    v_mfma_f32_16x16x32_bf16 v[128:131], a[108:111], a[12:15], v[128:131]
    s_barrier
    v_mfma_f32_16x16x32_bf16 v[136:139], a[96:99], a[16:19], v[204:207]
    s_add_u32 s66, s33, 0
    v_add_u32 v231, s27, v233
    v_add_u32 v230, s27, v232
    v_mfma_f32_16x16x32_bf16 v[136:139], a[100:103], a[20:23], v[136:139]
    s_add_u32 s67, s33, 65536
    v_mov_b32 v179, 0
    v_mov_b32 v182, 0
    v_mfma_f32_16x16x32_bf16 v[136:139], a[104:107], a[24:27], v[136:139]
    s_add_u32 s74, s33, 131072
    v_exp_f32 v128, v128
    v_mfma_f32_16x16x32_bf16 v[136:139], a[108:111], a[28:31], v[136:139]
    s_add_u32 s75, s33, 196608
    v_cndmask_b32 v128, 0, v128, s[40:41]
    v_add_f32 v224, v224, v128
    v_mfma_f32_16x16x32_bf16 v[64:67], a[128:131], v[184:187], v[64:67]
    s_add_u32 s35, s33, 262144
    v_exp_f32 v129, v129
    v_mfma_f32_16x16x32_bf16 v[96:99], a[128:131], v[188:191], v[96:99]
    v_cndmask_b32 v129, 0, v129, s[42:43]
    v_add_f32 v224, v224, v129
    v_mfma_f32_16x16x32_bf16 a[160:163], a[128:131], v[192:195], a[160:163]
    ds_read_b64_tr_b16 a[128:129], v231 offset:0
    v_cvt_pk_bf16_f32 v176, v128, v129
    v_mfma_f32_16x16x32_bf16 a[236:239], a[224:227], v[184:187], a[236:239]
    v_exp_f32 v130, v130
    v_mfma_f32_16x16x32_bf16 a[244:247], a[224:227], v[192:195], a[244:247]
    ds_read_b64_tr_b16 a[130:131], v231 offset:512
    v_cndmask_b32 v130, 0, v130, s[44:45]
    v_mfma_f32_16x16x32_bf16 v[68:71], a[132:135], v[184:187], v[68:71]
    v_add_f32 v224, v224, v130
    v_mov_b32 v183, 0
    v_mfma_f32_16x16x32_bf16 v[100:103], a[132:135], v[188:191], v[100:103]
    v_exp_f32 v131, v131
    v_mfma_f32_16x16x32_bf16 a[164:167], a[132:135], v[192:195], a[164:167]
    ds_read_b64_tr_b16 a[132:133], v231 offset:32
    v_cndmask_b32 v131, 0, v131, s[46:47]
    v_mfma_f32_16x16x32_bf16 v[72:75], a[136:139], v[184:187], v[72:75]
    v_add_f32 v224, v224, v131
    v_cvt_pk_bf16_f32 v177, v130, v131
    v_mfma_f32_16x16x32_bf16 v[104:107], a[136:139], v[188:191], v[104:107]
    ds_read_b64_tr_b16 a[134:135], v231 offset:544
    v_mov_b32 v201, v224
    v_mfma_f32_16x16x32_bf16 a[168:171], a[136:139], v[192:195], a[168:171]
    v_exp_f32 v136, v136
    v_mfma_f32_16x16x32_bf16 v[76:79], a[140:143], v[184:187], v[76:79]
    ds_read_b64_tr_b16 a[136:137], v231 offset:64
    v_cndmask_b32 v136, 0, v136, s[40:41]
    v_mfma_f32_16x16x32_bf16 v[108:111], a[140:143], v[188:191], v[108:111]
    ds_read_b64_tr_b16 a[138:139], v231 offset:576
    v_add_f32 v225, v225, v136
    v_mfma_f32_16x16x32_bf16 a[172:175], a[140:143], v[192:195], a[172:175]
    v_exp_f32 v137, v137
    v_mfma_f32_16x16x32_bf16 v[80:83], a[144:147], v[184:187], v[80:83]
    ds_read_b64_tr_b16 a[140:141], v231 offset:96
    v_cndmask_b32 v137, 0, v137, s[42:43]
    v_mfma_f32_16x16x32_bf16 v[112:115], a[144:147], v[188:191], v[112:115]
    v_permlane32_swap_b32 v201, v224
    v_add_f32 v225, v225, v137
    v_mfma_f32_16x16x32_bf16 a[176:179], a[144:147], v[192:195], a[176:179]
    ds_read_b64_tr_b16 a[142:143], v231 offset:608
    v_cvt_pk_bf16_f32 v180, v136, v137
    v_mfma_f32_16x16x32_bf16 v[84:87], a[148:151], v[184:187], v[84:87]
    ds_read_b64_tr_b16 a[144:145], v231 offset:128
    v_add_f32 v224, v224, v201
    v_mfma_f32_16x16x32_bf16 v[116:119], a[148:151], v[188:191], v[116:119]
    ds_read_b64_tr_b16 a[146:147], v231 offset:640
    v_mov_b32 v201, v224
    v_mfma_f32_16x16x32_bf16 a[180:183], a[148:151], v[192:195], a[180:183]
    v_exp_f32 v138, v138
    v_mfma_f32_16x16x32_bf16 v[88:91], a[152:155], v[184:187], v[88:91]
    v_permlane16_swap_b32 v201, v224
    v_cndmask_b32 v138, 0, v138, s[44:45]
    v_mfma_f32_16x16x32_bf16 v[120:123], a[152:155], v[188:191], v[120:123]
    ds_read_b64_tr_b16 a[148:149], v231 offset:160
    v_add_f32 v224, v224, v201
    v_mfma_f32_16x16x32_bf16 a[184:187], a[152:155], v[192:195], a[184:187]
    ds_read_b64_tr_b16 a[150:151], v231 offset:672
    v_add_f32 v225, v225, v138
    v_mfma_f32_16x16x32_bf16 v[92:95], a[156:159], v[184:187], v[92:95]
    ds_read_b64_tr_b16 a[152:153], v231 offset:192
    ds_read_b64_tr_b16 a[154:155], v231 offset:704
    v_mfma_f32_16x16x32_bf16 v[124:127], a[156:159], v[188:191], v[124:127]
    v_rcp_f32 v200, v224
    v_mfma_f32_16x16x32_bf16 a[188:191], a[156:159], v[192:195], a[188:191]
    v_exp_f32 v139, v139
    v_mfma_f32_16x16x32_bf16 v[144:147], a[96:99], a[32:35], v[208:211]
    ds_read_b64_tr_b16 a[156:157], v231 offset:224
    v_cndmask_b32 v139, 0, v139, s[46:47]
    v_mfma_f32_16x16x32_bf16 v[144:147], a[100:103], a[36:39], v[144:147]
    ds_read_b64_tr_b16 a[158:159], v231 offset:736
    v_add_f32 v225, v225, v139
    v_mfma_f32_16x16x32_bf16 v[144:147], a[104:107], a[40:43], v[144:147]
    v_cvt_pk_bf16_f32 v181, v138, v139
    v_mov_b32 v205, v225
    v_mfma_f32_16x16x32_bf16 v[144:147], a[108:111], a[44:47], v[144:147]
    v_mov_b32 v186, 0
    v_permlane32_swap_b32 v205, v225
    v_mfma_f32_16x16x32_bf16 v[152:155], a[96:99], a[48:51], v[212:215]
    v_add_f32 v225, v225, v205
    v_mov_b32 v205, v225
    v_mfma_f32_16x16x32_bf16 v[152:155], a[100:103], a[52:55], v[152:155]
    v_mov_b32 v187, 0
    v_permlane16_swap_b32 v205, v225
    v_mfma_f32_16x16x32_bf16 v[152:155], a[104:107], a[56:59], v[152:155]
    v_add_f32 v225, v225, v205
    v_mov_b32 v190, 0
    v_mfma_f32_16x16x32_bf16 v[152:155], a[108:111], a[60:63], v[152:155]
    v_rcp_f32 v204, v225
    v_mfma_f32_16x16x32_bf16 v[160:163], a[96:99], a[64:67], v[216:219]
    v_exp_f32 v144, v144
    v_mfma_f32_16x16x32_bf16 v[160:163], a[100:103], a[68:71], v[160:163]
    v_cndmask_b32 v144, 0, v144, s[40:41]
    v_mov_b32 v191, 0
    v_mfma_f32_16x16x32_bf16 v[160:163], a[104:107], a[72:75], v[160:163]
    v_exp_f32 v145, v145
    v_mfma_f32_16x16x32_bf16 v[160:163], a[108:111], a[76:79], v[160:163]
    s_waitcnt lgkmcnt(0)
    v_cndmask_b32 v145, 0, v145, s[42:43]
    v_cvt_pk_bf16_f32 v184, v144, v145
    v_mfma_f32_16x16x32_bf16 v[0:3], a[128:131], v[176:179], v[0:3]
    v_exp_f32 v146, v146
    v_mfma_f32_16x16x32_bf16 v[32:35], a[128:131], v[180:183], v[32:35]
    v_cndmask_b32 v146, 0, v146, s[44:45]
    v_mov_b32 v194, 0
    v_mfma_f32_16x16x32_bf16 v[4:7], a[132:135], v[176:179], v[4:7]
    v_exp_f32 v147, v147
    v_mfma_f32_16x16x32_bf16 v[36:39], a[132:135], v[180:183], v[36:39]
    v_cndmask_b32 v147, 0, v147, s[46:47]
    v_cvt_pk_bf16_f32 v185, v146, v147
    v_mfma_f32_16x16x32_bf16 v[8:11], a[136:139], v[176:179], v[8:11]
    v_exp_f32 v152, v152
    v_mfma_f32_16x16x32_bf16 v[40:43], a[136:139], v[180:183], v[40:43]
    v_cndmask_b32 v152, 0, v152, s[40:41]
    v_add_f32 v227, v227, v152
    v_mfma_f32_16x16x32_bf16 v[12:15], a[140:143], v[176:179], v[12:15]
    v_exp_f32 v153, v153
    v_mfma_f32_16x16x32_bf16 v[44:47], a[140:143], v[180:183], v[44:47]
    v_cndmask_b32 v153, 0, v153, s[42:43]
    v_add_f32 v227, v227, v153
    v_mfma_f32_16x16x32_bf16 v[16:19], a[144:147], v[176:179], v[16:19]
    v_cvt_pk_bf16_f32 v188, v152, v153
    v_mov_b32 v195, 0
    v_mfma_f32_16x16x32_bf16 v[48:51], a[144:147], v[180:183], v[48:51]
    v_exp_f32 v154, v154
    v_cmp_nle_f32 s[68:69], v224, s63
    v_mfma_f32_16x16x32_bf16 v[20:23], a[148:151], v[176:179], v[20:23]
    s_or_b64 s[56:57], s[56:57], s[68:69]
    v_cndmask_b32 v154, 0, v154, s[44:45]
    v_exp_f32 v155, v155
    v_mfma_f32_16x16x32_bf16 v[52:55], a[148:151], v[180:183], v[52:55]
    v_add_f32 v227, v227, v154
    v_cndmask_b32 v155, 0, v155, s[46:47]
    v_add_f32 v227, v227, v155
    v_mfma_f32_16x16x32_bf16 v[24:27], a[152:155], v[176:179], v[24:27]
    v_mov_b32 v213, v227
    v_cvt_pk_bf16_f32 v189, v154, v155
    v_cmp_nle_f32 s[68:69], v225, s63
    v_mfma_f32_16x16x32_bf16 v[56:59], a[152:155], v[180:183], v[56:59]
    s_or_b64 s[56:57], s[56:57], s[68:69]
    v_permlane32_swap_b32 v213, v227
    v_add_f32 v227, v227, v213
    v_mov_b32 v213, v227
    v_mfma_f32_16x16x32_bf16 v[28:31], a[156:159], v[176:179], v[28:31]
    v_exp_f32 v160, v160
    v_permlane16_swap_b32 v213, v227
    v_mfma_f32_16x16x32_bf16 v[60:63], a[156:159], v[180:183], v[60:63]
    v_pk_mul_f32 v[0:1], v[0:1], v[200:201] op_sel_hi:[1,0]
    v_pk_mul_f32 v[2:3], v[2:3], v[200:201] op_sel_hi:[1,0]
    v_cvt_pk_bf16_f32 v0, v0, v1
    v_pk_mul_f32 v[4:5], v[4:5], v[200:201] op_sel_hi:[1,0]
    v_pk_mul_f32 v[6:7], v[6:7], v[200:201] op_sel_hi:[1,0]
    v_pk_mul_f32 v[8:9], v[8:9], v[200:201] op_sel_hi:[1,0]
    v_pk_mul_f32 v[10:11], v[10:11], v[200:201] op_sel_hi:[1,0]
    v_pk_mul_f32 v[12:13], v[12:13], v[200:201] op_sel_hi:[1,0]
    v_pk_mul_f32 v[14:15], v[14:15], v[200:201] op_sel_hi:[1,0]
    v_pk_mul_f32 v[16:17], v[16:17], v[200:201] op_sel_hi:[1,0]
    v_pk_mul_f32 v[18:19], v[18:19], v[200:201] op_sel_hi:[1,0]
    v_pk_mul_f32 v[20:21], v[20:21], v[200:201] op_sel_hi:[1,0]
    v_pk_mul_f32 v[22:23], v[22:23], v[200:201] op_sel_hi:[1,0]
    v_pk_mul_f32 v[24:25], v[24:25], v[200:201] op_sel_hi:[1,0]
    v_pk_mul_f32 v[26:27], v[26:27], v[200:201] op_sel_hi:[1,0]
    v_pk_mul_f32 v[28:29], v[28:29], v[200:201] op_sel_hi:[1,0]
    v_pk_mul_f32 v[30:31], v[30:31], v[200:201] op_sel_hi:[1,0]
    v_pk_mul_f32 v[32:33], v[32:33], v[204:205] op_sel_hi:[1,0]
    v_pk_mul_f32 v[34:35], v[34:35], v[204:205] op_sel_hi:[1,0]
    v_pk_mul_f32 v[36:37], v[36:37], v[204:205] op_sel_hi:[1,0]
    v_pk_mul_f32 v[38:39], v[38:39], v[204:205] op_sel_hi:[1,0]
    v_pk_mul_f32 v[40:41], v[40:41], v[204:205] op_sel_hi:[1,0]
    v_pk_mul_f32 v[42:43], v[42:43], v[204:205] op_sel_hi:[1,0]
    v_pk_mul_f32 v[44:45], v[44:45], v[204:205] op_sel_hi:[1,0]
    v_pk_mul_f32 v[46:47], v[46:47], v[204:205] op_sel_hi:[1,0]
    v_pk_mul_f32 v[48:49], v[48:49], v[204:205] op_sel_hi:[1,0]
    v_pk_mul_f32 v[50:51], v[50:51], v[204:205] op_sel_hi:[1,0]
    v_pk_mul_f32 v[52:53], v[52:53], v[204:205] op_sel_hi:[1,0]
    v_pk_mul_f32 v[54:55], v[54:55], v[204:205] op_sel_hi:[1,0]
    v_pk_mul_f32 v[56:57], v[56:57], v[204:205] op_sel_hi:[1,0]
    v_pk_mul_f32 v[58:59], v[58:59], v[204:205] op_sel_hi:[1,0]
    v_pk_mul_f32 v[60:61], v[60:61], v[204:205] op_sel_hi:[1,0]
    v_pk_mul_f32 v[62:63], v[62:63], v[204:205] op_sel_hi:[1,0]
    v_mfma_f32_16x16x32_bf16 v[64:67], a[128:131], v[184:187], v[64:67]
    v_cvt_pk_bf16_f32 v1, v2, v3
    v_cvt_pk_bf16_f32 v2, v4, v5
    v_cvt_pk_bf16_f32 v3, v6, v7
    v_mfma_f32_16x16x32_bf16 v[96:99], a[128:131], v[188:191], v[96:99]
    ds_write_b64 v242, v[0:1] offset:0
    ds_write_b64 v242, v[2:3] offset:32
    v_cvt_pk_bf16_f32 v4, v8, v9
    v_cndmask_b32 v160, 0, v160, s[40:41]
    v_exp_f32 v161, v161
    v_exp_f32 v162, v162
    v_cndmask_b32 v161, 0, v161, s[42:43]
    v_cvt_pk_bf16_f32 v192, v160, v161
    v_cndmask_b32 v162, 0, v162, s[44:45]
    v_exp_f32 v163, v163
    v_cvt_pk_bf16_f32 v5, v10, v11
    v_cndmask_b32 v163, 0, v163, s[46:47]
    v_cvt_pk_bf16_f32 v193, v162, v163
    v_cvt_pk_bf16_f32 v6, v12, v13
    v_cvt_pk_bf16_f32 v7, v14, v15
    v_mfma_f32_16x16x32_bf16 a[160:163], a[128:131], v[192:195], a[160:163]
    ds_write_b64 v242, v[4:5] offset:64
    ds_write_b64 v242, v[6:7] offset:96
    v_cvt_pk_bf16_f32 v8, v16, v17
    v_mfma_f32_16x16x32_bf16 a[236:239], a[224:227], v[184:187], a[236:239]
    v_cvt_pk_bf16_f32 v9, v18, v19
    v_cvt_pk_bf16_f32 v10, v20, v21
    v_cvt_pk_bf16_f32 v11, v22, v23
    v_mfma_f32_16x16x32_bf16 a[244:247], a[224:227], v[192:195], a[244:247]
    ds_write_b64 v242, v[8:9] offset:128
    ds_write_b64 v242, v[10:11] offset:160
    v_cvt_pk_bf16_f32 v12, v24, v25
    v_mfma_f32_16x16x32_bf16 v[68:71], a[132:135], v[184:187], v[68:71]
    v_cvt_pk_bf16_f32 v13, v26, v27
    v_cvt_pk_bf16_f32 v14, v28, v29
    v_cvt_pk_bf16_f32 v15, v30, v31
    v_mfma_f32_16x16x32_bf16 v[100:103], a[132:135], v[188:191], v[100:103]
    ds_write_b64 v242, v[12:13] offset:192
    ds_write_b64 v242, v[14:15] offset:224
    ds_read_b64 v[16:17], v243 offset:0
    v_mfma_f32_16x16x32_bf16 a[164:167], a[132:135], v[192:195], a[164:167]
    ds_read_b64 v[18:19], v245 offset:0
    ds_read_b64 v[20:21], v243 offset:1056
    ds_read_b64 v[22:23], v245 offset:1056
    v_mfma_f32_16x16x32_bf16 v[72:75], a[136:139], v[184:187], v[72:75]
    ds_read_b64 v[24:25], v243 offset:2112
    ds_read_b64 v[26:27], v245 offset:2112
    ds_read_b64 v[28:29], v243 offset:3168
    v_mfma_f32_16x16x32_bf16 v[104:107], a[136:139], v[188:191], v[104:107]
    ds_read_b64 v[30:31], v245 offset:3168
    v_cvt_pk_bf16_f32 v32, v32, v33
    v_cvt_pk_bf16_f32 v33, v34, v35
    v_mfma_f32_16x16x32_bf16 a[168:171], a[136:139], v[192:195], a[168:171]
    ds_write_b64 v242, v[32:33] offset:0
    v_cvt_pk_bf16_f32 v34, v36, v37
    v_cvt_pk_bf16_f32 v35, v38, v39
    v_mfma_f32_16x16x32_bf16 v[76:79], a[140:143], v[184:187], v[76:79]
    ds_write_b64 v242, v[34:35] offset:32
    v_cvt_pk_bf16_f32 v36, v40, v41
    v_cvt_pk_bf16_f32 v37, v42, v43
    v_mfma_f32_16x16x32_bf16 v[108:111], a[140:143], v[188:191], v[108:111]
    ds_write_b64 v242, v[36:37] offset:64
    v_cvt_pk_bf16_f32 v38, v44, v45
    v_cvt_pk_bf16_f32 v39, v46, v47
    v_mfma_f32_16x16x32_bf16 a[172:175], a[140:143], v[192:195], a[172:175]
    ds_write_b64 v242, v[38:39] offset:96
    v_cvt_pk_bf16_f32 v40, v48, v49
    v_cvt_pk_bf16_f32 v41, v50, v51
    v_mfma_f32_16x16x32_bf16 v[80:83], a[144:147], v[184:187], v[80:83]
    s_waitcnt lgkmcnt(5)
    buffer_store_dwordx4 v[16:19], v239, s[20:23], s66 offen nt
    v_mfma_f32_16x16x32_bf16 v[112:115], a[144:147], v[188:191], v[112:115]
    buffer_store_dwordx4 v[20:23], v241, s[20:23], s66 offen nt
    v_mfma_f32_16x16x32_bf16 a[176:179], a[144:147], v[192:195], a[176:179]
    buffer_store_dwordx4 v[24:27], v246, s[20:23], s66 offen nt
    v_mfma_f32_16x16x32_bf16 v[84:87], a[148:151], v[184:187], v[84:87]
    s_waitcnt lgkmcnt(2)
    buffer_store_dwordx4 v[28:31], v247, s[20:23], s66 offen nt
    v_mfma_f32_16x16x32_bf16 v[116:119], a[148:151], v[188:191], v[116:119]
    ds_write_b64 v242, v[40:41] offset:128
    v_cvt_pk_bf16_f32 v42, v52, v53
    v_cvt_pk_bf16_f32 v43, v54, v55
    v_mfma_f32_16x16x32_bf16 a[180:183], a[148:151], v[192:195], a[180:183]
    ds_write_b64 v242, v[42:43] offset:160
    v_cvt_pk_bf16_f32 v44, v56, v57
    v_cvt_pk_bf16_f32 v45, v58, v59
    v_mfma_f32_16x16x32_bf16 v[88:91], a[152:155], v[184:187], v[88:91]
    ds_write_b64 v242, v[44:45] offset:192
    v_cvt_pk_bf16_f32 v46, v60, v61
    v_cvt_pk_bf16_f32 v47, v62, v63
    v_mfma_f32_16x16x32_bf16 v[120:123], a[152:155], v[188:191], v[120:123]
    ds_write_b64 v242, v[46:47] offset:224
    ds_read_b64 v[48:49], v243 offset:0
    ds_read_b64 v[50:51], v245 offset:0
    v_mfma_f32_16x16x32_bf16 a[184:187], a[152:155], v[192:195], a[184:187]
    ds_read_b64 v[52:53], v243 offset:1056
    v_accvgpr_read_b32 v226, a236
    v_add_f32 v227, v227, v213
    v_mfma_f32_16x16x32_bf16 v[92:95], a[156:159], v[184:187], v[92:95]
    ds_read_b64 v[54:55], v245 offset:1056
    ds_read_b64 v[56:57], v243 offset:2112
    ds_read_b64 v[58:59], v245 offset:2112
    v_mfma_f32_16x16x32_bf16 v[124:127], a[156:159], v[188:191], v[124:127]
    ds_read_b64 v[60:61], v243 offset:3168
    v_rcp_f32 v208, v226
    v_mfma_f32_16x16x32_bf16 a[188:191], a[156:159], v[192:195], a[188:191]
    ds_read_b64 v[62:63], v245 offset:3168
    v_pk_mul_f32 v[64:65], v[64:65], v[208:209] op_sel_hi:[1,0]
    v_pk_mul_f32 v[66:67], v[66:67], v[208:209] op_sel_hi:[1,0]
    v_cvt_pk_bf16_f32 v64, v64, v65
    v_pk_mul_f32 v[68:69], v[68:69], v[208:209] op_sel_hi:[1,0]
    v_pk_mul_f32 v[70:71], v[70:71], v[208:209] op_sel_hi:[1,0]
    v_cvt_pk_bf16_f32 v65, v66, v67
    v_pk_mul_f32 v[72:73], v[72:73], v[208:209] op_sel_hi:[1,0]
    v_pk_mul_f32 v[74:75], v[74:75], v[208:209] op_sel_hi:[1,0]
    ds_write_b64 v242, v[64:65] offset:0
    v_cvt_pk_bf16_f32 v66, v68, v69
    v_cvt_pk_bf16_f32 v67, v70, v71
    v_pk_mul_f32 v[76:77], v[76:77], v[208:209] op_sel_hi:[1,0]
    v_pk_mul_f32 v[78:79], v[78:79], v[208:209] op_sel_hi:[1,0]
    ds_write_b64 v242, v[66:67] offset:32
    v_cvt_pk_bf16_f32 v68, v72, v73
    v_cvt_pk_bf16_f32 v69, v74, v75
    v_pk_mul_f32 v[80:81], v[80:81], v[208:209] op_sel_hi:[1,0]
    v_pk_mul_f32 v[82:83], v[82:83], v[208:209] op_sel_hi:[1,0]
    ds_write_b64 v242, v[68:69] offset:64
    v_cvt_pk_bf16_f32 v70, v76, v77
    v_cvt_pk_bf16_f32 v71, v78, v79
    v_pk_mul_f32 v[84:85], v[84:85], v[208:209] op_sel_hi:[1,0]
    v_pk_mul_f32 v[86:87], v[86:87], v[208:209] op_sel_hi:[1,0]
    ds_write_b64 v242, v[70:71] offset:96
    v_cvt_pk_bf16_f32 v72, v80, v81
    v_cvt_pk_bf16_f32 v73, v82, v83
    v_pk_mul_f32 v[88:89], v[88:89], v[208:209] op_sel_hi:[1,0]
    v_pk_mul_f32 v[90:91], v[90:91], v[208:209] op_sel_hi:[1,0]
    ds_write_b64 v242, v[72:73] offset:128
    v_cvt_pk_bf16_f32 v74, v84, v85
    v_cvt_pk_bf16_f32 v75, v86, v87
    v_pk_mul_f32 v[92:93], v[92:93], v[208:209] op_sel_hi:[1,0]
    v_pk_mul_f32 v[94:95], v[94:95], v[208:209] op_sel_hi:[1,0]
    ds_write_b64 v242, v[74:75] offset:160
    v_cvt_pk_bf16_f32 v76, v88, v89
    v_cvt_pk_bf16_f32 v77, v90, v91
    ds_write_b64 v242, v[76:77] offset:192
    v_cvt_pk_bf16_f32 v78, v92, v93
    v_cvt_pk_bf16_f32 v79, v94, v95
    ds_write_b64 v242, v[78:79] offset:224
    ds_read_b64 v[80:81], v243 offset:0
    ds_read_b64 v[82:83], v245 offset:0
    ds_read_b64 v[84:85], v243 offset:1056
    ds_read_b64 v[86:87], v245 offset:1056
    ds_read_b64 v[88:89], v243 offset:2112
    v_rcp_f32 v212, v227
    ds_read_b64 v[90:91], v245 offset:2112
    v_pk_mul_f32 v[96:97], v[96:97], v[212:213] op_sel_hi:[1,0]
    ds_read_b64 v[92:93], v243 offset:3168
    v_pk_mul_f32 v[98:99], v[98:99], v[212:213] op_sel_hi:[1,0]
    v_cvt_pk_bf16_f32 v96, v96, v97
    ds_read_b64 v[94:95], v245 offset:3168
    v_pk_mul_f32 v[100:101], v[100:101], v[212:213] op_sel_hi:[1,0]
    v_pk_mul_f32 v[102:103], v[102:103], v[212:213] op_sel_hi:[1,0]
    v_cvt_pk_bf16_f32 v97, v98, v99
    v_pk_mul_f32 v[104:105], v[104:105], v[212:213] op_sel_hi:[1,0]
    v_pk_mul_f32 v[106:107], v[106:107], v[212:213] op_sel_hi:[1,0]
    ds_write_b64 v242, v[96:97] offset:0
    v_cvt_pk_bf16_f32 v98, v100, v101
    v_cvt_pk_bf16_f32 v99, v102, v103
    v_pk_mul_f32 v[108:109], v[108:109], v[212:213] op_sel_hi:[1,0]
    v_pk_mul_f32 v[110:111], v[110:111], v[212:213] op_sel_hi:[1,0]
    ds_write_b64 v242, v[98:99] offset:32
    v_cvt_pk_bf16_f32 v100, v104, v105
    v_cvt_pk_bf16_f32 v101, v106, v107
    v_pk_mul_f32 v[112:113], v[112:113], v[212:213] op_sel_hi:[1,0]
    v_pk_mul_f32 v[114:115], v[114:115], v[212:213] op_sel_hi:[1,0]
    ds_write_b64 v242, v[100:101] offset:64
    v_cvt_pk_bf16_f32 v102, v108, v109
    v_cvt_pk_bf16_f32 v103, v110, v111
    s_waitcnt lgkmcnt(11)
    buffer_store_dwordx4 v[48:51], v239, s[20:23], s67 offen nt
    v_pk_mul_f32 v[116:117], v[116:117], v[212:213] op_sel_hi:[1,0]
    v_pk_mul_f32 v[118:119], v[118:119], v[212:213] op_sel_hi:[1,0]
    ds_write_b64 v242, v[102:103] offset:96
    v_cvt_pk_bf16_f32 v104, v112, v113
    v_cvt_pk_bf16_f32 v105, v114, v115
    v_pk_mul_f32 v[120:121], v[120:121], v[212:213] op_sel_hi:[1,0]
    v_pk_mul_f32 v[122:123], v[122:123], v[212:213] op_sel_hi:[1,0]
    ds_write_b64 v242, v[104:105] offset:128
    v_cvt_pk_bf16_f32 v106, v116, v117
    v_cvt_pk_bf16_f32 v107, v118, v119
    v_pk_mul_f32 v[124:125], v[124:125], v[212:213] op_sel_hi:[1,0]
    v_pk_mul_f32 v[126:127], v[126:127], v[212:213] op_sel_hi:[1,0]
    ds_write_b64 v242, v[106:107] offset:160
    v_cvt_pk_bf16_f32 v108, v120, v121
    v_cvt_pk_bf16_f32 v109, v122, v123
    buffer_store_dwordx4 v[52:55], v241, s[20:23], s67 offen nt
    ds_write_b64 v242, v[108:109] offset:192
    v_cvt_pk_bf16_f32 v110, v124, v125
    v_cvt_pk_bf16_f32 v111, v126, v127
    ds_write_b64 v242, v[110:111] offset:224
    ds_read_b64 v[112:113], v243 offset:0
    buffer_store_dwordx4 v[56:59], v246, s[20:23], s67 offen nt
    ds_read_b64 v[114:115], v245 offset:0
    ds_read_b64 v[116:117], v243 offset:1056
    v_accvgpr_read_b32 v228, a244
    ds_read_b64 v[118:119], v245 offset:1056
    buffer_store_dwordx4 v[60:63], v247, s[20:23], s67 offen nt
    ds_read_b64 v[120:121], v243 offset:2112
    v_rcp_f32 v216, v228
    v_accvgpr_read_b32 v0, a160
    v_accvgpr_read_b32 v1, a161
    ds_read_b64 v[122:123], v245 offset:2112
    v_accvgpr_read_b32 v2, a162
    v_accvgpr_read_b32 v3, a163
    v_pk_mul_f32 v[0:1], v[0:1], v[216:217] op_sel_hi:[1,0]
    ds_read_b64 v[124:125], v243 offset:3168
    v_accvgpr_read_b32 v4, a164
    v_accvgpr_read_b32 v5, a165
    v_accvgpr_read_b32 v6, a166
    v_accvgpr_read_b32 v7, a167
    v_pk_mul_f32 v[2:3], v[2:3], v[216:217] op_sel_hi:[1,0]
    v_cvt_pk_bf16_f32 v0, v0, v1
    s_waitcnt lgkmcnt(10)
    buffer_store_dwordx4 v[80:83], v239, s[20:23], s74 offen nt
    ds_read_b64 v[126:127], v245 offset:3168
    v_accvgpr_read_b32 v8, a168
    v_accvgpr_read_b32 v9, a169
    v_accvgpr_read_b32 v10, a170
    v_accvgpr_read_b32 v11, a171
    v_pk_mul_f32 v[4:5], v[4:5], v[216:217] op_sel_hi:[1,0]
    v_pk_mul_f32 v[6:7], v[6:7], v[216:217] op_sel_hi:[1,0]
    v_cvt_pk_bf16_f32 v1, v2, v3
    v_accvgpr_read_b32 v12, a172
    v_accvgpr_read_b32 v13, a173
    v_accvgpr_read_b32 v14, a174
    v_accvgpr_read_b32 v15, a175
    v_pk_mul_f32 v[8:9], v[8:9], v[216:217] op_sel_hi:[1,0]
    v_pk_mul_f32 v[10:11], v[10:11], v[216:217] op_sel_hi:[1,0]
    ds_write_b64 v242, v[0:1] offset:0
    v_cvt_pk_bf16_f32 v2, v4, v5
    v_cvt_pk_bf16_f32 v3, v6, v7
    v_accvgpr_read_b32 v16, a176
    v_accvgpr_read_b32 v17, a177
    v_accvgpr_read_b32 v18, a178
    v_accvgpr_read_b32 v19, a179
    v_pk_mul_f32 v[12:13], v[12:13], v[216:217] op_sel_hi:[1,0]
    v_pk_mul_f32 v[14:15], v[14:15], v[216:217] op_sel_hi:[1,0]
    ds_write_b64 v242, v[2:3] offset:32
    v_cvt_pk_bf16_f32 v4, v8, v9
    v_cvt_pk_bf16_f32 v5, v10, v11
    buffer_store_dwordx4 v[84:87], v241, s[20:23], s74 offen nt
    v_accvgpr_read_b32 v20, a180
    v_accvgpr_read_b32 v21, a181
    v_accvgpr_read_b32 v22, a182
    v_accvgpr_read_b32 v23, a183
    v_pk_mul_f32 v[16:17], v[16:17], v[216:217] op_sel_hi:[1,0]
    v_pk_mul_f32 v[18:19], v[18:19], v[216:217] op_sel_hi:[1,0]
    ds_write_b64 v242, v[4:5] offset:64
    v_cvt_pk_bf16_f32 v6, v12, v13
    v_cvt_pk_bf16_f32 v7, v14, v15
    v_accvgpr_read_b32 v24, a184
    v_accvgpr_read_b32 v25, a185
    v_accvgpr_read_b32 v26, a186
    v_accvgpr_read_b32 v27, a187
    v_pk_mul_f32 v[20:21], v[20:21], v[216:217] op_sel_hi:[1,0]
    v_pk_mul_f32 v[22:23], v[22:23], v[216:217] op_sel_hi:[1,0]
    ds_write_b64 v242, v[6:7] offset:96
    v_cvt_pk_bf16_f32 v8, v16, v17
    v_cvt_pk_bf16_f32 v9, v18, v19
    v_accvgpr_read_b32 v28, a188
    v_accvgpr_read_b32 v29, a189
    v_accvgpr_read_b32 v30, a190
    v_accvgpr_read_b32 v31, a191
    v_pk_mul_f32 v[24:25], v[24:25], v[216:217] op_sel_hi:[1,0]
    v_pk_mul_f32 v[26:27], v[26:27], v[216:217] op_sel_hi:[1,0]
    ds_write_b64 v242, v[8:9] offset:128
    v_cvt_pk_bf16_f32 v10, v20, v21
    v_cvt_pk_bf16_f32 v11, v22, v23
    buffer_store_dwordx4 v[88:91], v246, s[20:23], s74 offen nt
    v_pk_mul_f32 v[28:29], v[28:29], v[216:217] op_sel_hi:[1,0]
    v_pk_mul_f32 v[30:31], v[30:31], v[216:217] op_sel_hi:[1,0]
    ds_write_b64 v242, v[10:11] offset:160
    v_cvt_pk_bf16_f32 v12, v24, v25
    v_cvt_pk_bf16_f32 v13, v26, v27
    ds_write_b64 v242, v[12:13] offset:192
    v_cvt_pk_bf16_f32 v14, v28, v29
    v_cvt_pk_bf16_f32 v15, v30, v31
    ds_write_b64 v242, v[14:15] offset:224
    buffer_store_dwordx4 v[92:95], v247, s[20:23], s74 offen nt
    ds_read_b64 v[16:17], v243 offset:0
    ds_read_b64 v[18:19], v245 offset:0
    s_waitcnt lgkmcnt(7)
    buffer_store_dwordx4 v[112:115], v239, s[20:23], s75 offen nt
    ds_read_b64 v[20:21], v243 offset:1056
    ds_read_b64 v[22:23], v245 offset:1056
    v_cmp_nle_f32 s[68:69], v226, s63
    buffer_store_dwordx4 v[116:119], v241, s[20:23], s75 offen nt
    ds_read_b64 v[24:25], v243 offset:2112
    s_or_b64 s[56:57], s[56:57], s[68:69]
    ds_read_b64 v[26:27], v245 offset:2112
    v_cmp_nle_f32 s[68:69], v227, s63
    buffer_store_dwordx4 v[120:123], v246, s[20:23], s75 offen nt
    ds_read_b64 v[28:29], v243 offset:3168
    s_or_b64 s[56:57], s[56:57], s[68:69]
    ds_read_b64 v[30:31], v245 offset:3168
    v_cmp_nle_f32 s[68:69], v228, s63
    buffer_store_dwordx4 v[124:127], v247, s[20:23], s75 offen nt
    s_or_b64 s[56:57], s[56:57], s[68:69]
    s_cmp_lg_u64 s[56:57], 0
    s_cselect_b32 s6, 1, 0
    s_lshl_b32 s6, s6, s59
    s_or_b32 s58, s58, s6
    s_mov_b64 s[56:57], 0
    s_add_u32 s59, s59, 1
    s_waitcnt lgkmcnt(6)
    buffer_store_dwordx4 v[16:19], v239, s[20:23], s35 offen nt
    s_waitcnt lgkmcnt(4)
    buffer_store_dwordx4 v[20:23], v241, s[20:23], s35 offen nt
    s_waitcnt lgkmcnt(2)
    buffer_store_dwordx4 v[24:27], v246, s[20:23], s35 offen nt
    s_waitcnt lgkmcnt(0)
    buffer_store_dwordx4 v[28:31], v247, s[20:23], s35 offen nt
    s_branch L_fin
L_tail5_8e:
L_fin:
    s_cmp_eq_u32 s58, 0
    s_cbranch_scc1 L_end
    s_waitcnt vmcnt(0) lgkmcnt(0)
    s_barrier
    v_mbcnt_lo_u32_b32 v131, -1, 0
    v_mbcnt_hi_u32_b32 v131, -1, v131
    v_and_b32 v130, 15, v131
    v_lshrrev_b32 v132, 4, v131
    v_lshlrev_b32 v134, 12, v130
    v_and_b32 v128, 1, v132
    v_lshl_add_u32 v136, v128, 5, v134
    v_lshrrev_b32 v128, 1, v132
    v_lshl_add_u32 v136, v128, 4, v136
    v_lshl_add_u32 v134, v132, 4, v134
    v_lshrrev_b32 v128, 2, v130
    v_lshl_add_u32 v128, v132, 2, v128
    v_and_b32 v129, 3, v131
    v_lshlrev_b32 v129, 3, v129
    v_lshl_add_u32 v135, v128, 8, v129
    v_add_u32 v135, s32, v135
    v_lshlrev_b32 v137, 4, v130
    v_lshl_add_u32 v137, v132, 12, v137
    v_mov_b32 v133, 0xff800000
    s_mov_b32 s84, 0
L_sp_pass:
    s_bitcmp1_b32 s58, s84
    s_cbranch_scc0 L_sp_next
    s_mov_b32 m0, s84
    s_nop 0
    s_movrels_b32 s89, s72
    s_and_b32 s4, s89, 0x1fff
    s_bfe_u32 s38, s89, 655373
    s_bfe_u32 s36, s89, 196635
    s_bfe_u32 s5, s89, 262167
    s_add_u32 s31, s4, s38
    s_lshl_b32 s31, s31, 12
    s_lshl4_add_u32 s4, s4, s65
    s_lshl_b32 s30, s4, 8
    s_mul_i32 s6, s36, s64
    s_lshl2_add_u32 s5, s5, s6
    s_lshl_b32 s5, s5, 2
    s_sub_u32 s5, s5, s64
    s_lshl_b32 s5, s5, 14
    s_add_u32 s34, s30, s5
    s_add_u32 s37, s38, 31
    s_lshr_b32 s37, s37, 5
    s_sub_u32 s38, s38, 1
    s_and_b32 s38, s38, 31
    s_add_u32 s38, s38, 1
    s_cmp_eq_u32 s36, 0
    s_cselect_b32 s30, 0x40000000, s30
    s_mov_b32 s10, s31
    s_add_u32 s14, s31, 4096
    s_mov_b32 s18, s31
    s_mov_b32 s22, s31
    s_lshl_b32 s88, s64, 14
    s_add_u32 s88, s88, s34
    v_sub_u32 v131, s38, v240
    v_cmp_gt_i32 s[40:41], v131, 0
    v_cmp_gt_i32 s[42:43], v131, 1
    v_cmp_gt_i32 s[44:45], v131, 2
    v_cmp_gt_i32 s[46:47], v131, 3
    v_cmp_gt_i32 s[48:49], v131, 16
    v_cmp_gt_i32 s[50:51], v131, 17
    v_cmp_gt_i32 s[52:53], v131, 18
    v_cmp_gt_i32 s[54:55], v131, 19
    s_mov_b32 s85, 0
L_sp_blk:
    buffer_load_dwordx4 v[48:51], v134, s[16:19], s88 offen offset:0
    buffer_load_dwordx4 v[52:55], v134, s[16:19], s88 offen offset:64
    buffer_load_dwordx4 v[56:59], v134, s[16:19], s88 offen offset:128
    buffer_load_dwordx4 v[60:63], v134, s[16:19], s88 offen offset:192
    v_mov_b32 v0, 0
    v_mov_b32 v1, 0
    v_mov_b32 v2, 0
    v_mov_b32 v3, 0
    v_mov_b32 v4, 0
    v_mov_b32 v5, 0
    v_mov_b32 v6, 0
    v_mov_b32 v7, 0
    v_mov_b32 v8, 0
    v_mov_b32 v9, 0
    v_mov_b32 v10, 0
    v_mov_b32 v11, 0
    v_mov_b32 v12, 0
    v_mov_b32 v13, 0
    v_mov_b32 v14, 0
    v_mov_b32 v15, 0
    v_mov_b32 v16, 0
    v_mov_b32 v17, 0
    v_mov_b32 v18, 0
    v_mov_b32 v19, 0
    v_mov_b32 v20, 0
    v_mov_b32 v21, 0
    v_mov_b32 v22, 0
    v_mov_b32 v23, 0
    v_mov_b32 v24, 0
    v_mov_b32 v25, 0
    v_mov_b32 v26, 0
    v_mov_b32 v27, 0
    v_mov_b32 v28, 0
    v_mov_b32 v29, 0
    v_mov_b32 v30, 0
    v_mov_b32 v31, 0
    v_mov_b32 v128, v133
    v_mov_b32 v129, 0
    s_waitcnt vmcnt(0)
    v_lshlrev_b32 v138, 16, v48
    v_and_b32 v139, s62, v48
    v_pk_mul_f32 v[138:139], v[138:139], s[60:61]
    v_cvt_pk_bf16_f32 v48, v138, v139
    v_lshlrev_b32 v138, 16, v49
    v_and_b32 v139, s62, v49
    v_pk_mul_f32 v[138:139], v[138:139], s[60:61]
    v_cvt_pk_bf16_f32 v49, v138, v139
    v_lshlrev_b32 v138, 16, v50
    v_and_b32 v139, s62, v50
    v_pk_mul_f32 v[138:139], v[138:139], s[60:61]
    v_cvt_pk_bf16_f32 v50, v138, v139
    v_lshlrev_b32 v138, 16, v51
    v_and_b32 v139, s62, v51
    v_pk_mul_f32 v[138:139], v[138:139], s[60:61]
    v_cvt_pk_bf16_f32 v51, v138, v139
    v_lshlrev_b32 v138, 16, v52
    v_and_b32 v139, s62, v52
    v_pk_mul_f32 v[138:139], v[138:139], s[60:61]
    v_cvt_pk_bf16_f32 v52, v138, v139
    v_lshlrev_b32 v138, 16, v53
    v_and_b32 v139, s62, v53
    v_pk_mul_f32 v[138:139], v[138:139], s[60:61]
    v_cvt_pk_bf16_f32 v53, v138, v139
    v_lshlrev_b32 v138, 16, v54
    v_and_b32 v139, s62, v54
    v_pk_mul_f32 v[138:139], v[138:139], s[60:61]
    v_cvt_pk_bf16_f32 v54, v138, v139
    v_lshlrev_b32 v138, 16, v55
    v_and_b32 v139, s62, v55
    v_pk_mul_f32 v[138:139], v[138:139], s[60:61]
    v_cvt_pk_bf16_f32 v55, v138, v139
    v_lshlrev_b32 v138, 16, v56
    v_and_b32 v139, s62, v56
    v_pk_mul_f32 v[138:139], v[138:139], s[60:61]
    v_cvt_pk_bf16_f32 v56, v138, v139
    v_lshlrev_b32 v138, 16, v57
    v_and_b32 v139, s62, v57
    v_pk_mul_f32 v[138:139], v[138:139], s[60:61]
    v_cvt_pk_bf16_f32 v57, v138, v139
    v_lshlrev_b32 v138, 16, v58
    v_and_b32 v139, s62, v58
    v_pk_mul_f32 v[138:139], v[138:139], s[60:61]
    v_cvt_pk_bf16_f32 v58, v138, v139
    v_lshlrev_b32 v138, 16, v59
    v_and_b32 v139, s62, v59
    v_pk_mul_f32 v[138:139], v[138:139], s[60:61]
    v_cvt_pk_bf16_f32 v59, v138, v139
    v_lshlrev_b32 v138, 16, v60
    v_and_b32 v139, s62, v60
    v_pk_mul_f32 v[138:139], v[138:139], s[60:61]
    v_cvt_pk_bf16_f32 v60, v138, v139
    v_lshlrev_b32 v138, 16, v61
    v_and_b32 v139, s62, v61
    v_pk_mul_f32 v[138:139], v[138:139], s[60:61]
    v_cvt_pk_bf16_f32 v61, v138, v139
    v_lshlrev_b32 v138, 16, v62
    v_and_b32 v139, s62, v62
    v_pk_mul_f32 v[138:139], v[138:139], s[60:61]
    v_cvt_pk_bf16_f32 v62, v138, v139
    v_lshlrev_b32 v138, 16, v63
    v_and_b32 v139, s62, v63
    v_pk_mul_f32 v[138:139], v[138:139], s[60:61]
    v_cvt_pk_bf16_f32 v63, v138, v139
    s_mov_b32 s87, s30
    s_mov_b32 s86, 1
L_sp_tile:
    s_add_u32 s90, s87, 0
    buffer_load_dwordx4 v[64:67], v134, s[8:11], s90 offen offset:0
    buffer_load_dwordx4 v[68:71], v134, s[8:11], s90 offen offset:64
    buffer_load_dwordx4 v[72:75], v134, s[8:11], s90 offen offset:128
    buffer_load_dwordx4 v[76:79], v134, s[8:11], s90 offen offset:192
    s_add_u32 s90, s87, 65536
    buffer_load_dwordx4 v[80:83], v134, s[8:11], s90 offen offset:0
    buffer_load_dwordx4 v[84:87], v134, s[8:11], s90 offen offset:64
    buffer_load_dwordx4 v[88:91], v134, s[8:11], s90 offen offset:128
    buffer_load_dwordx4 v[92:95], v134, s[8:11], s90 offen offset:192
    s_add_u32 m0, s32, 0
    s_add_u32 s90, s87, 4096
    buffer_load_dwordx4 v137, s[12:15], s90 offen lds
    s_add_u32 m0, s32, 1024
    s_add_u32 s90, s87, 20480
    buffer_load_dwordx4 v137, s[12:15], s90 offen lds
    s_add_u32 m0, s32, 2048
    s_add_u32 s90, s87, 36864
    buffer_load_dwordx4 v137, s[12:15], s90 offen lds
    s_add_u32 m0, s32, 3072
    s_add_u32 s90, s87, 53248
    buffer_load_dwordx4 v137, s[12:15], s90 offen lds
    s_add_u32 m0, s32, 4096
    s_add_u32 s90, s87, 69632
    buffer_load_dwordx4 v137, s[12:15], s90 offen lds
    s_add_u32 m0, s32, 5120
    s_add_u32 s90, s87, 86016
    buffer_load_dwordx4 v137, s[12:15], s90 offen lds
    s_add_u32 m0, s32, 6144
    s_add_u32 s90, s87, 102400
    buffer_load_dwordx4 v137, s[12:15], s90 offen lds
    s_add_u32 m0, s32, 7168
    s_add_u32 s90, s87, 118784
    buffer_load_dwordx4 v137, s[12:15], s90 offen lds
    s_waitcnt vmcnt(0)
    ds_read_b64_tr_b16 v[96:97], v135 offset:0
    ds_read_b64_tr_b16 v[98:99], v135 offset:4096
    ds_read_b64_tr_b16 v[100:101], v135 offset:32
    ds_read_b64_tr_b16 v[102:103], v135 offset:4128
    ds_read_b64_tr_b16 v[104:105], v135 offset:64
    ds_read_b64_tr_b16 v[106:107], v135 offset:4160
    ds_read_b64_tr_b16 v[108:109], v135 offset:96
    ds_read_b64_tr_b16 v[110:111], v135 offset:4192
    ds_read_b64_tr_b16 v[112:113], v135 offset:128
    ds_read_b64_tr_b16 v[114:115], v135 offset:4224
    ds_read_b64_tr_b16 v[116:117], v135 offset:160
    ds_read_b64_tr_b16 v[118:119], v135 offset:4256
    ds_read_b64_tr_b16 v[120:121], v135 offset:192
    ds_read_b64_tr_b16 v[122:123], v135 offset:4288
    ds_read_b64_tr_b16 v[124:125], v135 offset:224
    ds_read_b64_tr_b16 v[126:127], v135 offset:4320
    v_mfma_f32_16x16x32_bf16 v[32:35], v[64:67], v[48:51], 0
    v_mfma_f32_16x16x32_bf16 v[32:35], v[68:71], v[52:55], v[32:35]
    v_mfma_f32_16x16x32_bf16 v[32:35], v[72:75], v[56:59], v[32:35]
    v_mfma_f32_16x16x32_bf16 v[32:35], v[76:79], v[60:63], v[32:35]
    v_mfma_f32_16x16x32_bf16 v[36:39], v[80:83], v[48:51], 0
    v_mfma_f32_16x16x32_bf16 v[36:39], v[84:87], v[52:55], v[36:39]
    v_mfma_f32_16x16x32_bf16 v[36:39], v[88:91], v[56:59], v[36:39]
    v_mfma_f32_16x16x32_bf16 v[36:39], v[92:95], v[60:63], v[36:39]
    s_nop 7
    s_cmp_lg_u32 s86, s37
    s_cbranch_scc1 L_sp_full
    v_cndmask_b32 v32, v133, v32, s[40:41]
    v_cndmask_b32 v33, v133, v33, s[42:43]
    v_cndmask_b32 v34, v133, v34, s[44:45]
    v_cndmask_b32 v35, v133, v35, s[46:47]
    v_cndmask_b32 v36, v133, v36, s[48:49]
    v_cndmask_b32 v37, v133, v37, s[50:51]
    v_cndmask_b32 v38, v133, v38, s[52:53]
    v_cndmask_b32 v39, v133, v39, s[54:55]
L_sp_full:
    v_max3_f32 v132, v32, v33, v34
    v_max3_f32 v132, v132, v35, v36
    v_max3_f32 v132, v132, v37, v38
    v_max3_f32 v132, v132, v39, v128
    v_mov_b32 v131, v132
    s_nop 1
    v_permlane32_swap_b32 v131, v132
    v_max_f32 v132, v132, v131
    v_mov_b32 v131, v132
    s_nop 1
    v_permlane16_swap_b32 v131, v132
    v_max_f32 v132, v132, v131
    v_sub_f32 v130, v128, v132
    v_exp_f32 v130, v130
    v_mov_b32 v128, v132
    v_sub_f32 v32, v32, v128
    v_exp_f32 v32, v32
    v_sub_f32 v33, v33, v128
    v_exp_f32 v33, v33
    v_sub_f32 v34, v34, v128
    v_exp_f32 v34, v34
    v_sub_f32 v35, v35, v128
    v_exp_f32 v35, v35
    v_sub_f32 v36, v36, v128
    v_exp_f32 v36, v36
    v_sub_f32 v37, v37, v128
    v_exp_f32 v37, v37
    v_sub_f32 v38, v38, v128
    v_exp_f32 v38, v38
    v_sub_f32 v39, v39, v128
    v_exp_f32 v39, v39
    v_mul_f32 v129, v129, v130
    v_add_f32 v129, v129, v32
    v_add_f32 v129, v129, v33
    v_add_f32 v129, v129, v34
    v_add_f32 v129, v129, v35
    v_add_f32 v129, v129, v36
    v_add_f32 v129, v129, v37
    v_add_f32 v129, v129, v38
    v_add_f32 v129, v129, v39
    v_cvt_pk_bf16_f32 v40, v32, v33
    v_cvt_pk_bf16_f32 v41, v34, v35
    v_cvt_pk_bf16_f32 v42, v36, v37
    v_cvt_pk_bf16_f32 v43, v38, v39
    v_mul_f32 v0, v0, v130
    v_mul_f32 v1, v1, v130
    v_mul_f32 v2, v2, v130
    v_mul_f32 v3, v3, v130
    v_mul_f32 v4, v4, v130
    v_mul_f32 v5, v5, v130
    v_mul_f32 v6, v6, v130
    v_mul_f32 v7, v7, v130
    v_mul_f32 v8, v8, v130
    v_mul_f32 v9, v9, v130
    v_mul_f32 v10, v10, v130
    v_mul_f32 v11, v11, v130
    v_mul_f32 v12, v12, v130
    v_mul_f32 v13, v13, v130
    v_mul_f32 v14, v14, v130
    v_mul_f32 v15, v15, v130
    v_mul_f32 v16, v16, v130
    v_mul_f32 v17, v17, v130
    v_mul_f32 v18, v18, v130
    v_mul_f32 v19, v19, v130
    v_mul_f32 v20, v20, v130
    v_mul_f32 v21, v21, v130
    v_mul_f32 v22, v22, v130
    v_mul_f32 v23, v23, v130
    v_mul_f32 v24, v24, v130
    v_mul_f32 v25, v25, v130
    v_mul_f32 v26, v26, v130
    v_mul_f32 v27, v27, v130
    v_mul_f32 v28, v28, v130
    v_mul_f32 v29, v29, v130
    v_mul_f32 v30, v30, v130
    v_mul_f32 v31, v31, v130
    s_waitcnt lgkmcnt(0)
    v_mfma_f32_16x16x32_bf16 v[0:3], v[96:99], v[40:43], v[0:3]
    v_mfma_f32_16x16x32_bf16 v[4:7], v[100:103], v[40:43], v[4:7]
    v_mfma_f32_16x16x32_bf16 v[8:11], v[104:107], v[40:43], v[8:11]
    v_mfma_f32_16x16x32_bf16 v[12:15], v[108:111], v[40:43], v[12:15]
    v_mfma_f32_16x16x32_bf16 v[16:19], v[112:115], v[40:43], v[16:19]
    v_mfma_f32_16x16x32_bf16 v[20:23], v[116:119], v[40:43], v[20:23]
    v_mfma_f32_16x16x32_bf16 v[24:27], v[120:123], v[40:43], v[24:27]
    v_mfma_f32_16x16x32_bf16 v[28:31], v[124:127], v[40:43], v[28:31]
    s_nop 7
    s_add_u32 s87, s87, 131072
    s_add_u32 s86, s86, 1
    s_cmp_le_u32 s86, s37
    s_cbranch_scc1 L_sp_tile
    v_mov_b32 v131, v129
    s_nop 1
    v_permlane32_swap_b32 v131, v129
    v_add_f32 v129, v129, v131
    v_mov_b32 v131, v129
    s_nop 1
    v_permlane16_swap_b32 v131, v129
    v_add_f32 v129, v129, v131
    v_rcp_f32 v130, v129
    s_nop 0
    v_mul_f32 v0, v0, v130
    v_mul_f32 v1, v1, v130
    v_mul_f32 v2, v2, v130
    v_mul_f32 v3, v3, v130
    v_mul_f32 v4, v4, v130
    v_mul_f32 v5, v5, v130
    v_mul_f32 v6, v6, v130
    v_mul_f32 v7, v7, v130
    v_mul_f32 v8, v8, v130
    v_mul_f32 v9, v9, v130
    v_mul_f32 v10, v10, v130
    v_mul_f32 v11, v11, v130
    v_mul_f32 v12, v12, v130
    v_mul_f32 v13, v13, v130
    v_mul_f32 v14, v14, v130
    v_mul_f32 v15, v15, v130
    v_mul_f32 v16, v16, v130
    v_mul_f32 v17, v17, v130
    v_mul_f32 v18, v18, v130
    v_mul_f32 v19, v19, v130
    v_mul_f32 v20, v20, v130
    v_mul_f32 v21, v21, v130
    v_mul_f32 v22, v22, v130
    v_mul_f32 v23, v23, v130
    v_mul_f32 v24, v24, v130
    v_mul_f32 v25, v25, v130
    v_mul_f32 v26, v26, v130
    v_mul_f32 v27, v27, v130
    v_mul_f32 v28, v28, v130
    v_mul_f32 v29, v29, v130
    v_mul_f32 v30, v30, v130
    v_mul_f32 v31, v31, v130
    v_cvt_pk_bf16_f32 v0, v0, v1
    v_cvt_pk_bf16_f32 v1, v2, v3
    v_cvt_pk_bf16_f32 v2, v4, v5
    v_cvt_pk_bf16_f32 v3, v6, v7
    s_nop 0
    v_permlane16_swap_b32 v0, v2
    v_permlane16_swap_b32 v1, v3
    buffer_store_dwordx4 v[0:3], v136, s[20:23], s88 offen offset:0
    v_cvt_pk_bf16_f32 v8, v8, v9
    v_cvt_pk_bf16_f32 v9, v10, v11
    v_cvt_pk_bf16_f32 v10, v12, v13
    v_cvt_pk_bf16_f32 v11, v14, v15
    s_nop 0
    v_permlane16_swap_b32 v8, v10
    v_permlane16_swap_b32 v9, v11
    buffer_store_dwordx4 v[8:11], v136, s[20:23], s88 offen offset:64
    v_cvt_pk_bf16_f32 v16, v16, v17
    v_cvt_pk_bf16_f32 v17, v18, v19
    v_cvt_pk_bf16_f32 v18, v20, v21
    v_cvt_pk_bf16_f32 v19, v22, v23
    s_nop 0
    v_permlane16_swap_b32 v16, v18
    v_permlane16_swap_b32 v17, v19
    buffer_store_dwordx4 v[16:19], v136, s[20:23], s88 offen offset:128
    v_cvt_pk_bf16_f32 v24, v24, v25
    v_cvt_pk_bf16_f32 v25, v26, v27
    v_cvt_pk_bf16_f32 v26, v28, v29
    v_cvt_pk_bf16_f32 v27, v30, v31
    s_nop 0
    v_permlane16_swap_b32 v24, v26
    v_permlane16_swap_b32 v25, v27
    buffer_store_dwordx4 v[24:27], v136, s[20:23], s88 offen offset:192
    s_waitcnt vmcnt(0)
    s_nop 0
    s_add_u32 s88, s88, 0x10000
    s_add_u32 s85, s85, 1
    s_cmp_lt_u32 s85, s36
    s_cbranch_scc1 L_sp_blk
L_sp_next:
    s_add_u32 s84, s84, 1
    s_cmp_lt_u32 s84, 2
    s_cbranch_scc1 L_sp_pass
L_end:
    s_endpgm
L_codeend:
.section .rodata,"a"
.p2align 6
.amdhsa_kernel standalone__varlen_attn_packed__ragged_kernel
  .amdhsa_next_free_vgpr 512
  .amdhsa_next_free_sgpr 102
  .amdhsa_accum_offset 256
  .amdhsa_group_segment_fixed_size 0
  .amdhsa_kernarg_size 56
  .amdhsa_user_sgpr_count 2
  .amdhsa_user_sgpr_kernarg_segment_ptr 1
  .amdhsa_system_sgpr_workgroup_id_x 1
.end_amdhsa_kernel
```
